```python
import torch

def _softmax(x, axis=-1):
    return torch.softmax(x, dim=axis)

def _gelu(x):
    return torch.nn.functional.gelu(x, approximate='tanh')

def _silu(x):
    return torch.nn.functional.silu(x)

def _sigmoid(x):
    return torch.sigmoid(x)

def _layernorm(x, axis=-1, eps=1e-05):
    m = x.mean(dim=axis, keepdim=True)
    v = x.var(dim=axis, keepdim=True, unbiased=False)
    return (x - m) / torch.sqrt(v + eps)

def _scatter_add(tgt, idx, src, axis=0):
    return tgt.clone().index_add_(axis, idx, src)

def _segment_sum(src, seg, n):
    out = torch.zeros((n,) + src.shape[1:], dtype=src.dtype)
    return out.index_add_(0, seg, src)

def _pad(x, pw):
    flat = tuple((v for pair in reversed(pw) for v in pair))
    return torch.nn.functional.pad(x, flat)
kernel_name = 'recurrent_scan__mha_block_cached__mixer_gmlp__prompt'

def setup_inputs():

    _w = lambda a: (lambda t: t.to(torch.bfloat16) if t.is_floating_point() else t)(torch.as_tensor(a))

    def _A_setup():
        B, Sq, D = (1, 2048, 640)
        H, Sk, Dh = (32, 2048, 128)
        return {'x': _w((lambda *s: torch.randn(*s, dtype=torch.bfloat16) * 0.05)(B, Sq, D)), 'k_cache': _w((lambda *s: torch.randn(*s, dtype=torch.bfloat16) * 0.8)(B, H, Sk, Dh)), 'v_cache': _w((lambda *s: torch.randn(*s, dtype=torch.bfloat16) * 0.2)(B, H, Sk, Dh)), 'wq': _w((lambda *s: torch.randn(*s, dtype=torch.bfloat16) * 0.8)(D, H * Dh) * D ** (-0.5)), 'wo': _w((lambda *s: torch.randn(*s, dtype=torch.bfloat16) * 0.2)(H * Dh, D) * (H * Dh) ** (-0.5))}
    _A_in = _A_setup()

    def _B_setup():
        B, S, D, F = (1, 2048, 640, 1728)
        Fh = F // 2
        return {'x': _w((lambda *s: torch.randn(*s, dtype=torch.bfloat16) * 0.05)(B, S, D)), 'w_in': _w((lambda *s: torch.randn(*s, dtype=torch.bfloat16) * 0.4)(D, 2 * Fh)), 'w_sp': _w(0.01 * (lambda *s: torch.randn(*s, dtype=torch.bfloat16) * 0.4)(S, S)), 'b_sp': _w(1.0 + 0.01 * (lambda *s: torch.randn(*s, dtype=torch.bfloat16) * 0.1)(S)), 'w_out': _w((lambda *s: torch.randn(*s, dtype=torch.bfloat16) * 0.1)(Fh, D))}
    _B_in = _B_setup()
    return {'A_x': _A_in['x'], 'A_k_cache': _A_in['k_cache'], 'A_v_cache': _A_in['v_cache'], 'A_wq': _A_in['wq'], 'A_wo': _A_in['wo'], 'B_x': _B_in['x'], 'B_w_in': _B_in['w_in'], 'B_w_sp': _B_in['w_sp'], 'B_b_sp': _B_in['b_sp'], 'B_w_out': _B_in['w_out']}

def reference(A_x, A_k_cache, A_v_cache, A_wq, A_wo, B_x, B_w_in, B_w_sp, B_b_sp, B_w_out):

    def _A_ref(x, k_cache, v_cache, wq, wo):
        B, Sq, D = x.shape
        H, Dh = (32, 128)
        q = (lambda x, *d: x.permute(*d))((x @ wq).reshape(B, Sq, H, Dh), 0, 2, 1, 3)
        scores = torch.einsum('bhqd,bhkd->bhqk', q, k_cache) * Dh ** (-0.5)
        p = _softmax(scores, axis=-1)
        o = torch.einsum('bhqk,bhkd->bhqd', p, v_cache)
        return (lambda x, *d: x.permute(*d))(o, 0, 2, 1, 3).reshape(B, Sq, H * Dh) @ wo

    def _B_ref(x, w_in, w_sp, b_sp, w_out):
        B, S, D = x.shape
        F = w_in.shape[-1]
        Fh = F // 2
        z = _gelu(torch.einsum('bsd,df->bsf', x, w_in))
        z1 = z[..., :Fh].clone()
        z2 = _layernorm(z[..., Fh:], axis=-1)
        g = torch.einsum('ts,bsf->btf', w_sp, z2) + b_sp[None, :, None]
        return torch.einsum('bsf,fd->bsd', z1 * g, w_out)
    x = A_x
    xn = _layernorm(x, axis=-1)
    s = _A_ref(xn, A_k_cache, A_v_cache, A_wq, A_wo)
    g = _silu(_B_ref(xn, B_w_in, B_w_sp, B_b_sp, B_w_out))
    return x + s * g
```

```asm
; @launch kernel=lnx_kernel grid=(128,1,1) block=(256,1,1) lds=0
; @launch kernel=attn_kernel grid=(256,1,1) block=(256,1,1) lds=143360
; @launch kernel=mid_kernel grid=(256,1,1) block=(256,1,1) lds=147456
; @launch kernel=fin_kernel grid=(160,1,1) block=(256,1,1) lds=147456
.amdgcn_target "amdgcn-amd-amdhsa--gfx950"
.text
.p2align 8
TEXT_START:
.text
.globl lnx_kernel
.p2align 8
.type lnx_kernel,@function
lnx_kernel:
 s_cmp_ge_u32 s2, 128
 s_cbranch_scc1 lnx_kernel_done1
 s_load_dwordx2 s[4:5], s[0:1], 0
 s_load_dwordx2 s[6:7], s[0:1], 96
 s_getpc_b64 s[32:33]
lnx_kernel_pc2:
 s_sub_u32 s32, s32, lnx_kernel_pc2-TEXT_START
 s_subb_u32 s33, s33, 0
 s_and_b32 s33, s33, 0xffff
 s_mov_b32 s34, TEXT_END-TEXT_START
 s_mov_b32 s35, 0x00020000
 s_bfe_u32 s36, s2, 0x30003
 s_lshl_b32 s36, s36, 14
 v_lshlrev_b32 v88, 6, v0
 buffer_load_dword v89, v88, s[32:35], s36 offen
 s_load_dwordx2 s[16:17], s[0:1], 48
 s_load_dwordx2 s[18:19], s[0:1], 24
 v_lshrrev_b32 v1, 4, v0
 s_lshl_b32 s3, s2, 4
 v_add_u32 v1, s3, v1
 v_and_b32 v2, 15, v0
 v_lshrrev_b32 v87, 8, v1
 v_mul_u32_u24 v87, 20, v87
 v_lshrrev_b32 v3, 2, v2
 v_add_u32 v87, v87, v3
 v_lshlrev_b32 v87, 8, v87
 v_and_b32 v3, 255, v1
 v_add_u32 v87, v87, v3
 v_lshlrev_b32 v87, 6, v87
 v_bfe_u32 v3, v1, 2, 2
 v_and_b32 v81, 3, v2
 v_xor_b32 v3, v3, v81
 v_lshl_add_u32 v87, v3, 4, v87
 v_mul_u32_u24 v1, 1280, v1
 v_lshl_add_u32 v1, v2, 4, v1
 s_waitcnt lgkmcnt(0)
 s_mov_b32 s8, s4
 s_and_b32 s9, s5, 0xffff
 s_mov_b32 s10, 2621440
 s_mov_b32 s11, 0x00020000
 s_add_u32 s6, s6, 0
 s_addc_u32 s7, s7, 0
 s_mov_b32 s12, s6
 s_and_b32 s13, s7, 0xffff
 s_mov_b32 s14, 2621440
 s_mov_b32 s15, 0x00020000
 buffer_load_dwordx4 v[4:7], v1, s[8:11], 0 offen offset:0
 buffer_load_dwordx4 v[8:11], v1, s[8:11], 0 offen offset:256
 buffer_load_dwordx4 v[12:15], v1, s[8:11], 0 offen offset:512
 buffer_load_dwordx4 v[16:19], v1, s[8:11], 0 offen offset:768
 buffer_load_dwordx4 v[20:23], v1, s[8:11], 0 offen offset:1024
 s_mov_b32 s20, s16
 s_and_b32 s21, s17, 0xffff
 s_mov_b32 s22, 2211840
 s_mov_b32 s23, 0x00020000
 s_mov_b32 s24, s18
 s_and_b32 s25, s19, 0xffff
 s_mov_b32 s26, 5242880
 s_mov_b32 s27, 0x00020000
 s_lshl_b32 s3, s2, 8
 v_add_u32 v81, s3, v0
 v_lshlrev_b32 v81, 6, v81
 s_mov_b32 s3, 0x200000
 s_mov_b32 s28, 0x400000
 buffer_load_dword v82, v81, s[20:23], 0 offen
 buffer_load_dword v83, v81, s[20:23], s3 offen
 buffer_load_dword v84, v81, s[24:27], 0 offen
 buffer_load_dword v85, v81, s[24:27], s3 offen
 buffer_load_dword v86, v81, s[24:27], s28 offen
 v_mov_b32 v2, 0
 s_waitcnt vmcnt(9)
 v_lshlrev_b32 v32, 16, v4
 v_and_b32 v33, 0xffff0000, v4
 v_lshlrev_b32 v34, 16, v5
 v_and_b32 v35, 0xffff0000, v5
 v_lshlrev_b32 v36, 16, v6
 v_and_b32 v37, 0xffff0000, v6
 v_lshlrev_b32 v38, 16, v7
 v_and_b32 v39, 0xffff0000, v7
 v_add_f32 v2, v2, v32
 v_add_f32 v2, v2, v33
 v_add_f32 v2, v2, v34
 v_add_f32 v2, v2, v35
 v_add_f32 v2, v2, v36
 v_add_f32 v2, v2, v37
 v_add_f32 v2, v2, v38
 v_add_f32 v2, v2, v39
 s_waitcnt vmcnt(8)
 v_lshlrev_b32 v40, 16, v8
 v_and_b32 v41, 0xffff0000, v8
 v_lshlrev_b32 v42, 16, v9
 v_and_b32 v43, 0xffff0000, v9
 v_lshlrev_b32 v44, 16, v10
 v_and_b32 v45, 0xffff0000, v10
 v_lshlrev_b32 v46, 16, v11
 v_and_b32 v47, 0xffff0000, v11
 v_add_f32 v2, v2, v40
 v_add_f32 v2, v2, v41
 v_add_f32 v2, v2, v42
 v_add_f32 v2, v2, v43
 v_add_f32 v2, v2, v44
 v_add_f32 v2, v2, v45
 v_add_f32 v2, v2, v46
 v_add_f32 v2, v2, v47
 s_waitcnt vmcnt(7)
 v_lshlrev_b32 v48, 16, v12
 v_and_b32 v49, 0xffff0000, v12
 v_lshlrev_b32 v50, 16, v13
 v_and_b32 v51, 0xffff0000, v13
 v_lshlrev_b32 v52, 16, v14
 v_and_b32 v53, 0xffff0000, v14
 v_lshlrev_b32 v54, 16, v15
 v_and_b32 v55, 0xffff0000, v15
 v_add_f32 v2, v2, v48
 v_add_f32 v2, v2, v49
 v_add_f32 v2, v2, v50
 v_add_f32 v2, v2, v51
 v_add_f32 v2, v2, v52
 v_add_f32 v2, v2, v53
 v_add_f32 v2, v2, v54
 v_add_f32 v2, v2, v55
 s_waitcnt vmcnt(6)
 v_lshlrev_b32 v56, 16, v16
 v_and_b32 v57, 0xffff0000, v16
 v_lshlrev_b32 v58, 16, v17
 v_and_b32 v59, 0xffff0000, v17
 v_lshlrev_b32 v60, 16, v18
 v_and_b32 v61, 0xffff0000, v18
 v_lshlrev_b32 v62, 16, v19
 v_and_b32 v63, 0xffff0000, v19
 v_add_f32 v2, v2, v56
 v_add_f32 v2, v2, v57
 v_add_f32 v2, v2, v58
 v_add_f32 v2, v2, v59
 v_add_f32 v2, v2, v60
 v_add_f32 v2, v2, v61
 v_add_f32 v2, v2, v62
 v_add_f32 v2, v2, v63
 s_waitcnt vmcnt(5)
 v_lshlrev_b32 v64, 16, v20
 v_and_b32 v65, 0xffff0000, v20
 v_lshlrev_b32 v66, 16, v21
 v_and_b32 v67, 0xffff0000, v21
 v_lshlrev_b32 v68, 16, v22
 v_and_b32 v69, 0xffff0000, v22
 v_lshlrev_b32 v70, 16, v23
 v_and_b32 v71, 0xffff0000, v23
 v_add_f32 v2, v2, v64
 v_add_f32 v2, v2, v65
 v_add_f32 v2, v2, v66
 v_add_f32 v2, v2, v67
 v_add_f32 v2, v2, v68
 v_add_f32 v2, v2, v69
 v_add_f32 v2, v2, v70
 v_add_f32 v2, v2, v71
 s_nop 1
 v_add_f32_dpp v2, v2, v2 row_ror:8 row_mask:0xf bank_mask:0xf
 s_nop 1
 v_add_f32_dpp v2, v2, v2 row_ror:4 row_mask:0xf bank_mask:0xf
 s_nop 1
 v_add_f32_dpp v2, v2, v2 row_ror:2 row_mask:0xf bank_mask:0xf
 s_nop 1
 v_add_f32_dpp v2, v2, v2 row_ror:1 row_mask:0xf bank_mask:0xf
 v_mul_f32 v2, 0x3acccccd, v2
 v_mov_b32 v3, 0
 v_sub_f32 v80, v32, v2
 v_fmac_f32 v3, v80, v80
 v_sub_f32 v80, v33, v2
 v_fmac_f32 v3, v80, v80
 v_sub_f32 v80, v34, v2
 v_fmac_f32 v3, v80, v80
 v_sub_f32 v80, v35, v2
 v_fmac_f32 v3, v80, v80
 v_sub_f32 v80, v36, v2
 v_fmac_f32 v3, v80, v80
 v_sub_f32 v80, v37, v2
 v_fmac_f32 v3, v80, v80
 v_sub_f32 v80, v38, v2
 v_fmac_f32 v3, v80, v80
 v_sub_f32 v80, v39, v2
 v_fmac_f32 v3, v80, v80
 v_sub_f32 v80, v40, v2
 v_fmac_f32 v3, v80, v80
 v_sub_f32 v80, v41, v2
 v_fmac_f32 v3, v80, v80
 v_sub_f32 v80, v42, v2
 v_fmac_f32 v3, v80, v80
 v_sub_f32 v80, v43, v2
 v_fmac_f32 v3, v80, v80
 v_sub_f32 v80, v44, v2
 v_fmac_f32 v3, v80, v80
 v_sub_f32 v80, v45, v2
 v_fmac_f32 v3, v80, v80
 v_sub_f32 v80, v46, v2
 v_fmac_f32 v3, v80, v80
 v_sub_f32 v80, v47, v2
 v_fmac_f32 v3, v80, v80
 v_sub_f32 v80, v48, v2
 v_fmac_f32 v3, v80, v80
 v_sub_f32 v80, v49, v2
 v_fmac_f32 v3, v80, v80
 v_sub_f32 v80, v50, v2
 v_fmac_f32 v3, v80, v80
 v_sub_f32 v80, v51, v2
 v_fmac_f32 v3, v80, v80
 v_sub_f32 v80, v52, v2
 v_fmac_f32 v3, v80, v80
 v_sub_f32 v80, v53, v2
 v_fmac_f32 v3, v80, v80
 v_sub_f32 v80, v54, v2
 v_fmac_f32 v3, v80, v80
 v_sub_f32 v80, v55, v2
 v_fmac_f32 v3, v80, v80
 v_sub_f32 v80, v56, v2
 v_fmac_f32 v3, v80, v80
 v_sub_f32 v80, v57, v2
 v_fmac_f32 v3, v80, v80
 v_sub_f32 v80, v58, v2
 v_fmac_f32 v3, v80, v80
 v_sub_f32 v80, v59, v2
 v_fmac_f32 v3, v80, v80
 v_sub_f32 v80, v60, v2
 v_fmac_f32 v3, v80, v80
 v_sub_f32 v80, v61, v2
 v_fmac_f32 v3, v80, v80
 v_sub_f32 v80, v62, v2
 v_fmac_f32 v3, v80, v80
 v_sub_f32 v80, v63, v2
 v_fmac_f32 v3, v80, v80
 v_sub_f32 v80, v64, v2
 v_fmac_f32 v3, v80, v80
 v_sub_f32 v80, v65, v2
 v_fmac_f32 v3, v80, v80
 v_sub_f32 v80, v66, v2
 v_fmac_f32 v3, v80, v80
 v_sub_f32 v80, v67, v2
 v_fmac_f32 v3, v80, v80
 v_sub_f32 v80, v68, v2
 v_fmac_f32 v3, v80, v80
 v_sub_f32 v80, v69, v2
 v_fmac_f32 v3, v80, v80
 v_sub_f32 v80, v70, v2
 v_fmac_f32 v3, v80, v80
 v_sub_f32 v80, v71, v2
 v_fmac_f32 v3, v80, v80
 s_nop 1
 v_add_f32_dpp v3, v3, v3 row_ror:8 row_mask:0xf bank_mask:0xf
 s_nop 1
 v_add_f32_dpp v3, v3, v3 row_ror:4 row_mask:0xf bank_mask:0xf
 s_nop 1
 v_add_f32_dpp v3, v3, v3 row_ror:2 row_mask:0xf bank_mask:0xf
 s_nop 1
 v_add_f32_dpp v3, v3, v3 row_ror:1 row_mask:0xf bank_mask:0xf
 v_mul_f32 v3, 0x3acccccd, v3
 v_cvt_pk_bf16_f32 v2, v2, v2
 v_and_b32 v2, 0xffff0000, v2
 v_cvt_pk_bf16_f32 v3, v3, v3
 v_and_b32 v3, 0xffff0000, v3
 v_add_f32 v3, 0x3727c5ac, v3
 v_cvt_pk_bf16_f32 v3, v3, v3
 v_and_b32 v3, 0xffff0000, v3
 v_sqrt_f32 v3, v3
 s_nop 0
 v_cvt_pk_bf16_f32 v3, v3, v3
 v_and_b32 v3, 0xffff0000, v3
 v_rcp_f32 v3, v3
 s_nop 0
 v_sub_f32 v32, v32, v2
 v_sub_f32 v33, v33, v2
 v_cvt_pk_bf16_f32 v80, v32, v33
 v_lshlrev_b32 v32, 16, v80
 v_and_b32 v33, 0xffff0000, v80
 v_mul_f32 v32, v32, v3
 v_mul_f32 v33, v33, v3
 v_cvt_pk_bf16_f32 v4, v32, v33
 v_sub_f32 v34, v34, v2
 v_sub_f32 v35, v35, v2
 v_cvt_pk_bf16_f32 v80, v34, v35
 v_lshlrev_b32 v34, 16, v80
 v_and_b32 v35, 0xffff0000, v80
 v_mul_f32 v34, v34, v3
 v_mul_f32 v35, v35, v3
 v_cvt_pk_bf16_f32 v5, v34, v35
 v_sub_f32 v36, v36, v2
 v_sub_f32 v37, v37, v2
 v_cvt_pk_bf16_f32 v80, v36, v37
 v_lshlrev_b32 v36, 16, v80
 v_and_b32 v37, 0xffff0000, v80
 v_mul_f32 v36, v36, v3
 v_mul_f32 v37, v37, v3
 v_cvt_pk_bf16_f32 v6, v36, v37
 v_sub_f32 v38, v38, v2
 v_sub_f32 v39, v39, v2
 v_cvt_pk_bf16_f32 v80, v38, v39
 v_lshlrev_b32 v38, 16, v80
 v_and_b32 v39, 0xffff0000, v80
 v_mul_f32 v38, v38, v3
 v_mul_f32 v39, v39, v3
 v_cvt_pk_bf16_f32 v7, v38, v39
 s_mov_b32 s3, 0
 buffer_store_dwordx4 v[4:7], v87, s[12:15], s3 offen
 v_sub_f32 v40, v40, v2
 v_sub_f32 v41, v41, v2
 v_cvt_pk_bf16_f32 v80, v40, v41
 v_lshlrev_b32 v40, 16, v80
 v_and_b32 v41, 0xffff0000, v80
 v_mul_f32 v40, v40, v3
 v_mul_f32 v41, v41, v3
 v_cvt_pk_bf16_f32 v8, v40, v41
 v_sub_f32 v42, v42, v2
 v_sub_f32 v43, v43, v2
 v_cvt_pk_bf16_f32 v80, v42, v43
 v_lshlrev_b32 v42, 16, v80
 v_and_b32 v43, 0xffff0000, v80
 v_mul_f32 v42, v42, v3
 v_mul_f32 v43, v43, v3
 v_cvt_pk_bf16_f32 v9, v42, v43
 v_sub_f32 v44, v44, v2
 v_sub_f32 v45, v45, v2
 v_cvt_pk_bf16_f32 v80, v44, v45
 v_lshlrev_b32 v44, 16, v80
 v_and_b32 v45, 0xffff0000, v80
 v_mul_f32 v44, v44, v3
 v_mul_f32 v45, v45, v3
 v_cvt_pk_bf16_f32 v10, v44, v45
 v_sub_f32 v46, v46, v2
 v_sub_f32 v47, v47, v2
 v_cvt_pk_bf16_f32 v80, v46, v47
 v_lshlrev_b32 v46, 16, v80
 v_and_b32 v47, 0xffff0000, v80
 v_mul_f32 v46, v46, v3
 v_mul_f32 v47, v47, v3
 v_cvt_pk_bf16_f32 v11, v46, v47
 s_mov_b32 s3, 65536
 buffer_store_dwordx4 v[8:11], v87, s[12:15], s3 offen
 v_sub_f32 v48, v48, v2
 v_sub_f32 v49, v49, v2
 v_cvt_pk_bf16_f32 v80, v48, v49
 v_lshlrev_b32 v48, 16, v80
 v_and_b32 v49, 0xffff0000, v80
 v_mul_f32 v48, v48, v3
 v_mul_f32 v49, v49, v3
 v_cvt_pk_bf16_f32 v12, v48, v49
 v_sub_f32 v50, v50, v2
 v_sub_f32 v51, v51, v2
 v_cvt_pk_bf16_f32 v80, v50, v51
 v_lshlrev_b32 v50, 16, v80
 v_and_b32 v51, 0xffff0000, v80
 v_mul_f32 v50, v50, v3
 v_mul_f32 v51, v51, v3
 v_cvt_pk_bf16_f32 v13, v50, v51
 v_sub_f32 v52, v52, v2
 v_sub_f32 v53, v53, v2
 v_cvt_pk_bf16_f32 v80, v52, v53
 v_lshlrev_b32 v52, 16, v80
 v_and_b32 v53, 0xffff0000, v80
 v_mul_f32 v52, v52, v3
 v_mul_f32 v53, v53, v3
 v_cvt_pk_bf16_f32 v14, v52, v53
 v_sub_f32 v54, v54, v2
 v_sub_f32 v55, v55, v2
 v_cvt_pk_bf16_f32 v80, v54, v55
 v_lshlrev_b32 v54, 16, v80
 v_and_b32 v55, 0xffff0000, v80
 v_mul_f32 v54, v54, v3
 v_mul_f32 v55, v55, v3
 v_cvt_pk_bf16_f32 v15, v54, v55
 s_mov_b32 s3, 131072
 buffer_store_dwordx4 v[12:15], v87, s[12:15], s3 offen
 v_sub_f32 v56, v56, v2
 v_sub_f32 v57, v57, v2
 v_cvt_pk_bf16_f32 v80, v56, v57
 v_lshlrev_b32 v56, 16, v80
 v_and_b32 v57, 0xffff0000, v80
 v_mul_f32 v56, v56, v3
 v_mul_f32 v57, v57, v3
 v_cvt_pk_bf16_f32 v16, v56, v57
 v_sub_f32 v58, v58, v2
 v_sub_f32 v59, v59, v2
 v_cvt_pk_bf16_f32 v80, v58, v59
 v_lshlrev_b32 v58, 16, v80
 v_and_b32 v59, 0xffff0000, v80
 v_mul_f32 v58, v58, v3
 v_mul_f32 v59, v59, v3
 v_cvt_pk_bf16_f32 v17, v58, v59
 v_sub_f32 v60, v60, v2
 v_sub_f32 v61, v61, v2
 v_cvt_pk_bf16_f32 v80, v60, v61
 v_lshlrev_b32 v60, 16, v80
 v_and_b32 v61, 0xffff0000, v80
 v_mul_f32 v60, v60, v3
 v_mul_f32 v61, v61, v3
 v_cvt_pk_bf16_f32 v18, v60, v61
 v_sub_f32 v62, v62, v2
 v_sub_f32 v63, v63, v2
 v_cvt_pk_bf16_f32 v80, v62, v63
 v_lshlrev_b32 v62, 16, v80
 v_and_b32 v63, 0xffff0000, v80
 v_mul_f32 v62, v62, v3
 v_mul_f32 v63, v63, v3
 v_cvt_pk_bf16_f32 v19, v62, v63
 s_mov_b32 s3, 196608
 buffer_store_dwordx4 v[16:19], v87, s[12:15], s3 offen
 v_sub_f32 v64, v64, v2
 v_sub_f32 v65, v65, v2
 v_cvt_pk_bf16_f32 v80, v64, v65
 v_lshlrev_b32 v64, 16, v80
 v_and_b32 v65, 0xffff0000, v80
 v_mul_f32 v64, v64, v3
 v_mul_f32 v65, v65, v3
 v_cvt_pk_bf16_f32 v20, v64, v65
 v_sub_f32 v66, v66, v2
 v_sub_f32 v67, v67, v2
 v_cvt_pk_bf16_f32 v80, v66, v67
 v_lshlrev_b32 v66, 16, v80
 v_and_b32 v67, 0xffff0000, v80
 v_mul_f32 v66, v66, v3
 v_mul_f32 v67, v67, v3
 v_cvt_pk_bf16_f32 v21, v66, v67
 v_sub_f32 v68, v68, v2
 v_sub_f32 v69, v69, v2
 v_cvt_pk_bf16_f32 v80, v68, v69
 v_lshlrev_b32 v68, 16, v80
 v_and_b32 v69, 0xffff0000, v80
 v_mul_f32 v68, v68, v3
 v_mul_f32 v69, v69, v3
 v_cvt_pk_bf16_f32 v22, v68, v69
 v_sub_f32 v70, v70, v2
 v_sub_f32 v71, v71, v2
 v_cvt_pk_bf16_f32 v80, v70, v71
 v_lshlrev_b32 v70, 16, v80
 v_and_b32 v71, 0xffff0000, v80
 v_mul_f32 v70, v70, v3
 v_mul_f32 v71, v71, v3
 v_cvt_pk_bf16_f32 v23, v70, v71
 s_mov_b32 s3, 262144
 buffer_store_dwordx4 v[20:23], v87, s[12:15], s3 offen
lnx_kernel_done1:
 s_endpgm

.section .rodata,"a"
.p2align 6
.amdhsa_kernel lnx_kernel
  .amdhsa_next_free_vgpr 92
  .amdhsa_next_free_sgpr 40
  .amdhsa_accum_offset 92
  .amdhsa_group_segment_fixed_size 0
  .amdhsa_kernarg_size 104
  .amdhsa_user_sgpr_count 2
  .amdhsa_user_sgpr_kernarg_segment_ptr 1
  .amdhsa_system_sgpr_workgroup_id_x 1
.end_amdhsa_kernel

.text
.globl attn_kernel
.p2align 8
.type attn_kernel,@function
attn_kernel:
 s_cmp_ge_u32 s2, 256
 s_cbranch_scc1 attn_kernel_done1
 s_getpc_b64 s[92:93]
attn_kernel_pc2:
 s_sub_u32 s92, s92, attn_kernel_pc2-TEXT_START
 s_subb_u32 s93, s93, 0
 s_and_b32 s93, s93, 0xffff
 s_mov_b32 s94, TEXT_END-TEXT_START
 s_mov_b32 s95, 0x00020000
 s_bfe_u32 s96, s2, 0x30003
 s_lshl_b32 s96, s96, 14
 v_lshlrev_b32 v242, 6, v0
 buffer_load_dword v243, v242, s[92:95], s96 offen
 s_load_dwordx4 s[44:47], s[0:1], 8
 s_load_dwordx2 s[48:49], s[0:1], 24
 s_load_dwordx2 s[50:51], s[0:1], 96
 s_load_dwordx2 s[54:55], s[0:1], 32
 s_load_dwordx2 s[56:57], s[0:1], 56
 s_load_dwordx2 s[58:59], s[0:1], 72
 s_load_dwordx2 s[60:61], s[0:1], 48
 s_load_dwordx2 s[62:63], s[0:1], 88
 s_and_b32 s29, s2, 7
 s_lshl_b32 s29, s29, 2
 s_bfe_u32 s34, s2, 0x20003
 s_add_u32 s29, s29, s34
 s_lshr_b32 s30, s2, 5
 v_lshrrev_b32 v1, 6, v0
 s_nop 0
 v_readfirstlane_b32 s28, v1
 v_and_b32 v0, 63, v0
 s_lshl_b32 s31, s28, 12
 s_mov_b32 s36, 1166016512
 s_mov_b32 s37, 1040356334
 v_and_b32 v40, 31, v0
 v_lshrrev_b32 v41, 5, v0
 v_bfe_u32 v42, v0, 4, 1
 v_bfe_u32 v43, v0, 2, 2
 v_and_b32 v44, 3, v0
 v_lshrrev_b32 v45, 4, v0
 v_and_b32 v46, 15, v0
 v_add_u32 v47, 0, v41
 v_xor_b32 v47, v47, v46
 v_lshlrev_b32 v47, 4, v47
 v_lshl_add_u32 v2, v40, 8, v47
 v_add_u32 v47, 2, v41
 v_xor_b32 v47, v47, v46
 v_lshlrev_b32 v47, 4, v47
 v_lshl_add_u32 v3, v40, 8, v47
 v_add_u32 v47, 4, v41
 v_xor_b32 v47, v47, v46
 v_lshlrev_b32 v47, 4, v47
 v_lshl_add_u32 v4, v40, 8, v47
 v_add_u32 v47, 6, v41
 v_xor_b32 v47, v47, v46
 v_lshlrev_b32 v47, 4, v47
 v_lshl_add_u32 v5, v40, 8, v47
 v_add_u32 v47, 8, v41
 v_xor_b32 v47, v47, v46
 v_lshlrev_b32 v47, 4, v47
 v_lshl_add_u32 v6, v40, 8, v47
 v_add_u32 v47, 10, v41
 v_xor_b32 v47, v47, v46
 v_lshlrev_b32 v47, 4, v47
 v_lshl_add_u32 v7, v40, 8, v47
 v_add_u32 v47, 12, v41
 v_xor_b32 v47, v47, v46
 v_lshlrev_b32 v47, 4, v47
 v_lshl_add_u32 v8, v40, 8, v47
 v_add_u32 v47, 14, v41
 v_xor_b32 v47, v47, v46
 v_lshlrev_b32 v47, 4, v47
 v_lshl_add_u32 v9, v40, 8, v47
 v_lshlrev_b32 v47, 6, v43
 v_lshl_add_u32 v47, v42, 5, v47
 v_and_b32 v48, 1, v44
 v_lshl_add_u32 v47, v48, 4, v47
 v_lshrrev_b32 v48, 1, v44
 v_lshl_add_u32 v47, v48, 3, v47
 v_lshl_add_u32 v10, v41, 10, v47
 v_add_u32 v10, 0x10000, v10
 v_lshl_add_u32 v11, v41, 11, v47
 v_add_u32 v12, 0x10000, v11
 s_lshl_b32 s34, s28, 4
 v_add_u32 v47, s34, v45
 v_lshlrev_b32 v47, 8, v47
 v_add_u32 v48, 0, v45
 v_xor_b32 v48, v48, v46
 v_lshl_add_u32 v13, v48, 4, v47
 v_add_u32 v48, 4, v45
 v_xor_b32 v48, v48, v46
 v_lshl_add_u32 v14, v48, 4, v47
 v_add_u32 v48, 8, v45
 v_xor_b32 v48, v48, v46
 v_lshl_add_u32 v15, v48, 4, v47
 v_add_u32 v48, 12, v45
 v_xor_b32 v48, v48, v46
 v_lshl_add_u32 v16, v48, 4, v47
 v_add_u32 v47, s34, v43
 v_lshlrev_b32 v48, 6, v45
 v_lshl_add_u32 v48, v44, 4, v48
 v_lshl_add_u32 v17, v47, 8, v48
 s_lshl_b32 s34, s29, 8
 s_lshl_b32 s35, s28, 3
 v_add_u32 v47, s35, v43
 v_lshl_add_u32 v18, v47, 13, v48
 v_add_u32 v18, s34, v18
 v_add_u32 v19, 31744, v18
 s_min_u32 s75, s29, 26
 v_lshrrev_b32 v47, 5, v0
 v_lshl_add_u32 v47, v47, 2, v43
 v_add_u32 v47, s35, v47
 v_mul_u32_u24 v47, 3456, v47
 v_lshl_add_u32 v47, v42, 6, v47
 v_lshl_add_u32 v47, v44, 4, v47
 s_lshl_b32 s32, s75, 7
 v_add_u32 v20, s32, v47
 s_mul_i32 s32, s30, 327680
 s_add_u32 s32, s32, s31
 v_lshlrev_b32 v47, 4, v0
 v_add_u32 v192, s32, v47
 s_lshl_b32 s32, s28, 6
 v_add_u32 v47, s32, v40
 v_bfe_u32 v49, v47, 2, 2
 v_add_u32 v50, 0, v41
 v_xor_b32 v50, v50, v49
 v_lshlrev_b32 v50, 4, v50
 v_lshl_add_u32 v193, v47, 6, v50
 v_add_u32 v195, 65536, v193
 v_add_u32 v197, 131072, v193
 v_add_u32 v50, 2, v41
 v_xor_b32 v50, v50, v49
 v_lshlrev_b32 v50, 4, v50
 v_lshl_add_u32 v194, v47, 6, v50
 v_add_u32 v196, 65536, v194
 v_add_u32 v198, 131072, v194
 v_add_u32 v199, 0, v11
 v_add_u32 v202, -65536, v10
 v_add_u32 v200, 65536, v11
 v_add_u32 v203, 0, v10
 v_add_u32 v201, 131072, v11
 v_add_u32 v204, 65536, v10
 s_lshl_b32 s35, s30, 8
 v_add_u32 v47, s35, v47
 v_lshlrev_b32 v210, 3, v47
 v_lshrrev_b32 v49, 2, v47
 v_mul_u32_u24 v49, 1280, v49
 v_and_b32 v50, 3, v47
 v_lshl_add_u32 v49, v50, 6, v49
 v_lshl_add_u32 v211, v41, 4, v49
 s_lshl_b32 s32, s29, 1
 s_sub_u32 s33, s32, 27
 s_cmp_le_u32 s33, 26
 s_cselect_b32 s78, 1, 0
 s_sub_u32 s33, s32, 26
 s_cmp_le_u32 s33, 26
 s_cselect_b32 s79, 1, 0
 s_lshl_b32 s35, s30, 3
 s_lshl_b32 s32, s28, 1
 s_add_u32 s35, s35, s32
 v_lshlrev_b32 v47, 4, v0
 s_mul_i32 s32, s35, 110592
 s_lshl_b32 s33, s75, 12
 s_add_u32 s32, s32, s33
 v_add_u32 v209, s32, v47
 s_lshl_b32 s32, s35, 18
 s_lshl_b32 s33, s29, 13
 s_add_u32 s32, s32, s33
 v_add_u32 v205, s32, v47
 s_waitcnt lgkmcnt(0)
 s_lshl_b32 s34, s29, 19
 s_add_u32 s44, s44, s34
 s_addc_u32 s45, s45, 0
 s_add_u32 s46, s46, s34
 s_addc_u32 s47, s47, 0
 s_mov_b32 s8, s44
 s_and_b32 s9, s45, 0xffff
 s_mov_b32 s10, 524288
 s_mov_b32 s11, 0x00020000
 s_mov_b32 s12, s46
 s_and_b32 s13, s47, 0xffff
 s_mov_b32 s14, 524288
 s_mov_b32 s15, 0x00020000
 s_mov_b32 s16, s48
 s_and_b32 s17, s49, 0xffff
 s_mov_b32 s18, 5242880
 s_mov_b32 s19, 0x00020000
 s_add_u32 s52, s50, 0
 s_addc_u32 s53, s51, 0
 s_mov_b32 s20, s52
 s_and_b32 s21, s53, 0xffff
 s_mov_b32 s22, 2621440
 s_mov_b32 s23, 0x00020000
 s_add_u32 s52, s50, 16777216
 s_addc_u32 s53, s51, 0
 s_mov_b32 s24, s52
 s_and_b32 s25, s53, 0xffff
 s_mov_b32 s26, 16777216
 s_mov_b32 s27, 0x00020000
 s_mov_b32 s64, s60
 s_and_b32 s65, s61, 0xffff
 s_mov_b32 s66, 2211840
 s_mov_b32 s67, 0x00020000
 s_add_u32 s52, s50, 4194304
 s_addc_u32 s53, s51, 0
 s_mov_b32 s68, s52
 s_and_b32 s69, s53, 0xffff
 s_mov_b32 s70, 7077888
 s_mov_b32 s71, 0x00020000
 s_mov_b32 s32, 0
 s_mov_b32 s33, 0
 s_mov_b32 s72, 0
 s_mov_b32 s73, 0
 s_mov_b32 s74, 0
 s_lshl_b32 s76, s28, 11
 s_lshl_b32 s77, s28, 10
 s_add_u32 m0, s31, 0
 s_nop 0
 buffer_load_dwordx4 v192, s[20:23], s72 offen offset:0 lds
 buffer_load_dwordx4 v192, s[20:23], s72 offen offset:1024 lds
 buffer_load_dwordx4 v192, s[20:23], s72 offen offset:2048 lds
 buffer_load_dwordx4 v192, s[20:23], s72 offen offset:3072 lds
 s_add_u32 s72, s72, 16384
 s_add_u32 m0, s76, 16384
 s_nop 0
 buffer_load_dwordx4 v18, s[16:19], s73 offen lds
 buffer_load_dwordx4 v19, s[16:19], s73 offen offset:1024 lds
 s_add_u32 s73, s73, 262144
 s_add_u32 m0, s77, 24576
 s_nop 0
 buffer_load_dwordx4 v20, s[64:67], s74 offen lds
 s_add_u32 s74, s74, 110592
 s_add_u32 m0, s31, 28672
 s_nop 0
 buffer_load_dwordx4 v192, s[20:23], s72 offen offset:0 lds
 buffer_load_dwordx4 v192, s[20:23], s72 offen offset:1024 lds
 buffer_load_dwordx4 v192, s[20:23], s72 offen offset:2048 lds
 buffer_load_dwordx4 v192, s[20:23], s72 offen offset:3072 lds
 s_add_u32 s72, s72, 16384
 s_add_u32 m0, s76, 45056
 s_nop 0
 buffer_load_dwordx4 v18, s[16:19], s73 offen lds
 buffer_load_dwordx4 v19, s[16:19], s73 offen offset:1024 lds
 s_add_u32 s73, s73, 262144
 s_add_u32 m0, s77, 53248
 s_nop 0
 buffer_load_dwordx4 v20, s[64:67], s74 offen lds
 s_add_u32 s74, s74, 110592
 s_waitcnt vmcnt(7)
 s_barrier
 ds_read_b128 a[128:131], v193 offset:0
 ds_read_b64_tr_b16 a[136:137], v199 offset:16384
 ds_read_b64_tr_b16 a[138:139], v199 offset:17408
 ds_read_b128 a[132:135], v193 offset:2048
 ds_read_b64_tr_b16 a[140:141], v199 offset:16640
 ds_read_b64_tr_b16 a[142:143], v199 offset:17664
 ds_read_b64_tr_b16 a[144:145], v199 offset:16896
 ds_read_b64_tr_b16 a[146:147], v199 offset:17920
 ds_read_b64_tr_b16 a[148:149], v199 offset:17152
 ds_read_b64_tr_b16 a[150:151], v199 offset:18176
 ds_read_b64_tr_b16 a[152:153], v202 offset:24576
 ds_read_b64_tr_b16 a[154:155], v202 offset:25088
 ds_read_b64_tr_b16 a[156:157], v202 offset:24832
 ds_read_b64_tr_b16 a[158:159], v202 offset:25344
 s_waitcnt lgkmcnt(11)
 v_mfma_f32_32x32x16_bf16 a[0:15], a[136:139], a[128:131], 0
 ds_read_b128 a[160:163], v194 offset:0
 ds_read_b64_tr_b16 a[168:169], v199 offset:20480
 s_add_u32 m0, s31, 57344
 s_nop 0
 buffer_load_dwordx4 v192, s[20:23], s72 offen offset:0 lds
 s_waitcnt lgkmcnt(12)
 v_mfma_f32_32x32x16_bf16 a[64:79], a[136:139], a[132:135], 0
 ds_read_b64_tr_b16 a[170:171], v199 offset:21504
 ds_read_b128 a[164:167], v194 offset:2048
 buffer_load_dwordx4 v192, s[20:23], s72 offen offset:1024 lds
 s_waitcnt lgkmcnt(12)
 v_mfma_f32_32x32x16_bf16 a[16:31], a[140:143], a[128:131], 0
 ds_read_b64_tr_b16 a[172:173], v199 offset:20736
 ds_read_b64_tr_b16 a[174:175], v199 offset:21760
 buffer_load_dwordx4 v192, s[20:23], s72 offen offset:2048 lds
 v_mfma_f32_32x32x16_bf16 a[80:95], a[140:143], a[132:135], 0
 ds_read_b64_tr_b16 a[176:177], v199 offset:20992
 s_waitcnt lgkmcnt(10)
 ds_read_b64_tr_b16 a[178:179], v199 offset:22016
 buffer_load_dwordx4 v192, s[20:23], s72 offen offset:3072 lds
 s_add_u32 s72, s72, 16384
 v_mfma_f32_32x32x16_bf16 a[32:47], a[144:147], a[128:131], 0
 ds_read_b64_tr_b16 a[180:181], v199 offset:21248
 ds_read_b64_tr_b16 a[182:183], v199 offset:22272
 s_add_u32 m0, s76, 73728
 s_nop 0
 buffer_load_dwordx4 v18, s[16:19], s73 offen lds
 v_mfma_f32_32x32x16_bf16 a[96:111], a[144:147], a[132:135], 0
 ds_read_b64_tr_b16 a[184:185], v202 offset:26624
 ds_read_b64_tr_b16 a[186:187], v202 offset:27136
 buffer_load_dwordx4 v19, s[16:19], s73 offen offset:1024 lds
 s_add_u32 s73, s73, 262144
 v_mfma_f32_32x32x16_bf16 a[48:63], a[148:151], a[128:131], 0
 s_waitcnt lgkmcnt(10)
 ds_read_b64_tr_b16 a[188:189], v202 offset:26880
 ds_read_b64_tr_b16 a[190:191], v202 offset:27392
 s_add_u32 m0, s77, 81920
 s_nop 0
 buffer_load_dwordx4 v20, s[64:67], s74 offen lds
 s_add_u32 s74, s74, 110592
 v_mfma_f32_32x32x16_bf16 a[112:127], a[148:151], a[132:135], 0
 s_add_u32 m0, s31, 86016
 s_nop 0
 buffer_load_dwordx4 v192, s[20:23], s72 offen offset:0 lds
 v_mfma_f32_32x32x16_bf16 v[64:79], a[152:155], a[128:131], 0
 buffer_load_dwordx4 v192, s[20:23], s72 offen offset:1024 lds
 v_mfma_f32_32x32x16_bf16 v[96:111], a[152:155], a[132:135], 0
 buffer_load_dwordx4 v192, s[20:23], s72 offen offset:2048 lds
 v_mfma_f32_32x32x16_bf16 v[80:95], a[156:159], a[128:131], 0
 buffer_load_dwordx4 v192, s[20:23], s72 offen offset:3072 lds
 s_add_u32 s72, s72, 16384
 v_mfma_f32_32x32x16_bf16 v[112:127], a[156:159], a[132:135], 0
 s_add_u32 m0, s76, 102400
 s_nop 0
 buffer_load_dwordx4 v18, s[16:19], s73 offen lds
 s_waitcnt lgkmcnt(11)
 v_mfma_f32_32x32x16_bf16 a[0:15], a[168:171], a[160:163], a[0:15]
 s_waitcnt vmcnt(12)
 s_waitcnt lgkmcnt(0)
 s_barrier
 ds_read_b128 a[128:131], v193 offset:28672
 buffer_load_dwordx4 v19, s[16:19], s73 offen offset:1024 lds
 s_add_u32 s73, s73, 262144
 v_mfma_f32_32x32x16_bf16 a[64:79], a[168:171], a[164:167], a[64:79]
 ds_read_b64_tr_b16 a[136:137], v199 offset:45056
 ds_read_b64_tr_b16 a[138:139], v199 offset:46080
 s_add_u32 m0, s77, 110592
 s_nop 0
 buffer_load_dwordx4 v20, s[64:67], s74 offen lds
 s_add_u32 s74, s74, 110592
 v_mfma_f32_32x32x16_bf16 a[16:31], a[172:175], a[160:163], a[16:31]
 ds_read_b128 a[132:135], v193 offset:30720
 ds_read_b64_tr_b16 a[140:141], v199 offset:45312
 s_add_u32 m0, s31, 114688
 s_nop 0
 buffer_load_dwordx4 v192, s[20:23], s72 offen offset:0 lds
 v_mfma_f32_32x32x16_bf16 a[80:95], a[172:175], a[164:167], a[80:95]
 ds_read_b64_tr_b16 a[142:143], v199 offset:46336
 ds_read_b64_tr_b16 a[144:145], v199 offset:45568
 buffer_load_dwordx4 v192, s[20:23], s72 offen offset:1024 lds
 v_mfma_f32_32x32x16_bf16 a[32:47], a[176:179], a[160:163], a[32:47]
 ds_read_b64_tr_b16 a[146:147], v199 offset:46592
 ds_read_b64_tr_b16 a[148:149], v199 offset:45824
 buffer_load_dwordx4 v192, s[20:23], s72 offen offset:2048 lds
 v_mfma_f32_32x32x16_bf16 a[96:111], a[176:179], a[164:167], a[96:111]
 ds_read_b64_tr_b16 a[150:151], v199 offset:46848
 ds_read_b64_tr_b16 a[152:153], v202 offset:53248
 buffer_load_dwordx4 v192, s[20:23], s72 offen offset:3072 lds
 s_add_u32 s72, s72, 16384
 v_mfma_f32_32x32x16_bf16 a[48:63], a[180:183], a[160:163], a[48:63]
 ds_read_b64_tr_b16 a[154:155], v202 offset:53760
 ds_read_b64_tr_b16 a[156:157], v202 offset:53504
 s_add_u32 m0, s76, 131072
 s_nop 0
 buffer_load_dwordx4 v18, s[16:19], s73 offen lds
 v_mfma_f32_32x32x16_bf16 a[112:127], a[180:183], a[164:167], a[112:127]
 ds_read_b64_tr_b16 a[158:159], v202 offset:54016
 buffer_load_dwordx4 v19, s[16:19], s73 offen offset:1024 lds
 s_add_u32 s73, s73, 262144
 v_mfma_f32_32x32x16_bf16 v[64:79], a[184:187], a[160:163], v[64:79]
 s_add_u32 m0, s77, 139264
 s_nop 0
 buffer_load_dwordx4 v20, s[64:67], s74 offen lds
 s_add_u32 s74, s74, 110592
 v_mfma_f32_32x32x16_bf16 v[96:111], a[184:187], a[164:167], v[96:111]
 s_add_u32 m0, s31, 0
 s_nop 0
 buffer_load_dwordx4 v192, s[20:23], s72 offen offset:0 lds
 v_mfma_f32_32x32x16_bf16 v[80:95], a[188:191], a[160:163], v[80:95]
 buffer_load_dwordx4 v192, s[20:23], s72 offen offset:1024 lds
 v_mfma_f32_32x32x16_bf16 v[112:127], a[188:191], a[164:167], v[112:127]
 buffer_load_dwordx4 v192, s[20:23], s72 offen offset:2048 lds
 s_waitcnt lgkmcnt(11)
 v_mfma_f32_32x32x16_bf16 a[0:15], a[136:139], a[128:131], a[0:15]
 ds_read_b128 a[160:163], v194 offset:28672
 ds_read_b64_tr_b16 a[168:169], v199 offset:49152
 buffer_load_dwordx4 v192, s[20:23], s72 offen offset:3072 lds
 s_add_u32 s72, s72, 16384
 s_waitcnt lgkmcnt(12)
 v_mfma_f32_32x32x16_bf16 a[64:79], a[136:139], a[132:135], a[64:79]
 ds_read_b64_tr_b16 a[170:171], v199 offset:50176
 ds_read_b128 a[164:167], v194 offset:30720
 s_add_u32 m0, s76, 16384
 s_nop 0
 buffer_load_dwordx4 v18, s[16:19], s73 offen lds
 s_waitcnt lgkmcnt(12)
 v_mfma_f32_32x32x16_bf16 a[16:31], a[140:143], a[128:131], a[16:31]
 ds_read_b64_tr_b16 a[172:173], v199 offset:49408
 ds_read_b64_tr_b16 a[174:175], v199 offset:50432
 buffer_load_dwordx4 v19, s[16:19], s73 offen offset:1024 lds
 s_add_u32 s73, s73, 262144
 v_mfma_f32_32x32x16_bf16 a[80:95], a[140:143], a[132:135], a[80:95]
 ds_read_b64_tr_b16 a[176:177], v199 offset:49664
 s_waitcnt lgkmcnt(10)
 ds_read_b64_tr_b16 a[178:179], v199 offset:50688
 s_add_u32 m0, s77, 24576
 s_nop 0
 buffer_load_dwordx4 v20, s[64:67], s74 offen lds
 s_add_u32 s74, s74, 110592
 v_mfma_f32_32x32x16_bf16 a[32:47], a[144:147], a[128:131], a[32:47]
 ds_read_b64_tr_b16 a[180:181], v199 offset:49920
 ds_read_b64_tr_b16 a[182:183], v199 offset:50944
 v_mfma_f32_32x32x16_bf16 a[96:111], a[144:147], a[132:135], a[96:111]
 ds_read_b64_tr_b16 a[184:185], v202 offset:55296
 ds_read_b64_tr_b16 a[186:187], v202 offset:55808
 v_mfma_f32_32x32x16_bf16 a[48:63], a[148:151], a[128:131], a[48:63]
 s_waitcnt lgkmcnt(10)
 ds_read_b64_tr_b16 a[188:189], v202 offset:55552
 ds_read_b64_tr_b16 a[190:191], v202 offset:56064
 v_mfma_f32_32x32x16_bf16 a[112:127], a[148:151], a[132:135], a[112:127]
 v_mfma_f32_32x32x16_bf16 v[64:79], a[152:155], a[128:131], v[64:79]
 v_mfma_f32_32x32x16_bf16 v[96:111], a[152:155], a[132:135], v[96:111]
 v_mfma_f32_32x32x16_bf16 v[80:95], a[156:159], a[128:131], v[80:95]
 v_mfma_f32_32x32x16_bf16 v[112:127], a[156:159], a[132:135], v[112:127]
 s_waitcnt lgkmcnt(11)
 v_mfma_f32_32x32x16_bf16 a[0:15], a[168:171], a[160:163], a[0:15]
 s_waitcnt vmcnt(21)
 s_waitcnt lgkmcnt(0)
 s_barrier
 ds_read_b128 a[128:131], v193 offset:57344
 v_mfma_f32_32x32x16_bf16 a[64:79], a[168:171], a[164:167], a[64:79]
 ds_read_b64_tr_b16 a[136:137], v200 offset:8192
 ds_read_b64_tr_b16 a[138:139], v200 offset:9216
 s_add_u32 m0, s31, 28672
 s_nop 0
 buffer_load_dwordx4 v192, s[20:23], s72 offen offset:0 lds
 v_mfma_f32_32x32x16_bf16 a[16:31], a[172:175], a[160:163], a[16:31]
 ds_read_b128 a[132:135], v193 offset:59392
 ds_read_b64_tr_b16 a[140:141], v200 offset:8448
 v_mfma_f32_32x32x16_bf16 a[80:95], a[172:175], a[164:167], a[80:95]
 ds_read_b64_tr_b16 a[142:143], v200 offset:9472
 ds_read_b64_tr_b16 a[144:145], v200 offset:8704
 v_mfma_f32_32x32x16_bf16 a[32:47], a[176:179], a[160:163], a[32:47]
 ds_read_b64_tr_b16 a[146:147], v200 offset:9728
 ds_read_b64_tr_b16 a[148:149], v200 offset:8960
 buffer_load_dwordx4 v192, s[20:23], s72 offen offset:1024 lds
 v_mfma_f32_32x32x16_bf16 a[96:111], a[176:179], a[164:167], a[96:111]
 ds_read_b64_tr_b16 a[150:151], v200 offset:9984
 ds_read_b64_tr_b16 a[152:153], v203 offset:16384
 v_mfma_f32_32x32x16_bf16 a[48:63], a[180:183], a[160:163], a[48:63]
 ds_read_b64_tr_b16 a[154:155], v203 offset:16896
 ds_read_b64_tr_b16 a[156:157], v203 offset:16640
 v_mfma_f32_32x32x16_bf16 a[112:127], a[180:183], a[164:167], a[112:127]
 ds_read_b64_tr_b16 a[158:159], v203 offset:17152
 buffer_load_dwordx4 v192, s[20:23], s72 offen offset:2048 lds
 v_mfma_f32_32x32x16_bf16 v[64:79], a[184:187], a[160:163], v[64:79]
 v_mfma_f32_32x32x16_bf16 v[96:111], a[184:187], a[164:167], v[96:111]
 v_mfma_f32_32x32x16_bf16 v[80:95], a[188:191], a[160:163], v[80:95]
 buffer_load_dwordx4 v192, s[20:23], s72 offen offset:3072 lds
 s_add_u32 s72, s72, 16384
 v_mfma_f32_32x32x16_bf16 v[112:127], a[188:191], a[164:167], v[112:127]
 s_waitcnt lgkmcnt(11)
 v_mfma_f32_32x32x16_bf16 a[0:15], a[136:139], a[128:131], a[0:15]
 ds_read_b128 a[160:163], v194 offset:57344
 ds_read_b64_tr_b16 a[168:169], v200 offset:12288
 s_waitcnt lgkmcnt(12)
 v_mfma_f32_32x32x16_bf16 a[64:79], a[136:139], a[132:135], a[64:79]
 ds_read_b64_tr_b16 a[170:171], v200 offset:13312
 ds_read_b128 a[164:167], v194 offset:59392
 s_waitcnt lgkmcnt(12)
 v_mfma_f32_32x32x16_bf16 a[16:31], a[140:143], a[128:131], a[16:31]
 ds_read_b64_tr_b16 a[172:173], v200 offset:12544
 ds_read_b64_tr_b16 a[174:175], v200 offset:13568
 s_add_u32 m0, s76, 45056
 s_nop 0
 buffer_load_dwordx4 v18, s[16:19], s73 offen lds
 v_mfma_f32_32x32x16_bf16 a[80:95], a[140:143], a[132:135], a[80:95]
 ds_read_b64_tr_b16 a[176:177], v200 offset:12800
 s_waitcnt lgkmcnt(10)
 ds_read_b64_tr_b16 a[178:179], v200 offset:13824
 v_mfma_f32_32x32x16_bf16 a[32:47], a[144:147], a[128:131], a[32:47]
 ds_read_b64_tr_b16 a[180:181], v200 offset:13056
 ds_read_b64_tr_b16 a[182:183], v200 offset:14080
 v_mfma_f32_32x32x16_bf16 a[96:111], a[144:147], a[132:135], a[96:111]
 ds_read_b64_tr_b16 a[184:185], v203 offset:18432
 ds_read_b64_tr_b16 a[186:187], v203 offset:18944
 buffer_load_dwordx4 v19, s[16:19], s73 offen offset:1024 lds
 s_add_u32 s73, s73, 262144
 v_mfma_f32_32x32x16_bf16 a[48:63], a[148:151], a[128:131], a[48:63]
 s_waitcnt lgkmcnt(10)
 ds_read_b64_tr_b16 a[188:189], v203 offset:18688
 ds_read_b64_tr_b16 a[190:191], v203 offset:19200
 v_mfma_f32_32x32x16_bf16 a[112:127], a[148:151], a[132:135], a[112:127]
 v_mfma_f32_32x32x16_bf16 v[64:79], a[152:155], a[128:131], v[64:79]
 s_add_u32 m0, s77, 53248
 s_nop 0
 buffer_load_dwordx4 v20, s[64:67], s74 offen lds
 s_add_u32 s74, s74, 110592
 v_mfma_f32_32x32x16_bf16 v[96:111], a[152:155], a[132:135], v[96:111]
 v_mfma_f32_32x32x16_bf16 v[80:95], a[156:159], a[128:131], v[80:95]
 v_mfma_f32_32x32x16_bf16 v[112:127], a[156:159], a[132:135], v[112:127]
 s_waitcnt lgkmcnt(11)
 v_mfma_f32_32x32x16_bf16 a[0:15], a[168:171], a[160:163], a[0:15]
 s_waitcnt vmcnt(21)
 s_waitcnt lgkmcnt(0)
 s_barrier
 ds_read_b128 a[128:131], v195 offset:20480
 v_mfma_f32_32x32x16_bf16 a[64:79], a[168:171], a[164:167], a[64:79]
 ds_read_b64_tr_b16 a[136:137], v200 offset:36864
 ds_read_b64_tr_b16 a[138:139], v200 offset:37888
 s_add_u32 m0, s31, 57344
 s_nop 0
 buffer_load_dwordx4 v192, s[20:23], s72 offen offset:0 lds
 v_mfma_f32_32x32x16_bf16 a[16:31], a[172:175], a[160:163], a[16:31]
 ds_read_b128 a[132:135], v195 offset:22528
 ds_read_b64_tr_b16 a[140:141], v200 offset:37120
 v_mfma_f32_32x32x16_bf16 a[80:95], a[172:175], a[164:167], a[80:95]
 ds_read_b64_tr_b16 a[142:143], v200 offset:38144
 ds_read_b64_tr_b16 a[144:145], v200 offset:37376
 v_mfma_f32_32x32x16_bf16 a[32:47], a[176:179], a[160:163], a[32:47]
 ds_read_b64_tr_b16 a[146:147], v200 offset:38400
 ds_read_b64_tr_b16 a[148:149], v200 offset:37632
 buffer_load_dwordx4 v192, s[20:23], s72 offen offset:1024 lds
 v_mfma_f32_32x32x16_bf16 a[96:111], a[176:179], a[164:167], a[96:111]
 ds_read_b64_tr_b16 a[150:151], v200 offset:38656
 ds_read_b64_tr_b16 a[152:153], v203 offset:45056
 v_mfma_f32_32x32x16_bf16 a[48:63], a[180:183], a[160:163], a[48:63]
 ds_read_b64_tr_b16 a[154:155], v203 offset:45568
 ds_read_b64_tr_b16 a[156:157], v203 offset:45312
 v_mfma_f32_32x32x16_bf16 a[112:127], a[180:183], a[164:167], a[112:127]
 ds_read_b64_tr_b16 a[158:159], v203 offset:45824
 buffer_load_dwordx4 v192, s[20:23], s72 offen offset:2048 lds
 v_mfma_f32_32x32x16_bf16 v[64:79], a[184:187], a[160:163], v[64:79]
 v_mfma_f32_32x32x16_bf16 v[96:111], a[184:187], a[164:167], v[96:111]
 v_mfma_f32_32x32x16_bf16 v[80:95], a[188:191], a[160:163], v[80:95]
 buffer_load_dwordx4 v192, s[20:23], s72 offen offset:3072 lds
 s_add_u32 s72, s72, 16384
 v_mfma_f32_32x32x16_bf16 v[112:127], a[188:191], a[164:167], v[112:127]
 s_waitcnt lgkmcnt(11)
 v_mfma_f32_32x32x16_bf16 a[0:15], a[136:139], a[128:131], a[0:15]
 ds_read_b128 a[160:163], v196 offset:20480
 ds_read_b64_tr_b16 a[168:169], v200 offset:40960
 s_waitcnt lgkmcnt(12)
 v_mfma_f32_32x32x16_bf16 a[64:79], a[136:139], a[132:135], a[64:79]
 ds_read_b64_tr_b16 a[170:171], v200 offset:41984
 ds_read_b128 a[164:167], v196 offset:22528
 s_waitcnt lgkmcnt(12)
 v_mfma_f32_32x32x16_bf16 a[16:31], a[140:143], a[128:131], a[16:31]
 ds_read_b64_tr_b16 a[172:173], v200 offset:41216
 ds_read_b64_tr_b16 a[174:175], v200 offset:42240
 s_add_u32 m0, s76, 73728
 s_nop 0
 buffer_load_dwordx4 v18, s[16:19], s73 offen lds
 v_mfma_f32_32x32x16_bf16 a[80:95], a[140:143], a[132:135], a[80:95]
 ds_read_b64_tr_b16 a[176:177], v200 offset:41472
 s_waitcnt lgkmcnt(10)
 ds_read_b64_tr_b16 a[178:179], v200 offset:42496
 v_mfma_f32_32x32x16_bf16 a[32:47], a[144:147], a[128:131], a[32:47]
 ds_read_b64_tr_b16 a[180:181], v200 offset:41728
 ds_read_b64_tr_b16 a[182:183], v200 offset:42752
 v_mfma_f32_32x32x16_bf16 a[96:111], a[144:147], a[132:135], a[96:111]
 ds_read_b64_tr_b16 a[184:185], v203 offset:47104
 ds_read_b64_tr_b16 a[186:187], v203 offset:47616
 buffer_load_dwordx4 v19, s[16:19], s73 offen offset:1024 lds
 s_add_u32 s73, s73, 262144
 v_mfma_f32_32x32x16_bf16 a[48:63], a[148:151], a[128:131], a[48:63]
 s_waitcnt lgkmcnt(10)
 ds_read_b64_tr_b16 a[188:189], v203 offset:47360
 ds_read_b64_tr_b16 a[190:191], v203 offset:47872
 v_mfma_f32_32x32x16_bf16 a[112:127], a[148:151], a[132:135], a[112:127]
 v_mfma_f32_32x32x16_bf16 v[64:79], a[152:155], a[128:131], v[64:79]
 s_add_u32 m0, s77, 81920
 s_nop 0
 buffer_load_dwordx4 v20, s[64:67], s74 offen lds
 s_add_u32 s74, s74, 110592
 v_mfma_f32_32x32x16_bf16 v[96:111], a[152:155], a[132:135], v[96:111]
 v_mfma_f32_32x32x16_bf16 v[80:95], a[156:159], a[128:131], v[80:95]
 v_mfma_f32_32x32x16_bf16 v[112:127], a[156:159], a[132:135], v[112:127]
 s_waitcnt lgkmcnt(11)
 v_mfma_f32_32x32x16_bf16 a[0:15], a[168:171], a[160:163], a[0:15]
 s_waitcnt vmcnt(21)
 s_waitcnt lgkmcnt(0)
 s_barrier
 ds_read_b128 a[128:131], v195 offset:49152
 v_mfma_f32_32x32x16_bf16 a[64:79], a[168:171], a[164:167], a[64:79]
 ds_read_b64_tr_b16 a[136:137], v201 offset:0
 ds_read_b64_tr_b16 a[138:139], v201 offset:1024
 s_add_u32 m0, s31, 86016
 s_nop 0
 buffer_load_dwordx4 v192, s[20:23], s72 offen offset:0 lds
 v_mfma_f32_32x32x16_bf16 a[16:31], a[172:175], a[160:163], a[16:31]
 ds_read_b128 a[132:135], v195 offset:51200
 ds_read_b64_tr_b16 a[140:141], v201 offset:256
 v_mfma_f32_32x32x16_bf16 a[80:95], a[172:175], a[164:167], a[80:95]
 ds_read_b64_tr_b16 a[142:143], v201 offset:1280
 ds_read_b64_tr_b16 a[144:145], v201 offset:512
 v_mfma_f32_32x32x16_bf16 a[32:47], a[176:179], a[160:163], a[32:47]
 ds_read_b64_tr_b16 a[146:147], v201 offset:1536
 ds_read_b64_tr_b16 a[148:149], v201 offset:768
 buffer_load_dwordx4 v192, s[20:23], s72 offen offset:1024 lds
 v_mfma_f32_32x32x16_bf16 a[96:111], a[176:179], a[164:167], a[96:111]
 ds_read_b64_tr_b16 a[150:151], v201 offset:1792
 ds_read_b64_tr_b16 a[152:153], v204 offset:8192
 v_mfma_f32_32x32x16_bf16 a[48:63], a[180:183], a[160:163], a[48:63]
 ds_read_b64_tr_b16 a[154:155], v204 offset:8704
 ds_read_b64_tr_b16 a[156:157], v204 offset:8448
 v_mfma_f32_32x32x16_bf16 a[112:127], a[180:183], a[164:167], a[112:127]
 ds_read_b64_tr_b16 a[158:159], v204 offset:8960
 buffer_load_dwordx4 v192, s[20:23], s72 offen offset:2048 lds
 v_mfma_f32_32x32x16_bf16 v[64:79], a[184:187], a[160:163], v[64:79]
 v_mfma_f32_32x32x16_bf16 v[96:111], a[184:187], a[164:167], v[96:111]
 v_mfma_f32_32x32x16_bf16 v[80:95], a[188:191], a[160:163], v[80:95]
 buffer_load_dwordx4 v192, s[20:23], s72 offen offset:3072 lds
 s_add_u32 s72, s72, 16384
 v_mfma_f32_32x32x16_bf16 v[112:127], a[188:191], a[164:167], v[112:127]
 s_waitcnt lgkmcnt(11)
 v_mfma_f32_32x32x16_bf16 a[0:15], a[136:139], a[128:131], a[0:15]
 ds_read_b128 a[160:163], v196 offset:49152
 ds_read_b64_tr_b16 a[168:169], v201 offset:4096
 s_waitcnt lgkmcnt(12)
 v_mfma_f32_32x32x16_bf16 a[64:79], a[136:139], a[132:135], a[64:79]
 ds_read_b64_tr_b16 a[170:171], v201 offset:5120
 ds_read_b128 a[164:167], v196 offset:51200
 s_waitcnt lgkmcnt(12)
 v_mfma_f32_32x32x16_bf16 a[16:31], a[140:143], a[128:131], a[16:31]
 ds_read_b64_tr_b16 a[172:173], v201 offset:4352
 ds_read_b64_tr_b16 a[174:175], v201 offset:5376
 s_add_u32 m0, s76, 102400
 s_nop 0
 buffer_load_dwordx4 v18, s[16:19], s73 offen lds
 v_mfma_f32_32x32x16_bf16 a[80:95], a[140:143], a[132:135], a[80:95]
 ds_read_b64_tr_b16 a[176:177], v201 offset:4608
 s_waitcnt lgkmcnt(10)
 ds_read_b64_tr_b16 a[178:179], v201 offset:5632
 v_mfma_f32_32x32x16_bf16 a[32:47], a[144:147], a[128:131], a[32:47]
 ds_read_b64_tr_b16 a[180:181], v201 offset:4864
 ds_read_b64_tr_b16 a[182:183], v201 offset:5888
 v_mfma_f32_32x32x16_bf16 a[96:111], a[144:147], a[132:135], a[96:111]
 ds_read_b64_tr_b16 a[184:185], v204 offset:10240
 ds_read_b64_tr_b16 a[186:187], v204 offset:10752
 buffer_load_dwordx4 v19, s[16:19], s73 offen offset:1024 lds
 s_add_u32 s73, s73, 262144
 v_mfma_f32_32x32x16_bf16 a[48:63], a[148:151], a[128:131], a[48:63]
 s_waitcnt lgkmcnt(10)
 ds_read_b64_tr_b16 a[188:189], v204 offset:10496
 ds_read_b64_tr_b16 a[190:191], v204 offset:11008
 v_mfma_f32_32x32x16_bf16 a[112:127], a[148:151], a[132:135], a[112:127]
 v_mfma_f32_32x32x16_bf16 v[64:79], a[152:155], a[128:131], v[64:79]
 s_add_u32 m0, s77, 110592
 s_nop 0
 buffer_load_dwordx4 v20, s[64:67], s74 offen lds
 s_add_u32 s74, s74, 110592
 v_mfma_f32_32x32x16_bf16 v[96:111], a[152:155], a[132:135], v[96:111]
 v_mfma_f32_32x32x16_bf16 v[80:95], a[156:159], a[128:131], v[80:95]
 v_mfma_f32_32x32x16_bf16 v[112:127], a[156:159], a[132:135], v[112:127]
 s_waitcnt lgkmcnt(11)
 v_mfma_f32_32x32x16_bf16 a[0:15], a[168:171], a[160:163], a[0:15]
 s_waitcnt vmcnt(21)
 s_waitcnt lgkmcnt(0)
 s_barrier
 ds_read_b128 a[128:131], v193 offset:0
 v_mfma_f32_32x32x16_bf16 a[64:79], a[168:171], a[164:167], a[64:79]
 ds_read_b64_tr_b16 a[136:137], v199 offset:16384
 ds_read_b64_tr_b16 a[138:139], v199 offset:17408
 s_add_u32 m0, s31, 114688
 s_nop 0
 buffer_load_dwordx4 v192, s[20:23], s72 offen offset:0 lds
 v_mfma_f32_32x32x16_bf16 a[16:31], a[172:175], a[160:163], a[16:31]
 ds_read_b128 a[132:135], v193 offset:2048
 ds_read_b64_tr_b16 a[140:141], v199 offset:16640
 v_mfma_f32_32x32x16_bf16 a[80:95], a[172:175], a[164:167], a[80:95]
 ds_read_b64_tr_b16 a[142:143], v199 offset:17664
 ds_read_b64_tr_b16 a[144:145], v199 offset:16896
 v_mfma_f32_32x32x16_bf16 a[32:47], a[176:179], a[160:163], a[32:47]
 ds_read_b64_tr_b16 a[146:147], v199 offset:17920
 ds_read_b64_tr_b16 a[148:149], v199 offset:17152
 buffer_load_dwordx4 v192, s[20:23], s72 offen offset:1024 lds
 v_mfma_f32_32x32x16_bf16 a[96:111], a[176:179], a[164:167], a[96:111]
 ds_read_b64_tr_b16 a[150:151], v199 offset:18176
 ds_read_b64_tr_b16 a[152:153], v202 offset:24576
 v_mfma_f32_32x32x16_bf16 a[48:63], a[180:183], a[160:163], a[48:63]
 ds_read_b64_tr_b16 a[154:155], v202 offset:25088
 ds_read_b64_tr_b16 a[156:157], v202 offset:24832
 v_mfma_f32_32x32x16_bf16 a[112:127], a[180:183], a[164:167], a[112:127]
 ds_read_b64_tr_b16 a[158:159], v202 offset:25344
 buffer_load_dwordx4 v192, s[20:23], s72 offen offset:2048 lds
 v_mfma_f32_32x32x16_bf16 v[64:79], a[184:187], a[160:163], v[64:79]
 v_mfma_f32_32x32x16_bf16 v[96:111], a[184:187], a[164:167], v[96:111]
 v_mfma_f32_32x32x16_bf16 v[80:95], a[188:191], a[160:163], v[80:95]
 buffer_load_dwordx4 v192, s[20:23], s72 offen offset:3072 lds
 s_add_u32 s72, s72, 16384
 v_mfma_f32_32x32x16_bf16 v[112:127], a[188:191], a[164:167], v[112:127]
 s_waitcnt lgkmcnt(11)
 v_mfma_f32_32x32x16_bf16 a[0:15], a[136:139], a[128:131], a[0:15]
 ds_read_b128 a[160:163], v194 offset:0
 ds_read_b64_tr_b16 a[168:169], v199 offset:20480
 s_waitcnt lgkmcnt(12)
 v_mfma_f32_32x32x16_bf16 a[64:79], a[136:139], a[132:135], a[64:79]
 ds_read_b64_tr_b16 a[170:171], v199 offset:21504
 ds_read_b128 a[164:167], v194 offset:2048
 s_waitcnt lgkmcnt(12)
 v_mfma_f32_32x32x16_bf16 a[16:31], a[140:143], a[128:131], a[16:31]
 ds_read_b64_tr_b16 a[172:173], v199 offset:20736
 ds_read_b64_tr_b16 a[174:175], v199 offset:21760
 s_add_u32 m0, s76, 131072
 s_nop 0
 buffer_load_dwordx4 v18, s[16:19], s73 offen lds
 v_mfma_f32_32x32x16_bf16 a[80:95], a[140:143], a[132:135], a[80:95]
 ds_read_b64_tr_b16 a[176:177], v199 offset:20992
 s_waitcnt lgkmcnt(10)
 ds_read_b64_tr_b16 a[178:179], v199 offset:22016
 v_mfma_f32_32x32x16_bf16 a[32:47], a[144:147], a[128:131], a[32:47]
 ds_read_b64_tr_b16 a[180:181], v199 offset:21248
 ds_read_b64_tr_b16 a[182:183], v199 offset:22272
 v_mfma_f32_32x32x16_bf16 a[96:111], a[144:147], a[132:135], a[96:111]
 ds_read_b64_tr_b16 a[184:185], v202 offset:26624
 ds_read_b64_tr_b16 a[186:187], v202 offset:27136
 buffer_load_dwordx4 v19, s[16:19], s73 offen offset:1024 lds
 s_add_u32 s73, s73, 262144
 v_mfma_f32_32x32x16_bf16 a[48:63], a[148:151], a[128:131], a[48:63]
 s_waitcnt lgkmcnt(10)
 ds_read_b64_tr_b16 a[188:189], v202 offset:26880
 ds_read_b64_tr_b16 a[190:191], v202 offset:27392
 v_mfma_f32_32x32x16_bf16 a[112:127], a[148:151], a[132:135], a[112:127]
 v_mfma_f32_32x32x16_bf16 v[64:79], a[152:155], a[128:131], v[64:79]
 s_add_u32 m0, s77, 139264
 s_nop 0
 buffer_load_dwordx4 v20, s[64:67], s74 offen lds
 s_add_u32 s74, s74, 110592
 v_mfma_f32_32x32x16_bf16 v[96:111], a[152:155], a[132:135], v[96:111]
 v_mfma_f32_32x32x16_bf16 v[80:95], a[156:159], a[128:131], v[80:95]
 v_mfma_f32_32x32x16_bf16 v[112:127], a[156:159], a[132:135], v[112:127]
 s_waitcnt lgkmcnt(11)
 v_mfma_f32_32x32x16_bf16 a[0:15], a[168:171], a[160:163], a[0:15]
 s_waitcnt vmcnt(21)
 s_waitcnt lgkmcnt(0)
 s_barrier
 ds_read_b128 a[128:131], v193 offset:28672
 v_mfma_f32_32x32x16_bf16 a[64:79], a[168:171], a[164:167], a[64:79]
 ds_read_b64_tr_b16 a[136:137], v199 offset:45056
 ds_read_b64_tr_b16 a[138:139], v199 offset:46080
 s_add_u32 m0, s31, 0
 s_nop 0
 buffer_load_dwordx4 v192, s[20:23], s72 offen offset:0 lds
 v_mfma_f32_32x32x16_bf16 a[16:31], a[172:175], a[160:163], a[16:31]
 ds_read_b128 a[132:135], v193 offset:30720
 ds_read_b64_tr_b16 a[140:141], v199 offset:45312
 v_mfma_f32_32x32x16_bf16 a[80:95], a[172:175], a[164:167], a[80:95]
 ds_read_b64_tr_b16 a[142:143], v199 offset:46336
 ds_read_b64_tr_b16 a[144:145], v199 offset:45568
 v_mfma_f32_32x32x16_bf16 a[32:47], a[176:179], a[160:163], a[32:47]
 ds_read_b64_tr_b16 a[146:147], v199 offset:46592
 ds_read_b64_tr_b16 a[148:149], v199 offset:45824
 buffer_load_dwordx4 v192, s[20:23], s72 offen offset:1024 lds
 v_mfma_f32_32x32x16_bf16 a[96:111], a[176:179], a[164:167], a[96:111]
 ds_read_b64_tr_b16 a[150:151], v199 offset:46848
 ds_read_b64_tr_b16 a[152:153], v202 offset:53248
 v_mfma_f32_32x32x16_bf16 a[48:63], a[180:183], a[160:163], a[48:63]
 ds_read_b64_tr_b16 a[154:155], v202 offset:53760
 ds_read_b64_tr_b16 a[156:157], v202 offset:53504
 v_mfma_f32_32x32x16_bf16 a[112:127], a[180:183], a[164:167], a[112:127]
 ds_read_b64_tr_b16 a[158:159], v202 offset:54016
 buffer_load_dwordx4 v192, s[20:23], s72 offen offset:2048 lds
 v_mfma_f32_32x32x16_bf16 v[64:79], a[184:187], a[160:163], v[64:79]
 v_mfma_f32_32x32x16_bf16 v[96:111], a[184:187], a[164:167], v[96:111]
 v_mfma_f32_32x32x16_bf16 v[80:95], a[188:191], a[160:163], v[80:95]
 buffer_load_dwordx4 v192, s[20:23], s72 offen offset:3072 lds
 s_add_u32 s72, s72, 16384
 v_mfma_f32_32x32x16_bf16 v[112:127], a[188:191], a[164:167], v[112:127]
 s_waitcnt lgkmcnt(11)
 v_mfma_f32_32x32x16_bf16 a[0:15], a[136:139], a[128:131], a[0:15]
 ds_read_b128 a[160:163], v194 offset:28672
 ds_read_b64_tr_b16 a[168:169], v199 offset:49152
 s_waitcnt lgkmcnt(12)
 v_mfma_f32_32x32x16_bf16 a[64:79], a[136:139], a[132:135], a[64:79]
 ds_read_b64_tr_b16 a[170:171], v199 offset:50176
 ds_read_b128 a[164:167], v194 offset:30720
 s_waitcnt lgkmcnt(12)
 v_mfma_f32_32x32x16_bf16 a[16:31], a[140:143], a[128:131], a[16:31]
 ds_read_b64_tr_b16 a[172:173], v199 offset:49408
 ds_read_b64_tr_b16 a[174:175], v199 offset:50432
 s_add_u32 m0, s76, 16384
 s_nop 0
 buffer_load_dwordx4 v18, s[16:19], s73 offen lds
 v_mfma_f32_32x32x16_bf16 a[80:95], a[140:143], a[132:135], a[80:95]
 ds_read_b64_tr_b16 a[176:177], v199 offset:49664
 s_waitcnt lgkmcnt(10)
 ds_read_b64_tr_b16 a[178:179], v199 offset:50688
 v_mfma_f32_32x32x16_bf16 a[32:47], a[144:147], a[128:131], a[32:47]
 ds_read_b64_tr_b16 a[180:181], v199 offset:49920
 ds_read_b64_tr_b16 a[182:183], v199 offset:50944
 v_mfma_f32_32x32x16_bf16 a[96:111], a[144:147], a[132:135], a[96:111]
 ds_read_b64_tr_b16 a[184:185], v202 offset:55296
 ds_read_b64_tr_b16 a[186:187], v202 offset:55808
 buffer_load_dwordx4 v19, s[16:19], s73 offen offset:1024 lds
 s_add_u32 s73, s73, 262144
 v_mfma_f32_32x32x16_bf16 a[48:63], a[148:151], a[128:131], a[48:63]
 s_waitcnt lgkmcnt(10)
 ds_read_b64_tr_b16 a[188:189], v202 offset:55552
 ds_read_b64_tr_b16 a[190:191], v202 offset:56064
 v_mfma_f32_32x32x16_bf16 a[112:127], a[148:151], a[132:135], a[112:127]
 v_mfma_f32_32x32x16_bf16 v[64:79], a[152:155], a[128:131], v[64:79]
 s_add_u32 m0, s77, 24576
 s_nop 0
 buffer_load_dwordx4 v20, s[64:67], s74 offen lds
 s_add_u32 s74, s74, 110592
 v_mfma_f32_32x32x16_bf16 v[96:111], a[152:155], a[132:135], v[96:111]
 v_mfma_f32_32x32x16_bf16 v[80:95], a[156:159], a[128:131], v[80:95]
 v_mfma_f32_32x32x16_bf16 v[112:127], a[156:159], a[132:135], v[112:127]
 s_waitcnt lgkmcnt(11)
 v_mfma_f32_32x32x16_bf16 a[0:15], a[168:171], a[160:163], a[0:15]
 s_waitcnt vmcnt(21)
 s_waitcnt lgkmcnt(0)
 s_barrier
 ds_read_b128 a[128:131], v193 offset:57344
 v_mfma_f32_32x32x16_bf16 a[64:79], a[168:171], a[164:167], a[64:79]
 ds_read_b64_tr_b16 a[136:137], v200 offset:8192
 ds_read_b64_tr_b16 a[138:139], v200 offset:9216
 s_add_u32 m0, s31, 28672
 s_nop 0
 buffer_load_dwordx4 v192, s[20:23], s72 offen offset:0 lds
 v_mfma_f32_32x32x16_bf16 a[16:31], a[172:175], a[160:163], a[16:31]
 ds_read_b128 a[132:135], v193 offset:59392
 ds_read_b64_tr_b16 a[140:141], v200 offset:8448
 v_mfma_f32_32x32x16_bf16 a[80:95], a[172:175], a[164:167], a[80:95]
 ds_read_b64_tr_b16 a[142:143], v200 offset:9472
 ds_read_b64_tr_b16 a[144:145], v200 offset:8704
 v_mfma_f32_32x32x16_bf16 a[32:47], a[176:179], a[160:163], a[32:47]
 ds_read_b64_tr_b16 a[146:147], v200 offset:9728
 ds_read_b64_tr_b16 a[148:149], v200 offset:8960
 buffer_load_dwordx4 v192, s[20:23], s72 offen offset:1024 lds
 v_mfma_f32_32x32x16_bf16 a[96:111], a[176:179], a[164:167], a[96:111]
 ds_read_b64_tr_b16 a[150:151], v200 offset:9984
 ds_read_b64_tr_b16 a[152:153], v203 offset:16384
 v_mfma_f32_32x32x16_bf16 a[48:63], a[180:183], a[160:163], a[48:63]
 ds_read_b64_tr_b16 a[154:155], v203 offset:16896
 ds_read_b64_tr_b16 a[156:157], v203 offset:16640
 v_mfma_f32_32x32x16_bf16 a[112:127], a[180:183], a[164:167], a[112:127]
 ds_read_b64_tr_b16 a[158:159], v203 offset:17152
 buffer_load_dwordx4 v192, s[20:23], s72 offen offset:2048 lds
 v_mfma_f32_32x32x16_bf16 v[64:79], a[184:187], a[160:163], v[64:79]
 v_mfma_f32_32x32x16_bf16 v[96:111], a[184:187], a[164:167], v[96:111]
 v_mfma_f32_32x32x16_bf16 v[80:95], a[188:191], a[160:163], v[80:95]
 buffer_load_dwordx4 v192, s[20:23], s72 offen offset:3072 lds
 s_add_u32 s72, s72, 16384
 v_mfma_f32_32x32x16_bf16 v[112:127], a[188:191], a[164:167], v[112:127]
 s_waitcnt lgkmcnt(11)
 v_mfma_f32_32x32x16_bf16 a[0:15], a[136:139], a[128:131], a[0:15]
 ds_read_b128 a[160:163], v194 offset:57344
 ds_read_b64_tr_b16 a[168:169], v200 offset:12288
 s_waitcnt lgkmcnt(12)
 v_mfma_f32_32x32x16_bf16 a[64:79], a[136:139], a[132:135], a[64:79]
 ds_read_b64_tr_b16 a[170:171], v200 offset:13312
 ds_read_b128 a[164:167], v194 offset:59392
 s_waitcnt lgkmcnt(12)
 v_mfma_f32_32x32x16_bf16 a[16:31], a[140:143], a[128:131], a[16:31]
 ds_read_b64_tr_b16 a[172:173], v200 offset:12544
 ds_read_b64_tr_b16 a[174:175], v200 offset:13568
 s_add_u32 m0, s76, 45056
 s_nop 0
 buffer_load_dwordx4 v18, s[16:19], s73 offen lds
 v_mfma_f32_32x32x16_bf16 a[80:95], a[140:143], a[132:135], a[80:95]
 ds_read_b64_tr_b16 a[176:177], v200 offset:12800
 s_waitcnt lgkmcnt(10)
 ds_read_b64_tr_b16 a[178:179], v200 offset:13824
 v_mfma_f32_32x32x16_bf16 a[32:47], a[144:147], a[128:131], a[32:47]
 ds_read_b64_tr_b16 a[180:181], v200 offset:13056
 ds_read_b64_tr_b16 a[182:183], v200 offset:14080
 v_mfma_f32_32x32x16_bf16 a[96:111], a[144:147], a[132:135], a[96:111]
 ds_read_b64_tr_b16 a[184:185], v203 offset:18432
 ds_read_b64_tr_b16 a[186:187], v203 offset:18944
 buffer_load_dwordx4 v19, s[16:19], s73 offen offset:1024 lds
 s_add_u32 s73, s73, 262144
 v_mfma_f32_32x32x16_bf16 a[48:63], a[148:151], a[128:131], a[48:63]
 s_waitcnt lgkmcnt(10)
 ds_read_b64_tr_b16 a[188:189], v203 offset:18688
 ds_read_b64_tr_b16 a[190:191], v203 offset:19200
 v_mfma_f32_32x32x16_bf16 a[112:127], a[148:151], a[132:135], a[112:127]
 v_mfma_f32_32x32x16_bf16 v[64:79], a[152:155], a[128:131], v[64:79]
 s_add_u32 m0, s77, 53248
 s_nop 0
 buffer_load_dwordx4 v20, s[64:67], s74 offen lds
 s_add_u32 s74, s74, 110592
 v_mfma_f32_32x32x16_bf16 v[96:111], a[152:155], a[132:135], v[96:111]
 v_mfma_f32_32x32x16_bf16 v[80:95], a[156:159], a[128:131], v[80:95]
 v_mfma_f32_32x32x16_bf16 v[112:127], a[156:159], a[132:135], v[112:127]
 s_waitcnt lgkmcnt(11)
 v_mfma_f32_32x32x16_bf16 a[0:15], a[168:171], a[160:163], a[0:15]
 s_waitcnt vmcnt(21)
 s_waitcnt lgkmcnt(0)
 s_barrier
 ds_read_b128 a[128:131], v195 offset:20480
 v_mfma_f32_32x32x16_bf16 a[64:79], a[168:171], a[164:167], a[64:79]
 ds_read_b64_tr_b16 a[136:137], v200 offset:36864
 ds_read_b64_tr_b16 a[138:139], v200 offset:37888
 s_add_u32 m0, s31, 57344
 s_nop 0
 buffer_load_dwordx4 v192, s[20:23], s72 offen offset:0 lds
 v_mfma_f32_32x32x16_bf16 a[16:31], a[172:175], a[160:163], a[16:31]
 ds_read_b128 a[132:135], v195 offset:22528
 ds_read_b64_tr_b16 a[140:141], v200 offset:37120
 v_mfma_f32_32x32x16_bf16 a[80:95], a[172:175], a[164:167], a[80:95]
 ds_read_b64_tr_b16 a[142:143], v200 offset:38144
 ds_read_b64_tr_b16 a[144:145], v200 offset:37376
 v_mfma_f32_32x32x16_bf16 a[32:47], a[176:179], a[160:163], a[32:47]
 ds_read_b64_tr_b16 a[146:147], v200 offset:38400
 ds_read_b64_tr_b16 a[148:149], v200 offset:37632
 buffer_load_dwordx4 v192, s[20:23], s72 offen offset:1024 lds
 v_mfma_f32_32x32x16_bf16 a[96:111], a[176:179], a[164:167], a[96:111]
 ds_read_b64_tr_b16 a[150:151], v200 offset:38656
 ds_read_b64_tr_b16 a[152:153], v203 offset:45056
 v_mfma_f32_32x32x16_bf16 a[48:63], a[180:183], a[160:163], a[48:63]
 ds_read_b64_tr_b16 a[154:155], v203 offset:45568
 ds_read_b64_tr_b16 a[156:157], v203 offset:45312
 v_mfma_f32_32x32x16_bf16 a[112:127], a[180:183], a[164:167], a[112:127]
 ds_read_b64_tr_b16 a[158:159], v203 offset:45824
 buffer_load_dwordx4 v192, s[20:23], s72 offen offset:2048 lds
 v_mfma_f32_32x32x16_bf16 v[64:79], a[184:187], a[160:163], v[64:79]
 v_mfma_f32_32x32x16_bf16 v[96:111], a[184:187], a[164:167], v[96:111]
 v_mfma_f32_32x32x16_bf16 v[80:95], a[188:191], a[160:163], v[80:95]
 buffer_load_dwordx4 v192, s[20:23], s72 offen offset:3072 lds
 s_add_u32 s72, s72, 16384
 v_mfma_f32_32x32x16_bf16 v[112:127], a[188:191], a[164:167], v[112:127]
 s_waitcnt lgkmcnt(11)
 v_mfma_f32_32x32x16_bf16 a[0:15], a[136:139], a[128:131], a[0:15]
 ds_read_b128 a[160:163], v196 offset:20480
 ds_read_b64_tr_b16 a[168:169], v200 offset:40960
 s_waitcnt lgkmcnt(12)
 v_mfma_f32_32x32x16_bf16 a[64:79], a[136:139], a[132:135], a[64:79]
 ds_read_b64_tr_b16 a[170:171], v200 offset:41984
 ds_read_b128 a[164:167], v196 offset:22528
 s_waitcnt lgkmcnt(12)
 v_mfma_f32_32x32x16_bf16 a[16:31], a[140:143], a[128:131], a[16:31]
 ds_read_b64_tr_b16 a[172:173], v200 offset:41216
 ds_read_b64_tr_b16 a[174:175], v200 offset:42240
 s_add_u32 m0, s76, 73728
 s_nop 0
 buffer_load_dwordx4 v18, s[16:19], s73 offen lds
 v_mfma_f32_32x32x16_bf16 a[80:95], a[140:143], a[132:135], a[80:95]
 ds_read_b64_tr_b16 a[176:177], v200 offset:41472
 s_waitcnt lgkmcnt(10)
 ds_read_b64_tr_b16 a[178:179], v200 offset:42496
 v_mfma_f32_32x32x16_bf16 a[32:47], a[144:147], a[128:131], a[32:47]
 ds_read_b64_tr_b16 a[180:181], v200 offset:41728
 ds_read_b64_tr_b16 a[182:183], v200 offset:42752
 v_mfma_f32_32x32x16_bf16 a[96:111], a[144:147], a[132:135], a[96:111]
 ds_read_b64_tr_b16 a[184:185], v203 offset:47104
 ds_read_b64_tr_b16 a[186:187], v203 offset:47616
 buffer_load_dwordx4 v19, s[16:19], s73 offen offset:1024 lds
 s_add_u32 s73, s73, 262144
 v_mfma_f32_32x32x16_bf16 a[48:63], a[148:151], a[128:131], a[48:63]
 s_waitcnt lgkmcnt(10)
 ds_read_b64_tr_b16 a[188:189], v203 offset:47360
 ds_read_b64_tr_b16 a[190:191], v203 offset:47872
 v_mfma_f32_32x32x16_bf16 a[112:127], a[148:151], a[132:135], a[112:127]
 v_mfma_f32_32x32x16_bf16 v[64:79], a[152:155], a[128:131], v[64:79]
 s_add_u32 m0, s77, 81920
 s_nop 0
 buffer_load_dwordx4 v20, s[64:67], s74 offen lds
 s_add_u32 s74, s74, 110592
 v_mfma_f32_32x32x16_bf16 v[96:111], a[152:155], a[132:135], v[96:111]
 v_mfma_f32_32x32x16_bf16 v[80:95], a[156:159], a[128:131], v[80:95]
 v_mfma_f32_32x32x16_bf16 v[112:127], a[156:159], a[132:135], v[112:127]
 s_waitcnt lgkmcnt(11)
 v_mfma_f32_32x32x16_bf16 a[0:15], a[168:171], a[160:163], a[0:15]
 s_waitcnt vmcnt(21)
 s_waitcnt lgkmcnt(0)
 s_barrier
 ds_read_b128 a[128:131], v195 offset:49152
 v_mfma_f32_32x32x16_bf16 a[64:79], a[168:171], a[164:167], a[64:79]
 ds_read_b64_tr_b16 a[136:137], v201 offset:0
 ds_read_b64_tr_b16 a[138:139], v201 offset:1024
 s_add_u32 m0, s31, 86016
 s_nop 0
 buffer_load_dwordx4 v192, s[20:23], s72 offen offset:0 lds
 v_mfma_f32_32x32x16_bf16 a[16:31], a[172:175], a[160:163], a[16:31]
 ds_read_b128 a[132:135], v195 offset:51200
 ds_read_b64_tr_b16 a[140:141], v201 offset:256
 v_mfma_f32_32x32x16_bf16 a[80:95], a[172:175], a[164:167], a[80:95]
 ds_read_b64_tr_b16 a[142:143], v201 offset:1280
 ds_read_b64_tr_b16 a[144:145], v201 offset:512
 v_mfma_f32_32x32x16_bf16 a[32:47], a[176:179], a[160:163], a[32:47]
 ds_read_b64_tr_b16 a[146:147], v201 offset:1536
 ds_read_b64_tr_b16 a[148:149], v201 offset:768
 buffer_load_dwordx4 v192, s[20:23], s72 offen offset:1024 lds
 v_mfma_f32_32x32x16_bf16 a[96:111], a[176:179], a[164:167], a[96:111]
 ds_read_b64_tr_b16 a[150:151], v201 offset:1792
 ds_read_b64_tr_b16 a[152:153], v204 offset:8192
 v_mfma_f32_32x32x16_bf16 a[48:63], a[180:183], a[160:163], a[48:63]
 ds_read_b64_tr_b16 a[154:155], v204 offset:8704
 ds_read_b64_tr_b16 a[156:157], v204 offset:8448
 v_mfma_f32_32x32x16_bf16 a[112:127], a[180:183], a[164:167], a[112:127]
 ds_read_b64_tr_b16 a[158:159], v204 offset:8960
 buffer_load_dwordx4 v192, s[20:23], s72 offen offset:2048 lds
 v_mfma_f32_32x32x16_bf16 v[64:79], a[184:187], a[160:163], v[64:79]
 v_mfma_f32_32x32x16_bf16 v[96:111], a[184:187], a[164:167], v[96:111]
 v_mfma_f32_32x32x16_bf16 v[80:95], a[188:191], a[160:163], v[80:95]
 buffer_load_dwordx4 v192, s[20:23], s72 offen offset:3072 lds
 s_add_u32 s72, s72, 16384
 v_mfma_f32_32x32x16_bf16 v[112:127], a[188:191], a[164:167], v[112:127]
 s_waitcnt lgkmcnt(11)
 v_mfma_f32_32x32x16_bf16 a[0:15], a[136:139], a[128:131], a[0:15]
 ds_read_b128 a[160:163], v196 offset:49152
 ds_read_b64_tr_b16 a[168:169], v201 offset:4096
 s_waitcnt lgkmcnt(12)
 v_mfma_f32_32x32x16_bf16 a[64:79], a[136:139], a[132:135], a[64:79]
 ds_read_b64_tr_b16 a[170:171], v201 offset:5120
 ds_read_b128 a[164:167], v196 offset:51200
 s_waitcnt lgkmcnt(12)
 v_mfma_f32_32x32x16_bf16 a[16:31], a[140:143], a[128:131], a[16:31]
 ds_read_b64_tr_b16 a[172:173], v201 offset:4352
 ds_read_b64_tr_b16 a[174:175], v201 offset:5376
 s_add_u32 m0, s76, 102400
 s_nop 0
 buffer_load_dwordx4 v18, s[16:19], s73 offen lds
 v_mfma_f32_32x32x16_bf16 a[80:95], a[140:143], a[132:135], a[80:95]
 ds_read_b64_tr_b16 a[176:177], v201 offset:4608
 s_waitcnt lgkmcnt(10)
 ds_read_b64_tr_b16 a[178:179], v201 offset:5632
 v_mfma_f32_32x32x16_bf16 a[32:47], a[144:147], a[128:131], a[32:47]
 ds_read_b64_tr_b16 a[180:181], v201 offset:4864
 ds_read_b64_tr_b16 a[182:183], v201 offset:5888
 v_mfma_f32_32x32x16_bf16 a[96:111], a[144:147], a[132:135], a[96:111]
 ds_read_b64_tr_b16 a[184:185], v204 offset:10240
 ds_read_b64_tr_b16 a[186:187], v204 offset:10752
 buffer_load_dwordx4 v19, s[16:19], s73 offen offset:1024 lds
 s_add_u32 s73, s73, 262144
 v_mfma_f32_32x32x16_bf16 a[48:63], a[148:151], a[128:131], a[48:63]
 s_waitcnt lgkmcnt(10)
 ds_read_b64_tr_b16 a[188:189], v204 offset:10496
 ds_read_b64_tr_b16 a[190:191], v204 offset:11008
 v_mfma_f32_32x32x16_bf16 a[112:127], a[148:151], a[132:135], a[112:127]
 v_mfma_f32_32x32x16_bf16 v[64:79], a[152:155], a[128:131], v[64:79]
 s_add_u32 m0, s77, 110592
 s_nop 0
 buffer_load_dwordx4 v20, s[64:67], s74 offen lds
 s_add_u32 s74, s74, 110592
 v_mfma_f32_32x32x16_bf16 v[96:111], a[152:155], a[132:135], v[96:111]
 v_mfma_f32_32x32x16_bf16 v[80:95], a[156:159], a[128:131], v[80:95]
 v_mfma_f32_32x32x16_bf16 v[112:127], a[156:159], a[132:135], v[112:127]
 s_waitcnt lgkmcnt(11)
 v_mfma_f32_32x32x16_bf16 a[0:15], a[168:171], a[160:163], a[0:15]
 s_waitcnt vmcnt(21)
 s_waitcnt lgkmcnt(0)
 s_barrier
 ds_read_b128 a[128:131], v193 offset:0
 v_mfma_f32_32x32x16_bf16 a[64:79], a[168:171], a[164:167], a[64:79]
 ds_read_b64_tr_b16 a[136:137], v199 offset:16384
 ds_read_b64_tr_b16 a[138:139], v199 offset:17408
 s_add_u32 m0, s31, 114688
 s_nop 0
 buffer_load_dwordx4 v192, s[20:23], s72 offen offset:0 lds
 v_mfma_f32_32x32x16_bf16 a[16:31], a[172:175], a[160:163], a[16:31]
 ds_read_b128 a[132:135], v193 offset:2048
 ds_read_b64_tr_b16 a[140:141], v199 offset:16640
 v_mfma_f32_32x32x16_bf16 a[80:95], a[172:175], a[164:167], a[80:95]
 ds_read_b64_tr_b16 a[142:143], v199 offset:17664
 ds_read_b64_tr_b16 a[144:145], v199 offset:16896
 v_mfma_f32_32x32x16_bf16 a[32:47], a[176:179], a[160:163], a[32:47]
 ds_read_b64_tr_b16 a[146:147], v199 offset:17920
 ds_read_b64_tr_b16 a[148:149], v199 offset:17152
 buffer_load_dwordx4 v192, s[20:23], s72 offen offset:1024 lds
 v_mfma_f32_32x32x16_bf16 a[96:111], a[176:179], a[164:167], a[96:111]
 ds_read_b64_tr_b16 a[150:151], v199 offset:18176
 ds_read_b64_tr_b16 a[152:153], v202 offset:24576
 v_mfma_f32_32x32x16_bf16 a[48:63], a[180:183], a[160:163], a[48:63]
 ds_read_b64_tr_b16 a[154:155], v202 offset:25088
 ds_read_b64_tr_b16 a[156:157], v202 offset:24832
 v_mfma_f32_32x32x16_bf16 a[112:127], a[180:183], a[164:167], a[112:127]
 ds_read_b64_tr_b16 a[158:159], v202 offset:25344
 buffer_load_dwordx4 v192, s[20:23], s72 offen offset:2048 lds
 v_mfma_f32_32x32x16_bf16 v[64:79], a[184:187], a[160:163], v[64:79]
 v_mfma_f32_32x32x16_bf16 v[96:111], a[184:187], a[164:167], v[96:111]
 v_mfma_f32_32x32x16_bf16 v[80:95], a[188:191], a[160:163], v[80:95]
 buffer_load_dwordx4 v192, s[20:23], s72 offen offset:3072 lds
 s_add_u32 s72, s72, 16384
 v_mfma_f32_32x32x16_bf16 v[112:127], a[188:191], a[164:167], v[112:127]
 s_waitcnt lgkmcnt(11)
 v_mfma_f32_32x32x16_bf16 a[0:15], a[136:139], a[128:131], a[0:15]
 ds_read_b128 a[160:163], v194 offset:0
 ds_read_b64_tr_b16 a[168:169], v199 offset:20480
 s_waitcnt lgkmcnt(12)
 v_mfma_f32_32x32x16_bf16 a[64:79], a[136:139], a[132:135], a[64:79]
 ds_read_b64_tr_b16 a[170:171], v199 offset:21504
 ds_read_b128 a[164:167], v194 offset:2048
 s_waitcnt lgkmcnt(12)
 v_mfma_f32_32x32x16_bf16 a[16:31], a[140:143], a[128:131], a[16:31]
 ds_read_b64_tr_b16 a[172:173], v199 offset:20736
 ds_read_b64_tr_b16 a[174:175], v199 offset:21760
 s_add_u32 m0, s76, 131072
 s_nop 0
 buffer_load_dwordx4 v18, s[16:19], s73 offen lds
 v_mfma_f32_32x32x16_bf16 a[80:95], a[140:143], a[132:135], a[80:95]
 ds_read_b64_tr_b16 a[176:177], v199 offset:20992
 s_waitcnt lgkmcnt(10)
 ds_read_b64_tr_b16 a[178:179], v199 offset:22016
 v_mfma_f32_32x32x16_bf16 a[32:47], a[144:147], a[128:131], a[32:47]
 ds_read_b64_tr_b16 a[180:181], v199 offset:21248
 ds_read_b64_tr_b16 a[182:183], v199 offset:22272
 v_mfma_f32_32x32x16_bf16 a[96:111], a[144:147], a[132:135], a[96:111]
 ds_read_b64_tr_b16 a[184:185], v202 offset:26624
 ds_read_b64_tr_b16 a[186:187], v202 offset:27136
 buffer_load_dwordx4 v19, s[16:19], s73 offen offset:1024 lds
 s_add_u32 s73, s73, 262144
 v_mfma_f32_32x32x16_bf16 a[48:63], a[148:151], a[128:131], a[48:63]
 s_waitcnt lgkmcnt(10)
 ds_read_b64_tr_b16 a[188:189], v202 offset:26880
 ds_read_b64_tr_b16 a[190:191], v202 offset:27392
 v_mfma_f32_32x32x16_bf16 a[112:127], a[148:151], a[132:135], a[112:127]
 v_mfma_f32_32x32x16_bf16 v[64:79], a[152:155], a[128:131], v[64:79]
 s_add_u32 m0, s77, 139264
 s_nop 0
 buffer_load_dwordx4 v20, s[64:67], s74 offen lds
 s_add_u32 s74, s74, 110592
 v_mfma_f32_32x32x16_bf16 v[96:111], a[152:155], a[132:135], v[96:111]
 v_mfma_f32_32x32x16_bf16 v[80:95], a[156:159], a[128:131], v[80:95]
 v_mfma_f32_32x32x16_bf16 v[112:127], a[156:159], a[132:135], v[112:127]
 s_waitcnt lgkmcnt(11)
 v_mfma_f32_32x32x16_bf16 a[0:15], a[168:171], a[160:163], a[0:15]
 s_waitcnt vmcnt(21)
 s_waitcnt lgkmcnt(0)
 s_barrier
 ds_read_b128 a[128:131], v193 offset:28672
 v_mfma_f32_32x32x16_bf16 a[64:79], a[168:171], a[164:167], a[64:79]
 ds_read_b64_tr_b16 a[136:137], v199 offset:45056
 ds_read_b64_tr_b16 a[138:139], v199 offset:46080
 s_add_u32 m0, s31, 0
 s_nop 0
 buffer_load_dwordx4 v192, s[20:23], s72 offen offset:0 lds
 v_mfma_f32_32x32x16_bf16 a[16:31], a[172:175], a[160:163], a[16:31]
 ds_read_b128 a[132:135], v193 offset:30720
 ds_read_b64_tr_b16 a[140:141], v199 offset:45312
 v_mfma_f32_32x32x16_bf16 a[80:95], a[172:175], a[164:167], a[80:95]
 ds_read_b64_tr_b16 a[142:143], v199 offset:46336
 ds_read_b64_tr_b16 a[144:145], v199 offset:45568
 v_mfma_f32_32x32x16_bf16 a[32:47], a[176:179], a[160:163], a[32:47]
 ds_read_b64_tr_b16 a[146:147], v199 offset:46592
 ds_read_b64_tr_b16 a[148:149], v199 offset:45824
 buffer_load_dwordx4 v192, s[20:23], s72 offen offset:1024 lds
 v_mfma_f32_32x32x16_bf16 a[96:111], a[176:179], a[164:167], a[96:111]
 ds_read_b64_tr_b16 a[150:151], v199 offset:46848
 ds_read_b64_tr_b16 a[152:153], v202 offset:53248
 v_mfma_f32_32x32x16_bf16 a[48:63], a[180:183], a[160:163], a[48:63]
 ds_read_b64_tr_b16 a[154:155], v202 offset:53760
 ds_read_b64_tr_b16 a[156:157], v202 offset:53504
 v_mfma_f32_32x32x16_bf16 a[112:127], a[180:183], a[164:167], a[112:127]
 ds_read_b64_tr_b16 a[158:159], v202 offset:54016
 buffer_load_dwordx4 v192, s[20:23], s72 offen offset:2048 lds
 v_mfma_f32_32x32x16_bf16 v[64:79], a[184:187], a[160:163], v[64:79]
 v_mfma_f32_32x32x16_bf16 v[96:111], a[184:187], a[164:167], v[96:111]
 v_mfma_f32_32x32x16_bf16 v[80:95], a[188:191], a[160:163], v[80:95]
 buffer_load_dwordx4 v192, s[20:23], s72 offen offset:3072 lds
 s_add_u32 s72, s72, 16384
 v_mfma_f32_32x32x16_bf16 v[112:127], a[188:191], a[164:167], v[112:127]
 s_waitcnt lgkmcnt(11)
 v_mfma_f32_32x32x16_bf16 a[0:15], a[136:139], a[128:131], a[0:15]
 ds_read_b128 a[160:163], v194 offset:28672
 ds_read_b64_tr_b16 a[168:169], v199 offset:49152
 s_waitcnt lgkmcnt(12)
 v_mfma_f32_32x32x16_bf16 a[64:79], a[136:139], a[132:135], a[64:79]
 ds_read_b64_tr_b16 a[170:171], v199 offset:50176
 ds_read_b128 a[164:167], v194 offset:30720
 s_waitcnt lgkmcnt(12)
 v_mfma_f32_32x32x16_bf16 a[16:31], a[140:143], a[128:131], a[16:31]
 ds_read_b64_tr_b16 a[172:173], v199 offset:49408
 ds_read_b64_tr_b16 a[174:175], v199 offset:50432
 s_add_u32 m0, s76, 16384
 s_nop 0
 buffer_load_dwordx4 v18, s[16:19], s73 offen lds
 v_mfma_f32_32x32x16_bf16 a[80:95], a[140:143], a[132:135], a[80:95]
 ds_read_b64_tr_b16 a[176:177], v199 offset:49664
 s_waitcnt lgkmcnt(10)
 ds_read_b64_tr_b16 a[178:179], v199 offset:50688
 v_mfma_f32_32x32x16_bf16 a[32:47], a[144:147], a[128:131], a[32:47]
 ds_read_b64_tr_b16 a[180:181], v199 offset:49920
 ds_read_b64_tr_b16 a[182:183], v199 offset:50944
 v_mfma_f32_32x32x16_bf16 a[96:111], a[144:147], a[132:135], a[96:111]
 ds_read_b64_tr_b16 a[184:185], v202 offset:55296
 ds_read_b64_tr_b16 a[186:187], v202 offset:55808
 buffer_load_dwordx4 v19, s[16:19], s73 offen offset:1024 lds
 s_add_u32 s73, s73, 262144
 v_mfma_f32_32x32x16_bf16 a[48:63], a[148:151], a[128:131], a[48:63]
 s_waitcnt lgkmcnt(10)
 ds_read_b64_tr_b16 a[188:189], v202 offset:55552
 ds_read_b64_tr_b16 a[190:191], v202 offset:56064
 v_mfma_f32_32x32x16_bf16 a[112:127], a[148:151], a[132:135], a[112:127]
 v_mfma_f32_32x32x16_bf16 v[64:79], a[152:155], a[128:131], v[64:79]
 s_add_u32 m0, s77, 24576
 s_nop 0
 buffer_load_dwordx4 v20, s[64:67], s74 offen lds
 s_add_u32 s74, s74, 110592
 v_mfma_f32_32x32x16_bf16 v[96:111], a[152:155], a[132:135], v[96:111]
 v_mfma_f32_32x32x16_bf16 v[80:95], a[156:159], a[128:131], v[80:95]
 v_mfma_f32_32x32x16_bf16 v[112:127], a[156:159], a[132:135], v[112:127]
 s_waitcnt lgkmcnt(11)
 v_mfma_f32_32x32x16_bf16 a[0:15], a[168:171], a[160:163], a[0:15]
 s_waitcnt vmcnt(21)
 s_waitcnt lgkmcnt(0)
 s_barrier
 ds_read_b128 a[128:131], v193 offset:57344
 v_mfma_f32_32x32x16_bf16 a[64:79], a[168:171], a[164:167], a[64:79]
 ds_read_b64_tr_b16 a[136:137], v200 offset:8192
 ds_read_b64_tr_b16 a[138:139], v200 offset:9216
 s_add_u32 m0, s31, 28672
 s_nop 0
 buffer_load_dwordx4 v192, s[20:23], s72 offen offset:0 lds
 v_mfma_f32_32x32x16_bf16 a[16:31], a[172:175], a[160:163], a[16:31]
 ds_read_b128 a[132:135], v193 offset:59392
 ds_read_b64_tr_b16 a[140:141], v200 offset:8448
 v_mfma_f32_32x32x16_bf16 a[80:95], a[172:175], a[164:167], a[80:95]
 ds_read_b64_tr_b16 a[142:143], v200 offset:9472
 ds_read_b64_tr_b16 a[144:145], v200 offset:8704
 v_mfma_f32_32x32x16_bf16 a[32:47], a[176:179], a[160:163], a[32:47]
 ds_read_b64_tr_b16 a[146:147], v200 offset:9728
 ds_read_b64_tr_b16 a[148:149], v200 offset:8960
 buffer_load_dwordx4 v192, s[20:23], s72 offen offset:1024 lds
 v_mfma_f32_32x32x16_bf16 a[96:111], a[176:179], a[164:167], a[96:111]
 ds_read_b64_tr_b16 a[150:151], v200 offset:9984
 ds_read_b64_tr_b16 a[152:153], v203 offset:16384
 v_mfma_f32_32x32x16_bf16 a[48:63], a[180:183], a[160:163], a[48:63]
 ds_read_b64_tr_b16 a[154:155], v203 offset:16896
 ds_read_b64_tr_b16 a[156:157], v203 offset:16640
 v_mfma_f32_32x32x16_bf16 a[112:127], a[180:183], a[164:167], a[112:127]
 ds_read_b64_tr_b16 a[158:159], v203 offset:17152
 buffer_load_dwordx4 v192, s[20:23], s72 offen offset:2048 lds
 v_mfma_f32_32x32x16_bf16 v[64:79], a[184:187], a[160:163], v[64:79]
 v_mfma_f32_32x32x16_bf16 v[96:111], a[184:187], a[164:167], v[96:111]
 v_mfma_f32_32x32x16_bf16 v[80:95], a[188:191], a[160:163], v[80:95]
 buffer_load_dwordx4 v192, s[20:23], s72 offen offset:3072 lds
 s_add_u32 s72, s72, 16384
 v_mfma_f32_32x32x16_bf16 v[112:127], a[188:191], a[164:167], v[112:127]
 s_waitcnt lgkmcnt(11)
 v_mfma_f32_32x32x16_bf16 a[0:15], a[136:139], a[128:131], a[0:15]
 ds_read_b128 a[160:163], v194 offset:57344
 ds_read_b64_tr_b16 a[168:169], v200 offset:12288
 s_waitcnt lgkmcnt(12)
 v_mfma_f32_32x32x16_bf16 a[64:79], a[136:139], a[132:135], a[64:79]
 ds_read_b64_tr_b16 a[170:171], v200 offset:13312
 ds_read_b128 a[164:167], v194 offset:59392
 s_waitcnt lgkmcnt(12)
 v_mfma_f32_32x32x16_bf16 a[16:31], a[140:143], a[128:131], a[16:31]
 ds_read_b64_tr_b16 a[172:173], v200 offset:12544
 ds_read_b64_tr_b16 a[174:175], v200 offset:13568
 s_add_u32 m0, s76, 45056
 s_nop 0
 buffer_load_dwordx4 v18, s[16:19], s73 offen lds
 v_mfma_f32_32x32x16_bf16 a[80:95], a[140:143], a[132:135], a[80:95]
 ds_read_b64_tr_b16 a[176:177], v200 offset:12800
 s_waitcnt lgkmcnt(10)
 ds_read_b64_tr_b16 a[178:179], v200 offset:13824
 v_mfma_f32_32x32x16_bf16 a[32:47], a[144:147], a[128:131], a[32:47]
 ds_read_b64_tr_b16 a[180:181], v200 offset:13056
 ds_read_b64_tr_b16 a[182:183], v200 offset:14080
 v_mfma_f32_32x32x16_bf16 a[96:111], a[144:147], a[132:135], a[96:111]
 ds_read_b64_tr_b16 a[184:185], v203 offset:18432
 ds_read_b64_tr_b16 a[186:187], v203 offset:18944
 buffer_load_dwordx4 v19, s[16:19], s73 offen offset:1024 lds
 s_add_u32 s73, s73, 262144
 v_mfma_f32_32x32x16_bf16 a[48:63], a[148:151], a[128:131], a[48:63]
 s_waitcnt lgkmcnt(10)
 ds_read_b64_tr_b16 a[188:189], v203 offset:18688
 ds_read_b64_tr_b16 a[190:191], v203 offset:19200
 v_mfma_f32_32x32x16_bf16 a[112:127], a[148:151], a[132:135], a[112:127]
 v_mfma_f32_32x32x16_bf16 v[64:79], a[152:155], a[128:131], v[64:79]
 s_add_u32 m0, s77, 53248
 s_nop 0
 buffer_load_dwordx4 v20, s[64:67], s74 offen lds
 s_add_u32 s74, s74, 110592
 v_mfma_f32_32x32x16_bf16 v[96:111], a[152:155], a[132:135], v[96:111]
 v_mfma_f32_32x32x16_bf16 v[80:95], a[156:159], a[128:131], v[80:95]
 v_mfma_f32_32x32x16_bf16 v[112:127], a[156:159], a[132:135], v[112:127]
 s_waitcnt lgkmcnt(11)
 v_mfma_f32_32x32x16_bf16 a[0:15], a[168:171], a[160:163], a[0:15]
 s_waitcnt vmcnt(21)
 s_waitcnt lgkmcnt(0)
 s_barrier
 ds_read_b128 a[128:131], v195 offset:20480
 v_mfma_f32_32x32x16_bf16 a[64:79], a[168:171], a[164:167], a[64:79]
 ds_read_b64_tr_b16 a[136:137], v200 offset:36864
 ds_read_b64_tr_b16 a[138:139], v200 offset:37888
 s_add_u32 m0, s31, 57344
 s_nop 0
 buffer_load_dwordx4 v192, s[20:23], s72 offen offset:0 lds
 v_mfma_f32_32x32x16_bf16 a[16:31], a[172:175], a[160:163], a[16:31]
 ds_read_b128 a[132:135], v195 offset:22528
 ds_read_b64_tr_b16 a[140:141], v200 offset:37120
 v_mfma_f32_32x32x16_bf16 a[80:95], a[172:175], a[164:167], a[80:95]
 ds_read_b64_tr_b16 a[142:143], v200 offset:38144
 ds_read_b64_tr_b16 a[144:145], v200 offset:37376
 v_mfma_f32_32x32x16_bf16 a[32:47], a[176:179], a[160:163], a[32:47]
 ds_read_b64_tr_b16 a[146:147], v200 offset:38400
 ds_read_b64_tr_b16 a[148:149], v200 offset:37632
 buffer_load_dwordx4 v192, s[20:23], s72 offen offset:1024 lds
 v_mfma_f32_32x32x16_bf16 a[96:111], a[176:179], a[164:167], a[96:111]
 ds_read_b64_tr_b16 a[150:151], v200 offset:38656
 ds_read_b64_tr_b16 a[152:153], v203 offset:45056
 v_mfma_f32_32x32x16_bf16 a[48:63], a[180:183], a[160:163], a[48:63]
 ds_read_b64_tr_b16 a[154:155], v203 offset:45568
 ds_read_b64_tr_b16 a[156:157], v203 offset:45312
 v_mfma_f32_32x32x16_bf16 a[112:127], a[180:183], a[164:167], a[112:127]
 ds_read_b64_tr_b16 a[158:159], v203 offset:45824
 buffer_load_dwordx4 v192, s[20:23], s72 offen offset:2048 lds
 v_mfma_f32_32x32x16_bf16 v[64:79], a[184:187], a[160:163], v[64:79]
 v_mfma_f32_32x32x16_bf16 v[96:111], a[184:187], a[164:167], v[96:111]
 v_mfma_f32_32x32x16_bf16 v[80:95], a[188:191], a[160:163], v[80:95]
 buffer_load_dwordx4 v192, s[20:23], s72 offen offset:3072 lds
 s_add_u32 s72, s72, 16384
 v_mfma_f32_32x32x16_bf16 v[112:127], a[188:191], a[164:167], v[112:127]
 s_waitcnt lgkmcnt(11)
 v_mfma_f32_32x32x16_bf16 a[0:15], a[136:139], a[128:131], a[0:15]
 ds_read_b128 a[160:163], v196 offset:20480
 ds_read_b64_tr_b16 a[168:169], v200 offset:40960
 s_waitcnt lgkmcnt(12)
 v_mfma_f32_32x32x16_bf16 a[64:79], a[136:139], a[132:135], a[64:79]
 ds_read_b64_tr_b16 a[170:171], v200 offset:41984
 ds_read_b128 a[164:167], v196 offset:22528
 s_waitcnt lgkmcnt(12)
 v_mfma_f32_32x32x16_bf16 a[16:31], a[140:143], a[128:131], a[16:31]
 ds_read_b64_tr_b16 a[172:173], v200 offset:41216
 ds_read_b64_tr_b16 a[174:175], v200 offset:42240
 s_add_u32 m0, s76, 73728
 s_nop 0
 buffer_load_dwordx4 v18, s[16:19], s73 offen lds
 v_mfma_f32_32x32x16_bf16 a[80:95], a[140:143], a[132:135], a[80:95]
 ds_read_b64_tr_b16 a[176:177], v200 offset:41472
 s_waitcnt lgkmcnt(10)
 ds_read_b64_tr_b16 a[178:179], v200 offset:42496
 v_mfma_f32_32x32x16_bf16 a[32:47], a[144:147], a[128:131], a[32:47]
 ds_read_b64_tr_b16 a[180:181], v200 offset:41728
 ds_read_b64_tr_b16 a[182:183], v200 offset:42752
 v_mfma_f32_32x32x16_bf16 a[96:111], a[144:147], a[132:135], a[96:111]
 ds_read_b64_tr_b16 a[184:185], v203 offset:47104
 ds_read_b64_tr_b16 a[186:187], v203 offset:47616
 buffer_load_dwordx4 v19, s[16:19], s73 offen offset:1024 lds
 s_add_u32 s73, s73, 262144
 v_mfma_f32_32x32x16_bf16 a[48:63], a[148:151], a[128:131], a[48:63]
 s_waitcnt lgkmcnt(10)
 ds_read_b64_tr_b16 a[188:189], v203 offset:47360
 ds_read_b64_tr_b16 a[190:191], v203 offset:47872
 v_mfma_f32_32x32x16_bf16 a[112:127], a[148:151], a[132:135], a[112:127]
 v_mfma_f32_32x32x16_bf16 v[64:79], a[152:155], a[128:131], v[64:79]
 s_add_u32 m0, s77, 81920
 s_nop 0
 buffer_load_dwordx4 v20, s[64:67], s74 offen lds
 s_add_u32 s74, s74, 110592
 v_mfma_f32_32x32x16_bf16 v[96:111], a[152:155], a[132:135], v[96:111]
 v_mfma_f32_32x32x16_bf16 v[80:95], a[156:159], a[128:131], v[80:95]
 v_mfma_f32_32x32x16_bf16 v[112:127], a[156:159], a[132:135], v[112:127]
 s_waitcnt lgkmcnt(11)
 v_mfma_f32_32x32x16_bf16 a[0:15], a[168:171], a[160:163], a[0:15]
 s_waitcnt vmcnt(21)
 s_waitcnt lgkmcnt(0)
 s_barrier
 ds_read_b128 a[128:131], v195 offset:49152
 v_mfma_f32_32x32x16_bf16 a[64:79], a[168:171], a[164:167], a[64:79]
 ds_read_b64_tr_b16 a[136:137], v201 offset:0
 ds_read_b64_tr_b16 a[138:139], v201 offset:1024
 s_add_u32 m0, s31, 86016
 s_nop 0
 buffer_load_dwordx4 v192, s[20:23], s72 offen offset:0 lds
 v_mfma_f32_32x32x16_bf16 a[16:31], a[172:175], a[160:163], a[16:31]
 ds_read_b128 a[132:135], v195 offset:51200
 ds_read_b64_tr_b16 a[140:141], v201 offset:256
 v_mfma_f32_32x32x16_bf16 a[80:95], a[172:175], a[164:167], a[80:95]
 ds_read_b64_tr_b16 a[142:143], v201 offset:1280
 ds_read_b64_tr_b16 a[144:145], v201 offset:512
 v_mfma_f32_32x32x16_bf16 a[32:47], a[176:179], a[160:163], a[32:47]
 ds_read_b64_tr_b16 a[146:147], v201 offset:1536
 ds_read_b64_tr_b16 a[148:149], v201 offset:768
 buffer_load_dwordx4 v192, s[20:23], s72 offen offset:1024 lds
 v_mfma_f32_32x32x16_bf16 a[96:111], a[176:179], a[164:167], a[96:111]
 ds_read_b64_tr_b16 a[150:151], v201 offset:1792
 ds_read_b64_tr_b16 a[152:153], v204 offset:8192
 v_mfma_f32_32x32x16_bf16 a[48:63], a[180:183], a[160:163], a[48:63]
 ds_read_b64_tr_b16 a[154:155], v204 offset:8704
 ds_read_b64_tr_b16 a[156:157], v204 offset:8448
 v_mfma_f32_32x32x16_bf16 a[112:127], a[180:183], a[164:167], a[112:127]
 ds_read_b64_tr_b16 a[158:159], v204 offset:8960
 buffer_load_dwordx4 v192, s[20:23], s72 offen offset:2048 lds
 v_mfma_f32_32x32x16_bf16 v[64:79], a[184:187], a[160:163], v[64:79]
 v_mfma_f32_32x32x16_bf16 v[96:111], a[184:187], a[164:167], v[96:111]
 v_mfma_f32_32x32x16_bf16 v[80:95], a[188:191], a[160:163], v[80:95]
 buffer_load_dwordx4 v192, s[20:23], s72 offen offset:3072 lds
 s_add_u32 s72, s72, 16384
 v_mfma_f32_32x32x16_bf16 v[112:127], a[188:191], a[164:167], v[112:127]
 s_waitcnt lgkmcnt(11)
 v_mfma_f32_32x32x16_bf16 a[0:15], a[136:139], a[128:131], a[0:15]
 ds_read_b128 a[160:163], v196 offset:49152
 ds_read_b64_tr_b16 a[168:169], v201 offset:4096
 s_waitcnt lgkmcnt(12)
 v_mfma_f32_32x32x16_bf16 a[64:79], a[136:139], a[132:135], a[64:79]
 ds_read_b64_tr_b16 a[170:171], v201 offset:5120
 ds_read_b128 a[164:167], v196 offset:51200
 s_waitcnt lgkmcnt(12)
 v_mfma_f32_32x32x16_bf16 a[16:31], a[140:143], a[128:131], a[16:31]
 ds_read_b64_tr_b16 a[172:173], v201 offset:4352
 ds_read_b64_tr_b16 a[174:175], v201 offset:5376
 s_add_u32 m0, s76, 102400
 s_nop 0
 buffer_load_dwordx4 v18, s[16:19], s73 offen lds
 v_mfma_f32_32x32x16_bf16 a[80:95], a[140:143], a[132:135], a[80:95]
 ds_read_b64_tr_b16 a[176:177], v201 offset:4608
 s_waitcnt lgkmcnt(10)
 ds_read_b64_tr_b16 a[178:179], v201 offset:5632
 v_mfma_f32_32x32x16_bf16 a[32:47], a[144:147], a[128:131], a[32:47]
 ds_read_b64_tr_b16 a[180:181], v201 offset:4864
 ds_read_b64_tr_b16 a[182:183], v201 offset:5888
 v_mfma_f32_32x32x16_bf16 a[96:111], a[144:147], a[132:135], a[96:111]
 ds_read_b64_tr_b16 a[184:185], v204 offset:10240
 ds_read_b64_tr_b16 a[186:187], v204 offset:10752
 buffer_load_dwordx4 v19, s[16:19], s73 offen offset:1024 lds
 s_add_u32 s73, s73, 262144
 v_mfma_f32_32x32x16_bf16 a[48:63], a[148:151], a[128:131], a[48:63]
 s_waitcnt lgkmcnt(10)
 ds_read_b64_tr_b16 a[188:189], v204 offset:10496
 ds_read_b64_tr_b16 a[190:191], v204 offset:11008
 v_mfma_f32_32x32x16_bf16 a[112:127], a[148:151], a[132:135], a[112:127]
 v_mfma_f32_32x32x16_bf16 v[64:79], a[152:155], a[128:131], v[64:79]
 s_add_u32 m0, s77, 110592
 s_nop 0
 buffer_load_dwordx4 v20, s[64:67], s74 offen lds
 s_add_u32 s74, s74, 110592
 v_mfma_f32_32x32x16_bf16 v[96:111], a[152:155], a[132:135], v[96:111]
 v_mfma_f32_32x32x16_bf16 v[80:95], a[156:159], a[128:131], v[80:95]
 v_mfma_f32_32x32x16_bf16 v[112:127], a[156:159], a[132:135], v[112:127]
 s_waitcnt lgkmcnt(11)
 v_mfma_f32_32x32x16_bf16 a[0:15], a[168:171], a[160:163], a[0:15]
 s_waitcnt vmcnt(21)
 s_waitcnt lgkmcnt(0)
 s_barrier
 ds_read_b128 a[128:131], v193 offset:0
 v_mfma_f32_32x32x16_bf16 a[64:79], a[168:171], a[164:167], a[64:79]
 ds_read_b64_tr_b16 a[136:137], v199 offset:16384
 ds_read_b64_tr_b16 a[138:139], v199 offset:17408
 s_add_u32 m0, s31, 114688
 s_nop 0
 buffer_load_dwordx4 v192, s[20:23], s72 offen offset:0 lds
 v_mfma_f32_32x32x16_bf16 a[16:31], a[172:175], a[160:163], a[16:31]
 ds_read_b128 a[132:135], v193 offset:2048
 ds_read_b64_tr_b16 a[140:141], v199 offset:16640
 v_mfma_f32_32x32x16_bf16 a[80:95], a[172:175], a[164:167], a[80:95]
 ds_read_b64_tr_b16 a[142:143], v199 offset:17664
 ds_read_b64_tr_b16 a[144:145], v199 offset:16896
 v_mfma_f32_32x32x16_bf16 a[32:47], a[176:179], a[160:163], a[32:47]
 ds_read_b64_tr_b16 a[146:147], v199 offset:17920
 ds_read_b64_tr_b16 a[148:149], v199 offset:17152
 buffer_load_dwordx4 v192, s[20:23], s72 offen offset:1024 lds
 v_mfma_f32_32x32x16_bf16 a[96:111], a[176:179], a[164:167], a[96:111]
 ds_read_b64_tr_b16 a[150:151], v199 offset:18176
 ds_read_b64_tr_b16 a[152:153], v202 offset:24576
 v_mfma_f32_32x32x16_bf16 a[48:63], a[180:183], a[160:163], a[48:63]
 ds_read_b64_tr_b16 a[154:155], v202 offset:25088
 ds_read_b64_tr_b16 a[156:157], v202 offset:24832
 v_mfma_f32_32x32x16_bf16 a[112:127], a[180:183], a[164:167], a[112:127]
 ds_read_b64_tr_b16 a[158:159], v202 offset:25344
 buffer_load_dwordx4 v192, s[20:23], s72 offen offset:2048 lds
 v_mfma_f32_32x32x16_bf16 v[64:79], a[184:187], a[160:163], v[64:79]
 v_mfma_f32_32x32x16_bf16 v[96:111], a[184:187], a[164:167], v[96:111]
 v_mfma_f32_32x32x16_bf16 v[80:95], a[188:191], a[160:163], v[80:95]
 buffer_load_dwordx4 v192, s[20:23], s72 offen offset:3072 lds
 s_add_u32 s72, s72, 16384
 v_mfma_f32_32x32x16_bf16 v[112:127], a[188:191], a[164:167], v[112:127]
 s_waitcnt lgkmcnt(11)
 v_mfma_f32_32x32x16_bf16 a[0:15], a[136:139], a[128:131], a[0:15]
 ds_read_b128 a[160:163], v194 offset:0
 ds_read_b64_tr_b16 a[168:169], v199 offset:20480
 s_waitcnt lgkmcnt(12)
 v_mfma_f32_32x32x16_bf16 a[64:79], a[136:139], a[132:135], a[64:79]
 ds_read_b64_tr_b16 a[170:171], v199 offset:21504
 ds_read_b128 a[164:167], v194 offset:2048
 s_waitcnt lgkmcnt(12)
 v_mfma_f32_32x32x16_bf16 a[16:31], a[140:143], a[128:131], a[16:31]
 ds_read_b64_tr_b16 a[172:173], v199 offset:20736
 ds_read_b64_tr_b16 a[174:175], v199 offset:21760
 s_add_u32 m0, s76, 131072
 s_nop 0
 buffer_load_dwordx4 v18, s[16:19], s73 offen lds
 v_mfma_f32_32x32x16_bf16 a[80:95], a[140:143], a[132:135], a[80:95]
 ds_read_b64_tr_b16 a[176:177], v199 offset:20992
 s_waitcnt lgkmcnt(10)
 ds_read_b64_tr_b16 a[178:179], v199 offset:22016
 v_mfma_f32_32x32x16_bf16 a[32:47], a[144:147], a[128:131], a[32:47]
 ds_read_b64_tr_b16 a[180:181], v199 offset:21248
 ds_read_b64_tr_b16 a[182:183], v199 offset:22272
 v_mfma_f32_32x32x16_bf16 a[96:111], a[144:147], a[132:135], a[96:111]
 ds_read_b64_tr_b16 a[184:185], v202 offset:26624
 ds_read_b64_tr_b16 a[186:187], v202 offset:27136
 buffer_load_dwordx4 v19, s[16:19], s73 offen offset:1024 lds
 s_add_u32 s73, s73, 262144
 v_mfma_f32_32x32x16_bf16 a[48:63], a[148:151], a[128:131], a[48:63]
 s_waitcnt lgkmcnt(10)
 ds_read_b64_tr_b16 a[188:189], v202 offset:26880
 ds_read_b64_tr_b16 a[190:191], v202 offset:27392
 v_mfma_f32_32x32x16_bf16 a[112:127], a[148:151], a[132:135], a[112:127]
 v_mfma_f32_32x32x16_bf16 v[64:79], a[152:155], a[128:131], v[64:79]
 s_add_u32 m0, s77, 139264
 s_nop 0
 buffer_load_dwordx4 v20, s[64:67], s74 offen lds
 s_add_u32 s74, s74, 110592
 v_mfma_f32_32x32x16_bf16 v[96:111], a[152:155], a[132:135], v[96:111]
 v_mfma_f32_32x32x16_bf16 v[80:95], a[156:159], a[128:131], v[80:95]
 v_mfma_f32_32x32x16_bf16 v[112:127], a[156:159], a[132:135], v[112:127]
 s_waitcnt lgkmcnt(11)
 v_mfma_f32_32x32x16_bf16 a[0:15], a[168:171], a[160:163], a[0:15]
 s_waitcnt vmcnt(21)
 s_waitcnt lgkmcnt(0)
 s_barrier
 ds_read_b128 a[128:131], v193 offset:28672
 v_mfma_f32_32x32x16_bf16 a[64:79], a[168:171], a[164:167], a[64:79]
 ds_read_b64_tr_b16 a[136:137], v199 offset:45056
 ds_read_b64_tr_b16 a[138:139], v199 offset:46080
 s_add_u32 m0, s31, 0
 s_nop 0
 buffer_load_dwordx4 v13, s[8:11], s32 offen offset:0 lds
 v_mfma_f32_32x32x16_bf16 a[16:31], a[172:175], a[160:163], a[16:31]
 ds_read_b128 a[132:135], v193 offset:30720
 ds_read_b64_tr_b16 a[140:141], v199 offset:45312
 v_mfma_f32_32x32x16_bf16 a[80:95], a[172:175], a[164:167], a[80:95]
 ds_read_b64_tr_b16 a[142:143], v199 offset:46336
 ds_read_b64_tr_b16 a[144:145], v199 offset:45568
 v_mfma_f32_32x32x16_bf16 a[32:47], a[176:179], a[160:163], a[32:47]
 ds_read_b64_tr_b16 a[146:147], v199 offset:46592
 ds_read_b64_tr_b16 a[148:149], v199 offset:45824
 v_mfma_f32_32x32x16_bf16 a[96:111], a[176:179], a[164:167], a[96:111]
 ds_read_b64_tr_b16 a[150:151], v199 offset:46848
 ds_read_b64_tr_b16 a[152:153], v202 offset:53248
 v_mfma_f32_32x32x16_bf16 a[48:63], a[180:183], a[160:163], a[48:63]
 ds_read_b64_tr_b16 a[154:155], v202 offset:53760
 ds_read_b64_tr_b16 a[156:157], v202 offset:53504
 buffer_load_dwordx4 v14, s[8:11], s32 offen offset:1024 lds
 v_mfma_f32_32x32x16_bf16 a[112:127], a[180:183], a[164:167], a[112:127]
 ds_read_b64_tr_b16 a[158:159], v202 offset:54016
 v_mfma_f32_32x32x16_bf16 v[64:79], a[184:187], a[160:163], v[64:79]
 v_mfma_f32_32x32x16_bf16 v[96:111], a[184:187], a[164:167], v[96:111]
 v_mfma_f32_32x32x16_bf16 v[80:95], a[188:191], a[160:163], v[80:95]
 v_mfma_f32_32x32x16_bf16 v[112:127], a[188:191], a[164:167], v[112:127]
 s_waitcnt lgkmcnt(11)
 v_mfma_f32_32x32x16_bf16 a[0:15], a[136:139], a[128:131], a[0:15]
 ds_read_b128 a[160:163], v194 offset:28672
 ds_read_b64_tr_b16 a[168:169], v199 offset:49152
 buffer_load_dwordx4 v15, s[8:11], s32 offen offset:2048 lds
 s_waitcnt lgkmcnt(12)
 v_mfma_f32_32x32x16_bf16 a[64:79], a[136:139], a[132:135], a[64:79]
 ds_read_b64_tr_b16 a[170:171], v199 offset:50176
 ds_read_b128 a[164:167], v194 offset:30720
 s_waitcnt lgkmcnt(12)
 v_mfma_f32_32x32x16_bf16 a[16:31], a[140:143], a[128:131], a[16:31]
 ds_read_b64_tr_b16 a[172:173], v199 offset:49408
 ds_read_b64_tr_b16 a[174:175], v199 offset:50432
 v_mfma_f32_32x32x16_bf16 a[80:95], a[140:143], a[132:135], a[80:95]
 ds_read_b64_tr_b16 a[176:177], v199 offset:49664
 s_waitcnt lgkmcnt(10)
 ds_read_b64_tr_b16 a[178:179], v199 offset:50688
 v_mfma_f32_32x32x16_bf16 a[32:47], a[144:147], a[128:131], a[32:47]
 ds_read_b64_tr_b16 a[180:181], v199 offset:49920
 ds_read_b64_tr_b16 a[182:183], v199 offset:50944
 v_mfma_f32_32x32x16_bf16 a[96:111], a[144:147], a[132:135], a[96:111]
 ds_read_b64_tr_b16 a[184:185], v202 offset:55296
 ds_read_b64_tr_b16 a[186:187], v202 offset:55808
 v_mfma_f32_32x32x16_bf16 a[48:63], a[148:151], a[128:131], a[48:63]
 s_waitcnt lgkmcnt(10)
 ds_read_b64_tr_b16 a[188:189], v202 offset:55552
 ds_read_b64_tr_b16 a[190:191], v202 offset:56064
 buffer_load_dwordx4 v16, s[8:11], s32 offen offset:3072 lds
 s_add_u32 s32, s32, 16384
 v_mfma_f32_32x32x16_bf16 a[112:127], a[148:151], a[132:135], a[112:127]
 v_mfma_f32_32x32x16_bf16 v[64:79], a[152:155], a[128:131], v[64:79]
 v_mfma_f32_32x32x16_bf16 v[96:111], a[152:155], a[132:135], v[96:111]
 v_mfma_f32_32x32x16_bf16 v[80:95], a[156:159], a[128:131], v[80:95]
 v_mfma_f32_32x32x16_bf16 v[112:127], a[156:159], a[132:135], v[112:127]
 s_waitcnt lgkmcnt(11)
 v_mfma_f32_32x32x16_bf16 a[0:15], a[168:171], a[160:163], a[0:15]
 s_waitcnt vmcnt(18)
 s_waitcnt lgkmcnt(0)
 s_barrier
 ds_read_b128 a[128:131], v193 offset:57344
 v_mfma_f32_32x32x16_bf16 a[64:79], a[168:171], a[164:167], a[64:79]
 ds_read_b64_tr_b16 a[136:137], v200 offset:8192
 ds_read_b64_tr_b16 a[138:139], v200 offset:9216
 s_add_u32 m0, s31, 16384
 s_nop 0
 buffer_load_dwordx4 v13, s[8:11], s32 offen offset:0 lds
 v_mfma_f32_32x32x16_bf16 a[16:31], a[172:175], a[160:163], a[16:31]
 ds_read_b128 a[132:135], v193 offset:59392
 ds_read_b64_tr_b16 a[140:141], v200 offset:8448
 v_mfma_f32_32x32x16_bf16 a[80:95], a[172:175], a[164:167], a[80:95]
 ds_read_b64_tr_b16 a[142:143], v200 offset:9472
 ds_read_b64_tr_b16 a[144:145], v200 offset:8704
 buffer_load_dwordx4 v14, s[8:11], s32 offen offset:1024 lds
 v_mfma_f32_32x32x16_bf16 a[32:47], a[176:179], a[160:163], a[32:47]
 ds_read_b64_tr_b16 a[146:147], v200 offset:9728
 ds_read_b64_tr_b16 a[148:149], v200 offset:8960
 v_mfma_f32_32x32x16_bf16 a[96:111], a[176:179], a[164:167], a[96:111]
 ds_read_b64_tr_b16 a[150:151], v200 offset:9984
 ds_read_b64_tr_b16 a[152:153], v203 offset:16384
 v_mfma_f32_32x32x16_bf16 a[48:63], a[180:183], a[160:163], a[48:63]
 ds_read_b64_tr_b16 a[154:155], v203 offset:16896
 ds_read_b64_tr_b16 a[156:157], v203 offset:16640
 buffer_load_dwordx4 v15, s[8:11], s32 offen offset:2048 lds
 v_mfma_f32_32x32x16_bf16 a[112:127], a[180:183], a[164:167], a[112:127]
 ds_read_b64_tr_b16 a[158:159], v203 offset:17152
 v_mfma_f32_32x32x16_bf16 v[64:79], a[184:187], a[160:163], v[64:79]
 v_mfma_f32_32x32x16_bf16 v[96:111], a[184:187], a[164:167], v[96:111]
 buffer_load_dwordx4 v16, s[8:11], s32 offen offset:3072 lds
 s_add_u32 s32, s32, 16384
 v_mfma_f32_32x32x16_bf16 v[80:95], a[188:191], a[160:163], v[80:95]
 v_mfma_f32_32x32x16_bf16 v[112:127], a[188:191], a[164:167], v[112:127]
 s_waitcnt lgkmcnt(11)
 v_mfma_f32_32x32x16_bf16 a[0:15], a[136:139], a[128:131], a[0:15]
 ds_read_b128 a[160:163], v194 offset:57344
 ds_read_b64_tr_b16 a[168:169], v200 offset:12288
 s_add_u32 m0, s31, 32768
 s_nop 0
 buffer_load_dwordx4 v13, s[8:11], s32 offen offset:0 lds
 s_waitcnt lgkmcnt(12)
 v_mfma_f32_32x32x16_bf16 a[64:79], a[136:139], a[132:135], a[64:79]
 ds_read_b64_tr_b16 a[170:171], v200 offset:13312
 ds_read_b128 a[164:167], v194 offset:59392
 s_waitcnt lgkmcnt(12)
 v_mfma_f32_32x32x16_bf16 a[16:31], a[140:143], a[128:131], a[16:31]
 ds_read_b64_tr_b16 a[172:173], v200 offset:12544
 ds_read_b64_tr_b16 a[174:175], v200 offset:13568
 v_mfma_f32_32x32x16_bf16 a[80:95], a[140:143], a[132:135], a[80:95]
 ds_read_b64_tr_b16 a[176:177], v200 offset:12800
 s_waitcnt lgkmcnt(10)
 ds_read_b64_tr_b16 a[178:179], v200 offset:13824
 buffer_load_dwordx4 v14, s[8:11], s32 offen offset:1024 lds
 v_mfma_f32_32x32x16_bf16 a[32:47], a[144:147], a[128:131], a[32:47]
 ds_read_b64_tr_b16 a[180:181], v200 offset:13056
 ds_read_b64_tr_b16 a[182:183], v200 offset:14080
 v_mfma_f32_32x32x16_bf16 a[96:111], a[144:147], a[132:135], a[96:111]
 ds_read_b64_tr_b16 a[184:185], v203 offset:18432
 ds_read_b64_tr_b16 a[186:187], v203 offset:18944
 v_mfma_f32_32x32x16_bf16 a[48:63], a[148:151], a[128:131], a[48:63]
 s_waitcnt lgkmcnt(10)
 ds_read_b64_tr_b16 a[188:189], v203 offset:18688
 ds_read_b64_tr_b16 a[190:191], v203 offset:19200
 buffer_load_dwordx4 v15, s[8:11], s32 offen offset:2048 lds
 v_mfma_f32_32x32x16_bf16 a[112:127], a[148:151], a[132:135], a[112:127]
 v_mfma_f32_32x32x16_bf16 v[64:79], a[152:155], a[128:131], v[64:79]
 v_mfma_f32_32x32x16_bf16 v[96:111], a[152:155], a[132:135], v[96:111]
 buffer_load_dwordx4 v16, s[8:11], s32 offen offset:3072 lds
 s_add_u32 s32, s32, 16384
 v_mfma_f32_32x32x16_bf16 v[80:95], a[156:159], a[128:131], v[80:95]
 v_mfma_f32_32x32x16_bf16 v[112:127], a[156:159], a[132:135], v[112:127]
 s_waitcnt lgkmcnt(11)
 v_mfma_f32_32x32x16_bf16 a[0:15], a[168:171], a[160:163], a[0:15]
 s_waitcnt vmcnt(19)
 s_waitcnt lgkmcnt(0)
 s_barrier
 ds_read_b128 a[128:131], v195 offset:20480
 v_mfma_f32_32x32x16_bf16 a[64:79], a[168:171], a[164:167], a[64:79]
 ds_read_b64_tr_b16 a[136:137], v200 offset:36864
 ds_read_b64_tr_b16 a[138:139], v200 offset:37888
 v_mfma_f32_32x32x16_bf16 a[16:31], a[172:175], a[160:163], a[16:31]
 ds_read_b128 a[132:135], v195 offset:22528
 ds_read_b64_tr_b16 a[140:141], v200 offset:37120
 v_mfma_f32_32x32x16_bf16 a[80:95], a[172:175], a[164:167], a[80:95]
 ds_read_b64_tr_b16 a[142:143], v200 offset:38144
 ds_read_b64_tr_b16 a[144:145], v200 offset:37376
 v_mfma_f32_32x32x16_bf16 a[32:47], a[176:179], a[160:163], a[32:47]
 ds_read_b64_tr_b16 a[146:147], v200 offset:38400
 ds_read_b64_tr_b16 a[148:149], v200 offset:37632
 v_mfma_f32_32x32x16_bf16 a[96:111], a[176:179], a[164:167], a[96:111]
 ds_read_b64_tr_b16 a[150:151], v200 offset:38656
 ds_read_b64_tr_b16 a[152:153], v203 offset:45056
 v_mfma_f32_32x32x16_bf16 a[48:63], a[180:183], a[160:163], a[48:63]
 ds_read_b64_tr_b16 a[154:155], v203 offset:45568
 ds_read_b64_tr_b16 a[156:157], v203 offset:45312
 v_mfma_f32_32x32x16_bf16 a[112:127], a[180:183], a[164:167], a[112:127]
 ds_read_b64_tr_b16 a[158:159], v203 offset:45824
 v_mfma_f32_32x32x16_bf16 v[64:79], a[184:187], a[160:163], v[64:79]
 v_mfma_f32_32x32x16_bf16 v[96:111], a[184:187], a[164:167], v[96:111]
 v_mfma_f32_32x32x16_bf16 v[80:95], a[188:191], a[160:163], v[80:95]
 v_mfma_f32_32x32x16_bf16 v[112:127], a[188:191], a[164:167], v[112:127]
 s_waitcnt lgkmcnt(11)
 v_mfma_f32_32x32x16_bf16 a[0:15], a[136:139], a[128:131], a[0:15]
 ds_read_b128 a[160:163], v196 offset:20480
 ds_read_b64_tr_b16 a[168:169], v200 offset:40960
 s_waitcnt lgkmcnt(12)
 v_mfma_f32_32x32x16_bf16 a[64:79], a[136:139], a[132:135], a[64:79]
 ds_read_b64_tr_b16 a[170:171], v200 offset:41984
 ds_read_b128 a[164:167], v196 offset:22528
 s_waitcnt lgkmcnt(12)
 v_mfma_f32_32x32x16_bf16 a[16:31], a[140:143], a[128:131], a[16:31]
 ds_read_b64_tr_b16 a[172:173], v200 offset:41216
 ds_read_b64_tr_b16 a[174:175], v200 offset:42240
 v_mfma_f32_32x32x16_bf16 a[80:95], a[140:143], a[132:135], a[80:95]
 ds_read_b64_tr_b16 a[176:177], v200 offset:41472
 s_waitcnt lgkmcnt(10)
 ds_read_b64_tr_b16 a[178:179], v200 offset:42496
 v_mfma_f32_32x32x16_bf16 a[32:47], a[144:147], a[128:131], a[32:47]
 ds_read_b64_tr_b16 a[180:181], v200 offset:41728
 ds_read_b64_tr_b16 a[182:183], v200 offset:42752
 v_mfma_f32_32x32x16_bf16 a[96:111], a[144:147], a[132:135], a[96:111]
 ds_read_b64_tr_b16 a[184:185], v203 offset:47104
 ds_read_b64_tr_b16 a[186:187], v203 offset:47616
 v_mfma_f32_32x32x16_bf16 a[48:63], a[148:151], a[128:131], a[48:63]
 s_waitcnt lgkmcnt(10)
 ds_read_b64_tr_b16 a[188:189], v203 offset:47360
 ds_read_b64_tr_b16 a[190:191], v203 offset:47872
 v_mfma_f32_32x32x16_bf16 a[112:127], a[148:151], a[132:135], a[112:127]
 v_mfma_f32_32x32x16_bf16 v[64:79], a[152:155], a[128:131], v[64:79]
 v_mfma_f32_32x32x16_bf16 v[96:111], a[152:155], a[132:135], v[96:111]
 v_mfma_f32_32x32x16_bf16 v[80:95], a[156:159], a[128:131], v[80:95]
 v_mfma_f32_32x32x16_bf16 v[112:127], a[156:159], a[132:135], v[112:127]
 s_waitcnt lgkmcnt(11)
 v_mfma_f32_32x32x16_bf16 a[0:15], a[168:171], a[160:163], a[0:15]
 s_waitcnt vmcnt(12)
 s_waitcnt lgkmcnt(0)
 s_barrier
 ds_read_b128 a[128:131], v195 offset:49152
 v_mfma_f32_32x32x16_bf16 a[64:79], a[168:171], a[164:167], a[64:79]
 ds_read_b64_tr_b16 a[136:137], v201 offset:0
 ds_read_b64_tr_b16 a[138:139], v201 offset:1024
 s_add_u32 m0, s31, 98304
 s_nop 0
 buffer_load_dwordx4 v17, s[12:15], s33 offen offset:0 lds
 v_mfma_f32_32x32x16_bf16 a[16:31], a[172:175], a[160:163], a[16:31]
 ds_read_b128 a[132:135], v195 offset:51200
 ds_read_b64_tr_b16 a[140:141], v201 offset:256
 v_mfma_f32_32x32x16_bf16 a[80:95], a[172:175], a[164:167], a[80:95]
 ds_read_b64_tr_b16 a[142:143], v201 offset:1280
 ds_read_b64_tr_b16 a[144:145], v201 offset:512
 v_mfma_f32_32x32x16_bf16 a[32:47], a[176:179], a[160:163], a[32:47]
 ds_read_b64_tr_b16 a[146:147], v201 offset:1536
 ds_read_b64_tr_b16 a[148:149], v201 offset:768
 v_mfma_f32_32x32x16_bf16 a[96:111], a[176:179], a[164:167], a[96:111]
 ds_read_b64_tr_b16 a[150:151], v201 offset:1792
 ds_read_b64_tr_b16 a[152:153], v204 offset:8192
 v_mfma_f32_32x32x16_bf16 a[48:63], a[180:183], a[160:163], a[48:63]
 ds_read_b64_tr_b16 a[154:155], v204 offset:8704
 ds_read_b64_tr_b16 a[156:157], v204 offset:8448
 buffer_load_dwordx4 v17, s[12:15], s33 offen offset:1024 lds
 v_mfma_f32_32x32x16_bf16 a[112:127], a[180:183], a[164:167], a[112:127]
 ds_read_b64_tr_b16 a[158:159], v204 offset:8960
 v_mfma_f32_32x32x16_bf16 v[64:79], a[184:187], a[160:163], v[64:79]
 v_mfma_f32_32x32x16_bf16 v[96:111], a[184:187], a[164:167], v[96:111]
 v_mfma_f32_32x32x16_bf16 v[80:95], a[188:191], a[160:163], v[80:95]
 v_mfma_f32_32x32x16_bf16 v[112:127], a[188:191], a[164:167], v[112:127]
 s_waitcnt lgkmcnt(11)
 v_mfma_f32_32x32x16_bf16 a[0:15], a[136:139], a[128:131], a[0:15]
 ds_read_b128 a[160:163], v196 offset:49152
 ds_read_b64_tr_b16 a[168:169], v201 offset:4096
 buffer_load_dwordx4 v17, s[12:15], s33 offen offset:2048 lds
 s_waitcnt lgkmcnt(12)
 v_mfma_f32_32x32x16_bf16 a[64:79], a[136:139], a[132:135], a[64:79]
 ds_read_b64_tr_b16 a[170:171], v201 offset:5120
 ds_read_b128 a[164:167], v196 offset:51200
 s_waitcnt lgkmcnt(12)
 v_mfma_f32_32x32x16_bf16 a[16:31], a[140:143], a[128:131], a[16:31]
 ds_read_b64_tr_b16 a[172:173], v201 offset:4352
 ds_read_b64_tr_b16 a[174:175], v201 offset:5376
 v_mfma_f32_32x32x16_bf16 a[80:95], a[140:143], a[132:135], a[80:95]
 ds_read_b64_tr_b16 a[176:177], v201 offset:4608
 s_waitcnt lgkmcnt(10)
 ds_read_b64_tr_b16 a[178:179], v201 offset:5632
 v_mfma_f32_32x32x16_bf16 a[32:47], a[144:147], a[128:131], a[32:47]
 ds_read_b64_tr_b16 a[180:181], v201 offset:4864
 ds_read_b64_tr_b16 a[182:183], v201 offset:5888
 v_mfma_f32_32x32x16_bf16 a[96:111], a[144:147], a[132:135], a[96:111]
 ds_read_b64_tr_b16 a[184:185], v204 offset:10240
 ds_read_b64_tr_b16 a[186:187], v204 offset:10752
 v_mfma_f32_32x32x16_bf16 a[48:63], a[148:151], a[128:131], a[48:63]
 s_waitcnt lgkmcnt(10)
 ds_read_b64_tr_b16 a[188:189], v204 offset:10496
 ds_read_b64_tr_b16 a[190:191], v204 offset:11008
 buffer_load_dwordx4 v17, s[12:15], s33 offen offset:3072 lds
 s_add_u32 s33, s33, 16384
 v_mfma_f32_32x32x16_bf16 a[112:127], a[148:151], a[132:135], a[112:127]
 v_mfma_f32_32x32x16_bf16 v[64:79], a[152:155], a[128:131], v[64:79]
 v_mfma_f32_32x32x16_bf16 v[96:111], a[152:155], a[132:135], v[96:111]
 v_mfma_f32_32x32x16_bf16 v[80:95], a[156:159], a[128:131], v[80:95]
 v_mfma_f32_32x32x16_bf16 v[112:127], a[156:159], a[132:135], v[112:127]
 s_waitcnt lgkmcnt(11)
 v_mfma_f32_32x32x16_bf16 a[0:15], a[168:171], a[160:163], a[0:15]
 s_waitcnt lgkmcnt(10)
 v_mfma_f32_32x32x16_bf16 a[64:79], a[168:171], a[164:167], a[64:79]
 s_waitcnt lgkmcnt(8)
 v_mfma_f32_32x32x16_bf16 a[16:31], a[172:175], a[160:163], a[16:31]
 v_mfma_f32_32x32x16_bf16 a[80:95], a[172:175], a[164:167], a[80:95]
 s_waitcnt lgkmcnt(6)
 v_mfma_f32_32x32x16_bf16 a[32:47], a[176:179], a[160:163], a[32:47]
 v_mfma_f32_32x32x16_bf16 a[96:111], a[176:179], a[164:167], a[96:111]
 s_waitcnt lgkmcnt(4)
 v_mfma_f32_32x32x16_bf16 a[48:63], a[180:183], a[160:163], a[48:63]
 v_mfma_f32_32x32x16_bf16 a[112:127], a[180:183], a[164:167], a[112:127]
 s_waitcnt lgkmcnt(2)
 v_mfma_f32_32x32x16_bf16 v[64:79], a[184:187], a[160:163], v[64:79]
 v_mfma_f32_32x32x16_bf16 v[96:111], a[184:187], a[164:167], v[96:111]
 s_waitcnt lgkmcnt(0)
 v_mfma_f32_32x32x16_bf16 v[80:95], a[188:191], a[160:163], v[80:95]
 v_mfma_f32_32x32x16_bf16 v[112:127], a[188:191], a[164:167], v[112:127]
 s_nop 11
 v_accvgpr_read_b32 v32, a0
 v_accvgpr_read_b32 v33, a1
 v_mul_f32 v32, s37, v32
 v_mul_f32 v33, s37, v33
 v_cvt_pk_bf16_f32 v32, v32, v33
 v_accvgpr_write_b32 a128, v32
 v_accvgpr_read_b32 v34, a2
 v_accvgpr_read_b32 v35, a3
 v_mul_f32 v34, s37, v34
 v_mul_f32 v35, s37, v35
 v_cvt_pk_bf16_f32 v34, v34, v35
 v_accvgpr_write_b32 a129, v34
 v_accvgpr_read_b32 v36, a4
 v_accvgpr_read_b32 v37, a5
 v_mul_f32 v36, s37, v36
 v_mul_f32 v37, s37, v37
 v_cvt_pk_bf16_f32 v36, v36, v37
 v_accvgpr_write_b32 a130, v36
 v_accvgpr_read_b32 v38, a6
 v_accvgpr_read_b32 v39, a7
 v_mul_f32 v38, s37, v38
 v_mul_f32 v39, s37, v39
 v_cvt_pk_bf16_f32 v38, v38, v39
 v_accvgpr_write_b32 a131, v38
 v_accvgpr_read_b32 v32, a8
 v_accvgpr_read_b32 v33, a9
 v_mul_f32 v32, s37, v32
 v_mul_f32 v33, s37, v33
 v_cvt_pk_bf16_f32 v32, v32, v33
 v_accvgpr_write_b32 a132, v32
 v_accvgpr_read_b32 v34, a10
 v_accvgpr_read_b32 v35, a11
 v_mul_f32 v34, s37, v34
 v_mul_f32 v35, s37, v35
 v_cvt_pk_bf16_f32 v34, v34, v35
 v_accvgpr_write_b32 a133, v34
 v_accvgpr_read_b32 v36, a12
 v_accvgpr_read_b32 v37, a13
 v_mul_f32 v36, s37, v36
 v_mul_f32 v37, s37, v37
 v_cvt_pk_bf16_f32 v36, v36, v37
 v_accvgpr_write_b32 a134, v36
 v_accvgpr_read_b32 v38, a14
 v_accvgpr_read_b32 v39, a15
 v_mul_f32 v38, s37, v38
 v_mul_f32 v39, s37, v39
 v_cvt_pk_bf16_f32 v38, v38, v39
 v_accvgpr_write_b32 a135, v38
 v_accvgpr_read_b32 v32, a16
 v_accvgpr_read_b32 v33, a17
 v_mul_f32 v32, s37, v32
 v_mul_f32 v33, s37, v33
 v_cvt_pk_bf16_f32 v32, v32, v33
 v_accvgpr_write_b32 a136, v32
 v_accvgpr_read_b32 v34, a18
 v_accvgpr_read_b32 v35, a19
 v_mul_f32 v34, s37, v34
 v_mul_f32 v35, s37, v35
 v_cvt_pk_bf16_f32 v34, v34, v35
 v_accvgpr_write_b32 a137, v34
 v_accvgpr_read_b32 v36, a20
 v_accvgpr_read_b32 v37, a21
 v_mul_f32 v36, s37, v36
 v_mul_f32 v37, s37, v37
 v_cvt_pk_bf16_f32 v36, v36, v37
 v_accvgpr_write_b32 a138, v36
 v_accvgpr_read_b32 v38, a22
 v_accvgpr_read_b32 v39, a23
 v_mul_f32 v38, s37, v38
 v_mul_f32 v39, s37, v39
 v_cvt_pk_bf16_f32 v38, v38, v39
 v_accvgpr_write_b32 a139, v38
 v_accvgpr_read_b32 v32, a24
 v_accvgpr_read_b32 v33, a25
 v_mul_f32 v32, s37, v32
 v_mul_f32 v33, s37, v33
 v_cvt_pk_bf16_f32 v32, v32, v33
 v_accvgpr_write_b32 a140, v32
 v_accvgpr_read_b32 v34, a26
 v_accvgpr_read_b32 v35, a27
 v_mul_f32 v34, s37, v34
 v_mul_f32 v35, s37, v35
 v_cvt_pk_bf16_f32 v34, v34, v35
 v_accvgpr_write_b32 a141, v34
 v_accvgpr_read_b32 v36, a28
 v_accvgpr_read_b32 v37, a29
 v_mul_f32 v36, s37, v36
 v_mul_f32 v37, s37, v37
 v_cvt_pk_bf16_f32 v36, v36, v37
 v_accvgpr_write_b32 a142, v36
 v_accvgpr_read_b32 v38, a30
 v_accvgpr_read_b32 v39, a31
 v_mul_f32 v38, s37, v38
 v_mul_f32 v39, s37, v39
 v_cvt_pk_bf16_f32 v38, v38, v39
 v_accvgpr_write_b32 a143, v38
 v_accvgpr_read_b32 v32, a32
 v_accvgpr_read_b32 v33, a33
 v_mul_f32 v32, s37, v32
 v_mul_f32 v33, s37, v33
 v_cvt_pk_bf16_f32 v32, v32, v33
 v_accvgpr_write_b32 a144, v32
 v_accvgpr_read_b32 v34, a34
 v_accvgpr_read_b32 v35, a35
 v_mul_f32 v34, s37, v34
 v_mul_f32 v35, s37, v35
 v_cvt_pk_bf16_f32 v34, v34, v35
 v_accvgpr_write_b32 a145, v34
 v_accvgpr_read_b32 v36, a36
 v_accvgpr_read_b32 v37, a37
 v_mul_f32 v36, s37, v36
 v_mul_f32 v37, s37, v37
 v_cvt_pk_bf16_f32 v36, v36, v37
 v_accvgpr_write_b32 a146, v36
 v_accvgpr_read_b32 v38, a38
 v_accvgpr_read_b32 v39, a39
 v_mul_f32 v38, s37, v38
 v_mul_f32 v39, s37, v39
 v_cvt_pk_bf16_f32 v38, v38, v39
 v_accvgpr_write_b32 a147, v38
 v_accvgpr_read_b32 v32, a40
 v_accvgpr_read_b32 v33, a41
 v_mul_f32 v32, s37, v32
 v_mul_f32 v33, s37, v33
 v_cvt_pk_bf16_f32 v32, v32, v33
 v_accvgpr_write_b32 a148, v32
 v_accvgpr_read_b32 v34, a42
 v_accvgpr_read_b32 v35, a43
 v_mul_f32 v34, s37, v34
 v_mul_f32 v35, s37, v35
 v_cvt_pk_bf16_f32 v34, v34, v35
 v_accvgpr_write_b32 a149, v34
 v_accvgpr_read_b32 v36, a44
 v_accvgpr_read_b32 v37, a45
 v_mul_f32 v36, s37, v36
 v_mul_f32 v37, s37, v37
 v_cvt_pk_bf16_f32 v36, v36, v37
 v_accvgpr_write_b32 a150, v36
 v_accvgpr_read_b32 v38, a46
 v_accvgpr_read_b32 v39, a47
 v_mul_f32 v38, s37, v38
 v_mul_f32 v39, s37, v39
 v_cvt_pk_bf16_f32 v38, v38, v39
 v_accvgpr_write_b32 a151, v38
 v_accvgpr_read_b32 v32, a48
 v_accvgpr_read_b32 v33, a49
 v_mul_f32 v32, s37, v32
 v_mul_f32 v33, s37, v33
 v_cvt_pk_bf16_f32 v32, v32, v33
 v_accvgpr_write_b32 a152, v32
 v_accvgpr_read_b32 v34, a50
 v_accvgpr_read_b32 v35, a51
 v_mul_f32 v34, s37, v34
 v_mul_f32 v35, s37, v35
 v_cvt_pk_bf16_f32 v34, v34, v35
 v_accvgpr_write_b32 a153, v34
 v_accvgpr_read_b32 v36, a52
 v_accvgpr_read_b32 v37, a53
 v_mul_f32 v36, s37, v36
 v_mul_f32 v37, s37, v37
 v_cvt_pk_bf16_f32 v36, v36, v37
 v_accvgpr_write_b32 a154, v36
 v_accvgpr_read_b32 v38, a54
 v_accvgpr_read_b32 v39, a55
 v_mul_f32 v38, s37, v38
 v_mul_f32 v39, s37, v39
 v_cvt_pk_bf16_f32 v38, v38, v39
 v_accvgpr_write_b32 a155, v38
 v_accvgpr_read_b32 v32, a56
 v_accvgpr_read_b32 v33, a57
 v_mul_f32 v32, s37, v32
 v_mul_f32 v33, s37, v33
 v_cvt_pk_bf16_f32 v32, v32, v33
 v_accvgpr_write_b32 a156, v32
 v_accvgpr_read_b32 v34, a58
 v_accvgpr_read_b32 v35, a59
 v_mul_f32 v34, s37, v34
 v_mul_f32 v35, s37, v35
 v_cvt_pk_bf16_f32 v34, v34, v35
 v_accvgpr_write_b32 a157, v34
 v_accvgpr_read_b32 v36, a60
 v_accvgpr_read_b32 v37, a61
 v_mul_f32 v36, s37, v36
 v_mul_f32 v37, s37, v37
 v_cvt_pk_bf16_f32 v36, v36, v37
 v_accvgpr_write_b32 a158, v36
 v_accvgpr_read_b32 v38, a62
 v_accvgpr_read_b32 v39, a63
 v_mul_f32 v38, s37, v38
 v_mul_f32 v39, s37, v39
 v_cvt_pk_bf16_f32 v38, v38, v39
 v_accvgpr_write_b32 a159, v38
 v_accvgpr_read_b32 v32, a64
 v_accvgpr_read_b32 v33, a65
 v_mul_f32 v32, s37, v32
 v_mul_f32 v33, s37, v33
 v_cvt_pk_bf16_f32 v32, v32, v33
 v_accvgpr_write_b32 a160, v32
 v_accvgpr_read_b32 v34, a66
 v_accvgpr_read_b32 v35, a67
 v_mul_f32 v34, s37, v34
 v_mul_f32 v35, s37, v35
 v_cvt_pk_bf16_f32 v34, v34, v35
 v_accvgpr_write_b32 a161, v34
 v_accvgpr_read_b32 v36, a68
 v_accvgpr_read_b32 v37, a69
 v_mul_f32 v36, s37, v36
 v_mul_f32 v37, s37, v37
 v_cvt_pk_bf16_f32 v36, v36, v37
 v_accvgpr_write_b32 a162, v36
 v_accvgpr_read_b32 v38, a70
 v_accvgpr_read_b32 v39, a71
 v_mul_f32 v38, s37, v38
 v_mul_f32 v39, s37, v39
 v_cvt_pk_bf16_f32 v38, v38, v39
 v_accvgpr_write_b32 a163, v38
 v_accvgpr_read_b32 v32, a72
 v_accvgpr_read_b32 v33, a73
 v_mul_f32 v32, s37, v32
 v_mul_f32 v33, s37, v33
 v_cvt_pk_bf16_f32 v32, v32, v33
 v_accvgpr_write_b32 a164, v32
 v_accvgpr_read_b32 v34, a74
 v_accvgpr_read_b32 v35, a75
 v_mul_f32 v34, s37, v34
 v_mul_f32 v35, s37, v35
 v_cvt_pk_bf16_f32 v34, v34, v35
 v_accvgpr_write_b32 a165, v34
 v_accvgpr_read_b32 v36, a76
 v_accvgpr_read_b32 v37, a77
 v_mul_f32 v36, s37, v36
 v_mul_f32 v37, s37, v37
 v_cvt_pk_bf16_f32 v36, v36, v37
 v_accvgpr_write_b32 a166, v36
 v_accvgpr_read_b32 v38, a78
 v_accvgpr_read_b32 v39, a79
 v_mul_f32 v38, s37, v38
 v_mul_f32 v39, s37, v39
 v_cvt_pk_bf16_f32 v38, v38, v39
 v_accvgpr_write_b32 a167, v38
 v_accvgpr_read_b32 v32, a80
 v_accvgpr_read_b32 v33, a81
 v_mul_f32 v32, s37, v32
 v_mul_f32 v33, s37, v33
 v_cvt_pk_bf16_f32 v32, v32, v33
 v_accvgpr_write_b32 a168, v32
 v_accvgpr_read_b32 v34, a82
 v_accvgpr_read_b32 v35, a83
 v_mul_f32 v34, s37, v34
 v_mul_f32 v35, s37, v35
 v_cvt_pk_bf16_f32 v34, v34, v35
 v_accvgpr_write_b32 a169, v34
 v_accvgpr_read_b32 v36, a84
 v_accvgpr_read_b32 v37, a85
 v_mul_f32 v36, s37, v36
 v_mul_f32 v37, s37, v37
 v_cvt_pk_bf16_f32 v36, v36, v37
 v_accvgpr_write_b32 a170, v36
 v_accvgpr_read_b32 v38, a86
 v_accvgpr_read_b32 v39, a87
 v_mul_f32 v38, s37, v38
 v_mul_f32 v39, s37, v39
 v_cvt_pk_bf16_f32 v38, v38, v39
 v_accvgpr_write_b32 a171, v38
 v_accvgpr_read_b32 v32, a88
 v_accvgpr_read_b32 v33, a89
 v_mul_f32 v32, s37, v32
 v_mul_f32 v33, s37, v33
 v_cvt_pk_bf16_f32 v32, v32, v33
 v_accvgpr_write_b32 a172, v32
 v_accvgpr_read_b32 v34, a90
 v_accvgpr_read_b32 v35, a91
 v_mul_f32 v34, s37, v34
 v_mul_f32 v35, s37, v35
 v_cvt_pk_bf16_f32 v34, v34, v35
 v_accvgpr_write_b32 a173, v34
 v_accvgpr_read_b32 v36, a92
 v_accvgpr_read_b32 v37, a93
 v_mul_f32 v36, s37, v36
 v_mul_f32 v37, s37, v37
 v_cvt_pk_bf16_f32 v36, v36, v37
 v_accvgpr_write_b32 a174, v36
 v_accvgpr_read_b32 v38, a94
 v_accvgpr_read_b32 v39, a95
 v_mul_f32 v38, s37, v38
 v_mul_f32 v39, s37, v39
 v_cvt_pk_bf16_f32 v38, v38, v39
 v_accvgpr_write_b32 a175, v38
 v_accvgpr_read_b32 v32, a96
 v_accvgpr_read_b32 v33, a97
 v_mul_f32 v32, s37, v32
 v_mul_f32 v33, s37, v33
 v_cvt_pk_bf16_f32 v32, v32, v33
 v_accvgpr_write_b32 a176, v32
 v_accvgpr_read_b32 v34, a98
 v_accvgpr_read_b32 v35, a99
 v_mul_f32 v34, s37, v34
 v_mul_f32 v35, s37, v35
 v_cvt_pk_bf16_f32 v34, v34, v35
 v_accvgpr_write_b32 a177, v34
 v_accvgpr_read_b32 v36, a100
 v_accvgpr_read_b32 v37, a101
 v_mul_f32 v36, s37, v36
 v_mul_f32 v37, s37, v37
 v_cvt_pk_bf16_f32 v36, v36, v37
 v_accvgpr_write_b32 a178, v36
 v_accvgpr_read_b32 v38, a102
 v_accvgpr_read_b32 v39, a103
 v_mul_f32 v38, s37, v38
 v_mul_f32 v39, s37, v39
 v_cvt_pk_bf16_f32 v38, v38, v39
 v_accvgpr_write_b32 a179, v38
 v_accvgpr_read_b32 v32, a104
 v_accvgpr_read_b32 v33, a105
 v_mul_f32 v32, s37, v32
 v_mul_f32 v33, s37, v33
 v_cvt_pk_bf16_f32 v32, v32, v33
 v_accvgpr_write_b32 a180, v32
 v_accvgpr_read_b32 v34, a106
 v_accvgpr_read_b32 v35, a107
 v_mul_f32 v34, s37, v34
 v_mul_f32 v35, s37, v35
 v_cvt_pk_bf16_f32 v34, v34, v35
 v_accvgpr_write_b32 a181, v34
 v_accvgpr_read_b32 v36, a108
 v_accvgpr_read_b32 v37, a109
 v_mul_f32 v36, s37, v36
 v_mul_f32 v37, s37, v37
 v_cvt_pk_bf16_f32 v36, v36, v37
 v_accvgpr_write_b32 a182, v36
 v_accvgpr_read_b32 v38, a110
 v_accvgpr_read_b32 v39, a111
 v_mul_f32 v38, s37, v38
 v_mul_f32 v39, s37, v39
 v_cvt_pk_bf16_f32 v38, v38, v39
 v_accvgpr_write_b32 a183, v38
 v_accvgpr_read_b32 v32, a112
 v_accvgpr_read_b32 v33, a113
 v_mul_f32 v32, s37, v32
 v_mul_f32 v33, s37, v33
 v_cvt_pk_bf16_f32 v32, v32, v33
 v_accvgpr_write_b32 a184, v32
 v_accvgpr_read_b32 v34, a114
 v_accvgpr_read_b32 v35, a115
 v_mul_f32 v34, s37, v34
 v_mul_f32 v35, s37, v35
 v_cvt_pk_bf16_f32 v34, v34, v35
 v_accvgpr_write_b32 a185, v34
 v_accvgpr_read_b32 v36, a116
 v_accvgpr_read_b32 v37, a117
 v_mul_f32 v36, s37, v36
 v_mul_f32 v37, s37, v37
 v_cvt_pk_bf16_f32 v36, v36, v37
 v_accvgpr_write_b32 a186, v36
 v_accvgpr_read_b32 v38, a118
 v_accvgpr_read_b32 v39, a119
 v_mul_f32 v38, s37, v38
 v_mul_f32 v39, s37, v39
 v_cvt_pk_bf16_f32 v38, v38, v39
 v_accvgpr_write_b32 a187, v38
 v_accvgpr_read_b32 v32, a120
 v_accvgpr_read_b32 v33, a121
 v_mul_f32 v32, s37, v32
 v_mul_f32 v33, s37, v33
 v_cvt_pk_bf16_f32 v32, v32, v33
 v_accvgpr_write_b32 a188, v32
 v_accvgpr_read_b32 v34, a122
 v_accvgpr_read_b32 v35, a123
 v_mul_f32 v34, s37, v34
 v_mul_f32 v35, s37, v35
 v_cvt_pk_bf16_f32 v34, v34, v35
 v_accvgpr_write_b32 a189, v34
 v_accvgpr_read_b32 v36, a124
 v_accvgpr_read_b32 v37, a125
 v_mul_f32 v36, s37, v36
 v_mul_f32 v37, s37, v37
 v_cvt_pk_bf16_f32 v36, v36, v37
 v_accvgpr_write_b32 a190, v36
 v_accvgpr_read_b32 v38, a126
 v_accvgpr_read_b32 v39, a127
 v_mul_f32 v38, s37, v38
 v_mul_f32 v39, s37, v39
 v_cvt_pk_bf16_f32 v38, v38, v39
 v_accvgpr_write_b32 a191, v38
 s_mov_b32 s34, 0xbdd2d3e8
 v_mov_b32 v29, 0xc0135761
 s_mov_b32 s35, 110592
 s_add_u32 s20, s50, 3145728
 s_addc_u32 s21, s51, 0
 s_and_b32 s21, s21, 0xffff
 s_mov_b32 s22, 229376
 s_sub_u32 s72, s29, 13
 s_lshl_b32 s72, s72, 14
 s_mov_b32 s23, 0x00020000
 v_mov_b32 v32, 0
 v_mov_b32 v33, 0
 v_mul_f32 v128, v64, v64
 v_mul_f32 v129, v65, v65
 v_mul_f32 v130, v66, v66
 v_mul_f32 v131, v67, v67
 v_mul_f32 v132, v68, v68
 v_mul_f32 v133, v69, v69
 v_mul_f32 v134, v70, v70
 v_mul_f32 v135, v71, v71
 v_fma_f32 v128, v128, s34, v29
 v_fma_f32 v129, v129, s34, v29
 v_fma_f32 v130, v130, s34, v29
 v_fma_f32 v131, v131, s34, v29
 v_fma_f32 v132, v132, s34, v29
 v_fma_f32 v133, v133, s34, v29
 v_fma_f32 v134, v134, s34, v29
 v_fma_f32 v135, v135, s34, v29
 v_mul_f32 v128, v128, v64
 v_mul_f32 v129, v129, v65
 v_mul_f32 v130, v130, v66
 v_mul_f32 v131, v131, v67
 v_mul_f32 v132, v132, v68
 v_mul_f32 v133, v133, v69
 v_mul_f32 v134, v134, v70
 v_mul_f32 v135, v135, v71
 v_exp_f32 v128, v128
 v_exp_f32 v129, v129
 v_exp_f32 v130, v130
 v_exp_f32 v131, v131
 v_exp_f32 v132, v132
 v_exp_f32 v133, v133
 v_exp_f32 v134, v134
 v_exp_f32 v135, v135
 v_add_f32 v128, 1.0, v128
 v_add_f32 v129, 1.0, v129
 v_add_f32 v130, 1.0, v130
 v_add_f32 v131, 1.0, v131
 v_add_f32 v132, 1.0, v132
 v_add_f32 v133, 1.0, v133
 v_add_f32 v134, 1.0, v134
 v_add_f32 v135, 1.0, v135
 v_rcp_f32 v128, v128
 v_rcp_f32 v129, v129
 v_rcp_f32 v130, v130
 v_rcp_f32 v131, v131
 v_rcp_f32 v132, v132
 v_rcp_f32 v133, v133
 v_rcp_f32 v134, v134
 v_rcp_f32 v135, v135
 v_mul_f32 v128, v64, v128
 v_mul_f32 v129, v65, v129
 v_mul_f32 v130, v66, v130
 v_mul_f32 v131, v67, v131
 v_mul_f32 v132, v68, v132
 v_mul_f32 v133, v69, v133
 v_mul_f32 v134, v70, v134
 v_mul_f32 v135, v71, v135
 v_cvt_pk_bf16_f32 v64, v128, v129
 v_cvt_pk_bf16_f32 v65, v130, v131
 v_cvt_pk_bf16_f32 v66, v132, v133
 v_cvt_pk_bf16_f32 v67, v134, v135
 v_accvgpr_write_b32 a224, v64
 v_accvgpr_write_b32 a225, v65
 v_accvgpr_write_b32 a226, v66
 v_accvgpr_write_b32 a227, v67
 buffer_store_dwordx4 v[64:67], v209, s[68:71], 0 offen offset:0 sc0 sc1
 v_mul_f32 v136, v72, v72
 v_mul_f32 v137, v73, v73
 v_mul_f32 v138, v74, v74
 v_mul_f32 v139, v75, v75
 v_mul_f32 v140, v76, v76
 v_mul_f32 v141, v77, v77
 v_mul_f32 v142, v78, v78
 v_mul_f32 v143, v79, v79
 v_fma_f32 v136, v136, s34, v29
 v_fma_f32 v137, v137, s34, v29
 v_fma_f32 v138, v138, s34, v29
 v_fma_f32 v139, v139, s34, v29
 v_fma_f32 v140, v140, s34, v29
 v_fma_f32 v141, v141, s34, v29
 v_fma_f32 v142, v142, s34, v29
 v_fma_f32 v143, v143, s34, v29
 v_mul_f32 v136, v136, v72
 v_mul_f32 v137, v137, v73
 v_mul_f32 v138, v138, v74
 v_mul_f32 v139, v139, v75
 v_mul_f32 v140, v140, v76
 v_mul_f32 v141, v141, v77
 v_mul_f32 v142, v142, v78
 v_mul_f32 v143, v143, v79
 v_exp_f32 v136, v136
 v_exp_f32 v137, v137
 v_exp_f32 v138, v138
 v_exp_f32 v139, v139
 v_exp_f32 v140, v140
 v_exp_f32 v141, v141
 v_exp_f32 v142, v142
 v_exp_f32 v143, v143
 v_add_f32 v136, 1.0, v136
 v_add_f32 v137, 1.0, v137
 v_add_f32 v138, 1.0, v138
 v_add_f32 v139, 1.0, v139
 v_add_f32 v140, 1.0, v140
 v_add_f32 v141, 1.0, v141
 v_add_f32 v142, 1.0, v142
 v_add_f32 v143, 1.0, v143
 v_rcp_f32 v136, v136
 v_rcp_f32 v137, v137
 v_rcp_f32 v138, v138
 v_rcp_f32 v139, v139
 v_rcp_f32 v140, v140
 v_rcp_f32 v141, v141
 v_rcp_f32 v142, v142
 v_rcp_f32 v143, v143
 v_mul_f32 v136, v72, v136
 v_mul_f32 v137, v73, v137
 v_mul_f32 v138, v74, v138
 v_mul_f32 v139, v75, v139
 v_mul_f32 v140, v76, v140
 v_mul_f32 v141, v77, v141
 v_mul_f32 v142, v78, v142
 v_mul_f32 v143, v79, v143
 v_cvt_pk_bf16_f32 v72, v136, v137
 v_cvt_pk_bf16_f32 v73, v138, v139
 v_cvt_pk_bf16_f32 v74, v140, v141
 v_cvt_pk_bf16_f32 v75, v142, v143
 v_accvgpr_write_b32 a228, v72
 v_accvgpr_write_b32 a229, v73
 v_accvgpr_write_b32 a230, v74
 v_accvgpr_write_b32 a231, v75
 buffer_store_dwordx4 v[72:75], v209, s[68:71], 0 offen offset:1024 sc0 sc1
 s_cmp_eq_u32 s78, 0
 s_cbranch_scc1 attn_kernel_nost3
 v_lshlrev_b32 v34, 16, v64
 v_and_b32 v35, 0xffff0000, v64
 v_add_f32 v32, v32, v34
 v_fmac_f32 v33, v34, v34
 v_add_f32 v32, v32, v35
 v_fmac_f32 v33, v35, v35
 v_lshlrev_b32 v34, 16, v65
 v_and_b32 v35, 0xffff0000, v65
 v_add_f32 v32, v32, v34
 v_fmac_f32 v33, v34, v34
 v_add_f32 v32, v32, v35
 v_fmac_f32 v33, v35, v35
 v_lshlrev_b32 v34, 16, v66
 v_and_b32 v35, 0xffff0000, v66
 v_add_f32 v32, v32, v34
 v_fmac_f32 v33, v34, v34
 v_add_f32 v32, v32, v35
 v_fmac_f32 v33, v35, v35
 v_lshlrev_b32 v34, 16, v67
 v_and_b32 v35, 0xffff0000, v67
 v_add_f32 v32, v32, v34
 v_fmac_f32 v33, v34, v34
 v_add_f32 v32, v32, v35
 v_fmac_f32 v33, v35, v35
 v_lshlrev_b32 v34, 16, v72
 v_and_b32 v35, 0xffff0000, v72
 v_add_f32 v32, v32, v34
 v_fmac_f32 v33, v34, v34
 v_add_f32 v32, v32, v35
 v_fmac_f32 v33, v35, v35
 v_lshlrev_b32 v34, 16, v73
 v_and_b32 v35, 0xffff0000, v73
 v_add_f32 v32, v32, v34
 v_fmac_f32 v33, v34, v34
 v_add_f32 v32, v32, v35
 v_fmac_f32 v33, v35, v35
 v_lshlrev_b32 v34, 16, v74
 v_and_b32 v35, 0xffff0000, v74
 v_add_f32 v32, v32, v34
 v_fmac_f32 v33, v34, v34
 v_add_f32 v32, v32, v35
 v_fmac_f32 v33, v35, v35
 v_lshlrev_b32 v34, 16, v75
 v_and_b32 v35, 0xffff0000, v75
 v_add_f32 v32, v32, v34
 v_fmac_f32 v33, v34, v34
 v_add_f32 v32, v32, v35
 v_fmac_f32 v33, v35, v35
attn_kernel_nost3:
 v_mul_f32 v128, v80, v80
 v_mul_f32 v129, v81, v81
 v_mul_f32 v130, v82, v82
 v_mul_f32 v131, v83, v83
 v_mul_f32 v132, v84, v84
 v_mul_f32 v133, v85, v85
 v_mul_f32 v134, v86, v86
 v_mul_f32 v135, v87, v87
 v_fma_f32 v128, v128, s34, v29
 v_fma_f32 v129, v129, s34, v29
 v_fma_f32 v130, v130, s34, v29
 v_fma_f32 v131, v131, s34, v29
 v_fma_f32 v132, v132, s34, v29
 v_fma_f32 v133, v133, s34, v29
 v_fma_f32 v134, v134, s34, v29
 v_fma_f32 v135, v135, s34, v29
 v_mul_f32 v128, v128, v80
 v_mul_f32 v129, v129, v81
 v_mul_f32 v130, v130, v82
 v_mul_f32 v131, v131, v83
 v_mul_f32 v132, v132, v84
 v_mul_f32 v133, v133, v85
 v_mul_f32 v134, v134, v86
 v_mul_f32 v135, v135, v87
 v_exp_f32 v128, v128
 v_exp_f32 v129, v129
 v_exp_f32 v130, v130
 v_exp_f32 v131, v131
 v_exp_f32 v132, v132
 v_exp_f32 v133, v133
 v_exp_f32 v134, v134
 v_exp_f32 v135, v135
 v_add_f32 v128, 1.0, v128
 v_add_f32 v129, 1.0, v129
 v_add_f32 v130, 1.0, v130
 v_add_f32 v131, 1.0, v131
 v_add_f32 v132, 1.0, v132
 v_add_f32 v133, 1.0, v133
 v_add_f32 v134, 1.0, v134
 v_add_f32 v135, 1.0, v135
 v_rcp_f32 v128, v128
 v_rcp_f32 v129, v129
 v_rcp_f32 v130, v130
 v_rcp_f32 v131, v131
 v_rcp_f32 v132, v132
 v_rcp_f32 v133, v133
 v_rcp_f32 v134, v134
 v_rcp_f32 v135, v135
 v_mul_f32 v128, v80, v128
 v_mul_f32 v129, v81, v129
 v_mul_f32 v130, v82, v130
 v_mul_f32 v131, v83, v131
 v_mul_f32 v132, v84, v132
 v_mul_f32 v133, v85, v133
 v_mul_f32 v134, v86, v134
 v_mul_f32 v135, v87, v135
 v_cvt_pk_bf16_f32 v80, v128, v129
 v_cvt_pk_bf16_f32 v81, v130, v131
 v_cvt_pk_bf16_f32 v82, v132, v133
 v_cvt_pk_bf16_f32 v83, v134, v135
 v_accvgpr_write_b32 a232, v80
 v_accvgpr_write_b32 a233, v81
 v_accvgpr_write_b32 a234, v82
 v_accvgpr_write_b32 a235, v83
 buffer_store_dwordx4 v[80:83], v209, s[68:71], 0 offen offset:2048 sc0 sc1
 v_mul_f32 v136, v88, v88
 v_mul_f32 v137, v89, v89
 v_mul_f32 v138, v90, v90
 v_mul_f32 v139, v91, v91
 v_mul_f32 v140, v92, v92
 v_mul_f32 v141, v93, v93
 v_mul_f32 v142, v94, v94
 v_mul_f32 v143, v95, v95
 v_fma_f32 v136, v136, s34, v29
 v_fma_f32 v137, v137, s34, v29
 v_fma_f32 v138, v138, s34, v29
 v_fma_f32 v139, v139, s34, v29
 v_fma_f32 v140, v140, s34, v29
 v_fma_f32 v141, v141, s34, v29
 v_fma_f32 v142, v142, s34, v29
 v_fma_f32 v143, v143, s34, v29
 v_mul_f32 v136, v136, v88
 v_mul_f32 v137, v137, v89
 v_mul_f32 v138, v138, v90
 v_mul_f32 v139, v139, v91
 v_mul_f32 v140, v140, v92
 v_mul_f32 v141, v141, v93
 v_mul_f32 v142, v142, v94
 v_mul_f32 v143, v143, v95
 v_exp_f32 v136, v136
 v_exp_f32 v137, v137
 v_exp_f32 v138, v138
 v_exp_f32 v139, v139
 v_exp_f32 v140, v140
 v_exp_f32 v141, v141
 v_exp_f32 v142, v142
 v_exp_f32 v143, v143
 v_add_f32 v136, 1.0, v136
 v_add_f32 v137, 1.0, v137
 v_add_f32 v138, 1.0, v138
 v_add_f32 v139, 1.0, v139
 v_add_f32 v140, 1.0, v140
 v_add_f32 v141, 1.0, v141
 v_add_f32 v142, 1.0, v142
 v_add_f32 v143, 1.0, v143
 v_rcp_f32 v136, v136
 v_rcp_f32 v137, v137
 v_rcp_f32 v138, v138
 v_rcp_f32 v139, v139
 v_rcp_f32 v140, v140
 v_rcp_f32 v141, v141
 v_rcp_f32 v142, v142
 v_rcp_f32 v143, v143
 v_mul_f32 v136, v88, v136
 v_mul_f32 v137, v89, v137
 v_mul_f32 v138, v90, v138
 v_mul_f32 v139, v91, v139
 v_mul_f32 v140, v92, v140
 v_mul_f32 v141, v93, v141
 v_mul_f32 v142, v94, v142
 v_mul_f32 v143, v95, v143
 v_cvt_pk_bf16_f32 v88, v136, v137
 v_cvt_pk_bf16_f32 v89, v138, v139
 v_cvt_pk_bf16_f32 v90, v140, v141
 v_cvt_pk_bf16_f32 v91, v142, v143
 v_accvgpr_write_b32 a236, v88
 v_accvgpr_write_b32 a237, v89
 v_accvgpr_write_b32 a238, v90
 v_accvgpr_write_b32 a239, v91
 buffer_store_dwordx4 v[88:91], v209, s[68:71], 0 offen offset:3072 sc0 sc1
 s_cmp_eq_u32 s79, 0
 s_cbranch_scc1 attn_kernel_nost4
 v_lshlrev_b32 v34, 16, v80
 v_and_b32 v35, 0xffff0000, v80
 v_add_f32 v32, v32, v34
 v_fmac_f32 v33, v34, v34
 v_add_f32 v32, v32, v35
 v_fmac_f32 v33, v35, v35
 v_lshlrev_b32 v34, 16, v81
 v_and_b32 v35, 0xffff0000, v81
 v_add_f32 v32, v32, v34
 v_fmac_f32 v33, v34, v34
 v_add_f32 v32, v32, v35
 v_fmac_f32 v33, v35, v35
 v_lshlrev_b32 v34, 16, v82
 v_and_b32 v35, 0xffff0000, v82
 v_add_f32 v32, v32, v34
 v_fmac_f32 v33, v34, v34
 v_add_f32 v32, v32, v35
 v_fmac_f32 v33, v35, v35
 v_lshlrev_b32 v34, 16, v83
 v_and_b32 v35, 0xffff0000, v83
 v_add_f32 v32, v32, v34
 v_fmac_f32 v33, v34, v34
 v_add_f32 v32, v32, v35
 v_fmac_f32 v33, v35, v35
 v_lshlrev_b32 v34, 16, v88
 v_and_b32 v35, 0xffff0000, v88
 v_add_f32 v32, v32, v34
 v_fmac_f32 v33, v34, v34
 v_add_f32 v32, v32, v35
 v_fmac_f32 v33, v35, v35
 v_lshlrev_b32 v34, 16, v89
 v_and_b32 v35, 0xffff0000, v89
 v_add_f32 v32, v32, v34
 v_fmac_f32 v33, v34, v34
 v_add_f32 v32, v32, v35
 v_fmac_f32 v33, v35, v35
 v_lshlrev_b32 v34, 16, v90
 v_and_b32 v35, 0xffff0000, v90
 v_add_f32 v32, v32, v34
 v_fmac_f32 v33, v34, v34
 v_add_f32 v32, v32, v35
 v_fmac_f32 v33, v35, v35
 v_lshlrev_b32 v34, 16, v91
 v_and_b32 v35, 0xffff0000, v91
 v_add_f32 v32, v32, v34
 v_fmac_f32 v33, v34, v34
 v_add_f32 v32, v32, v35
 v_fmac_f32 v33, v35, v35
attn_kernel_nost4:
 s_cmp_eq_u32 s79, 0
 s_cbranch_scc1 attn_kernel_nopart5
 v_mov_b32 v34, v32
 v_mov_b32 v35, v33
 s_nop 1
 v_permlane32_swap_b32 v32, v34
 v_permlane32_swap_b32 v33, v35
 s_nop 1
 v_add_f32 v32, v32, v34
 v_add_f32 v33, v33, v35
 s_mov_b64 exec, 0xffffffff
 buffer_store_dwordx2 v[32:33], v210, s[20:23], s72 offen offset:0 sc0 sc1
 s_mov_b64 exec, -1
attn_kernel_nopart5:
 s_nop 1
 v_mov_b32 v32, 0
 v_mov_b32 v33, 0
 v_mul_f32 v128, v96, v96
 v_mul_f32 v129, v97, v97
 v_mul_f32 v130, v98, v98
 v_mul_f32 v131, v99, v99
 v_mul_f32 v132, v100, v100
 v_mul_f32 v133, v101, v101
 v_mul_f32 v134, v102, v102
 v_mul_f32 v135, v103, v103
 v_fma_f32 v128, v128, s34, v29
 v_fma_f32 v129, v129, s34, v29
 v_fma_f32 v130, v130, s34, v29
 v_fma_f32 v131, v131, s34, v29
 v_fma_f32 v132, v132, s34, v29
 v_fma_f32 v133, v133, s34, v29
 v_fma_f32 v134, v134, s34, v29
 v_fma_f32 v135, v135, s34, v29
 v_mul_f32 v128, v128, v96
 v_mul_f32 v129, v129, v97
 v_mul_f32 v130, v130, v98
 v_mul_f32 v131, v131, v99
 v_mul_f32 v132, v132, v100
 v_mul_f32 v133, v133, v101
 v_mul_f32 v134, v134, v102
 v_mul_f32 v135, v135, v103
 v_exp_f32 v128, v128
 v_exp_f32 v129, v129
 v_exp_f32 v130, v130
 v_exp_f32 v131, v131
 v_exp_f32 v132, v132
 v_exp_f32 v133, v133
 v_exp_f32 v134, v134
 v_exp_f32 v135, v135
 v_add_f32 v128, 1.0, v128
 v_add_f32 v129, 1.0, v129
 v_add_f32 v130, 1.0, v130
 v_add_f32 v131, 1.0, v131
 v_add_f32 v132, 1.0, v132
 v_add_f32 v133, 1.0, v133
 v_add_f32 v134, 1.0, v134
 v_add_f32 v135, 1.0, v135
 v_rcp_f32 v128, v128
 v_rcp_f32 v129, v129
 v_rcp_f32 v130, v130
 v_rcp_f32 v131, v131
 v_rcp_f32 v132, v132
 v_rcp_f32 v133, v133
 v_rcp_f32 v134, v134
 v_rcp_f32 v135, v135
 v_mul_f32 v128, v96, v128
 v_mul_f32 v129, v97, v129
 v_mul_f32 v130, v98, v130
 v_mul_f32 v131, v99, v131
 v_mul_f32 v132, v100, v132
 v_mul_f32 v133, v101, v133
 v_mul_f32 v134, v102, v134
 v_mul_f32 v135, v103, v135
 v_cvt_pk_bf16_f32 v96, v128, v129
 v_cvt_pk_bf16_f32 v97, v130, v131
 v_cvt_pk_bf16_f32 v98, v132, v133
 v_cvt_pk_bf16_f32 v99, v134, v135
 v_accvgpr_write_b32 a240, v96
 v_accvgpr_write_b32 a241, v97
 v_accvgpr_write_b32 a242, v98
 v_accvgpr_write_b32 a243, v99
 buffer_store_dwordx4 v[96:99], v209, s[68:71], s35 offen offset:0 sc0 sc1
 v_mul_f32 v136, v104, v104
 v_mul_f32 v137, v105, v105
 v_mul_f32 v138, v106, v106
 v_mul_f32 v139, v107, v107
 v_mul_f32 v140, v108, v108
 v_mul_f32 v141, v109, v109
 v_mul_f32 v142, v110, v110
 v_mul_f32 v143, v111, v111
 v_fma_f32 v136, v136, s34, v29
 v_fma_f32 v137, v137, s34, v29
 v_fma_f32 v138, v138, s34, v29
 v_fma_f32 v139, v139, s34, v29
 v_fma_f32 v140, v140, s34, v29
 v_fma_f32 v141, v141, s34, v29
 v_fma_f32 v142, v142, s34, v29
 v_fma_f32 v143, v143, s34, v29
 v_mul_f32 v136, v136, v104
 v_mul_f32 v137, v137, v105
 v_mul_f32 v138, v138, v106
 v_mul_f32 v139, v139, v107
 v_mul_f32 v140, v140, v108
 v_mul_f32 v141, v141, v109
 v_mul_f32 v142, v142, v110
 v_mul_f32 v143, v143, v111
 v_exp_f32 v136, v136
 v_exp_f32 v137, v137
 v_exp_f32 v138, v138
 v_exp_f32 v139, v139
 v_exp_f32 v140, v140
 v_exp_f32 v141, v141
 v_exp_f32 v142, v142
 v_exp_f32 v143, v143
 v_add_f32 v136, 1.0, v136
 v_add_f32 v137, 1.0, v137
 v_add_f32 v138, 1.0, v138
 v_add_f32 v139, 1.0, v139
 v_add_f32 v140, 1.0, v140
 v_add_f32 v141, 1.0, v141
 v_add_f32 v142, 1.0, v142
 v_add_f32 v143, 1.0, v143
 v_rcp_f32 v136, v136
 v_rcp_f32 v137, v137
 v_rcp_f32 v138, v138
 v_rcp_f32 v139, v139
 v_rcp_f32 v140, v140
 v_rcp_f32 v141, v141
 v_rcp_f32 v142, v142
 v_rcp_f32 v143, v143
 v_mul_f32 v136, v104, v136
 v_mul_f32 v137, v105, v137
 v_mul_f32 v138, v106, v138
 v_mul_f32 v139, v107, v139
 v_mul_f32 v140, v108, v140
 v_mul_f32 v141, v109, v141
 v_mul_f32 v142, v110, v142
 v_mul_f32 v143, v111, v143
 v_cvt_pk_bf16_f32 v104, v136, v137
 v_cvt_pk_bf16_f32 v105, v138, v139
 v_cvt_pk_bf16_f32 v106, v140, v141
 v_cvt_pk_bf16_f32 v107, v142, v143
 v_accvgpr_write_b32 a244, v104
 v_accvgpr_write_b32 a245, v105
 v_accvgpr_write_b32 a246, v106
 v_accvgpr_write_b32 a247, v107
 buffer_store_dwordx4 v[104:107], v209, s[68:71], s35 offen offset:1024 sc0 sc1
 s_cmp_eq_u32 s78, 0
 s_cbranch_scc1 attn_kernel_nost6
 v_lshlrev_b32 v34, 16, v96
 v_and_b32 v35, 0xffff0000, v96
 v_add_f32 v32, v32, v34
 v_fmac_f32 v33, v34, v34
 v_add_f32 v32, v32, v35
 v_fmac_f32 v33, v35, v35
 v_lshlrev_b32 v34, 16, v97
 v_and_b32 v35, 0xffff0000, v97
 v_add_f32 v32, v32, v34
 v_fmac_f32 v33, v34, v34
 v_add_f32 v32, v32, v35
 v_fmac_f32 v33, v35, v35
 v_lshlrev_b32 v34, 16, v98
 v_and_b32 v35, 0xffff0000, v98
 v_add_f32 v32, v32, v34
 v_fmac_f32 v33, v34, v34
 v_add_f32 v32, v32, v35
 v_fmac_f32 v33, v35, v35
 v_lshlrev_b32 v34, 16, v99
 v_and_b32 v35, 0xffff0000, v99
 v_add_f32 v32, v32, v34
 v_fmac_f32 v33, v34, v34
 v_add_f32 v32, v32, v35
 v_fmac_f32 v33, v35, v35
 v_lshlrev_b32 v34, 16, v104
 v_and_b32 v35, 0xffff0000, v104
 v_add_f32 v32, v32, v34
 v_fmac_f32 v33, v34, v34
 v_add_f32 v32, v32, v35
 v_fmac_f32 v33, v35, v35
 v_lshlrev_b32 v34, 16, v105
 v_and_b32 v35, 0xffff0000, v105
 v_add_f32 v32, v32, v34
 v_fmac_f32 v33, v34, v34
 v_add_f32 v32, v32, v35
 v_fmac_f32 v33, v35, v35
 v_lshlrev_b32 v34, 16, v106
 v_and_b32 v35, 0xffff0000, v106
 v_add_f32 v32, v32, v34
 v_fmac_f32 v33, v34, v34
 v_add_f32 v32, v32, v35
 v_fmac_f32 v33, v35, v35
 v_lshlrev_b32 v34, 16, v107
 v_and_b32 v35, 0xffff0000, v107
 v_add_f32 v32, v32, v34
 v_fmac_f32 v33, v34, v34
 v_add_f32 v32, v32, v35
 v_fmac_f32 v33, v35, v35
attn_kernel_nost6:
 v_mul_f32 v128, v112, v112
 v_mul_f32 v129, v113, v113
 v_mul_f32 v130, v114, v114
 v_mul_f32 v131, v115, v115
 v_mul_f32 v132, v116, v116
 v_mul_f32 v133, v117, v117
 v_mul_f32 v134, v118, v118
 v_mul_f32 v135, v119, v119
 v_fma_f32 v128, v128, s34, v29
 v_fma_f32 v129, v129, s34, v29
 v_fma_f32 v130, v130, s34, v29
 v_fma_f32 v131, v131, s34, v29
 v_fma_f32 v132, v132, s34, v29
 v_fma_f32 v133, v133, s34, v29
 v_fma_f32 v134, v134, s34, v29
 v_fma_f32 v135, v135, s34, v29
 v_mul_f32 v128, v128, v112
 v_mul_f32 v129, v129, v113
 v_mul_f32 v130, v130, v114
 v_mul_f32 v131, v131, v115
 v_mul_f32 v132, v132, v116
 v_mul_f32 v133, v133, v117
 v_mul_f32 v134, v134, v118
 v_mul_f32 v135, v135, v119
 v_exp_f32 v128, v128
 v_exp_f32 v129, v129
 v_exp_f32 v130, v130
 v_exp_f32 v131, v131
 v_exp_f32 v132, v132
 v_exp_f32 v133, v133
 v_exp_f32 v134, v134
 v_exp_f32 v135, v135
 v_add_f32 v128, 1.0, v128
 v_add_f32 v129, 1.0, v129
 v_add_f32 v130, 1.0, v130
 v_add_f32 v131, 1.0, v131
 v_add_f32 v132, 1.0, v132
 v_add_f32 v133, 1.0, v133
 v_add_f32 v134, 1.0, v134
 v_add_f32 v135, 1.0, v135
 v_rcp_f32 v128, v128
 v_rcp_f32 v129, v129
 v_rcp_f32 v130, v130
 v_rcp_f32 v131, v131
 v_rcp_f32 v132, v132
 v_rcp_f32 v133, v133
 v_rcp_f32 v134, v134
 v_rcp_f32 v135, v135
 v_mul_f32 v128, v112, v128
 v_mul_f32 v129, v113, v129
 v_mul_f32 v130, v114, v130
 v_mul_f32 v131, v115, v131
 v_mul_f32 v132, v116, v132
 v_mul_f32 v133, v117, v133
 v_mul_f32 v134, v118, v134
 v_mul_f32 v135, v119, v135
 v_cvt_pk_bf16_f32 v112, v128, v129
 v_cvt_pk_bf16_f32 v113, v130, v131
 v_cvt_pk_bf16_f32 v114, v132, v133
 v_cvt_pk_bf16_f32 v115, v134, v135
 v_accvgpr_write_b32 a248, v112
 v_accvgpr_write_b32 a249, v113
 v_accvgpr_write_b32 a250, v114
 v_accvgpr_write_b32 a251, v115
 buffer_store_dwordx4 v[112:115], v209, s[68:71], s35 offen offset:2048 sc0 sc1
 v_mul_f32 v136, v120, v120
 v_mul_f32 v137, v121, v121
 v_mul_f32 v138, v122, v122
 v_mul_f32 v139, v123, v123
 v_mul_f32 v140, v124, v124
 v_mul_f32 v141, v125, v125
 v_mul_f32 v142, v126, v126
 v_mul_f32 v143, v127, v127
 v_fma_f32 v136, v136, s34, v29
 v_fma_f32 v137, v137, s34, v29
 v_fma_f32 v138, v138, s34, v29
 v_fma_f32 v139, v139, s34, v29
 v_fma_f32 v140, v140, s34, v29
 v_fma_f32 v141, v141, s34, v29
 v_fma_f32 v142, v142, s34, v29
 v_fma_f32 v143, v143, s34, v29
 v_mul_f32 v136, v136, v120
 v_mul_f32 v137, v137, v121
 v_mul_f32 v138, v138, v122
 v_mul_f32 v139, v139, v123
 v_mul_f32 v140, v140, v124
 v_mul_f32 v141, v141, v125
 v_mul_f32 v142, v142, v126
 v_mul_f32 v143, v143, v127
 v_exp_f32 v136, v136
 v_exp_f32 v137, v137
 v_exp_f32 v138, v138
 v_exp_f32 v139, v139
 v_exp_f32 v140, v140
 v_exp_f32 v141, v141
 v_exp_f32 v142, v142
 v_exp_f32 v143, v143
 v_add_f32 v136, 1.0, v136
 v_add_f32 v137, 1.0, v137
 v_add_f32 v138, 1.0, v138
 v_add_f32 v139, 1.0, v139
 v_add_f32 v140, 1.0, v140
 v_add_f32 v141, 1.0, v141
 v_add_f32 v142, 1.0, v142
 v_add_f32 v143, 1.0, v143
 v_rcp_f32 v136, v136
 v_rcp_f32 v137, v137
 v_rcp_f32 v138, v138
 v_rcp_f32 v139, v139
 v_rcp_f32 v140, v140
 v_rcp_f32 v141, v141
 v_rcp_f32 v142, v142
 v_rcp_f32 v143, v143
 v_mul_f32 v136, v120, v136
 v_mul_f32 v137, v121, v137
 v_mul_f32 v138, v122, v138
 v_mul_f32 v139, v123, v139
 v_mul_f32 v140, v124, v140
 v_mul_f32 v141, v125, v141
 v_mul_f32 v142, v126, v142
 v_mul_f32 v143, v127, v143
 v_cvt_pk_bf16_f32 v120, v136, v137
 v_cvt_pk_bf16_f32 v121, v138, v139
 v_cvt_pk_bf16_f32 v122, v140, v141
 v_cvt_pk_bf16_f32 v123, v142, v143
 v_accvgpr_write_b32 a252, v120
 v_accvgpr_write_b32 a253, v121
 v_accvgpr_write_b32 a254, v122
 v_accvgpr_write_b32 a255, v123
 buffer_store_dwordx4 v[120:123], v209, s[68:71], s35 offen offset:3072 sc0 sc1
 s_cmp_eq_u32 s79, 0
 s_cbranch_scc1 attn_kernel_nost7
 v_lshlrev_b32 v34, 16, v112
 v_and_b32 v35, 0xffff0000, v112
 v_add_f32 v32, v32, v34
 v_fmac_f32 v33, v34, v34
 v_add_f32 v32, v32, v35
 v_fmac_f32 v33, v35, v35
 v_lshlrev_b32 v34, 16, v113
 v_and_b32 v35, 0xffff0000, v113
 v_add_f32 v32, v32, v34
 v_fmac_f32 v33, v34, v34
 v_add_f32 v32, v32, v35
 v_fmac_f32 v33, v35, v35
 v_lshlrev_b32 v34, 16, v114
 v_and_b32 v35, 0xffff0000, v114
 v_add_f32 v32, v32, v34
 v_fmac_f32 v33, v34, v34
 v_add_f32 v32, v32, v35
 v_fmac_f32 v33, v35, v35
 v_lshlrev_b32 v34, 16, v115
 v_and_b32 v35, 0xffff0000, v115
 v_add_f32 v32, v32, v34
 v_fmac_f32 v33, v34, v34
 v_add_f32 v32, v32, v35
 v_fmac_f32 v33, v35, v35
 v_lshlrev_b32 v34, 16, v120
 v_and_b32 v35, 0xffff0000, v120
 v_add_f32 v32, v32, v34
 v_fmac_f32 v33, v34, v34
 v_add_f32 v32, v32, v35
 v_fmac_f32 v33, v35, v35
 v_lshlrev_b32 v34, 16, v121
 v_and_b32 v35, 0xffff0000, v121
 v_add_f32 v32, v32, v34
 v_fmac_f32 v33, v34, v34
 v_add_f32 v32, v32, v35
 v_fmac_f32 v33, v35, v35
 v_lshlrev_b32 v34, 16, v122
 v_and_b32 v35, 0xffff0000, v122
 v_add_f32 v32, v32, v34
 v_fmac_f32 v33, v34, v34
 v_add_f32 v32, v32, v35
 v_fmac_f32 v33, v35, v35
 v_lshlrev_b32 v34, 16, v123
 v_and_b32 v35, 0xffff0000, v123
 v_add_f32 v32, v32, v34
 v_fmac_f32 v33, v34, v34
 v_add_f32 v32, v32, v35
 v_fmac_f32 v33, v35, v35
attn_kernel_nost7:
 s_cmp_eq_u32 s79, 0
 s_cbranch_scc1 attn_kernel_nopart8
 v_mov_b32 v34, v32
 v_mov_b32 v35, v33
 s_nop 1
 v_permlane32_swap_b32 v32, v34
 v_permlane32_swap_b32 v33, v35
 s_nop 1
 v_add_f32 v32, v32, v34
 v_add_f32 v33, v33, v35
 s_mov_b64 exec, 0xffffffff
 buffer_store_dwordx2 v[32:33], v210, s[20:23], s72 offen offset:256 sc0 sc1
 s_mov_b64 exec, -1
attn_kernel_nopart8:
 s_nop 1
 s_nop 1
 v_mov_b32 v23, 0
 v_mov_b32 v24, 0
 s_waitcnt vmcnt(20)
 s_barrier
 s_add_u32 s52, s50, 12582912
 s_addc_u32 s53, s51, 0
 s_mov_b32 s68, s52
 s_and_b32 s69, s53, 0xffff
 s_mov_b32 s70, 3932160
 s_mov_b32 s71, 0x00020000
 s_mov_b32 s64, s62
 s_and_b32 s65, s63, 0xffff
 s_mov_b32 s66, 256
 s_mov_b32 s67, 0x00020000
 s_lshl_b32 s44, s2, 8
 s_lshl_b32 s45, s28, 6
 s_add_u32 s44, s44, s45
 v_add_u32 v48, s44, v0
 v_lshlrev_b32 v48, 6, v48
 s_mov_b32 s44, s56
 s_and_b32 s45, s57, 0xffff
 s_mov_b32 s46, 8388608
 s_mov_b32 s47, 0x00020000
 s_mov_b32 s48, s54
 s_and_b32 s49, s55, 0xffff
 s_mov_b32 s50, 5242880
 s_mov_b32 s51, 0x00020000
 s_mov_b32 s52, s58
 s_and_b32 s53, s59, 0xffff
 s_mov_b32 s54, 1105920
 s_mov_b32 s55, 0x00020000
 s_mov_b32 s60, 0
 s_add_u32 m0, s31, 49152
 s_nop 0
 buffer_load_dwordx4 v13, s[8:11], s32 offen offset:0 lds
 buffer_load_dwordx4 v14, s[8:11], s32 offen offset:1024 lds
 buffer_load_dwordx4 v15, s[8:11], s32 offen offset:2048 lds
 buffer_load_dwordx4 v16, s[8:11], s32 offen offset:3072 lds
 s_add_u32 s32, s32, 16384
 s_add_u32 m0, s31, 114688
 s_nop 0
 buffer_load_dwordx4 v17, s[12:15], s33 offen offset:0 lds
 buffer_load_dwordx4 v17, s[12:15], s33 offen offset:1024 lds
 buffer_load_dwordx4 v17, s[12:15], s33 offen offset:2048 lds
 buffer_load_dwordx4 v17, s[12:15], s33 offen offset:3072 lds
 s_add_u32 s33, s33, 16384
 ds_read_b128 a[192:195], v2 offset:0
 ds_read_b128 a[196:199], v3 offset:0
 ds_read_b128 a[200:203], v4 offset:0
 ds_read_b128 a[204:207], v5 offset:0
 ds_read_b128 a[208:211], v6 offset:0
 s_waitcnt lgkmcnt(4)
 v_mfma_f32_32x32x16_bf16 v[64:79], a[192:195], a[128:131], 0
 ds_read_b128 a[212:215], v7 offset:0
 v_mfma_f32_32x32x16_bf16 v[80:95], a[192:195], a[160:163], 0
 s_waitcnt lgkmcnt(4)
 v_mfma_f32_32x32x16_bf16 v[64:79], a[196:199], a[132:135], v[64:79]
 ds_read_b128 a[216:219], v8 offset:0
 v_mfma_f32_32x32x16_bf16 v[80:95], a[196:199], a[164:167], v[80:95]
 s_waitcnt lgkmcnt(4)
 v_mfma_f32_32x32x16_bf16 v[64:79], a[200:203], a[136:139], v[64:79]
 ds_read_b128 a[220:223], v9 offset:0
 v_mfma_f32_32x32x16_bf16 v[80:95], a[200:203], a[168:171], v[80:95]
 s_waitcnt lgkmcnt(4)
 v_mfma_f32_32x32x16_bf16 v[64:79], a[204:207], a[140:143], v[64:79]
 ds_read_b128 a[192:195], v2 offset:8192
 v_mfma_f32_32x32x16_bf16 v[80:95], a[204:207], a[172:175], v[80:95]
 s_waitcnt lgkmcnt(4)
 v_mfma_f32_32x32x16_bf16 v[64:79], a[208:211], a[144:147], v[64:79]
 ds_read_b128 a[196:199], v3 offset:8192
 v_mfma_f32_32x32x16_bf16 v[80:95], a[208:211], a[176:179], v[80:95]
 s_waitcnt lgkmcnt(4)
 v_mfma_f32_32x32x16_bf16 v[64:79], a[212:215], a[148:151], v[64:79]
 ds_read_b128 a[200:203], v4 offset:8192
 v_mfma_f32_32x32x16_bf16 v[80:95], a[212:215], a[180:183], v[80:95]
 s_waitcnt lgkmcnt(4)
 v_mfma_f32_32x32x16_bf16 v[64:79], a[216:219], a[152:155], v[64:79]
 ds_read_b128 a[204:207], v5 offset:8192
 v_mfma_f32_32x32x16_bf16 v[80:95], a[216:219], a[184:187], v[80:95]
 s_waitcnt lgkmcnt(4)
 v_mfma_f32_32x32x16_bf16 v[64:79], a[220:223], a[156:159], v[64:79]
 ds_read_b128 a[208:211], v6 offset:8192
 v_mfma_f32_32x32x16_bf16 v[80:95], a[220:223], a[188:191], v[80:95]
 s_nop 15
 v_max3_f32 v40, v64, v65, v66
 v_max3_f32 v40, v40, v67, v68
 v_max3_f32 v40, v40, v69, v70
 v_max3_f32 v40, v40, v71, v72
 v_max3_f32 v40, v40, v73, v74
 v_max3_f32 v40, v40, v75, v76
 v_max3_f32 v40, v40, v77, v78
 v_max_f32 v40, v40, v79
 v_mov_b32 v41, v40
 s_nop 1
 v_permlane32_swap_b32 v40, v41
 s_nop 1
 v_max_f32 v40, v40, v41
 v_sub_f32 v64, v64, v40
 v_sub_f32 v160, 0, v40
 v_sub_f32 v65, v65, v40
 v_sub_f32 v161, 0, v40
 v_sub_f32 v66, v66, v40
 v_sub_f32 v162, 0, v40
 v_sub_f32 v67, v67, v40
 v_sub_f32 v163, 0, v40
 v_sub_f32 v68, v68, v40
 v_sub_f32 v164, 0, v40
 v_sub_f32 v69, v69, v40
 v_sub_f32 v165, 0, v40
 v_sub_f32 v70, v70, v40
 v_sub_f32 v166, 0, v40
 v_sub_f32 v71, v71, v40
 v_sub_f32 v167, 0, v40
 v_sub_f32 v72, v72, v40
 v_sub_f32 v168, 0, v40
 v_sub_f32 v73, v73, v40
 v_sub_f32 v169, 0, v40
 v_sub_f32 v74, v74, v40
 v_sub_f32 v170, 0, v40
 v_sub_f32 v75, v75, v40
 v_sub_f32 v171, 0, v40
 v_sub_f32 v76, v76, v40
 v_sub_f32 v172, 0, v40
 v_sub_f32 v77, v77, v40
 v_sub_f32 v173, 0, v40
 v_sub_f32 v78, v78, v40
 v_sub_f32 v174, 0, v40
 v_sub_f32 v79, v79, v40
 v_sub_f32 v175, 0, v40
 v_max3_f32 v40, v80, v81, v82
 v_max3_f32 v40, v40, v83, v84
 v_max3_f32 v40, v40, v85, v86
 v_max3_f32 v40, v40, v87, v88
 v_max3_f32 v40, v40, v89, v90
 v_max3_f32 v40, v40, v91, v92
 v_max3_f32 v40, v40, v93, v94
 v_max_f32 v40, v40, v95
 v_mov_b32 v41, v40
 s_nop 1
 v_permlane32_swap_b32 v40, v41
 s_nop 1
 v_max_f32 v40, v40, v41
 v_sub_f32 v80, v80, v40
 v_sub_f32 v176, 0, v40
 v_sub_f32 v81, v81, v40
 v_sub_f32 v177, 0, v40
 v_sub_f32 v82, v82, v40
 v_sub_f32 v178, 0, v40
 v_sub_f32 v83, v83, v40
 v_sub_f32 v179, 0, v40
 v_sub_f32 v84, v84, v40
 v_sub_f32 v180, 0, v40
 v_sub_f32 v85, v85, v40
 v_sub_f32 v181, 0, v40
 v_sub_f32 v86, v86, v40
 v_sub_f32 v182, 0, v40
 v_sub_f32 v87, v87, v40
 v_sub_f32 v183, 0, v40
 v_sub_f32 v88, v88, v40
 v_sub_f32 v184, 0, v40
 v_sub_f32 v89, v89, v40
 v_sub_f32 v185, 0, v40
 v_sub_f32 v90, v90, v40
 v_sub_f32 v186, 0, v40
 v_sub_f32 v91, v91, v40
 v_sub_f32 v187, 0, v40
 v_sub_f32 v92, v92, v40
 v_sub_f32 v188, 0, v40
 v_sub_f32 v93, v93, v40
 v_sub_f32 v189, 0, v40
 v_sub_f32 v94, v94, v40
 v_sub_f32 v190, 0, v40
 v_sub_f32 v95, v95, v40
 v_sub_f32 v191, 0, v40
 s_nop 1
 s_waitcnt lgkmcnt(4)
 v_mfma_f32_32x32x16_bf16 v[96:111], a[192:195], a[128:131], v[160:175]
 ds_read_b128 a[212:215], v7 offset:8192
 v_exp_f32 v32, v64
 v_exp_f32 v33, v65
 v_exp_f32 v34, v66
 v_mfma_f32_32x32x16_bf16 v[112:127], a[192:195], a[160:163], v[176:191]
 v_add_f32 v25, v32, v33
 v_cvt_pk_bf16_f32 v128, v32, v33
 v_exp_f32 v35, v67
 v_exp_f32 v36, v68
 s_waitcnt lgkmcnt(4)
 v_mfma_f32_32x32x16_bf16 v[96:111], a[196:199], a[132:135], v[96:111]
 ds_read_b128 a[216:219], v8 offset:8192
 v_add_f32 v25, v25, v34
 v_add_f32 v25, v25, v35
 v_cvt_pk_bf16_f32 v129, v34, v35
 v_exp_f32 v37, v69
 v_exp_f32 v38, v70
 v_mfma_f32_32x32x16_bf16 v[112:127], a[196:199], a[164:167], v[112:127]
 v_add_f32 v25, v25, v36
 v_add_f32 v25, v25, v37
 v_cvt_pk_bf16_f32 v130, v36, v37
 v_exp_f32 v39, v71
 v_exp_f32 v32, v72
 v_exp_f32 v33, v73
 s_waitcnt lgkmcnt(4)
 v_mfma_f32_32x32x16_bf16 v[96:111], a[200:203], a[136:139], v[96:111]
 ds_read_b128 a[220:223], v9 offset:8192
 v_add_f32 v25, v25, v38
 v_add_f32 v25, v25, v39
 v_cvt_pk_bf16_f32 v131, v38, v39
 v_add_f32 v25, v25, v32
 v_add_f32 v25, v25, v33
 v_cvt_pk_bf16_f32 v132, v32, v33
 v_exp_f32 v34, v74
 v_exp_f32 v35, v75
 v_mfma_f32_32x32x16_bf16 v[112:127], a[200:203], a[168:171], v[112:127]
 s_waitcnt vmcnt(24)
 s_waitcnt vmcnt(16)
 s_barrier
 v_add_f32 v25, v25, v34
 v_add_f32 v25, v25, v35
 v_cvt_pk_bf16_f32 v133, v34, v35
 v_exp_f32 v36, v76
 v_exp_f32 v37, v77
 s_waitcnt lgkmcnt(4)
 v_mfma_f32_32x32x16_bf16 v[96:111], a[204:207], a[140:143], v[96:111]
 ds_read_b128 a[192:195], v2 offset:16384
 s_add_u32 m0, s31, 0
 s_nop 0
 buffer_load_dwordx4 v13, s[8:11], s32 offen offset:0 lds
 v_add_f32 v25, v25, v36
 v_add_f32 v25, v25, v37
 v_cvt_pk_bf16_f32 v134, v36, v37
 v_exp_f32 v38, v78
 v_exp_f32 v39, v79
 v_mfma_f32_32x32x16_bf16 v[112:127], a[204:207], a[172:175], v[112:127]
 v_add_f32 v25, v25, v38
 v_add_f32 v25, v25, v39
 v_cvt_pk_bf16_f32 v135, v38, v39
 v_exp_f32 v32, v80
 v_exp_f32 v33, v81
 v_exp_f32 v34, v82
 s_waitcnt lgkmcnt(4)
 v_mfma_f32_32x32x16_bf16 v[96:111], a[208:211], a[144:147], v[96:111]
 ds_read_b128 a[196:199], v3 offset:16384
 v_add_f32 v26, v32, v33
 v_cvt_pk_bf16_f32 v136, v32, v33
 v_exp_f32 v35, v83
 v_exp_f32 v36, v84
 v_mfma_f32_32x32x16_bf16 v[112:127], a[208:211], a[176:179], v[112:127]
 v_add_f32 v26, v26, v34
 v_add_f32 v26, v26, v35
 v_cvt_pk_bf16_f32 v137, v34, v35
 v_exp_f32 v37, v85
 v_exp_f32 v38, v86
 s_waitcnt lgkmcnt(4)
 v_mfma_f32_32x32x16_bf16 v[96:111], a[212:215], a[148:151], v[96:111]
 ds_read_b128 a[200:203], v4 offset:16384
 v_add_f32 v26, v26, v36
 v_add_f32 v26, v26, v37
 v_cvt_pk_bf16_f32 v138, v36, v37
 v_exp_f32 v39, v87
 v_exp_f32 v32, v88
 v_exp_f32 v33, v89
 v_mfma_f32_32x32x16_bf16 v[112:127], a[212:215], a[180:183], v[112:127]
 buffer_load_dwordx4 v14, s[8:11], s32 offen offset:1024 lds
 v_add_f32 v26, v26, v38
 v_add_f32 v26, v26, v39
 v_cvt_pk_bf16_f32 v139, v38, v39
 v_add_f32 v26, v26, v32
 v_add_f32 v26, v26, v33
 v_cvt_pk_bf16_f32 v140, v32, v33
 v_exp_f32 v34, v90
 v_exp_f32 v35, v91
 s_waitcnt lgkmcnt(4)
 v_mfma_f32_32x32x16_bf16 v[96:111], a[216:219], a[152:155], v[96:111]
 ds_read_b128 a[204:207], v5 offset:16384
 v_add_f32 v26, v26, v34
 v_add_f32 v26, v26, v35
 v_cvt_pk_bf16_f32 v141, v34, v35
 v_exp_f32 v36, v92
 v_exp_f32 v37, v93
 v_mfma_f32_32x32x16_bf16 v[112:127], a[216:219], a[184:187], v[112:127]
 v_add_f32 v26, v26, v36
 v_add_f32 v26, v26, v37
 v_cvt_pk_bf16_f32 v142, v36, v37
 v_exp_f32 v38, v94
 v_exp_f32 v39, v95
 s_waitcnt lgkmcnt(4)
 v_mfma_f32_32x32x16_bf16 v[96:111], a[220:223], a[156:159], v[96:111]
 ds_read_b128 a[208:211], v6 offset:16384
 v_add_f32 v26, v26, v38
 v_add_f32 v26, v26, v39
 v_cvt_pk_bf16_f32 v143, v38, v39
 v_mfma_f32_32x32x16_bf16 v[112:127], a[220:223], a[188:191], v[112:127]
 v_max_f32 v29, v25, v26
 v_cmp_lt_f32 vcc, s36, v29
 s_cbranch_vccnz attn_kernel_rs9
attn_kernel_rb10:
 s_waitcnt lgkmcnt(4)
 v_mfma_f32_32x32x16_bf16 v[64:79], a[192:195], a[128:131], v[160:175]
 ds_read_b128 a[212:215], v7 offset:16384
 buffer_load_dwordx4 v15, s[8:11], s32 offen offset:2048 lds
 v_add_f32 v23, v23, v25
 v_add_f32 v24, v24, v26
 v_exp_f32 v32, v96
 v_exp_f32 v33, v97
 v_mfma_f32_32x32x16_bf16 v[80:95], a[192:195], a[160:163], v[176:191]
 v_add_f32 v27, v32, v33
 v_cvt_pk_bf16_f32 v144, v32, v33
 v_exp_f32 v34, v98
 s_waitcnt lgkmcnt(4)
 v_mfma_f32_32x32x16_bf16 v[64:79], a[196:199], a[132:135], v[64:79]
 ds_read_b128 a[216:219], v8 offset:16384
 v_exp_f32 v35, v99
 v_mfma_f32_32x32x16_bf16 v[80:95], a[196:199], a[164:167], v[80:95]
 v_add_f32 v27, v27, v34
 v_add_f32 v27, v27, v35
 v_cvt_pk_bf16_f32 v145, v34, v35
 v_exp_f32 v36, v100
 s_waitcnt lgkmcnt(4)
 v_mfma_f32_32x32x16_bf16 v[64:79], a[200:203], a[136:139], v[64:79]
 ds_read_b128 a[220:223], v9 offset:16384
 v_exp_f32 v37, v101
 v_mfma_f32_32x32x16_bf16 v[80:95], a[200:203], a[168:171], v[80:95]
 buffer_load_dwordx4 v16, s[8:11], s32 offen offset:3072 lds
 s_add_u32 s32, s32, 16384
 v_add_f32 v27, v27, v36
 v_add_f32 v27, v27, v37
 v_cvt_pk_bf16_f32 v146, v36, v37
 v_exp_f32 v38, v102
 s_waitcnt lgkmcnt(4)
 v_mfma_f32_32x32x16_bf16 v[64:79], a[204:207], a[140:143], v[64:79]
 ds_read_b64_tr_b16 a[192:193], v10 offset:32768
 ds_read_b64_tr_b16 a[194:195], v10 offset:34816
 v_exp_f32 v39, v103
 v_mfma_f32_32x32x16_bf16 v[80:95], a[204:207], a[172:175], v[80:95]
 v_add_f32 v27, v27, v38
 v_add_f32 v27, v27, v39
 v_cvt_pk_bf16_f32 v147, v38, v39
 v_exp_f32 v32, v104
 s_waitcnt lgkmcnt(5)
 v_mfma_f32_32x32x16_bf16 v[64:79], a[208:211], a[144:147], v[64:79]
 ds_read_b64_tr_b16 a[196:197], v10 offset:33024
 ds_read_b64_tr_b16 a[198:199], v10 offset:35072
 v_exp_f32 v33, v105
 v_mfma_f32_32x32x16_bf16 v[80:95], a[208:211], a[176:179], v[80:95]
 v_add_f32 v27, v27, v32
 v_add_f32 v27, v27, v33
 v_cvt_pk_bf16_f32 v148, v32, v33
 v_exp_f32 v34, v106
 s_waitcnt lgkmcnt(6)
 v_mfma_f32_32x32x16_bf16 v[64:79], a[212:215], a[148:151], v[64:79]
 ds_read_b64_tr_b16 a[200:201], v10 offset:33280
 ds_read_b64_tr_b16 a[202:203], v10 offset:35328
 s_add_u32 m0, s31, 65536
 s_nop 0
 buffer_load_dwordx4 v17, s[12:15], s33 offen offset:0 lds
 v_exp_f32 v35, v107
 v_mfma_f32_32x32x16_bf16 v[80:95], a[212:215], a[180:183], v[80:95]
 v_add_f32 v27, v27, v34
 v_add_f32 v27, v27, v35
 v_cvt_pk_bf16_f32 v149, v34, v35
 v_exp_f32 v36, v108
 s_waitcnt lgkmcnt(7)
 v_mfma_f32_32x32x16_bf16 v[64:79], a[216:219], a[152:155], v[64:79]
 ds_read_b64_tr_b16 a[204:205], v10 offset:33536
 ds_read_b64_tr_b16 a[206:207], v10 offset:35584
 v_exp_f32 v37, v109
 v_mfma_f32_32x32x16_bf16 v[80:95], a[216:219], a[184:187], v[80:95]
 v_add_f32 v27, v27, v36
 v_add_f32 v27, v27, v37
 v_cvt_pk_bf16_f32 v150, v36, v37
 v_exp_f32 v38, v110
 s_waitcnt lgkmcnt(8)
 v_mfma_f32_32x32x16_bf16 v[64:79], a[220:223], a[156:159], v[64:79]
 ds_read_b64_tr_b16 a[208:209], v10 offset:36864
 ds_read_b64_tr_b16 a[210:211], v10 offset:38912
 v_exp_f32 v39, v111
 v_mfma_f32_32x32x16_bf16 v[80:95], a[220:223], a[188:191], v[80:95]
 buffer_load_dwordx4 v17, s[12:15], s33 offen offset:1024 lds
 v_add_f32 v27, v27, v38
 v_add_f32 v27, v27, v39
 v_cvt_pk_bf16_f32 v151, v38, v39
 v_exp_f32 v32, v112
 v_exp_f32 v33, v113
 s_waitcnt lgkmcnt(8)
 v_mfma_f32_32x32x16_bf16 a[0:15], a[192:195], v[128:131], 0
 ds_read_b64_tr_b16 a[212:213], v10 offset:37120
 ds_read_b64_tr_b16 a[214:215], v10 offset:39168
 v_add_f32 v28, v32, v33
 v_cvt_pk_bf16_f32 v152, v32, v33
 v_exp_f32 v34, v114
 v_mfma_f32_32x32x16_bf16 a[64:79], a[192:195], v[136:139], 0
 v_exp_f32 v35, v115
 s_waitcnt lgkmcnt(8)
 v_mfma_f32_32x32x16_bf16 a[16:31], a[196:199], v[128:131], 0
 ds_read_b64_tr_b16 a[216:217], v10 offset:37376
 ds_read_b64_tr_b16 a[218:219], v10 offset:39424
 v_add_f32 v28, v28, v34
 v_add_f32 v28, v28, v35
 v_cvt_pk_bf16_f32 v153, v34, v35
 v_exp_f32 v36, v116
 v_mfma_f32_32x32x16_bf16 a[80:95], a[196:199], v[136:139], 0
 v_exp_f32 v37, v117
 s_waitcnt lgkmcnt(8)
 v_mfma_f32_32x32x16_bf16 a[32:47], a[200:203], v[128:131], 0
 ds_read_b64_tr_b16 a[220:221], v10 offset:37632
 ds_read_b64_tr_b16 a[222:223], v10 offset:39680
 buffer_load_dwordx4 v17, s[12:15], s33 offen offset:2048 lds
 v_add_f32 v28, v28, v36
 v_add_f32 v28, v28, v37
 v_cvt_pk_bf16_f32 v154, v36, v37
 v_exp_f32 v38, v118
 v_mfma_f32_32x32x16_bf16 a[96:111], a[200:203], v[136:139], 0
 v_exp_f32 v39, v119
 s_waitcnt lgkmcnt(8)
 v_mfma_f32_32x32x16_bf16 a[48:63], a[204:207], v[128:131], 0
 ds_read_b128 a[192:195], v2 offset:24576
 v_add_f32 v28, v28, v38
 v_add_f32 v28, v28, v39
 v_cvt_pk_bf16_f32 v155, v38, v39
 v_exp_f32 v32, v120
 v_mfma_f32_32x32x16_bf16 a[112:127], a[204:207], v[136:139], 0
 v_exp_f32 v33, v121
 s_waitcnt lgkmcnt(7)
 v_mfma_f32_32x32x16_bf16 a[0:15], a[208:211], v[132:135], a[0:15]
 ds_read_b128 a[196:199], v3 offset:24576
 v_add_f32 v28, v28, v32
 v_add_f32 v28, v28, v33
 v_cvt_pk_bf16_f32 v156, v32, v33
 v_exp_f32 v34, v122
 v_mfma_f32_32x32x16_bf16 a[64:79], a[208:211], v[140:143], a[64:79]
 buffer_load_dwordx4 v17, s[12:15], s33 offen offset:3072 lds
 s_add_u32 s33, s33, 16384
 v_exp_f32 v35, v123
 s_waitcnt lgkmcnt(6)
 v_mfma_f32_32x32x16_bf16 a[16:31], a[212:215], v[132:135], a[16:31]
 ds_read_b128 a[200:203], v4 offset:24576
 v_add_f32 v28, v28, v34
 v_add_f32 v28, v28, v35
 v_cvt_pk_bf16_f32 v157, v34, v35
 v_exp_f32 v36, v124
 v_mfma_f32_32x32x16_bf16 a[80:95], a[212:215], v[140:143], a[80:95]
 v_exp_f32 v37, v125
 s_waitcnt lgkmcnt(5)
 v_mfma_f32_32x32x16_bf16 a[32:47], a[216:219], v[132:135], a[32:47]
 ds_read_b128 a[204:207], v5 offset:24576
 v_add_f32 v28, v28, v36
 v_add_f32 v28, v28, v37
 v_cvt_pk_bf16_f32 v158, v36, v37
 v_exp_f32 v38, v126
 v_mfma_f32_32x32x16_bf16 a[96:111], a[216:219], v[140:143], a[96:111]
 v_exp_f32 v39, v127
 s_waitcnt lgkmcnt(4)
 v_mfma_f32_32x32x16_bf16 a[48:63], a[220:223], v[132:135], a[48:63]
 ds_read_b128 a[208:211], v6 offset:24576
 v_add_f32 v28, v28, v38
 v_add_f32 v28, v28, v39
 v_cvt_pk_bf16_f32 v159, v38, v39
 v_mfma_f32_32x32x16_bf16 a[112:127], a[220:223], v[140:143], a[112:127]
 v_max_f32 v29, v27, v28
 v_cmp_lt_f32 vcc, s36, v29
 s_cbranch_vccnz attn_kernel_rs11
attn_kernel_rb12:
 s_waitcnt vmcnt(12)
 s_lshl_b32 s34, s30, 4
 s_lshl_b32 s35, s28, 2
 s_add_u32 s34, s34, s35
 v_mov_b32 v50, s34
 v_mov_b32 v51, s79
 s_mov_b64 exec, 1
 buffer_atomic_add v51, v50, s[64:67], 0 offen
 s_mov_b64 exec, -1
 s_mov_b32 s35, 7
attn_kernel_loop13:
 s_waitcnt lgkmcnt(4)
 v_mfma_f32_32x32x16_bf16 v[96:111], a[192:195], a[128:131], v[160:175]
 ds_read_b128 a[212:215], v7 offset:24576
 v_add_f32 v23, v23, v27
 v_add_f32 v24, v24, v28
 v_exp_f32 v32, v64
 v_exp_f32 v33, v65
 v_mfma_f32_32x32x16_bf16 v[112:127], a[192:195], a[160:163], v[176:191]
 v_add_f32 v25, v32, v33
 v_cvt_pk_bf16_f32 v128, v32, v33
 v_exp_f32 v34, v66
 s_waitcnt lgkmcnt(4)
 v_mfma_f32_32x32x16_bf16 v[96:111], a[196:199], a[132:135], v[96:111]
 ds_read_b128 a[216:219], v8 offset:24576
 v_exp_f32 v35, v67
 v_mfma_f32_32x32x16_bf16 v[112:127], a[196:199], a[164:167], v[112:127]
 v_add_f32 v25, v25, v34
 v_add_f32 v25, v25, v35
 v_cvt_pk_bf16_f32 v129, v34, v35
 v_exp_f32 v36, v68
 s_waitcnt lgkmcnt(4)
 v_mfma_f32_32x32x16_bf16 v[96:111], a[200:203], a[136:139], v[96:111]
 ds_read_b128 a[220:223], v9 offset:24576
 v_exp_f32 v37, v69
 v_mfma_f32_32x32x16_bf16 v[112:127], a[200:203], a[168:171], v[112:127]
 v_add_f32 v25, v25, v36
 v_add_f32 v25, v25, v37
 v_cvt_pk_bf16_f32 v130, v36, v37
 v_exp_f32 v38, v70
 s_waitcnt lgkmcnt(4)
 v_mfma_f32_32x32x16_bf16 v[96:111], a[204:207], a[140:143], v[96:111]
 ds_read_b64_tr_b16 a[192:193], v10 offset:40960
 ds_read_b64_tr_b16 a[194:195], v10 offset:43008
 v_exp_f32 v39, v71
 v_mfma_f32_32x32x16_bf16 v[112:127], a[204:207], a[172:175], v[112:127]
 v_add_f32 v25, v25, v38
 v_add_f32 v25, v25, v39
 v_cvt_pk_bf16_f32 v131, v38, v39
 v_exp_f32 v32, v72
 s_waitcnt lgkmcnt(5)
 v_mfma_f32_32x32x16_bf16 v[96:111], a[208:211], a[144:147], v[96:111]
 ds_read_b64_tr_b16 a[196:197], v10 offset:41216
 ds_read_b64_tr_b16 a[198:199], v10 offset:43264
 v_exp_f32 v33, v73
 v_mfma_f32_32x32x16_bf16 v[112:127], a[208:211], a[176:179], v[112:127]
 v_add_f32 v25, v25, v32
 v_add_f32 v25, v25, v33
 v_cvt_pk_bf16_f32 v132, v32, v33
 v_exp_f32 v34, v74
 s_waitcnt lgkmcnt(6)
 v_mfma_f32_32x32x16_bf16 v[96:111], a[212:215], a[148:151], v[96:111]
 ds_read_b64_tr_b16 a[200:201], v10 offset:41472
 ds_read_b64_tr_b16 a[202:203], v10 offset:43520
 v_exp_f32 v35, v75
 v_mfma_f32_32x32x16_bf16 v[112:127], a[212:215], a[180:183], v[112:127]
 v_add_f32 v25, v25, v34
 v_add_f32 v25, v25, v35
 v_cvt_pk_bf16_f32 v133, v34, v35
 v_exp_f32 v36, v76
 s_waitcnt lgkmcnt(7)
 v_mfma_f32_32x32x16_bf16 v[96:111], a[216:219], a[152:155], v[96:111]
 ds_read_b64_tr_b16 a[204:205], v10 offset:41728
 ds_read_b64_tr_b16 a[206:207], v10 offset:43776
 v_exp_f32 v37, v77
 v_mfma_f32_32x32x16_bf16 v[112:127], a[216:219], a[184:187], v[112:127]
 v_add_f32 v25, v25, v36
 v_add_f32 v25, v25, v37
 v_cvt_pk_bf16_f32 v134, v36, v37
 v_exp_f32 v38, v78
 s_waitcnt lgkmcnt(8)
 v_mfma_f32_32x32x16_bf16 v[96:111], a[220:223], a[156:159], v[96:111]
 ds_read_b64_tr_b16 a[208:209], v10 offset:45056
 ds_read_b64_tr_b16 a[210:211], v10 offset:47104
 v_exp_f32 v39, v79
 v_mfma_f32_32x32x16_bf16 v[112:127], a[220:223], a[188:191], v[112:127]
 v_add_f32 v25, v25, v38
 v_add_f32 v25, v25, v39
 v_cvt_pk_bf16_f32 v135, v38, v39
 v_exp_f32 v32, v80
 v_exp_f32 v33, v81
 s_waitcnt lgkmcnt(8)
 v_mfma_f32_32x32x16_bf16 a[0:15], a[192:195], v[144:147], a[0:15]
 ds_read_b64_tr_b16 a[212:213], v10 offset:45312
 ds_read_b64_tr_b16 a[214:215], v10 offset:47360
 v_add_f32 v26, v32, v33
 v_cvt_pk_bf16_f32 v136, v32, v33
 v_exp_f32 v34, v82
 v_mfma_f32_32x32x16_bf16 a[64:79], a[192:195], v[152:155], a[64:79]
 v_exp_f32 v35, v83
 s_waitcnt lgkmcnt(8)
 v_mfma_f32_32x32x16_bf16 a[16:31], a[196:199], v[144:147], a[16:31]
 ds_read_b64_tr_b16 a[216:217], v10 offset:45568
 ds_read_b64_tr_b16 a[218:219], v10 offset:47616
 v_add_f32 v26, v26, v34
 v_add_f32 v26, v26, v35
 v_cvt_pk_bf16_f32 v137, v34, v35
 v_exp_f32 v36, v84
 v_mfma_f32_32x32x16_bf16 a[80:95], a[196:199], v[152:155], a[80:95]
 v_exp_f32 v37, v85
 s_waitcnt lgkmcnt(8)
 v_mfma_f32_32x32x16_bf16 a[32:47], a[200:203], v[144:147], a[32:47]
 ds_read_b64_tr_b16 a[220:221], v10 offset:45824
 ds_read_b64_tr_b16 a[222:223], v10 offset:47872
 v_add_f32 v26, v26, v36
 v_add_f32 v26, v26, v37
 v_cvt_pk_bf16_f32 v138, v36, v37
 v_exp_f32 v38, v86
 v_mfma_f32_32x32x16_bf16 a[96:111], a[200:203], v[152:155], a[96:111]
 s_waitcnt vmcnt(8)
 s_barrier
 v_exp_f32 v39, v87
 s_waitcnt lgkmcnt(8)
 v_mfma_f32_32x32x16_bf16 a[48:63], a[204:207], v[144:147], a[48:63]
 ds_read_b128 a[192:195], v2 offset:32768
 s_add_u32 m0, s31, 16384
 s_nop 0
 buffer_load_dwordx4 v13, s[8:11], s32 offen offset:0 lds
 v_add_f32 v26, v26, v38
 v_add_f32 v26, v26, v39
 v_cvt_pk_bf16_f32 v139, v38, v39
 v_exp_f32 v32, v88
 v_mfma_f32_32x32x16_bf16 a[112:127], a[204:207], v[152:155], a[112:127]
 v_exp_f32 v33, v89
 s_waitcnt lgkmcnt(7)
 v_mfma_f32_32x32x16_bf16 a[0:15], a[208:211], v[148:151], a[0:15]
 ds_read_b128 a[196:199], v3 offset:32768
 v_add_f32 v26, v26, v32
 v_add_f32 v26, v26, v33
 v_cvt_pk_bf16_f32 v140, v32, v33
 v_exp_f32 v34, v90
 v_mfma_f32_32x32x16_bf16 a[64:79], a[208:211], v[156:159], a[64:79]
 v_exp_f32 v35, v91
 s_waitcnt lgkmcnt(6)
 v_mfma_f32_32x32x16_bf16 a[16:31], a[212:215], v[148:151], a[16:31]
 ds_read_b128 a[200:203], v4 offset:32768
 v_add_f32 v26, v26, v34
 v_add_f32 v26, v26, v35
 v_cvt_pk_bf16_f32 v141, v34, v35
 v_exp_f32 v36, v92
 v_mfma_f32_32x32x16_bf16 a[80:95], a[212:215], v[156:159], a[80:95]
 buffer_load_dwordx4 v14, s[8:11], s32 offen offset:1024 lds
 v_exp_f32 v37, v93
 s_waitcnt lgkmcnt(5)
 v_mfma_f32_32x32x16_bf16 a[32:47], a[216:219], v[148:151], a[32:47]
 ds_read_b128 a[204:207], v5 offset:32768
 v_add_f32 v26, v26, v36
 v_add_f32 v26, v26, v37
 v_cvt_pk_bf16_f32 v142, v36, v37
 v_exp_f32 v38, v94
 v_mfma_f32_32x32x16_bf16 a[96:111], a[216:219], v[156:159], a[96:111]
 v_exp_f32 v39, v95
 s_waitcnt lgkmcnt(4)
 v_mfma_f32_32x32x16_bf16 a[48:63], a[220:223], v[148:151], a[48:63]
 ds_read_b128 a[208:211], v6 offset:32768
 v_add_f32 v26, v26, v38
 v_add_f32 v26, v26, v39
 v_cvt_pk_bf16_f32 v143, v38, v39
 v_mfma_f32_32x32x16_bf16 a[112:127], a[220:223], v[156:159], a[112:127]
 v_max_f32 v29, v25, v26
 v_cmp_lt_f32 vcc, s36, v29
 s_cbranch_vccnz attn_kernel_rs14
attn_kernel_rb15:
 s_waitcnt lgkmcnt(4)
 v_mfma_f32_32x32x16_bf16 v[64:79], a[192:195], a[128:131], v[160:175]
 ds_read_b128 a[212:215], v7 offset:32768
 buffer_load_dwordx4 v15, s[8:11], s32 offen offset:2048 lds
 v_add_f32 v23, v23, v25
 v_add_f32 v24, v24, v26
 v_exp_f32 v32, v96
 v_exp_f32 v33, v97
 v_mfma_f32_32x32x16_bf16 v[80:95], a[192:195], a[160:163], v[176:191]
 v_add_f32 v27, v32, v33
 v_cvt_pk_bf16_f32 v144, v32, v33
 v_exp_f32 v34, v98
 s_waitcnt lgkmcnt(4)
 v_mfma_f32_32x32x16_bf16 v[64:79], a[196:199], a[132:135], v[64:79]
 ds_read_b128 a[216:219], v8 offset:32768
 v_exp_f32 v35, v99
 v_mfma_f32_32x32x16_bf16 v[80:95], a[196:199], a[164:167], v[80:95]
 v_add_f32 v27, v27, v34
 v_add_f32 v27, v27, v35
 v_cvt_pk_bf16_f32 v145, v34, v35
 v_exp_f32 v36, v100
 s_waitcnt lgkmcnt(4)
 v_mfma_f32_32x32x16_bf16 v[64:79], a[200:203], a[136:139], v[64:79]
 ds_read_b128 a[220:223], v9 offset:32768
 v_exp_f32 v37, v101
 v_mfma_f32_32x32x16_bf16 v[80:95], a[200:203], a[168:171], v[80:95]
 buffer_load_dwordx4 v16, s[8:11], s32 offen offset:3072 lds
 s_add_u32 s32, s32, 16384
 v_add_f32 v27, v27, v36
 v_add_f32 v27, v27, v37
 v_cvt_pk_bf16_f32 v146, v36, v37
 v_exp_f32 v38, v102
 s_waitcnt lgkmcnt(4)
 v_mfma_f32_32x32x16_bf16 v[64:79], a[204:207], a[140:143], v[64:79]
 ds_read_b64_tr_b16 a[192:193], v10 offset:49152
 ds_read_b64_tr_b16 a[194:195], v10 offset:51200
 v_exp_f32 v39, v103
 v_mfma_f32_32x32x16_bf16 v[80:95], a[204:207], a[172:175], v[80:95]
 v_add_f32 v27, v27, v38
 v_add_f32 v27, v27, v39
 v_cvt_pk_bf16_f32 v147, v38, v39
 v_exp_f32 v32, v104
 s_waitcnt lgkmcnt(5)
 v_mfma_f32_32x32x16_bf16 v[64:79], a[208:211], a[144:147], v[64:79]
 ds_read_b64_tr_b16 a[196:197], v10 offset:49408
 ds_read_b64_tr_b16 a[198:199], v10 offset:51456
 v_exp_f32 v33, v105
 v_mfma_f32_32x32x16_bf16 v[80:95], a[208:211], a[176:179], v[80:95]
 v_add_f32 v27, v27, v32
 v_add_f32 v27, v27, v33
 v_cvt_pk_bf16_f32 v148, v32, v33
 v_exp_f32 v34, v106
 s_waitcnt lgkmcnt(6)
 v_mfma_f32_32x32x16_bf16 v[64:79], a[212:215], a[148:151], v[64:79]
 ds_read_b64_tr_b16 a[200:201], v10 offset:49664
 ds_read_b64_tr_b16 a[202:203], v10 offset:51712
 s_add_u32 m0, s31, 81920
 s_nop 0
 buffer_load_dwordx4 v17, s[12:15], s33 offen offset:0 lds
 v_exp_f32 v35, v107
 v_mfma_f32_32x32x16_bf16 v[80:95], a[212:215], a[180:183], v[80:95]
 v_add_f32 v27, v27, v34
 v_add_f32 v27, v27, v35
 v_cvt_pk_bf16_f32 v149, v34, v35
 v_exp_f32 v36, v108
 s_waitcnt lgkmcnt(7)
 v_mfma_f32_32x32x16_bf16 v[64:79], a[216:219], a[152:155], v[64:79]
 ds_read_b64_tr_b16 a[204:205], v10 offset:49920
 ds_read_b64_tr_b16 a[206:207], v10 offset:51968
 v_exp_f32 v37, v109
 v_mfma_f32_32x32x16_bf16 v[80:95], a[216:219], a[184:187], v[80:95]
 v_add_f32 v27, v27, v36
 v_add_f32 v27, v27, v37
 v_cvt_pk_bf16_f32 v150, v36, v37
 v_exp_f32 v38, v110
 s_waitcnt lgkmcnt(8)
 v_mfma_f32_32x32x16_bf16 v[64:79], a[220:223], a[156:159], v[64:79]
 ds_read_b64_tr_b16 a[208:209], v10 offset:53248
 ds_read_b64_tr_b16 a[210:211], v10 offset:55296
 v_exp_f32 v39, v111
 v_mfma_f32_32x32x16_bf16 v[80:95], a[220:223], a[188:191], v[80:95]
 buffer_load_dwordx4 v17, s[12:15], s33 offen offset:1024 lds
 v_add_f32 v27, v27, v38
 v_add_f32 v27, v27, v39
 v_cvt_pk_bf16_f32 v151, v38, v39
 v_exp_f32 v32, v112
 v_exp_f32 v33, v113
 s_waitcnt lgkmcnt(8)
 v_mfma_f32_32x32x16_bf16 a[0:15], a[192:195], v[128:131], a[0:15]
 ds_read_b64_tr_b16 a[212:213], v10 offset:53504
 ds_read_b64_tr_b16 a[214:215], v10 offset:55552
 v_add_f32 v28, v32, v33
 v_cvt_pk_bf16_f32 v152, v32, v33
 v_exp_f32 v34, v114
 v_mfma_f32_32x32x16_bf16 a[64:79], a[192:195], v[136:139], a[64:79]
 v_exp_f32 v35, v115
 s_waitcnt lgkmcnt(8)
 v_mfma_f32_32x32x16_bf16 a[16:31], a[196:199], v[128:131], a[16:31]
 ds_read_b64_tr_b16 a[216:217], v10 offset:53760
 ds_read_b64_tr_b16 a[218:219], v10 offset:55808
 v_add_f32 v28, v28, v34
 v_add_f32 v28, v28, v35
 v_cvt_pk_bf16_f32 v153, v34, v35
 v_exp_f32 v36, v116
 v_mfma_f32_32x32x16_bf16 a[80:95], a[196:199], v[136:139], a[80:95]
 v_exp_f32 v37, v117
 s_waitcnt lgkmcnt(8)
 v_mfma_f32_32x32x16_bf16 a[32:47], a[200:203], v[128:131], a[32:47]
 ds_read_b64_tr_b16 a[220:221], v10 offset:54016
 ds_read_b64_tr_b16 a[222:223], v10 offset:56064
 buffer_load_dwordx4 v17, s[12:15], s33 offen offset:2048 lds
 v_add_f32 v28, v28, v36
 v_add_f32 v28, v28, v37
 v_cvt_pk_bf16_f32 v154, v36, v37
 v_exp_f32 v38, v118
 v_mfma_f32_32x32x16_bf16 a[96:111], a[200:203], v[136:139], a[96:111]
 v_exp_f32 v39, v119
 s_waitcnt lgkmcnt(8)
 v_mfma_f32_32x32x16_bf16 a[48:63], a[204:207], v[128:131], a[48:63]
 ds_read_b128 a[192:195], v2 offset:40960
 v_add_f32 v28, v28, v38
 v_add_f32 v28, v28, v39
 v_cvt_pk_bf16_f32 v155, v38, v39
 v_exp_f32 v32, v120
 v_mfma_f32_32x32x16_bf16 a[112:127], a[204:207], v[136:139], a[112:127]
 v_exp_f32 v33, v121
 s_waitcnt lgkmcnt(7)
 v_mfma_f32_32x32x16_bf16 a[0:15], a[208:211], v[132:135], a[0:15]
 ds_read_b128 a[196:199], v3 offset:40960
 v_add_f32 v28, v28, v32
 v_add_f32 v28, v28, v33
 v_cvt_pk_bf16_f32 v156, v32, v33
 v_exp_f32 v34, v122
 v_mfma_f32_32x32x16_bf16 a[64:79], a[208:211], v[140:143], a[64:79]
 buffer_load_dwordx4 v17, s[12:15], s33 offen offset:3072 lds
 s_add_u32 s33, s33, 16384
 v_exp_f32 v35, v123
 s_waitcnt lgkmcnt(6)
 v_mfma_f32_32x32x16_bf16 a[16:31], a[212:215], v[132:135], a[16:31]
 ds_read_b128 a[200:203], v4 offset:40960
 v_add_f32 v28, v28, v34
 v_add_f32 v28, v28, v35
 v_cvt_pk_bf16_f32 v157, v34, v35
 v_exp_f32 v36, v124
 v_mfma_f32_32x32x16_bf16 a[80:95], a[212:215], v[140:143], a[80:95]
 v_exp_f32 v37, v125
 s_waitcnt lgkmcnt(5)
 v_mfma_f32_32x32x16_bf16 a[32:47], a[216:219], v[132:135], a[32:47]
 ds_read_b128 a[204:207], v5 offset:40960
 buffer_load_dword v49, v48, s[44:47], s60 offen
 v_add_f32 v28, v28, v36
 v_add_f32 v28, v28, v37
 v_cvt_pk_bf16_f32 v158, v36, v37
 v_exp_f32 v38, v126
 v_mfma_f32_32x32x16_bf16 a[96:111], a[216:219], v[140:143], a[96:111]
 v_exp_f32 v39, v127
 s_waitcnt lgkmcnt(4)
 v_mfma_f32_32x32x16_bf16 a[48:63], a[220:223], v[132:135], a[48:63]
 ds_read_b128 a[208:211], v6 offset:40960
 v_add_f32 v28, v28, v38
 v_add_f32 v28, v28, v39
 v_cvt_pk_bf16_f32 v159, v38, v39
 v_mfma_f32_32x32x16_bf16 a[112:127], a[220:223], v[140:143], a[112:127]
 v_max_f32 v29, v27, v28
 v_cmp_lt_f32 vcc, s36, v29
 s_cbranch_vccnz attn_kernel_rs16
attn_kernel_rb17:
 s_waitcnt lgkmcnt(4)
 v_mfma_f32_32x32x16_bf16 v[96:111], a[192:195], a[128:131], v[160:175]
 ds_read_b128 a[212:215], v7 offset:40960
 v_add_f32 v23, v23, v27
 v_add_f32 v24, v24, v28
 v_exp_f32 v32, v64
 v_exp_f32 v33, v65
 v_mfma_f32_32x32x16_bf16 v[112:127], a[192:195], a[160:163], v[176:191]
 v_add_f32 v25, v32, v33
 v_cvt_pk_bf16_f32 v128, v32, v33
 v_exp_f32 v34, v66
 s_waitcnt lgkmcnt(4)
 v_mfma_f32_32x32x16_bf16 v[96:111], a[196:199], a[132:135], v[96:111]
 ds_read_b128 a[216:219], v8 offset:40960
 v_exp_f32 v35, v67
 v_mfma_f32_32x32x16_bf16 v[112:127], a[196:199], a[164:167], v[112:127]
 v_add_f32 v25, v25, v34
 v_add_f32 v25, v25, v35
 v_cvt_pk_bf16_f32 v129, v34, v35
 v_exp_f32 v36, v68
 s_waitcnt lgkmcnt(4)
 v_mfma_f32_32x32x16_bf16 v[96:111], a[200:203], a[136:139], v[96:111]
 ds_read_b128 a[220:223], v9 offset:40960
 v_exp_f32 v37, v69
 v_mfma_f32_32x32x16_bf16 v[112:127], a[200:203], a[168:171], v[112:127]
 v_add_f32 v25, v25, v36
 v_add_f32 v25, v25, v37
 v_cvt_pk_bf16_f32 v130, v36, v37
 v_exp_f32 v38, v70
 s_waitcnt lgkmcnt(4)
 v_mfma_f32_32x32x16_bf16 v[96:111], a[204:207], a[140:143], v[96:111]
 ds_read_b64_tr_b16 a[192:193], v10 offset:57344
 ds_read_b64_tr_b16 a[194:195], v10 offset:59392
 v_exp_f32 v39, v71
 v_mfma_f32_32x32x16_bf16 v[112:127], a[204:207], a[172:175], v[112:127]
 v_add_f32 v25, v25, v38
 v_add_f32 v25, v25, v39
 v_cvt_pk_bf16_f32 v131, v38, v39
 v_exp_f32 v32, v72
 s_waitcnt lgkmcnt(5)
 v_mfma_f32_32x32x16_bf16 v[96:111], a[208:211], a[144:147], v[96:111]
 ds_read_b64_tr_b16 a[196:197], v10 offset:57600
 ds_read_b64_tr_b16 a[198:199], v10 offset:59648
 v_exp_f32 v33, v73
 v_mfma_f32_32x32x16_bf16 v[112:127], a[208:211], a[176:179], v[112:127]
 v_add_f32 v25, v25, v32
 v_add_f32 v25, v25, v33
 v_cvt_pk_bf16_f32 v132, v32, v33
 v_exp_f32 v34, v74
 s_waitcnt lgkmcnt(6)
 v_mfma_f32_32x32x16_bf16 v[96:111], a[212:215], a[148:151], v[96:111]
 ds_read_b64_tr_b16 a[200:201], v10 offset:57856
 ds_read_b64_tr_b16 a[202:203], v10 offset:59904
 v_exp_f32 v35, v75
 v_mfma_f32_32x32x16_bf16 v[112:127], a[212:215], a[180:183], v[112:127]
 v_add_f32 v25, v25, v34
 v_add_f32 v25, v25, v35
 v_cvt_pk_bf16_f32 v133, v34, v35
 v_exp_f32 v36, v76
 s_waitcnt lgkmcnt(7)
 v_mfma_f32_32x32x16_bf16 v[96:111], a[216:219], a[152:155], v[96:111]
 ds_read_b64_tr_b16 a[204:205], v10 offset:58112
 ds_read_b64_tr_b16 a[206:207], v10 offset:60160
 v_exp_f32 v37, v77
 v_mfma_f32_32x32x16_bf16 v[112:127], a[216:219], a[184:187], v[112:127]
 v_add_f32 v25, v25, v36
 v_add_f32 v25, v25, v37
 v_cvt_pk_bf16_f32 v134, v36, v37
 v_exp_f32 v38, v78
 s_waitcnt lgkmcnt(8)
 v_mfma_f32_32x32x16_bf16 v[96:111], a[220:223], a[156:159], v[96:111]
 ds_read_b64_tr_b16 a[208:209], v10 offset:61440
 ds_read_b64_tr_b16 a[210:211], v10 offset:63488
 v_exp_f32 v39, v79
 v_mfma_f32_32x32x16_bf16 v[112:127], a[220:223], a[188:191], v[112:127]
 v_add_f32 v25, v25, v38
 v_add_f32 v25, v25, v39
 v_cvt_pk_bf16_f32 v135, v38, v39
 v_exp_f32 v32, v80
 v_exp_f32 v33, v81
 s_waitcnt lgkmcnt(8)
 v_mfma_f32_32x32x16_bf16 a[0:15], a[192:195], v[144:147], a[0:15]
 ds_read_b64_tr_b16 a[212:213], v10 offset:61696
 ds_read_b64_tr_b16 a[214:215], v10 offset:63744
 v_add_f32 v26, v32, v33
 v_cvt_pk_bf16_f32 v136, v32, v33
 v_exp_f32 v34, v82
 v_mfma_f32_32x32x16_bf16 a[64:79], a[192:195], v[152:155], a[64:79]
 v_exp_f32 v35, v83
 s_waitcnt lgkmcnt(8)
 v_mfma_f32_32x32x16_bf16 a[16:31], a[196:199], v[144:147], a[16:31]
 ds_read_b64_tr_b16 a[216:217], v10 offset:61952
 ds_read_b64_tr_b16 a[218:219], v10 offset:64000
 v_add_f32 v26, v26, v34
 v_add_f32 v26, v26, v35
 v_cvt_pk_bf16_f32 v137, v34, v35
 v_exp_f32 v36, v84
 v_mfma_f32_32x32x16_bf16 a[80:95], a[196:199], v[152:155], a[80:95]
 v_exp_f32 v37, v85
 s_waitcnt lgkmcnt(8)
 v_mfma_f32_32x32x16_bf16 a[32:47], a[200:203], v[144:147], a[32:47]
 ds_read_b64_tr_b16 a[220:221], v10 offset:62208
 ds_read_b64_tr_b16 a[222:223], v10 offset:64256
 v_add_f32 v26, v26, v36
 v_add_f32 v26, v26, v37
 v_cvt_pk_bf16_f32 v138, v36, v37
 v_exp_f32 v38, v86
 v_mfma_f32_32x32x16_bf16 a[96:111], a[200:203], v[152:155], a[96:111]
 s_waitcnt vmcnt(8)
 s_barrier
 v_exp_f32 v39, v87
 s_waitcnt lgkmcnt(8)
 v_mfma_f32_32x32x16_bf16 a[48:63], a[204:207], v[144:147], a[48:63]
 ds_read_b128 a[192:195], v2 offset:49152
 s_add_u32 m0, s31, 32768
 s_nop 0
 buffer_load_dwordx4 v13, s[8:11], s32 offen offset:0 lds
 v_add_f32 v26, v26, v38
 v_add_f32 v26, v26, v39
 v_cvt_pk_bf16_f32 v139, v38, v39
 v_exp_f32 v32, v88
 v_mfma_f32_32x32x16_bf16 a[112:127], a[204:207], v[152:155], a[112:127]
 v_exp_f32 v33, v89
 s_waitcnt lgkmcnt(7)
 v_mfma_f32_32x32x16_bf16 a[0:15], a[208:211], v[148:151], a[0:15]
 ds_read_b128 a[196:199], v3 offset:49152
 v_add_f32 v26, v26, v32
 v_add_f32 v26, v26, v33
 v_cvt_pk_bf16_f32 v140, v32, v33
 v_exp_f32 v34, v90
 v_mfma_f32_32x32x16_bf16 a[64:79], a[208:211], v[156:159], a[64:79]
 v_exp_f32 v35, v91
 s_waitcnt lgkmcnt(6)
 v_mfma_f32_32x32x16_bf16 a[16:31], a[212:215], v[148:151], a[16:31]
 ds_read_b128 a[200:203], v4 offset:49152
 v_add_f32 v26, v26, v34
 v_add_f32 v26, v26, v35
 v_cvt_pk_bf16_f32 v141, v34, v35
 v_exp_f32 v36, v92
 v_mfma_f32_32x32x16_bf16 a[80:95], a[212:215], v[156:159], a[80:95]
 buffer_load_dwordx4 v14, s[8:11], s32 offen offset:1024 lds
 v_exp_f32 v37, v93
 s_waitcnt lgkmcnt(5)
 v_mfma_f32_32x32x16_bf16 a[32:47], a[216:219], v[148:151], a[32:47]
 ds_read_b128 a[204:207], v5 offset:49152
 v_add_f32 v26, v26, v36
 v_add_f32 v26, v26, v37
 v_cvt_pk_bf16_f32 v142, v36, v37
 v_exp_f32 v38, v94
 v_mfma_f32_32x32x16_bf16 a[96:111], a[216:219], v[156:159], a[96:111]
 v_exp_f32 v39, v95
 s_waitcnt lgkmcnt(4)
 v_mfma_f32_32x32x16_bf16 a[48:63], a[220:223], v[148:151], a[48:63]
 ds_read_b128 a[208:211], v6 offset:49152
 v_add_f32 v26, v26, v38
 v_add_f32 v26, v26, v39
 v_cvt_pk_bf16_f32 v143, v38, v39
 v_mfma_f32_32x32x16_bf16 a[112:127], a[220:223], v[156:159], a[112:127]
 v_max_f32 v29, v25, v26
 v_cmp_lt_f32 vcc, s36, v29
 s_cbranch_vccnz attn_kernel_rs18
attn_kernel_rb19:
 s_waitcnt lgkmcnt(4)
 v_mfma_f32_32x32x16_bf16 v[64:79], a[192:195], a[128:131], v[160:175]
 ds_read_b128 a[212:215], v7 offset:49152
 buffer_load_dwordx4 v15, s[8:11], s32 offen offset:2048 lds
 v_add_f32 v23, v23, v25
 v_add_f32 v24, v24, v26
 v_exp_f32 v32, v96
 v_exp_f32 v33, v97
 v_mfma_f32_32x32x16_bf16 v[80:95], a[192:195], a[160:163], v[176:191]
 v_add_f32 v27, v32, v33
 v_cvt_pk_bf16_f32 v144, v32, v33
 v_exp_f32 v34, v98
 s_waitcnt lgkmcnt(4)
 v_mfma_f32_32x32x16_bf16 v[64:79], a[196:199], a[132:135], v[64:79]
 ds_read_b128 a[216:219], v8 offset:49152
 v_exp_f32 v35, v99
 v_mfma_f32_32x32x16_bf16 v[80:95], a[196:199], a[164:167], v[80:95]
 v_add_f32 v27, v27, v34
 v_add_f32 v27, v27, v35
 v_cvt_pk_bf16_f32 v145, v34, v35
 v_exp_f32 v36, v100
 s_waitcnt lgkmcnt(4)
 v_mfma_f32_32x32x16_bf16 v[64:79], a[200:203], a[136:139], v[64:79]
 ds_read_b128 a[220:223], v9 offset:49152
 v_exp_f32 v37, v101
 v_mfma_f32_32x32x16_bf16 v[80:95], a[200:203], a[168:171], v[80:95]
 buffer_load_dwordx4 v16, s[8:11], s32 offen offset:3072 lds
 s_add_u32 s32, s32, 16384
 v_add_f32 v27, v27, v36
 v_add_f32 v27, v27, v37
 v_cvt_pk_bf16_f32 v146, v36, v37
 v_exp_f32 v38, v102
 s_waitcnt lgkmcnt(4)
 v_mfma_f32_32x32x16_bf16 v[64:79], a[204:207], a[140:143], v[64:79]
 ds_read_b64_tr_b16 a[192:193], v10 offset:0
 ds_read_b64_tr_b16 a[194:195], v10 offset:2048
 v_exp_f32 v39, v103
 v_mfma_f32_32x32x16_bf16 v[80:95], a[204:207], a[172:175], v[80:95]
 v_add_f32 v27, v27, v38
 v_add_f32 v27, v27, v39
 v_cvt_pk_bf16_f32 v147, v38, v39
 v_exp_f32 v32, v104
 s_waitcnt lgkmcnt(5)
 v_mfma_f32_32x32x16_bf16 v[64:79], a[208:211], a[144:147], v[64:79]
 ds_read_b64_tr_b16 a[196:197], v10 offset:256
 ds_read_b64_tr_b16 a[198:199], v10 offset:2304
 v_exp_f32 v33, v105
 v_mfma_f32_32x32x16_bf16 v[80:95], a[208:211], a[176:179], v[80:95]
 v_add_f32 v27, v27, v32
 v_add_f32 v27, v27, v33
 v_cvt_pk_bf16_f32 v148, v32, v33
 v_exp_f32 v34, v106
 s_waitcnt lgkmcnt(6)
 v_mfma_f32_32x32x16_bf16 v[64:79], a[212:215], a[148:151], v[64:79]
 ds_read_b64_tr_b16 a[200:201], v10 offset:512
 ds_read_b64_tr_b16 a[202:203], v10 offset:2560
 s_add_u32 m0, s31, 98304
 s_nop 0
 buffer_load_dwordx4 v17, s[12:15], s33 offen offset:0 lds
 v_exp_f32 v35, v107
 v_mfma_f32_32x32x16_bf16 v[80:95], a[212:215], a[180:183], v[80:95]
 v_add_f32 v27, v27, v34
 v_add_f32 v27, v27, v35
 v_cvt_pk_bf16_f32 v149, v34, v35
 v_exp_f32 v36, v108
 s_waitcnt lgkmcnt(7)
 v_mfma_f32_32x32x16_bf16 v[64:79], a[216:219], a[152:155], v[64:79]
 ds_read_b64_tr_b16 a[204:205], v10 offset:768
 ds_read_b64_tr_b16 a[206:207], v10 offset:2816
 v_exp_f32 v37, v109
 v_mfma_f32_32x32x16_bf16 v[80:95], a[216:219], a[184:187], v[80:95]
 v_add_f32 v27, v27, v36
 v_add_f32 v27, v27, v37
 v_cvt_pk_bf16_f32 v150, v36, v37
 v_exp_f32 v38, v110
 s_waitcnt lgkmcnt(8)
 v_mfma_f32_32x32x16_bf16 v[64:79], a[220:223], a[156:159], v[64:79]
 ds_read_b64_tr_b16 a[208:209], v10 offset:4096
 ds_read_b64_tr_b16 a[210:211], v10 offset:6144
 v_exp_f32 v39, v111
 v_mfma_f32_32x32x16_bf16 v[80:95], a[220:223], a[188:191], v[80:95]
 buffer_load_dwordx4 v17, s[12:15], s33 offen offset:1024 lds
 v_add_f32 v27, v27, v38
 v_add_f32 v27, v27, v39
 v_cvt_pk_bf16_f32 v151, v38, v39
 v_exp_f32 v32, v112
 v_exp_f32 v33, v113
 s_waitcnt lgkmcnt(8)
 v_mfma_f32_32x32x16_bf16 a[0:15], a[192:195], v[128:131], a[0:15]
 ds_read_b64_tr_b16 a[212:213], v10 offset:4352
 ds_read_b64_tr_b16 a[214:215], v10 offset:6400
 v_add_f32 v28, v32, v33
 v_cvt_pk_bf16_f32 v152, v32, v33
 v_exp_f32 v34, v114
 v_mfma_f32_32x32x16_bf16 a[64:79], a[192:195], v[136:139], a[64:79]
 v_exp_f32 v35, v115
 s_waitcnt lgkmcnt(8)
 v_mfma_f32_32x32x16_bf16 a[16:31], a[196:199], v[128:131], a[16:31]
 ds_read_b64_tr_b16 a[216:217], v10 offset:4608
 ds_read_b64_tr_b16 a[218:219], v10 offset:6656
 v_add_f32 v28, v28, v34
 v_add_f32 v28, v28, v35
 v_cvt_pk_bf16_f32 v153, v34, v35
 v_exp_f32 v36, v116
 v_mfma_f32_32x32x16_bf16 a[80:95], a[196:199], v[136:139], a[80:95]
 v_exp_f32 v37, v117
 s_waitcnt lgkmcnt(8)
 v_mfma_f32_32x32x16_bf16 a[32:47], a[200:203], v[128:131], a[32:47]
 ds_read_b64_tr_b16 a[220:221], v10 offset:4864
 ds_read_b64_tr_b16 a[222:223], v10 offset:6912
 buffer_load_dwordx4 v17, s[12:15], s33 offen offset:2048 lds
 v_add_f32 v28, v28, v36
 v_add_f32 v28, v28, v37
 v_cvt_pk_bf16_f32 v154, v36, v37
 v_exp_f32 v38, v118
 v_mfma_f32_32x32x16_bf16 a[96:111], a[200:203], v[136:139], a[96:111]
 v_exp_f32 v39, v119
 s_waitcnt lgkmcnt(8)
 v_mfma_f32_32x32x16_bf16 a[48:63], a[204:207], v[128:131], a[48:63]
 ds_read_b128 a[192:195], v2 offset:57344
 v_add_f32 v28, v28, v38
 v_add_f32 v28, v28, v39
 v_cvt_pk_bf16_f32 v155, v38, v39
 v_exp_f32 v32, v120
 v_mfma_f32_32x32x16_bf16 a[112:127], a[204:207], v[136:139], a[112:127]
 v_exp_f32 v33, v121
 s_waitcnt lgkmcnt(7)
 v_mfma_f32_32x32x16_bf16 a[0:15], a[208:211], v[132:135], a[0:15]
 ds_read_b128 a[196:199], v3 offset:57344
 v_add_f32 v28, v28, v32
 v_add_f32 v28, v28, v33
 v_cvt_pk_bf16_f32 v156, v32, v33
 v_exp_f32 v34, v122
 v_mfma_f32_32x32x16_bf16 a[64:79], a[208:211], v[140:143], a[64:79]
 buffer_load_dwordx4 v17, s[12:15], s33 offen offset:3072 lds
 s_add_u32 s33, s33, 16384
 v_exp_f32 v35, v123
 s_waitcnt lgkmcnt(6)
 v_mfma_f32_32x32x16_bf16 a[16:31], a[212:215], v[132:135], a[16:31]
 ds_read_b128 a[200:203], v4 offset:57344
 v_add_f32 v28, v28, v34
 v_add_f32 v28, v28, v35
 v_cvt_pk_bf16_f32 v157, v34, v35
 v_exp_f32 v36, v124
 v_mfma_f32_32x32x16_bf16 a[80:95], a[212:215], v[140:143], a[80:95]
 v_exp_f32 v37, v125
 s_waitcnt lgkmcnt(5)
 v_mfma_f32_32x32x16_bf16 a[32:47], a[216:219], v[132:135], a[32:47]
 ds_read_b128 a[204:207], v5 offset:57344
 buffer_load_dword v49, v48, s[48:51], s60 offen
 v_add_f32 v28, v28, v36
 v_add_f32 v28, v28, v37
 v_cvt_pk_bf16_f32 v158, v36, v37
 v_exp_f32 v38, v126
 v_mfma_f32_32x32x16_bf16 a[96:111], a[216:219], v[140:143], a[96:111]
 v_exp_f32 v39, v127
 s_waitcnt lgkmcnt(4)
 v_mfma_f32_32x32x16_bf16 a[48:63], a[220:223], v[132:135], a[48:63]
 ds_read_b128 a[208:211], v6 offset:57344
 v_add_f32 v28, v28, v38
 v_add_f32 v28, v28, v39
 v_cvt_pk_bf16_f32 v159, v38, v39
 v_mfma_f32_32x32x16_bf16 a[112:127], a[220:223], v[140:143], a[112:127]
 v_max_f32 v29, v27, v28
 v_cmp_lt_f32 vcc, s36, v29
 s_cbranch_vccnz attn_kernel_rs20
attn_kernel_rb21:
 s_waitcnt lgkmcnt(4)
 v_mfma_f32_32x32x16_bf16 v[96:111], a[192:195], a[128:131], v[160:175]
 ds_read_b128 a[212:215], v7 offset:57344
 v_add_f32 v23, v23, v27
 v_add_f32 v24, v24, v28
 v_exp_f32 v32, v64
 v_exp_f32 v33, v65
 v_mfma_f32_32x32x16_bf16 v[112:127], a[192:195], a[160:163], v[176:191]
 v_add_f32 v25, v32, v33
 v_cvt_pk_bf16_f32 v128, v32, v33
 v_exp_f32 v34, v66
 s_waitcnt lgkmcnt(4)
 v_mfma_f32_32x32x16_bf16 v[96:111], a[196:199], a[132:135], v[96:111]
 ds_read_b128 a[216:219], v8 offset:57344
 v_exp_f32 v35, v67
 v_mfma_f32_32x32x16_bf16 v[112:127], a[196:199], a[164:167], v[112:127]
 v_add_f32 v25, v25, v34
 v_add_f32 v25, v25, v35
 v_cvt_pk_bf16_f32 v129, v34, v35
 v_exp_f32 v36, v68
 s_waitcnt lgkmcnt(4)
 v_mfma_f32_32x32x16_bf16 v[96:111], a[200:203], a[136:139], v[96:111]
 ds_read_b128 a[220:223], v9 offset:57344
 v_exp_f32 v37, v69
 v_mfma_f32_32x32x16_bf16 v[112:127], a[200:203], a[168:171], v[112:127]
 v_add_f32 v25, v25, v36
 v_add_f32 v25, v25, v37
 v_cvt_pk_bf16_f32 v130, v36, v37
 v_exp_f32 v38, v70
 s_waitcnt lgkmcnt(4)
 v_mfma_f32_32x32x16_bf16 v[96:111], a[204:207], a[140:143], v[96:111]
 ds_read_b64_tr_b16 a[192:193], v10 offset:8192
 ds_read_b64_tr_b16 a[194:195], v10 offset:10240
 v_exp_f32 v39, v71
 v_mfma_f32_32x32x16_bf16 v[112:127], a[204:207], a[172:175], v[112:127]
 v_add_f32 v25, v25, v38
 v_add_f32 v25, v25, v39
 v_cvt_pk_bf16_f32 v131, v38, v39
 v_exp_f32 v32, v72
 s_waitcnt lgkmcnt(5)
 v_mfma_f32_32x32x16_bf16 v[96:111], a[208:211], a[144:147], v[96:111]
 ds_read_b64_tr_b16 a[196:197], v10 offset:8448
 ds_read_b64_tr_b16 a[198:199], v10 offset:10496
 v_exp_f32 v33, v73
 v_mfma_f32_32x32x16_bf16 v[112:127], a[208:211], a[176:179], v[112:127]
 v_add_f32 v25, v25, v32
 v_add_f32 v25, v25, v33
 v_cvt_pk_bf16_f32 v132, v32, v33
 v_exp_f32 v34, v74
 s_waitcnt lgkmcnt(6)
 v_mfma_f32_32x32x16_bf16 v[96:111], a[212:215], a[148:151], v[96:111]
 ds_read_b64_tr_b16 a[200:201], v10 offset:8704
 ds_read_b64_tr_b16 a[202:203], v10 offset:10752
 v_exp_f32 v35, v75
 v_mfma_f32_32x32x16_bf16 v[112:127], a[212:215], a[180:183], v[112:127]
 v_add_f32 v25, v25, v34
 v_add_f32 v25, v25, v35
 v_cvt_pk_bf16_f32 v133, v34, v35
 v_exp_f32 v36, v76
 s_waitcnt lgkmcnt(7)
 v_mfma_f32_32x32x16_bf16 v[96:111], a[216:219], a[152:155], v[96:111]
 ds_read_b64_tr_b16 a[204:205], v10 offset:8960
 ds_read_b64_tr_b16 a[206:207], v10 offset:11008
 v_exp_f32 v37, v77
 v_mfma_f32_32x32x16_bf16 v[112:127], a[216:219], a[184:187], v[112:127]
 v_add_f32 v25, v25, v36
 v_add_f32 v25, v25, v37
 v_cvt_pk_bf16_f32 v134, v36, v37
 v_exp_f32 v38, v78
 s_waitcnt lgkmcnt(8)
 v_mfma_f32_32x32x16_bf16 v[96:111], a[220:223], a[156:159], v[96:111]
 ds_read_b64_tr_b16 a[208:209], v10 offset:12288
 ds_read_b64_tr_b16 a[210:211], v10 offset:14336
 v_exp_f32 v39, v79
 v_mfma_f32_32x32x16_bf16 v[112:127], a[220:223], a[188:191], v[112:127]
 v_add_f32 v25, v25, v38
 v_add_f32 v25, v25, v39
 v_cvt_pk_bf16_f32 v135, v38, v39
 v_exp_f32 v32, v80
 v_exp_f32 v33, v81
 s_waitcnt lgkmcnt(8)
 v_mfma_f32_32x32x16_bf16 a[0:15], a[192:195], v[144:147], a[0:15]
 ds_read_b64_tr_b16 a[212:213], v10 offset:12544
 ds_read_b64_tr_b16 a[214:215], v10 offset:14592
 v_add_f32 v26, v32, v33
 v_cvt_pk_bf16_f32 v136, v32, v33
 v_exp_f32 v34, v82
 v_mfma_f32_32x32x16_bf16 a[64:79], a[192:195], v[152:155], a[64:79]
 v_exp_f32 v35, v83
 s_waitcnt lgkmcnt(8)
 v_mfma_f32_32x32x16_bf16 a[16:31], a[196:199], v[144:147], a[16:31]
 ds_read_b64_tr_b16 a[216:217], v10 offset:12800
 ds_read_b64_tr_b16 a[218:219], v10 offset:14848
 v_add_f32 v26, v26, v34
 v_add_f32 v26, v26, v35
 v_cvt_pk_bf16_f32 v137, v34, v35
 v_exp_f32 v36, v84
 v_mfma_f32_32x32x16_bf16 a[80:95], a[196:199], v[152:155], a[80:95]
 v_exp_f32 v37, v85
 s_waitcnt lgkmcnt(8)
 v_mfma_f32_32x32x16_bf16 a[32:47], a[200:203], v[144:147], a[32:47]
 ds_read_b64_tr_b16 a[220:221], v10 offset:13056
 ds_read_b64_tr_b16 a[222:223], v10 offset:15104
 v_add_f32 v26, v26, v36
 v_add_f32 v26, v26, v37
 v_cvt_pk_bf16_f32 v138, v36, v37
 v_exp_f32 v38, v86
 v_mfma_f32_32x32x16_bf16 a[96:111], a[200:203], v[152:155], a[96:111]
 s_waitcnt vmcnt(8)
 s_barrier
 v_exp_f32 v39, v87
 s_waitcnt lgkmcnt(8)
 v_mfma_f32_32x32x16_bf16 a[48:63], a[204:207], v[144:147], a[48:63]
 ds_read_b128 a[192:195], v2 offset:0
 s_add_u32 m0, s31, 49152
 s_nop 0
 buffer_load_dwordx4 v13, s[8:11], s32 offen offset:0 lds
 v_add_f32 v26, v26, v38
 v_add_f32 v26, v26, v39
 v_cvt_pk_bf16_f32 v139, v38, v39
 v_exp_f32 v32, v88
 v_mfma_f32_32x32x16_bf16 a[112:127], a[204:207], v[152:155], a[112:127]
 v_exp_f32 v33, v89
 s_waitcnt lgkmcnt(7)
 v_mfma_f32_32x32x16_bf16 a[0:15], a[208:211], v[148:151], a[0:15]
 ds_read_b128 a[196:199], v3 offset:0
 v_add_f32 v26, v26, v32
 v_add_f32 v26, v26, v33
 v_cvt_pk_bf16_f32 v140, v32, v33
 v_exp_f32 v34, v90
 v_mfma_f32_32x32x16_bf16 a[64:79], a[208:211], v[156:159], a[64:79]
 v_exp_f32 v35, v91
 s_waitcnt lgkmcnt(6)
 v_mfma_f32_32x32x16_bf16 a[16:31], a[212:215], v[148:151], a[16:31]
 ds_read_b128 a[200:203], v4 offset:0
 v_add_f32 v26, v26, v34
 v_add_f32 v26, v26, v35
 v_cvt_pk_bf16_f32 v141, v34, v35
 v_exp_f32 v36, v92
 v_mfma_f32_32x32x16_bf16 a[80:95], a[212:215], v[156:159], a[80:95]
 buffer_load_dwordx4 v14, s[8:11], s32 offen offset:1024 lds
 v_exp_f32 v37, v93
 s_waitcnt lgkmcnt(5)
 v_mfma_f32_32x32x16_bf16 a[32:47], a[216:219], v[148:151], a[32:47]
 ds_read_b128 a[204:207], v5 offset:0
 v_add_f32 v26, v26, v36
 v_add_f32 v26, v26, v37
 v_cvt_pk_bf16_f32 v142, v36, v37
 v_exp_f32 v38, v94
 v_mfma_f32_32x32x16_bf16 a[96:111], a[216:219], v[156:159], a[96:111]
 v_exp_f32 v39, v95
 s_waitcnt lgkmcnt(4)
 v_mfma_f32_32x32x16_bf16 a[48:63], a[220:223], v[148:151], a[48:63]
 ds_read_b128 a[208:211], v6 offset:0
 v_add_f32 v26, v26, v38
 v_add_f32 v26, v26, v39
 v_cvt_pk_bf16_f32 v143, v38, v39
 v_mfma_f32_32x32x16_bf16 a[112:127], a[220:223], v[156:159], a[112:127]
 v_max_f32 v29, v25, v26
 v_cmp_lt_f32 vcc, s36, v29
 s_cbranch_vccnz attn_kernel_rs22
attn_kernel_rb23:
 s_waitcnt lgkmcnt(4)
 v_mfma_f32_32x32x16_bf16 v[64:79], a[192:195], a[128:131], v[160:175]
 ds_read_b128 a[212:215], v7 offset:0
 buffer_load_dwordx4 v15, s[8:11], s32 offen offset:2048 lds
 v_add_f32 v23, v23, v25
 v_add_f32 v24, v24, v26
 v_exp_f32 v32, v96
 v_exp_f32 v33, v97
 v_mfma_f32_32x32x16_bf16 v[80:95], a[192:195], a[160:163], v[176:191]
 v_add_f32 v27, v32, v33
 v_cvt_pk_bf16_f32 v144, v32, v33
 v_exp_f32 v34, v98
 s_waitcnt lgkmcnt(4)
 v_mfma_f32_32x32x16_bf16 v[64:79], a[196:199], a[132:135], v[64:79]
 ds_read_b128 a[216:219], v8 offset:0
 v_exp_f32 v35, v99
 v_mfma_f32_32x32x16_bf16 v[80:95], a[196:199], a[164:167], v[80:95]
 v_add_f32 v27, v27, v34
 v_add_f32 v27, v27, v35
 v_cvt_pk_bf16_f32 v145, v34, v35
 v_exp_f32 v36, v100
 s_waitcnt lgkmcnt(4)
 v_mfma_f32_32x32x16_bf16 v[64:79], a[200:203], a[136:139], v[64:79]
 ds_read_b128 a[220:223], v9 offset:0
 v_exp_f32 v37, v101
 v_mfma_f32_32x32x16_bf16 v[80:95], a[200:203], a[168:171], v[80:95]
 buffer_load_dwordx4 v16, s[8:11], s32 offen offset:3072 lds
 s_add_u32 s32, s32, 16384
 v_add_f32 v27, v27, v36
 v_add_f32 v27, v27, v37
 v_cvt_pk_bf16_f32 v146, v36, v37
 v_exp_f32 v38, v102
 s_waitcnt lgkmcnt(4)
 v_mfma_f32_32x32x16_bf16 v[64:79], a[204:207], a[140:143], v[64:79]
 ds_read_b64_tr_b16 a[192:193], v10 offset:16384
 ds_read_b64_tr_b16 a[194:195], v10 offset:18432
 v_exp_f32 v39, v103
 v_mfma_f32_32x32x16_bf16 v[80:95], a[204:207], a[172:175], v[80:95]
 v_add_f32 v27, v27, v38
 v_add_f32 v27, v27, v39
 v_cvt_pk_bf16_f32 v147, v38, v39
 v_exp_f32 v32, v104
 s_waitcnt lgkmcnt(5)
 v_mfma_f32_32x32x16_bf16 v[64:79], a[208:211], a[144:147], v[64:79]
 ds_read_b64_tr_b16 a[196:197], v10 offset:16640
 ds_read_b64_tr_b16 a[198:199], v10 offset:18688
 v_exp_f32 v33, v105
 v_mfma_f32_32x32x16_bf16 v[80:95], a[208:211], a[176:179], v[80:95]
 v_add_f32 v27, v27, v32
 v_add_f32 v27, v27, v33
 v_cvt_pk_bf16_f32 v148, v32, v33
 v_exp_f32 v34, v106
 s_waitcnt lgkmcnt(6)
 v_mfma_f32_32x32x16_bf16 v[64:79], a[212:215], a[148:151], v[64:79]
 ds_read_b64_tr_b16 a[200:201], v10 offset:16896
 ds_read_b64_tr_b16 a[202:203], v10 offset:18944
 s_add_u32 m0, s31, 114688
 s_nop 0
 buffer_load_dwordx4 v17, s[12:15], s33 offen offset:0 lds
 v_exp_f32 v35, v107
 v_mfma_f32_32x32x16_bf16 v[80:95], a[212:215], a[180:183], v[80:95]
 v_add_f32 v27, v27, v34
 v_add_f32 v27, v27, v35
 v_cvt_pk_bf16_f32 v149, v34, v35
 v_exp_f32 v36, v108
 s_waitcnt lgkmcnt(7)
 v_mfma_f32_32x32x16_bf16 v[64:79], a[216:219], a[152:155], v[64:79]
 ds_read_b64_tr_b16 a[204:205], v10 offset:17152
 ds_read_b64_tr_b16 a[206:207], v10 offset:19200
 v_exp_f32 v37, v109
 v_mfma_f32_32x32x16_bf16 v[80:95], a[216:219], a[184:187], v[80:95]
 v_add_f32 v27, v27, v36
 v_add_f32 v27, v27, v37
 v_cvt_pk_bf16_f32 v150, v36, v37
 v_exp_f32 v38, v110
 s_waitcnt lgkmcnt(8)
 v_mfma_f32_32x32x16_bf16 v[64:79], a[220:223], a[156:159], v[64:79]
 ds_read_b64_tr_b16 a[208:209], v10 offset:20480
 ds_read_b64_tr_b16 a[210:211], v10 offset:22528
 v_exp_f32 v39, v111
 v_mfma_f32_32x32x16_bf16 v[80:95], a[220:223], a[188:191], v[80:95]
 buffer_load_dwordx4 v17, s[12:15], s33 offen offset:1024 lds
 v_add_f32 v27, v27, v38
 v_add_f32 v27, v27, v39
 v_cvt_pk_bf16_f32 v151, v38, v39
 v_exp_f32 v32, v112
 v_exp_f32 v33, v113
 s_waitcnt lgkmcnt(8)
 v_mfma_f32_32x32x16_bf16 a[0:15], a[192:195], v[128:131], a[0:15]
 ds_read_b64_tr_b16 a[212:213], v10 offset:20736
 ds_read_b64_tr_b16 a[214:215], v10 offset:22784
 v_add_f32 v28, v32, v33
 v_cvt_pk_bf16_f32 v152, v32, v33
 v_exp_f32 v34, v114
 v_mfma_f32_32x32x16_bf16 a[64:79], a[192:195], v[136:139], a[64:79]
 v_exp_f32 v35, v115
 s_waitcnt lgkmcnt(8)
 v_mfma_f32_32x32x16_bf16 a[16:31], a[196:199], v[128:131], a[16:31]
 ds_read_b64_tr_b16 a[216:217], v10 offset:20992
 ds_read_b64_tr_b16 a[218:219], v10 offset:23040
 v_add_f32 v28, v28, v34
 v_add_f32 v28, v28, v35
 v_cvt_pk_bf16_f32 v153, v34, v35
 v_exp_f32 v36, v116
 v_mfma_f32_32x32x16_bf16 a[80:95], a[196:199], v[136:139], a[80:95]
 v_exp_f32 v37, v117
 s_waitcnt lgkmcnt(8)
 v_mfma_f32_32x32x16_bf16 a[32:47], a[200:203], v[128:131], a[32:47]
 ds_read_b64_tr_b16 a[220:221], v10 offset:21248
 ds_read_b64_tr_b16 a[222:223], v10 offset:23296
 buffer_load_dwordx4 v17, s[12:15], s33 offen offset:2048 lds
 v_add_f32 v28, v28, v36
 v_add_f32 v28, v28, v37
 v_cvt_pk_bf16_f32 v154, v36, v37
 v_exp_f32 v38, v118
 v_mfma_f32_32x32x16_bf16 a[96:111], a[200:203], v[136:139], a[96:111]
 v_exp_f32 v39, v119
 s_waitcnt lgkmcnt(8)
 v_mfma_f32_32x32x16_bf16 a[48:63], a[204:207], v[128:131], a[48:63]
 ds_read_b128 a[192:195], v2 offset:8192
 v_add_f32 v28, v28, v38
 v_add_f32 v28, v28, v39
 v_cvt_pk_bf16_f32 v155, v38, v39
 v_exp_f32 v32, v120
 v_mfma_f32_32x32x16_bf16 a[112:127], a[204:207], v[136:139], a[112:127]
 v_exp_f32 v33, v121
 s_waitcnt lgkmcnt(7)
 v_mfma_f32_32x32x16_bf16 a[0:15], a[208:211], v[132:135], a[0:15]
 ds_read_b128 a[196:199], v3 offset:8192
 v_add_f32 v28, v28, v32
 v_add_f32 v28, v28, v33
 v_cvt_pk_bf16_f32 v156, v32, v33
 v_exp_f32 v34, v122
 v_mfma_f32_32x32x16_bf16 a[64:79], a[208:211], v[140:143], a[64:79]
 buffer_load_dwordx4 v17, s[12:15], s33 offen offset:3072 lds
 s_add_u32 s33, s33, 16384
 v_exp_f32 v35, v123
 s_waitcnt lgkmcnt(6)
 v_mfma_f32_32x32x16_bf16 a[16:31], a[212:215], v[132:135], a[16:31]
 ds_read_b128 a[200:203], v4 offset:8192
 v_add_f32 v28, v28, v34
 v_add_f32 v28, v28, v35
 v_cvt_pk_bf16_f32 v157, v34, v35
 v_exp_f32 v36, v124
 v_mfma_f32_32x32x16_bf16 a[80:95], a[212:215], v[140:143], a[80:95]
 v_exp_f32 v37, v125
 s_waitcnt lgkmcnt(5)
 v_mfma_f32_32x32x16_bf16 a[32:47], a[216:219], v[132:135], a[32:47]
 ds_read_b128 a[204:207], v5 offset:8192
 buffer_load_dword v49, v48, s[52:55], s60 offen
 s_add_u32 s60, s60, 0x400000
 v_add_f32 v28, v28, v36
 v_add_f32 v28, v28, v37
 v_cvt_pk_bf16_f32 v158, v36, v37
 v_exp_f32 v38, v126
 v_mfma_f32_32x32x16_bf16 a[96:111], a[216:219], v[140:143], a[96:111]
 v_exp_f32 v39, v127
 s_waitcnt lgkmcnt(4)
 v_mfma_f32_32x32x16_bf16 a[48:63], a[220:223], v[132:135], a[48:63]
 ds_read_b128 a[208:211], v6 offset:8192
 v_add_f32 v28, v28, v38
 v_add_f32 v28, v28, v39
 v_cvt_pk_bf16_f32 v159, v38, v39
 v_mfma_f32_32x32x16_bf16 a[112:127], a[220:223], v[140:143], a[112:127]
 v_max_f32 v29, v27, v28
 v_cmp_lt_f32 vcc, s36, v29
 s_cbranch_vccnz attn_kernel_rs24
attn_kernel_rb25:
 s_waitcnt lgkmcnt(4)
 v_mfma_f32_32x32x16_bf16 v[96:111], a[192:195], a[128:131], v[160:175]
 ds_read_b128 a[212:215], v7 offset:8192
 v_add_f32 v23, v23, v27
 v_add_f32 v24, v24, v28
 v_exp_f32 v32, v64
 v_exp_f32 v33, v65
 v_mfma_f32_32x32x16_bf16 v[112:127], a[192:195], a[160:163], v[176:191]
 v_add_f32 v25, v32, v33
 v_cvt_pk_bf16_f32 v128, v32, v33
 v_exp_f32 v34, v66
 s_waitcnt lgkmcnt(4)
 v_mfma_f32_32x32x16_bf16 v[96:111], a[196:199], a[132:135], v[96:111]
 ds_read_b128 a[216:219], v8 offset:8192
 v_exp_f32 v35, v67
 v_mfma_f32_32x32x16_bf16 v[112:127], a[196:199], a[164:167], v[112:127]
 v_add_f32 v25, v25, v34
 v_add_f32 v25, v25, v35
 v_cvt_pk_bf16_f32 v129, v34, v35
 v_exp_f32 v36, v68
 s_waitcnt lgkmcnt(4)
 v_mfma_f32_32x32x16_bf16 v[96:111], a[200:203], a[136:139], v[96:111]
 ds_read_b128 a[220:223], v9 offset:8192
 v_exp_f32 v37, v69
 v_mfma_f32_32x32x16_bf16 v[112:127], a[200:203], a[168:171], v[112:127]
 v_add_f32 v25, v25, v36
 v_add_f32 v25, v25, v37
 v_cvt_pk_bf16_f32 v130, v36, v37
 v_exp_f32 v38, v70
 s_waitcnt lgkmcnt(4)
 v_mfma_f32_32x32x16_bf16 v[96:111], a[204:207], a[140:143], v[96:111]
 ds_read_b64_tr_b16 a[192:193], v10 offset:24576
 ds_read_b64_tr_b16 a[194:195], v10 offset:26624
 v_exp_f32 v39, v71
 v_mfma_f32_32x32x16_bf16 v[112:127], a[204:207], a[172:175], v[112:127]
 v_add_f32 v25, v25, v38
 v_add_f32 v25, v25, v39
 v_cvt_pk_bf16_f32 v131, v38, v39
 v_exp_f32 v32, v72
 s_waitcnt lgkmcnt(5)
 v_mfma_f32_32x32x16_bf16 v[96:111], a[208:211], a[144:147], v[96:111]
 ds_read_b64_tr_b16 a[196:197], v10 offset:24832
 ds_read_b64_tr_b16 a[198:199], v10 offset:26880
 v_exp_f32 v33, v73
 v_mfma_f32_32x32x16_bf16 v[112:127], a[208:211], a[176:179], v[112:127]
 v_add_f32 v25, v25, v32
 v_add_f32 v25, v25, v33
 v_cvt_pk_bf16_f32 v132, v32, v33
 v_exp_f32 v34, v74
 s_waitcnt lgkmcnt(6)
 v_mfma_f32_32x32x16_bf16 v[96:111], a[212:215], a[148:151], v[96:111]
 ds_read_b64_tr_b16 a[200:201], v10 offset:25088
 ds_read_b64_tr_b16 a[202:203], v10 offset:27136
 v_exp_f32 v35, v75
 v_mfma_f32_32x32x16_bf16 v[112:127], a[212:215], a[180:183], v[112:127]
 v_add_f32 v25, v25, v34
 v_add_f32 v25, v25, v35
 v_cvt_pk_bf16_f32 v133, v34, v35
 v_exp_f32 v36, v76
 s_waitcnt lgkmcnt(7)
 v_mfma_f32_32x32x16_bf16 v[96:111], a[216:219], a[152:155], v[96:111]
 ds_read_b64_tr_b16 a[204:205], v10 offset:25344
 ds_read_b64_tr_b16 a[206:207], v10 offset:27392
 v_exp_f32 v37, v77
 v_mfma_f32_32x32x16_bf16 v[112:127], a[216:219], a[184:187], v[112:127]
 v_add_f32 v25, v25, v36
 v_add_f32 v25, v25, v37
 v_cvt_pk_bf16_f32 v134, v36, v37
 v_exp_f32 v38, v78
 s_waitcnt lgkmcnt(8)
 v_mfma_f32_32x32x16_bf16 v[96:111], a[220:223], a[156:159], v[96:111]
 ds_read_b64_tr_b16 a[208:209], v10 offset:28672
 ds_read_b64_tr_b16 a[210:211], v10 offset:30720
 v_exp_f32 v39, v79
 v_mfma_f32_32x32x16_bf16 v[112:127], a[220:223], a[188:191], v[112:127]
 v_add_f32 v25, v25, v38
 v_add_f32 v25, v25, v39
 v_cvt_pk_bf16_f32 v135, v38, v39
 v_exp_f32 v32, v80
 v_exp_f32 v33, v81
 s_waitcnt lgkmcnt(8)
 v_mfma_f32_32x32x16_bf16 a[0:15], a[192:195], v[144:147], a[0:15]
 ds_read_b64_tr_b16 a[212:213], v10 offset:28928
 ds_read_b64_tr_b16 a[214:215], v10 offset:30976
 v_add_f32 v26, v32, v33
 v_cvt_pk_bf16_f32 v136, v32, v33
 v_exp_f32 v34, v82
 v_mfma_f32_32x32x16_bf16 a[64:79], a[192:195], v[152:155], a[64:79]
 v_exp_f32 v35, v83
 s_waitcnt lgkmcnt(8)
 v_mfma_f32_32x32x16_bf16 a[16:31], a[196:199], v[144:147], a[16:31]
 ds_read_b64_tr_b16 a[216:217], v10 offset:29184
 ds_read_b64_tr_b16 a[218:219], v10 offset:31232
 v_add_f32 v26, v26, v34
 v_add_f32 v26, v26, v35
 v_cvt_pk_bf16_f32 v137, v34, v35
 v_exp_f32 v36, v84
 v_mfma_f32_32x32x16_bf16 a[80:95], a[196:199], v[152:155], a[80:95]
 v_exp_f32 v37, v85
 s_waitcnt lgkmcnt(8)
 v_mfma_f32_32x32x16_bf16 a[32:47], a[200:203], v[144:147], a[32:47]
 ds_read_b64_tr_b16 a[220:221], v10 offset:29440
 ds_read_b64_tr_b16 a[222:223], v10 offset:31488
 v_add_f32 v26, v26, v36
 v_add_f32 v26, v26, v37
 v_cvt_pk_bf16_f32 v138, v36, v37
 v_exp_f32 v38, v86
 v_mfma_f32_32x32x16_bf16 a[96:111], a[200:203], v[152:155], a[96:111]
 s_waitcnt vmcnt(8)
 s_barrier
 v_exp_f32 v39, v87
 s_waitcnt lgkmcnt(8)
 v_mfma_f32_32x32x16_bf16 a[48:63], a[204:207], v[144:147], a[48:63]
 ds_read_b128 a[192:195], v2 offset:16384
 s_add_u32 m0, s31, 0
 s_nop 0
 buffer_load_dwordx4 v13, s[8:11], s32 offen offset:0 lds
 v_add_f32 v26, v26, v38
 v_add_f32 v26, v26, v39
 v_cvt_pk_bf16_f32 v139, v38, v39
 v_exp_f32 v32, v88
 v_mfma_f32_32x32x16_bf16 a[112:127], a[204:207], v[152:155], a[112:127]
 v_exp_f32 v33, v89
 s_waitcnt lgkmcnt(7)
 v_mfma_f32_32x32x16_bf16 a[0:15], a[208:211], v[148:151], a[0:15]
 ds_read_b128 a[196:199], v3 offset:16384
 v_add_f32 v26, v26, v32
 v_add_f32 v26, v26, v33
 v_cvt_pk_bf16_f32 v140, v32, v33
 v_exp_f32 v34, v90
 v_mfma_f32_32x32x16_bf16 a[64:79], a[208:211], v[156:159], a[64:79]
 v_exp_f32 v35, v91
 s_waitcnt lgkmcnt(6)
 v_mfma_f32_32x32x16_bf16 a[16:31], a[212:215], v[148:151], a[16:31]
 ds_read_b128 a[200:203], v4 offset:16384
 v_add_f32 v26, v26, v34
 v_add_f32 v26, v26, v35
 v_cvt_pk_bf16_f32 v141, v34, v35
 v_exp_f32 v36, v92
 v_mfma_f32_32x32x16_bf16 a[80:95], a[212:215], v[156:159], a[80:95]
 buffer_load_dwordx4 v14, s[8:11], s32 offen offset:1024 lds
 v_exp_f32 v37, v93
 s_waitcnt lgkmcnt(5)
 v_mfma_f32_32x32x16_bf16 a[32:47], a[216:219], v[148:151], a[32:47]
 ds_read_b128 a[204:207], v5 offset:16384
 v_add_f32 v26, v26, v36
 v_add_f32 v26, v26, v37
 v_cvt_pk_bf16_f32 v142, v36, v37
 v_exp_f32 v38, v94
 v_mfma_f32_32x32x16_bf16 a[96:111], a[216:219], v[156:159], a[96:111]
 v_exp_f32 v39, v95
 s_waitcnt lgkmcnt(4)
 v_mfma_f32_32x32x16_bf16 a[48:63], a[220:223], v[148:151], a[48:63]
 ds_read_b128 a[208:211], v6 offset:16384
 v_add_f32 v26, v26, v38
 v_add_f32 v26, v26, v39
 v_cvt_pk_bf16_f32 v143, v38, v39
 v_mfma_f32_32x32x16_bf16 a[112:127], a[220:223], v[156:159], a[112:127]
 v_max_f32 v29, v25, v26
 v_cmp_lt_f32 vcc, s36, v29
 s_cbranch_vccnz attn_kernel_rs26
attn_kernel_rb27:
 s_waitcnt lgkmcnt(4)
 v_mfma_f32_32x32x16_bf16 v[64:79], a[192:195], a[128:131], v[160:175]
 ds_read_b128 a[212:215], v7 offset:16384
 buffer_load_dwordx4 v15, s[8:11], s32 offen offset:2048 lds
 v_add_f32 v23, v23, v25
 v_add_f32 v24, v24, v26
 v_exp_f32 v32, v96
 v_exp_f32 v33, v97
 v_mfma_f32_32x32x16_bf16 v[80:95], a[192:195], a[160:163], v[176:191]
 v_add_f32 v27, v32, v33
 v_cvt_pk_bf16_f32 v144, v32, v33
 v_exp_f32 v34, v98
 s_waitcnt lgkmcnt(4)
 v_mfma_f32_32x32x16_bf16 v[64:79], a[196:199], a[132:135], v[64:79]
 ds_read_b128 a[216:219], v8 offset:16384
 v_exp_f32 v35, v99
 v_mfma_f32_32x32x16_bf16 v[80:95], a[196:199], a[164:167], v[80:95]
 v_add_f32 v27, v27, v34
 v_add_f32 v27, v27, v35
 v_cvt_pk_bf16_f32 v145, v34, v35
 v_exp_f32 v36, v100
 s_waitcnt lgkmcnt(4)
 v_mfma_f32_32x32x16_bf16 v[64:79], a[200:203], a[136:139], v[64:79]
 ds_read_b128 a[220:223], v9 offset:16384
 v_exp_f32 v37, v101
 v_mfma_f32_32x32x16_bf16 v[80:95], a[200:203], a[168:171], v[80:95]
 buffer_load_dwordx4 v16, s[8:11], s32 offen offset:3072 lds
 s_add_u32 s32, s32, 16384
 v_add_f32 v27, v27, v36
 v_add_f32 v27, v27, v37
 v_cvt_pk_bf16_f32 v146, v36, v37
 v_exp_f32 v38, v102
 s_waitcnt lgkmcnt(4)
 v_mfma_f32_32x32x16_bf16 v[64:79], a[204:207], a[140:143], v[64:79]
 ds_read_b64_tr_b16 a[192:193], v10 offset:32768
 ds_read_b64_tr_b16 a[194:195], v10 offset:34816
 v_exp_f32 v39, v103
 v_mfma_f32_32x32x16_bf16 v[80:95], a[204:207], a[172:175], v[80:95]
 v_add_f32 v27, v27, v38
 v_add_f32 v27, v27, v39
 v_cvt_pk_bf16_f32 v147, v38, v39
 v_exp_f32 v32, v104
 s_waitcnt lgkmcnt(5)
 v_mfma_f32_32x32x16_bf16 v[64:79], a[208:211], a[144:147], v[64:79]
 ds_read_b64_tr_b16 a[196:197], v10 offset:33024
 ds_read_b64_tr_b16 a[198:199], v10 offset:35072
 v_exp_f32 v33, v105
 v_mfma_f32_32x32x16_bf16 v[80:95], a[208:211], a[176:179], v[80:95]
 v_add_f32 v27, v27, v32
 v_add_f32 v27, v27, v33
 v_cvt_pk_bf16_f32 v148, v32, v33
 v_exp_f32 v34, v106
 s_waitcnt lgkmcnt(6)
 v_mfma_f32_32x32x16_bf16 v[64:79], a[212:215], a[148:151], v[64:79]
 ds_read_b64_tr_b16 a[200:201], v10 offset:33280
 ds_read_b64_tr_b16 a[202:203], v10 offset:35328
 s_add_u32 m0, s31, 65536
 s_nop 0
 buffer_load_dwordx4 v17, s[12:15], s33 offen offset:0 lds
 v_exp_f32 v35, v107
 v_mfma_f32_32x32x16_bf16 v[80:95], a[212:215], a[180:183], v[80:95]
 v_add_f32 v27, v27, v34
 v_add_f32 v27, v27, v35
 v_cvt_pk_bf16_f32 v149, v34, v35
 v_exp_f32 v36, v108
 s_waitcnt lgkmcnt(7)
 v_mfma_f32_32x32x16_bf16 v[64:79], a[216:219], a[152:155], v[64:79]
 ds_read_b64_tr_b16 a[204:205], v10 offset:33536
 ds_read_b64_tr_b16 a[206:207], v10 offset:35584
 v_exp_f32 v37, v109
 v_mfma_f32_32x32x16_bf16 v[80:95], a[216:219], a[184:187], v[80:95]
 v_add_f32 v27, v27, v36
 v_add_f32 v27, v27, v37
 v_cvt_pk_bf16_f32 v150, v36, v37
 v_exp_f32 v38, v110
 s_waitcnt lgkmcnt(8)
 v_mfma_f32_32x32x16_bf16 v[64:79], a[220:223], a[156:159], v[64:79]
 ds_read_b64_tr_b16 a[208:209], v10 offset:36864
 ds_read_b64_tr_b16 a[210:211], v10 offset:38912
 v_exp_f32 v39, v111
 v_mfma_f32_32x32x16_bf16 v[80:95], a[220:223], a[188:191], v[80:95]
 buffer_load_dwordx4 v17, s[12:15], s33 offen offset:1024 lds
 v_add_f32 v27, v27, v38
 v_add_f32 v27, v27, v39
 v_cvt_pk_bf16_f32 v151, v38, v39
 v_exp_f32 v32, v112
 v_exp_f32 v33, v113
 s_waitcnt lgkmcnt(8)
 v_mfma_f32_32x32x16_bf16 a[0:15], a[192:195], v[128:131], a[0:15]
 ds_read_b64_tr_b16 a[212:213], v10 offset:37120
 ds_read_b64_tr_b16 a[214:215], v10 offset:39168
 v_add_f32 v28, v32, v33
 v_cvt_pk_bf16_f32 v152, v32, v33
 v_exp_f32 v34, v114
 v_mfma_f32_32x32x16_bf16 a[64:79], a[192:195], v[136:139], a[64:79]
 v_exp_f32 v35, v115
 s_waitcnt lgkmcnt(8)
 v_mfma_f32_32x32x16_bf16 a[16:31], a[196:199], v[128:131], a[16:31]
 ds_read_b64_tr_b16 a[216:217], v10 offset:37376
 ds_read_b64_tr_b16 a[218:219], v10 offset:39424
 v_add_f32 v28, v28, v34
 v_add_f32 v28, v28, v35
 v_cvt_pk_bf16_f32 v153, v34, v35
 v_exp_f32 v36, v116
 v_mfma_f32_32x32x16_bf16 a[80:95], a[196:199], v[136:139], a[80:95]
 v_exp_f32 v37, v117
 s_waitcnt lgkmcnt(8)
 v_mfma_f32_32x32x16_bf16 a[32:47], a[200:203], v[128:131], a[32:47]
 ds_read_b64_tr_b16 a[220:221], v10 offset:37632
 ds_read_b64_tr_b16 a[222:223], v10 offset:39680
 buffer_load_dwordx4 v17, s[12:15], s33 offen offset:2048 lds
 v_add_f32 v28, v28, v36
 v_add_f32 v28, v28, v37
 v_cvt_pk_bf16_f32 v154, v36, v37
 v_exp_f32 v38, v118
 v_mfma_f32_32x32x16_bf16 a[96:111], a[200:203], v[136:139], a[96:111]
 v_exp_f32 v39, v119
 s_waitcnt lgkmcnt(8)
 v_mfma_f32_32x32x16_bf16 a[48:63], a[204:207], v[128:131], a[48:63]
 ds_read_b128 a[192:195], v2 offset:24576
 v_add_f32 v28, v28, v38
 v_add_f32 v28, v28, v39
 v_cvt_pk_bf16_f32 v155, v38, v39
 v_exp_f32 v32, v120
 v_mfma_f32_32x32x16_bf16 a[112:127], a[204:207], v[136:139], a[112:127]
 v_exp_f32 v33, v121
 s_waitcnt lgkmcnt(7)
 v_mfma_f32_32x32x16_bf16 a[0:15], a[208:211], v[132:135], a[0:15]
 ds_read_b128 a[196:199], v3 offset:24576
 v_add_f32 v28, v28, v32
 v_add_f32 v28, v28, v33
 v_cvt_pk_bf16_f32 v156, v32, v33
 v_exp_f32 v34, v122
 v_mfma_f32_32x32x16_bf16 a[64:79], a[208:211], v[140:143], a[64:79]
 buffer_load_dwordx4 v17, s[12:15], s33 offen offset:3072 lds
 s_add_u32 s33, s33, 16384
 v_exp_f32 v35, v123
 s_waitcnt lgkmcnt(6)
 v_mfma_f32_32x32x16_bf16 a[16:31], a[212:215], v[132:135], a[16:31]
 ds_read_b128 a[200:203], v4 offset:24576
 v_add_f32 v28, v28, v34
 v_add_f32 v28, v28, v35
 v_cvt_pk_bf16_f32 v157, v34, v35
 v_exp_f32 v36, v124
 v_mfma_f32_32x32x16_bf16 a[80:95], a[212:215], v[140:143], a[80:95]
 v_exp_f32 v37, v125
 s_waitcnt lgkmcnt(5)
 v_mfma_f32_32x32x16_bf16 a[32:47], a[216:219], v[132:135], a[32:47]
 ds_read_b128 a[204:207], v5 offset:24576
 v_add_f32 v28, v28, v36
 v_add_f32 v28, v28, v37
 v_cvt_pk_bf16_f32 v158, v36, v37
 v_exp_f32 v38, v126
 v_mfma_f32_32x32x16_bf16 a[96:111], a[216:219], v[140:143], a[96:111]
 v_exp_f32 v39, v127
 s_waitcnt lgkmcnt(4)
 v_mfma_f32_32x32x16_bf16 a[48:63], a[220:223], v[132:135], a[48:63]
 ds_read_b128 a[208:211], v6 offset:24576
 v_add_f32 v28, v28, v38
 v_add_f32 v28, v28, v39
 v_cvt_pk_bf16_f32 v159, v38, v39
 v_mfma_f32_32x32x16_bf16 a[112:127], a[220:223], v[140:143], a[112:127]
 v_max_f32 v29, v27, v28
 v_cmp_lt_f32 vcc, s36, v29
 s_cbranch_vccnz attn_kernel_rs28
attn_kernel_rb29:
 s_sub_u32 s35, s35, 1
 s_cmp_lg_u32 s35, 0
 s_cbranch_scc1 attn_kernel_loop13
 s_cmp_eq_u32 s79, 0
 s_cbranch_scc1 attn_kernel_nc30
 v_mov_b32 v51, 0
 s_mov_b64 exec, 1
 buffer_atomic_add v51, v50, s[64:67], 0 offen sc0
 s_mov_b64 exec, -1
attn_kernel_nc30:
 s_waitcnt lgkmcnt(4)
 v_mfma_f32_32x32x16_bf16 v[96:111], a[192:195], a[128:131], v[160:175]
 ds_read_b128 a[212:215], v7 offset:24576
 v_add_f32 v23, v23, v27
 v_add_f32 v24, v24, v28
 v_exp_f32 v32, v64
 v_exp_f32 v33, v65
 v_mfma_f32_32x32x16_bf16 v[112:127], a[192:195], a[160:163], v[176:191]
 v_add_f32 v25, v32, v33
 v_cvt_pk_bf16_f32 v128, v32, v33
 v_exp_f32 v34, v66
 s_waitcnt lgkmcnt(4)
 v_mfma_f32_32x32x16_bf16 v[96:111], a[196:199], a[132:135], v[96:111]
 ds_read_b128 a[216:219], v8 offset:24576
 v_exp_f32 v35, v67
 v_mfma_f32_32x32x16_bf16 v[112:127], a[196:199], a[164:167], v[112:127]
 v_add_f32 v25, v25, v34
 v_add_f32 v25, v25, v35
 v_cvt_pk_bf16_f32 v129, v34, v35
 v_exp_f32 v36, v68
 s_waitcnt lgkmcnt(4)
 v_mfma_f32_32x32x16_bf16 v[96:111], a[200:203], a[136:139], v[96:111]
 ds_read_b128 a[220:223], v9 offset:24576
 v_exp_f32 v37, v69
 v_mfma_f32_32x32x16_bf16 v[112:127], a[200:203], a[168:171], v[112:127]
 v_add_f32 v25, v25, v36
 v_add_f32 v25, v25, v37
 v_cvt_pk_bf16_f32 v130, v36, v37
 v_exp_f32 v38, v70
 s_waitcnt lgkmcnt(4)
 v_mfma_f32_32x32x16_bf16 v[96:111], a[204:207], a[140:143], v[96:111]
 ds_read_b64_tr_b16 a[192:193], v10 offset:40960
 ds_read_b64_tr_b16 a[194:195], v10 offset:43008
 v_exp_f32 v39, v71
 v_mfma_f32_32x32x16_bf16 v[112:127], a[204:207], a[172:175], v[112:127]
 v_add_f32 v25, v25, v38
 v_add_f32 v25, v25, v39
 v_cvt_pk_bf16_f32 v131, v38, v39
 v_exp_f32 v32, v72
 s_waitcnt lgkmcnt(5)
 v_mfma_f32_32x32x16_bf16 v[96:111], a[208:211], a[144:147], v[96:111]
 ds_read_b64_tr_b16 a[196:197], v10 offset:41216
 ds_read_b64_tr_b16 a[198:199], v10 offset:43264
 v_exp_f32 v33, v73
 v_mfma_f32_32x32x16_bf16 v[112:127], a[208:211], a[176:179], v[112:127]
 v_add_f32 v25, v25, v32
 v_add_f32 v25, v25, v33
 v_cvt_pk_bf16_f32 v132, v32, v33
 v_exp_f32 v34, v74
 s_waitcnt lgkmcnt(6)
 v_mfma_f32_32x32x16_bf16 v[96:111], a[212:215], a[148:151], v[96:111]
 ds_read_b64_tr_b16 a[200:201], v10 offset:41472
 ds_read_b64_tr_b16 a[202:203], v10 offset:43520
 v_exp_f32 v35, v75
 v_mfma_f32_32x32x16_bf16 v[112:127], a[212:215], a[180:183], v[112:127]
 v_add_f32 v25, v25, v34
 v_add_f32 v25, v25, v35
 v_cvt_pk_bf16_f32 v133, v34, v35
 v_exp_f32 v36, v76
 s_waitcnt lgkmcnt(7)
 v_mfma_f32_32x32x16_bf16 v[96:111], a[216:219], a[152:155], v[96:111]
 ds_read_b64_tr_b16 a[204:205], v10 offset:41728
 ds_read_b64_tr_b16 a[206:207], v10 offset:43776
 v_exp_f32 v37, v77
 v_mfma_f32_32x32x16_bf16 v[112:127], a[216:219], a[184:187], v[112:127]
 v_add_f32 v25, v25, v36
 v_add_f32 v25, v25, v37
 v_cvt_pk_bf16_f32 v134, v36, v37
 v_exp_f32 v38, v78
 s_waitcnt lgkmcnt(8)
 v_mfma_f32_32x32x16_bf16 v[96:111], a[220:223], a[156:159], v[96:111]
 ds_read_b64_tr_b16 a[208:209], v10 offset:45056
 ds_read_b64_tr_b16 a[210:211], v10 offset:47104
 v_exp_f32 v39, v79
 v_mfma_f32_32x32x16_bf16 v[112:127], a[220:223], a[188:191], v[112:127]
 v_add_f32 v25, v25, v38
 v_add_f32 v25, v25, v39
 v_cvt_pk_bf16_f32 v135, v38, v39
 v_exp_f32 v32, v80
 v_exp_f32 v33, v81
 s_waitcnt lgkmcnt(8)
 v_mfma_f32_32x32x16_bf16 a[0:15], a[192:195], v[144:147], a[0:15]
 ds_read_b64_tr_b16 a[212:213], v10 offset:45312
 ds_read_b64_tr_b16 a[214:215], v10 offset:47360
 v_add_f32 v26, v32, v33
 v_cvt_pk_bf16_f32 v136, v32, v33
 v_exp_f32 v34, v82
 v_mfma_f32_32x32x16_bf16 a[64:79], a[192:195], v[152:155], a[64:79]
 v_exp_f32 v35, v83
 s_waitcnt lgkmcnt(8)
 v_mfma_f32_32x32x16_bf16 a[16:31], a[196:199], v[144:147], a[16:31]
 ds_read_b64_tr_b16 a[216:217], v10 offset:45568
 ds_read_b64_tr_b16 a[218:219], v10 offset:47616
 v_add_f32 v26, v26, v34
 v_add_f32 v26, v26, v35
 v_cvt_pk_bf16_f32 v137, v34, v35
 v_exp_f32 v36, v84
 v_mfma_f32_32x32x16_bf16 a[80:95], a[196:199], v[152:155], a[80:95]
 v_exp_f32 v37, v85
 s_waitcnt lgkmcnt(8)
 v_mfma_f32_32x32x16_bf16 a[32:47], a[200:203], v[144:147], a[32:47]
 ds_read_b64_tr_b16 a[220:221], v10 offset:45824
 ds_read_b64_tr_b16 a[222:223], v10 offset:47872
 v_add_f32 v26, v26, v36
 v_add_f32 v26, v26, v37
 v_cvt_pk_bf16_f32 v138, v36, v37
 v_exp_f32 v38, v86
 v_mfma_f32_32x32x16_bf16 a[96:111], a[200:203], v[152:155], a[96:111]
 s_waitcnt vmcnt(8)
 s_barrier
 v_exp_f32 v39, v87
 s_waitcnt lgkmcnt(8)
 v_mfma_f32_32x32x16_bf16 a[48:63], a[204:207], v[144:147], a[48:63]
 ds_read_b128 a[192:195], v2 offset:32768
 s_add_u32 m0, s31, 81920
 s_nop 0
 buffer_load_dwordx4 v17, s[12:15], s33 offen offset:0 lds
 v_add_f32 v26, v26, v38
 v_add_f32 v26, v26, v39
 v_cvt_pk_bf16_f32 v139, v38, v39
 v_exp_f32 v32, v88
 v_mfma_f32_32x32x16_bf16 a[112:127], a[204:207], v[152:155], a[112:127]
 v_exp_f32 v33, v89
 s_waitcnt lgkmcnt(7)
 v_mfma_f32_32x32x16_bf16 a[0:15], a[208:211], v[148:151], a[0:15]
 ds_read_b128 a[196:199], v3 offset:32768
 v_add_f32 v26, v26, v32
 v_add_f32 v26, v26, v33
 v_cvt_pk_bf16_f32 v140, v32, v33
 v_exp_f32 v34, v90
 v_mfma_f32_32x32x16_bf16 a[64:79], a[208:211], v[156:159], a[64:79]
 v_exp_f32 v35, v91
 s_waitcnt lgkmcnt(6)
 v_mfma_f32_32x32x16_bf16 a[16:31], a[212:215], v[148:151], a[16:31]
 ds_read_b128 a[200:203], v4 offset:32768
 v_add_f32 v26, v26, v34
 v_add_f32 v26, v26, v35
 v_cvt_pk_bf16_f32 v141, v34, v35
 v_exp_f32 v36, v92
 v_mfma_f32_32x32x16_bf16 a[80:95], a[212:215], v[156:159], a[80:95]
 buffer_load_dwordx4 v17, s[12:15], s33 offen offset:1024 lds
 v_exp_f32 v37, v93
 s_waitcnt lgkmcnt(5)
 v_mfma_f32_32x32x16_bf16 a[32:47], a[216:219], v[148:151], a[32:47]
 ds_read_b128 a[204:207], v5 offset:32768
 v_add_f32 v26, v26, v36
 v_add_f32 v26, v26, v37
 v_cvt_pk_bf16_f32 v142, v36, v37
 v_exp_f32 v38, v94
 v_mfma_f32_32x32x16_bf16 a[96:111], a[216:219], v[156:159], a[96:111]
 v_exp_f32 v39, v95
 s_waitcnt lgkmcnt(4)
 v_mfma_f32_32x32x16_bf16 a[48:63], a[220:223], v[148:151], a[48:63]
 ds_read_b128 a[208:211], v6 offset:32768
 v_add_f32 v26, v26, v38
 v_add_f32 v26, v26, v39
 v_cvt_pk_bf16_f32 v143, v38, v39
 v_mfma_f32_32x32x16_bf16 a[112:127], a[220:223], v[156:159], a[112:127]
 v_max_f32 v29, v25, v26
 v_cmp_lt_f32 vcc, s36, v29
 s_cbranch_vccnz attn_kernel_rs31
attn_kernel_rb32:
 s_waitcnt lgkmcnt(4)
 v_mfma_f32_32x32x16_bf16 v[64:79], a[192:195], a[128:131], v[160:175]
 ds_read_b128 a[212:215], v7 offset:32768
 buffer_load_dwordx4 v17, s[12:15], s33 offen offset:2048 lds
 v_add_f32 v23, v23, v25
 v_add_f32 v24, v24, v26
 v_exp_f32 v32, v96
 v_exp_f32 v33, v97
 v_mfma_f32_32x32x16_bf16 v[80:95], a[192:195], a[160:163], v[176:191]
 v_add_f32 v27, v32, v33
 v_cvt_pk_bf16_f32 v144, v32, v33
 v_exp_f32 v34, v98
 s_waitcnt lgkmcnt(4)
 v_mfma_f32_32x32x16_bf16 v[64:79], a[196:199], a[132:135], v[64:79]
 ds_read_b128 a[216:219], v8 offset:32768
 v_exp_f32 v35, v99
 v_mfma_f32_32x32x16_bf16 v[80:95], a[196:199], a[164:167], v[80:95]
 v_add_f32 v27, v27, v34
 v_add_f32 v27, v27, v35
 v_cvt_pk_bf16_f32 v145, v34, v35
 v_exp_f32 v36, v100
 s_waitcnt lgkmcnt(4)
 v_mfma_f32_32x32x16_bf16 v[64:79], a[200:203], a[136:139], v[64:79]
 ds_read_b128 a[220:223], v9 offset:32768
 v_exp_f32 v37, v101
 v_mfma_f32_32x32x16_bf16 v[80:95], a[200:203], a[168:171], v[80:95]
 buffer_load_dwordx4 v17, s[12:15], s33 offen offset:3072 lds
 s_add_u32 s33, s33, 16384
 v_add_f32 v27, v27, v36
 v_add_f32 v27, v27, v37
 v_cvt_pk_bf16_f32 v146, v36, v37
 v_exp_f32 v38, v102
 s_waitcnt lgkmcnt(4)
 v_mfma_f32_32x32x16_bf16 v[64:79], a[204:207], a[140:143], v[64:79]
 ds_read_b64_tr_b16 a[192:193], v10 offset:49152
 ds_read_b64_tr_b16 a[194:195], v10 offset:51200
 v_exp_f32 v39, v103
 v_mfma_f32_32x32x16_bf16 v[80:95], a[204:207], a[172:175], v[80:95]
 v_add_f32 v27, v27, v38
 v_add_f32 v27, v27, v39
 v_cvt_pk_bf16_f32 v147, v38, v39
 v_exp_f32 v32, v104
 s_waitcnt lgkmcnt(5)
 v_mfma_f32_32x32x16_bf16 v[64:79], a[208:211], a[144:147], v[64:79]
 ds_read_b64_tr_b16 a[196:197], v10 offset:49408
 ds_read_b64_tr_b16 a[198:199], v10 offset:51456
 v_exp_f32 v33, v105
 v_mfma_f32_32x32x16_bf16 v[80:95], a[208:211], a[176:179], v[80:95]
 v_add_f32 v27, v27, v32
 v_add_f32 v27, v27, v33
 v_cvt_pk_bf16_f32 v148, v32, v33
 v_exp_f32 v34, v106
 s_waitcnt lgkmcnt(6)
 v_mfma_f32_32x32x16_bf16 v[64:79], a[212:215], a[148:151], v[64:79]
 ds_read_b64_tr_b16 a[200:201], v10 offset:49664
 ds_read_b64_tr_b16 a[202:203], v10 offset:51712
 v_exp_f32 v35, v107
 v_mfma_f32_32x32x16_bf16 v[80:95], a[212:215], a[180:183], v[80:95]
 v_add_f32 v27, v27, v34
 v_add_f32 v27, v27, v35
 v_cvt_pk_bf16_f32 v149, v34, v35
 v_exp_f32 v36, v108
 s_waitcnt lgkmcnt(7)
 v_mfma_f32_32x32x16_bf16 v[64:79], a[216:219], a[152:155], v[64:79]
 ds_read_b64_tr_b16 a[204:205], v10 offset:49920
 ds_read_b64_tr_b16 a[206:207], v10 offset:51968
 v_exp_f32 v37, v109
 v_mfma_f32_32x32x16_bf16 v[80:95], a[216:219], a[184:187], v[80:95]
 v_add_f32 v27, v27, v36
 v_add_f32 v27, v27, v37
 v_cvt_pk_bf16_f32 v150, v36, v37
 v_exp_f32 v38, v110
 s_waitcnt lgkmcnt(8)
 v_mfma_f32_32x32x16_bf16 v[64:79], a[220:223], a[156:159], v[64:79]
 ds_read_b64_tr_b16 a[208:209], v10 offset:53248
 ds_read_b64_tr_b16 a[210:211], v10 offset:55296
 v_exp_f32 v39, v111
 v_mfma_f32_32x32x16_bf16 v[80:95], a[220:223], a[188:191], v[80:95]
 v_add_f32 v27, v27, v38
 v_add_f32 v27, v27, v39
 v_cvt_pk_bf16_f32 v151, v38, v39
 v_exp_f32 v32, v112
 v_exp_f32 v33, v113
 s_waitcnt lgkmcnt(8)
 v_mfma_f32_32x32x16_bf16 a[0:15], a[192:195], v[128:131], a[0:15]
 ds_read_b64_tr_b16 a[212:213], v10 offset:53504
 ds_read_b64_tr_b16 a[214:215], v10 offset:55552
 v_add_f32 v28, v32, v33
 v_cvt_pk_bf16_f32 v152, v32, v33
 v_exp_f32 v34, v114
 v_mfma_f32_32x32x16_bf16 a[64:79], a[192:195], v[136:139], a[64:79]
 v_exp_f32 v35, v115
 s_waitcnt lgkmcnt(8)
 v_mfma_f32_32x32x16_bf16 a[16:31], a[196:199], v[128:131], a[16:31]
 ds_read_b64_tr_b16 a[216:217], v10 offset:53760
 ds_read_b64_tr_b16 a[218:219], v10 offset:55808
 v_add_f32 v28, v28, v34
 v_add_f32 v28, v28, v35
 v_cvt_pk_bf16_f32 v153, v34, v35
 v_exp_f32 v36, v116
 v_mfma_f32_32x32x16_bf16 a[80:95], a[196:199], v[136:139], a[80:95]
 v_exp_f32 v37, v117
 s_waitcnt lgkmcnt(8)
 v_mfma_f32_32x32x16_bf16 a[32:47], a[200:203], v[128:131], a[32:47]
 ds_read_b64_tr_b16 a[220:221], v10 offset:54016
 ds_read_b64_tr_b16 a[222:223], v10 offset:56064
 v_add_f32 v28, v28, v36
 v_add_f32 v28, v28, v37
 v_cvt_pk_bf16_f32 v154, v36, v37
 v_exp_f32 v38, v118
 v_mfma_f32_32x32x16_bf16 a[96:111], a[200:203], v[136:139], a[96:111]
 v_exp_f32 v39, v119
 s_waitcnt lgkmcnt(8)
 v_mfma_f32_32x32x16_bf16 a[48:63], a[204:207], v[128:131], a[48:63]
 ds_read_b128 a[192:195], v2 offset:40960
 v_add_f32 v28, v28, v38
 v_add_f32 v28, v28, v39
 v_cvt_pk_bf16_f32 v155, v38, v39
 v_exp_f32 v32, v120
 v_mfma_f32_32x32x16_bf16 a[112:127], a[204:207], v[136:139], a[112:127]
 v_exp_f32 v33, v121
 s_waitcnt lgkmcnt(7)
 v_mfma_f32_32x32x16_bf16 a[0:15], a[208:211], v[132:135], a[0:15]
 ds_read_b128 a[196:199], v3 offset:40960
 v_add_f32 v28, v28, v32
 v_add_f32 v28, v28, v33
 v_cvt_pk_bf16_f32 v156, v32, v33
 v_exp_f32 v34, v122
 v_mfma_f32_32x32x16_bf16 a[64:79], a[208:211], v[140:143], a[64:79]
 v_exp_f32 v35, v123
 s_waitcnt lgkmcnt(6)
 v_mfma_f32_32x32x16_bf16 a[16:31], a[212:215], v[132:135], a[16:31]
 ds_read_b128 a[200:203], v4 offset:40960
 v_add_f32 v28, v28, v34
 v_add_f32 v28, v28, v35
 v_cvt_pk_bf16_f32 v157, v34, v35
 v_exp_f32 v36, v124
 v_mfma_f32_32x32x16_bf16 a[80:95], a[212:215], v[140:143], a[80:95]
 v_exp_f32 v37, v125
 s_waitcnt lgkmcnt(5)
 v_mfma_f32_32x32x16_bf16 a[32:47], a[216:219], v[132:135], a[32:47]
 ds_read_b128 a[204:207], v5 offset:40960
 v_add_f32 v28, v28, v36
 v_add_f32 v28, v28, v37
 v_cvt_pk_bf16_f32 v158, v36, v37
 v_exp_f32 v38, v126
 v_mfma_f32_32x32x16_bf16 a[96:111], a[216:219], v[140:143], a[96:111]
 v_exp_f32 v39, v127
 s_waitcnt lgkmcnt(4)
 v_mfma_f32_32x32x16_bf16 a[48:63], a[220:223], v[132:135], a[48:63]
 ds_read_b128 a[208:211], v6 offset:40960
 v_add_f32 v28, v28, v38
 v_add_f32 v28, v28, v39
 v_cvt_pk_bf16_f32 v159, v38, v39
 v_mfma_f32_32x32x16_bf16 a[112:127], a[220:223], v[140:143], a[112:127]
 v_max_f32 v29, v27, v28
 v_cmp_lt_f32 vcc, s36, v29
 s_cbranch_vccnz attn_kernel_rs33
attn_kernel_rb34:
 s_waitcnt lgkmcnt(4)
 v_mfma_f32_32x32x16_bf16 v[96:111], a[192:195], a[128:131], v[160:175]
 ds_read_b128 a[212:215], v7 offset:40960
 v_add_f32 v23, v23, v27
 v_add_f32 v24, v24, v28
 v_exp_f32 v32, v64
 v_exp_f32 v33, v65
 v_mfma_f32_32x32x16_bf16 v[112:127], a[192:195], a[160:163], v[176:191]
 v_add_f32 v25, v32, v33
 v_cvt_pk_bf16_f32 v128, v32, v33
 v_exp_f32 v34, v66
 s_waitcnt lgkmcnt(4)
 v_mfma_f32_32x32x16_bf16 v[96:111], a[196:199], a[132:135], v[96:111]
 ds_read_b128 a[216:219], v8 offset:40960
 v_exp_f32 v35, v67
 v_mfma_f32_32x32x16_bf16 v[112:127], a[196:199], a[164:167], v[112:127]
 v_add_f32 v25, v25, v34
 v_add_f32 v25, v25, v35
 v_cvt_pk_bf16_f32 v129, v34, v35
 v_exp_f32 v36, v68
 s_waitcnt lgkmcnt(4)
 v_mfma_f32_32x32x16_bf16 v[96:111], a[200:203], a[136:139], v[96:111]
 ds_read_b128 a[220:223], v9 offset:40960
 v_exp_f32 v37, v69
 v_mfma_f32_32x32x16_bf16 v[112:127], a[200:203], a[168:171], v[112:127]
 v_add_f32 v25, v25, v36
 v_add_f32 v25, v25, v37
 v_cvt_pk_bf16_f32 v130, v36, v37
 v_exp_f32 v38, v70
 s_waitcnt lgkmcnt(4)
 v_mfma_f32_32x32x16_bf16 v[96:111], a[204:207], a[140:143], v[96:111]
 ds_read_b64_tr_b16 a[192:193], v10 offset:57344
 ds_read_b64_tr_b16 a[194:195], v10 offset:59392
 v_exp_f32 v39, v71
 v_mfma_f32_32x32x16_bf16 v[112:127], a[204:207], a[172:175], v[112:127]
 v_add_f32 v25, v25, v38
 v_add_f32 v25, v25, v39
 v_cvt_pk_bf16_f32 v131, v38, v39
 v_exp_f32 v32, v72
 s_waitcnt lgkmcnt(5)
 v_mfma_f32_32x32x16_bf16 v[96:111], a[208:211], a[144:147], v[96:111]
 ds_read_b64_tr_b16 a[196:197], v10 offset:57600
 ds_read_b64_tr_b16 a[198:199], v10 offset:59648
 v_exp_f32 v33, v73
 v_mfma_f32_32x32x16_bf16 v[112:127], a[208:211], a[176:179], v[112:127]
 v_add_f32 v25, v25, v32
 v_add_f32 v25, v25, v33
 v_cvt_pk_bf16_f32 v132, v32, v33
 v_exp_f32 v34, v74
 s_waitcnt lgkmcnt(6)
 v_mfma_f32_32x32x16_bf16 v[96:111], a[212:215], a[148:151], v[96:111]
 ds_read_b64_tr_b16 a[200:201], v10 offset:57856
 ds_read_b64_tr_b16 a[202:203], v10 offset:59904
 v_exp_f32 v35, v75
 v_mfma_f32_32x32x16_bf16 v[112:127], a[212:215], a[180:183], v[112:127]
 v_add_f32 v25, v25, v34
 v_add_f32 v25, v25, v35
 v_cvt_pk_bf16_f32 v133, v34, v35
 v_exp_f32 v36, v76
 s_waitcnt lgkmcnt(7)
 v_mfma_f32_32x32x16_bf16 v[96:111], a[216:219], a[152:155], v[96:111]
 ds_read_b64_tr_b16 a[204:205], v10 offset:58112
 ds_read_b64_tr_b16 a[206:207], v10 offset:60160
 v_exp_f32 v37, v77
 v_mfma_f32_32x32x16_bf16 v[112:127], a[216:219], a[184:187], v[112:127]
 v_add_f32 v25, v25, v36
 v_add_f32 v25, v25, v37
 v_cvt_pk_bf16_f32 v134, v36, v37
 v_exp_f32 v38, v78
 s_waitcnt lgkmcnt(8)
 v_mfma_f32_32x32x16_bf16 v[96:111], a[220:223], a[156:159], v[96:111]
 ds_read_b64_tr_b16 a[208:209], v10 offset:61440
 ds_read_b64_tr_b16 a[210:211], v10 offset:63488
 v_exp_f32 v39, v79
 v_mfma_f32_32x32x16_bf16 v[112:127], a[220:223], a[188:191], v[112:127]
 v_add_f32 v25, v25, v38
 v_add_f32 v25, v25, v39
 v_cvt_pk_bf16_f32 v135, v38, v39
 v_exp_f32 v32, v80
 v_exp_f32 v33, v81
 s_waitcnt lgkmcnt(8)
 v_mfma_f32_32x32x16_bf16 a[0:15], a[192:195], v[144:147], a[0:15]
 ds_read_b64_tr_b16 a[212:213], v10 offset:61696
 ds_read_b64_tr_b16 a[214:215], v10 offset:63744
 v_add_f32 v26, v32, v33
 v_cvt_pk_bf16_f32 v136, v32, v33
 v_exp_f32 v34, v82
 v_mfma_f32_32x32x16_bf16 a[64:79], a[192:195], v[152:155], a[64:79]
 v_exp_f32 v35, v83
 s_waitcnt lgkmcnt(8)
 v_mfma_f32_32x32x16_bf16 a[16:31], a[196:199], v[144:147], a[16:31]
 ds_read_b64_tr_b16 a[216:217], v10 offset:61952
 ds_read_b64_tr_b16 a[218:219], v10 offset:64000
 v_add_f32 v26, v26, v34
 v_add_f32 v26, v26, v35
 v_cvt_pk_bf16_f32 v137, v34, v35
 v_exp_f32 v36, v84
 v_mfma_f32_32x32x16_bf16 a[80:95], a[196:199], v[152:155], a[80:95]
 v_exp_f32 v37, v85
 s_waitcnt lgkmcnt(8)
 v_mfma_f32_32x32x16_bf16 a[32:47], a[200:203], v[144:147], a[32:47]
 ds_read_b64_tr_b16 a[220:221], v10 offset:62208
 ds_read_b64_tr_b16 a[222:223], v10 offset:64256
 v_add_f32 v26, v26, v36
 v_add_f32 v26, v26, v37
 v_cvt_pk_bf16_f32 v138, v36, v37
 v_exp_f32 v38, v86
 v_mfma_f32_32x32x16_bf16 a[96:111], a[200:203], v[152:155], a[96:111]
 s_waitcnt vmcnt(4)
 s_barrier
 v_exp_f32 v39, v87
 s_waitcnt lgkmcnt(8)
 v_mfma_f32_32x32x16_bf16 a[48:63], a[204:207], v[144:147], a[48:63]
 ds_read_b128 a[192:195], v2 offset:49152
 v_add_f32 v26, v26, v38
 v_add_f32 v26, v26, v39
 v_cvt_pk_bf16_f32 v139, v38, v39
 v_exp_f32 v32, v88
 v_mfma_f32_32x32x16_bf16 a[112:127], a[204:207], v[152:155], a[112:127]
 v_exp_f32 v33, v89
 s_waitcnt lgkmcnt(7)
 v_mfma_f32_32x32x16_bf16 a[0:15], a[208:211], v[148:151], a[0:15]
 ds_read_b128 a[196:199], v3 offset:49152
 v_add_f32 v26, v26, v32
 v_add_f32 v26, v26, v33
 v_cvt_pk_bf16_f32 v140, v32, v33
 v_exp_f32 v34, v90
 v_mfma_f32_32x32x16_bf16 a[64:79], a[208:211], v[156:159], a[64:79]
 v_exp_f32 v35, v91
 s_waitcnt lgkmcnt(6)
 v_mfma_f32_32x32x16_bf16 a[16:31], a[212:215], v[148:151], a[16:31]
 ds_read_b128 a[200:203], v4 offset:49152
 v_add_f32 v26, v26, v34
 v_add_f32 v26, v26, v35
 v_cvt_pk_bf16_f32 v141, v34, v35
 v_exp_f32 v36, v92
 v_mfma_f32_32x32x16_bf16 a[80:95], a[212:215], v[156:159], a[80:95]
 v_exp_f32 v37, v93
 s_waitcnt lgkmcnt(5)
 v_mfma_f32_32x32x16_bf16 a[32:47], a[216:219], v[148:151], a[32:47]
 ds_read_b128 a[204:207], v5 offset:49152
 v_add_f32 v26, v26, v36
 v_add_f32 v26, v26, v37
 v_cvt_pk_bf16_f32 v142, v36, v37
 v_exp_f32 v38, v94
 v_mfma_f32_32x32x16_bf16 a[96:111], a[216:219], v[156:159], a[96:111]
 v_exp_f32 v39, v95
 s_waitcnt lgkmcnt(4)
 v_mfma_f32_32x32x16_bf16 a[48:63], a[220:223], v[148:151], a[48:63]
 ds_read_b128 a[208:211], v6 offset:49152
 v_add_f32 v26, v26, v38
 v_add_f32 v26, v26, v39
 v_cvt_pk_bf16_f32 v143, v38, v39
 v_mfma_f32_32x32x16_bf16 a[112:127], a[220:223], v[156:159], a[112:127]
 v_max_f32 v29, v25, v26
 v_cmp_lt_f32 vcc, s36, v29
 s_cbranch_vccnz attn_kernel_rs35
attn_kernel_rb36:
 s_waitcnt lgkmcnt(4)
 v_mfma_f32_32x32x16_bf16 v[64:79], a[192:195], a[128:131], v[160:175]
 ds_read_b128 a[212:215], v7 offset:49152
 v_add_f32 v23, v23, v25
 v_add_f32 v24, v24, v26
 v_exp_f32 v32, v96
 v_exp_f32 v33, v97
 v_mfma_f32_32x32x16_bf16 v[80:95], a[192:195], a[160:163], v[176:191]
 v_add_f32 v27, v32, v33
 v_cvt_pk_bf16_f32 v144, v32, v33
 v_exp_f32 v34, v98
 s_waitcnt lgkmcnt(4)
 v_mfma_f32_32x32x16_bf16 v[64:79], a[196:199], a[132:135], v[64:79]
 ds_read_b128 a[216:219], v8 offset:49152
 v_exp_f32 v35, v99
 v_mfma_f32_32x32x16_bf16 v[80:95], a[196:199], a[164:167], v[80:95]
 v_add_f32 v27, v27, v34
 v_add_f32 v27, v27, v35
 v_cvt_pk_bf16_f32 v145, v34, v35
 v_exp_f32 v36, v100
 s_waitcnt lgkmcnt(4)
 v_mfma_f32_32x32x16_bf16 v[64:79], a[200:203], a[136:139], v[64:79]
 ds_read_b128 a[220:223], v9 offset:49152
 v_exp_f32 v37, v101
 v_mfma_f32_32x32x16_bf16 v[80:95], a[200:203], a[168:171], v[80:95]
 v_add_f32 v27, v27, v36
 v_add_f32 v27, v27, v37
 v_cvt_pk_bf16_f32 v146, v36, v37
 v_exp_f32 v38, v102
 s_waitcnt lgkmcnt(4)
 v_mfma_f32_32x32x16_bf16 v[64:79], a[204:207], a[140:143], v[64:79]
 ds_read_b64_tr_b16 a[192:193], v10 offset:0
 ds_read_b64_tr_b16 a[194:195], v10 offset:2048
 v_exp_f32 v39, v103
 v_mfma_f32_32x32x16_bf16 v[80:95], a[204:207], a[172:175], v[80:95]
 v_add_f32 v27, v27, v38
 v_add_f32 v27, v27, v39
 v_cvt_pk_bf16_f32 v147, v38, v39
 v_exp_f32 v32, v104
 s_waitcnt lgkmcnt(5)
 v_mfma_f32_32x32x16_bf16 v[64:79], a[208:211], a[144:147], v[64:79]
 ds_read_b64_tr_b16 a[196:197], v10 offset:256
 ds_read_b64_tr_b16 a[198:199], v10 offset:2304
 v_exp_f32 v33, v105
 v_mfma_f32_32x32x16_bf16 v[80:95], a[208:211], a[176:179], v[80:95]
 v_add_f32 v27, v27, v32
 v_add_f32 v27, v27, v33
 v_cvt_pk_bf16_f32 v148, v32, v33
 v_exp_f32 v34, v106
 s_waitcnt lgkmcnt(6)
 v_mfma_f32_32x32x16_bf16 v[64:79], a[212:215], a[148:151], v[64:79]
 ds_read_b64_tr_b16 a[200:201], v10 offset:512
 ds_read_b64_tr_b16 a[202:203], v10 offset:2560
 v_exp_f32 v35, v107
 v_mfma_f32_32x32x16_bf16 v[80:95], a[212:215], a[180:183], v[80:95]
 v_add_f32 v27, v27, v34
 v_add_f32 v27, v27, v35
 v_cvt_pk_bf16_f32 v149, v34, v35
 v_exp_f32 v36, v108
 s_waitcnt lgkmcnt(7)
 v_mfma_f32_32x32x16_bf16 v[64:79], a[216:219], a[152:155], v[64:79]
 ds_read_b64_tr_b16 a[204:205], v10 offset:768
 ds_read_b64_tr_b16 a[206:207], v10 offset:2816
 v_exp_f32 v37, v109
 v_mfma_f32_32x32x16_bf16 v[80:95], a[216:219], a[184:187], v[80:95]
 v_add_f32 v27, v27, v36
 v_add_f32 v27, v27, v37
 v_cvt_pk_bf16_f32 v150, v36, v37
 v_exp_f32 v38, v110
 s_waitcnt lgkmcnt(8)
 v_mfma_f32_32x32x16_bf16 v[64:79], a[220:223], a[156:159], v[64:79]
 ds_read_b64_tr_b16 a[208:209], v10 offset:4096
 ds_read_b64_tr_b16 a[210:211], v10 offset:6144
 v_exp_f32 v39, v111
 v_mfma_f32_32x32x16_bf16 v[80:95], a[220:223], a[188:191], v[80:95]
 v_add_f32 v27, v27, v38
 v_add_f32 v27, v27, v39
 v_cvt_pk_bf16_f32 v151, v38, v39
 v_exp_f32 v32, v112
 v_exp_f32 v33, v113
 s_waitcnt lgkmcnt(8)
 v_mfma_f32_32x32x16_bf16 a[0:15], a[192:195], v[128:131], a[0:15]
 ds_read_b64_tr_b16 a[212:213], v10 offset:4352
 ds_read_b64_tr_b16 a[214:215], v10 offset:6400
 v_add_f32 v28, v32, v33
 v_cvt_pk_bf16_f32 v152, v32, v33
 v_exp_f32 v34, v114
 v_mfma_f32_32x32x16_bf16 a[64:79], a[192:195], v[136:139], a[64:79]
 v_exp_f32 v35, v115
 s_waitcnt lgkmcnt(8)
 v_mfma_f32_32x32x16_bf16 a[16:31], a[196:199], v[128:131], a[16:31]
 ds_read_b64_tr_b16 a[216:217], v10 offset:4608
 ds_read_b64_tr_b16 a[218:219], v10 offset:6656
 v_add_f32 v28, v28, v34
 v_add_f32 v28, v28, v35
 v_cvt_pk_bf16_f32 v153, v34, v35
 v_exp_f32 v36, v116
 v_mfma_f32_32x32x16_bf16 a[80:95], a[196:199], v[136:139], a[80:95]
 v_exp_f32 v37, v117
 s_waitcnt lgkmcnt(8)
 v_mfma_f32_32x32x16_bf16 a[32:47], a[200:203], v[128:131], a[32:47]
 ds_read_b64_tr_b16 a[220:221], v10 offset:4864
 ds_read_b64_tr_b16 a[222:223], v10 offset:6912
 v_add_f32 v28, v28, v36
 v_add_f32 v28, v28, v37
 v_cvt_pk_bf16_f32 v154, v36, v37
 v_exp_f32 v38, v118
 v_mfma_f32_32x32x16_bf16 a[96:111], a[200:203], v[136:139], a[96:111]
 v_exp_f32 v39, v119
 s_waitcnt lgkmcnt(8)
 v_mfma_f32_32x32x16_bf16 a[48:63], a[204:207], v[128:131], a[48:63]
 ds_read_b128 a[192:195], v2 offset:57344
 v_add_f32 v28, v28, v38
 v_add_f32 v28, v28, v39
 v_cvt_pk_bf16_f32 v155, v38, v39
 v_exp_f32 v32, v120
 v_mfma_f32_32x32x16_bf16 a[112:127], a[204:207], v[136:139], a[112:127]
 v_exp_f32 v33, v121
 s_waitcnt lgkmcnt(7)
 v_mfma_f32_32x32x16_bf16 a[0:15], a[208:211], v[132:135], a[0:15]
 ds_read_b128 a[196:199], v3 offset:57344
 v_add_f32 v28, v28, v32
 v_add_f32 v28, v28, v33
 v_cvt_pk_bf16_f32 v156, v32, v33
 v_exp_f32 v34, v122
 v_mfma_f32_32x32x16_bf16 a[64:79], a[208:211], v[140:143], a[64:79]
 v_exp_f32 v35, v123
 s_waitcnt lgkmcnt(6)
 v_mfma_f32_32x32x16_bf16 a[16:31], a[212:215], v[132:135], a[16:31]
 ds_read_b128 a[200:203], v4 offset:57344
 v_add_f32 v28, v28, v34
 v_add_f32 v28, v28, v35
 v_cvt_pk_bf16_f32 v157, v34, v35
 v_exp_f32 v36, v124
 v_mfma_f32_32x32x16_bf16 a[80:95], a[212:215], v[140:143], a[80:95]
 v_exp_f32 v37, v125
 s_waitcnt lgkmcnt(5)
 v_mfma_f32_32x32x16_bf16 a[32:47], a[216:219], v[132:135], a[32:47]
 ds_read_b128 a[204:207], v5 offset:57344
 v_add_f32 v28, v28, v36
 v_add_f32 v28, v28, v37
 v_cvt_pk_bf16_f32 v158, v36, v37
 v_exp_f32 v38, v126
 v_mfma_f32_32x32x16_bf16 a[96:111], a[216:219], v[140:143], a[96:111]
 v_exp_f32 v39, v127
 s_waitcnt lgkmcnt(4)
 v_mfma_f32_32x32x16_bf16 a[48:63], a[220:223], v[132:135], a[48:63]
 ds_read_b128 a[208:211], v6 offset:57344
 v_add_f32 v28, v28, v38
 v_add_f32 v28, v28, v39
 v_cvt_pk_bf16_f32 v159, v38, v39
 v_mfma_f32_32x32x16_bf16 a[112:127], a[220:223], v[140:143], a[112:127]
 v_max_f32 v29, v27, v28
 v_cmp_lt_f32 vcc, s36, v29
 s_cbranch_vccnz attn_kernel_rs37
attn_kernel_rb38:
 s_cmp_eq_u32 s79, 0
 s_cbranch_scc1 attn_kernel_nc39
 s_mov_b32 s72, 200000
attn_kernel_poll40:
 s_waitcnt vmcnt(0)
 v_readfirstlane_b32 s34, v51
 s_cmp_ge_u32 s34, 14
 s_cbranch_scc1 attn_kernel_pok41
 s_sub_u32 s72, s72, 1
 s_cmp_eq_u32 s72, 0
 s_cbranch_scc1 attn_kernel_pok41
 s_sleep 8
 v_mov_b32 v51, 0
 s_mov_b64 exec, 1
 buffer_atomic_add v51, v50, s[64:67], 0 offen sc0
 s_mov_b64 exec, -1
 s_branch attn_kernel_poll40
attn_kernel_pok41:
 s_lshl_b32 s34, s30, 8
 s_lshl_b32 s72, s28, 6
 s_add_u32 s34, s34, s72
 v_add_u32 v52, s34, v0
 v_lshlrev_b32 v52, 3, v52
 s_mov_b32 s34, 0
 buffer_load_dwordx2 v[214:215], v52, s[20:23], s34 offen sc0 sc1
 s_mov_b32 s34, 16384
 buffer_load_dwordx2 v[216:217], v52, s[20:23], s34 offen sc0 sc1
 s_mov_b32 s34, 32768
 buffer_load_dwordx2 v[218:219], v52, s[20:23], s34 offen sc0 sc1
 s_mov_b32 s34, 49152
 buffer_load_dwordx2 v[220:221], v52, s[20:23], s34 offen sc0 sc1
 s_mov_b32 s34, 65536
 buffer_load_dwordx2 v[222:223], v52, s[20:23], s34 offen sc0 sc1
 s_mov_b32 s34, 81920
 buffer_load_dwordx2 v[224:225], v52, s[20:23], s34 offen sc0 sc1
 s_mov_b32 s34, 98304
 buffer_load_dwordx2 v[226:227], v52, s[20:23], s34 offen sc0 sc1
 s_mov_b32 s34, 114688
 buffer_load_dwordx2 v[228:229], v52, s[20:23], s34 offen sc0 sc1
 s_mov_b32 s34, 131072
 buffer_load_dwordx2 v[230:231], v52, s[20:23], s34 offen sc0 sc1
 s_mov_b32 s34, 147456
 buffer_load_dwordx2 v[232:233], v52, s[20:23], s34 offen sc0 sc1
 s_mov_b32 s34, 163840
 buffer_load_dwordx2 v[234:235], v52, s[20:23], s34 offen sc0 sc1
 s_mov_b32 s34, 180224
 buffer_load_dwordx2 v[236:237], v52, s[20:23], s34 offen sc0 sc1
 s_mov_b32 s34, 196608
 buffer_load_dwordx2 v[238:239], v52, s[20:23], s34 offen sc0 sc1
 s_mov_b32 s34, 212992
 buffer_load_dwordx2 v[240:241], v52, s[20:23], s34 offen sc0 sc1
attn_kernel_nc39:
 s_waitcnt lgkmcnt(4)
 v_mfma_f32_32x32x16_bf16 v[96:111], a[192:195], a[128:131], v[160:175]
 ds_read_b128 a[212:215], v7 offset:57344
 v_add_f32 v23, v23, v27
 v_add_f32 v24, v24, v28
 v_exp_f32 v32, v64
 v_exp_f32 v33, v65
 v_mfma_f32_32x32x16_bf16 v[112:127], a[192:195], a[160:163], v[176:191]
 v_add_f32 v25, v32, v33
 v_cvt_pk_bf16_f32 v128, v32, v33
 v_exp_f32 v34, v66
 s_waitcnt lgkmcnt(4)
 v_mfma_f32_32x32x16_bf16 v[96:111], a[196:199], a[132:135], v[96:111]
 ds_read_b128 a[216:219], v8 offset:57344
 v_exp_f32 v35, v67
 v_mfma_f32_32x32x16_bf16 v[112:127], a[196:199], a[164:167], v[112:127]
 v_add_f32 v25, v25, v34
 v_add_f32 v25, v25, v35
 v_cvt_pk_bf16_f32 v129, v34, v35
 v_exp_f32 v36, v68
 s_waitcnt lgkmcnt(4)
 v_mfma_f32_32x32x16_bf16 v[96:111], a[200:203], a[136:139], v[96:111]
 ds_read_b128 a[220:223], v9 offset:57344
 v_exp_f32 v37, v69
 v_mfma_f32_32x32x16_bf16 v[112:127], a[200:203], a[168:171], v[112:127]
 v_add_f32 v25, v25, v36
 v_add_f32 v25, v25, v37
 v_cvt_pk_bf16_f32 v130, v36, v37
 v_exp_f32 v38, v70
 s_waitcnt lgkmcnt(4)
 v_mfma_f32_32x32x16_bf16 v[96:111], a[204:207], a[140:143], v[96:111]
 ds_read_b64_tr_b16 a[192:193], v10 offset:8192
 ds_read_b64_tr_b16 a[194:195], v10 offset:10240
 v_exp_f32 v39, v71
 v_mfma_f32_32x32x16_bf16 v[112:127], a[204:207], a[172:175], v[112:127]
 v_add_f32 v25, v25, v38
 v_add_f32 v25, v25, v39
 v_cvt_pk_bf16_f32 v131, v38, v39
 v_exp_f32 v32, v72
 s_waitcnt lgkmcnt(5)
 v_mfma_f32_32x32x16_bf16 v[96:111], a[208:211], a[144:147], v[96:111]
 ds_read_b64_tr_b16 a[196:197], v10 offset:8448
 ds_read_b64_tr_b16 a[198:199], v10 offset:10496
 v_exp_f32 v33, v73
 v_mfma_f32_32x32x16_bf16 v[112:127], a[208:211], a[176:179], v[112:127]
 v_add_f32 v25, v25, v32
 v_add_f32 v25, v25, v33
 v_cvt_pk_bf16_f32 v132, v32, v33
 v_exp_f32 v34, v74
 s_waitcnt lgkmcnt(6)
 v_mfma_f32_32x32x16_bf16 v[96:111], a[212:215], a[148:151], v[96:111]
 ds_read_b64_tr_b16 a[200:201], v10 offset:8704
 ds_read_b64_tr_b16 a[202:203], v10 offset:10752
 v_exp_f32 v35, v75
 v_mfma_f32_32x32x16_bf16 v[112:127], a[212:215], a[180:183], v[112:127]
 v_add_f32 v25, v25, v34
 v_add_f32 v25, v25, v35
 v_cvt_pk_bf16_f32 v133, v34, v35
 v_exp_f32 v36, v76
 s_waitcnt lgkmcnt(7)
 v_mfma_f32_32x32x16_bf16 v[96:111], a[216:219], a[152:155], v[96:111]
 ds_read_b64_tr_b16 a[204:205], v10 offset:8960
 ds_read_b64_tr_b16 a[206:207], v10 offset:11008
 v_exp_f32 v37, v77
 v_mfma_f32_32x32x16_bf16 v[112:127], a[216:219], a[184:187], v[112:127]
 v_add_f32 v25, v25, v36
 v_add_f32 v25, v25, v37
 v_cvt_pk_bf16_f32 v134, v36, v37
 v_exp_f32 v38, v78
 s_waitcnt lgkmcnt(8)
 v_mfma_f32_32x32x16_bf16 v[96:111], a[220:223], a[156:159], v[96:111]
 ds_read_b64_tr_b16 a[208:209], v10 offset:12288
 ds_read_b64_tr_b16 a[210:211], v10 offset:14336
 v_exp_f32 v39, v79
 v_mfma_f32_32x32x16_bf16 v[112:127], a[220:223], a[188:191], v[112:127]
 v_add_f32 v25, v25, v38
 v_add_f32 v25, v25, v39
 v_cvt_pk_bf16_f32 v135, v38, v39
 v_exp_f32 v32, v80
 v_exp_f32 v33, v81
 s_waitcnt lgkmcnt(8)
 v_mfma_f32_32x32x16_bf16 a[0:15], a[192:195], v[144:147], a[0:15]
 ds_read_b64_tr_b16 a[212:213], v10 offset:12544
 ds_read_b64_tr_b16 a[214:215], v10 offset:14592
 v_add_f32 v26, v32, v33
 v_cvt_pk_bf16_f32 v136, v32, v33
 v_exp_f32 v34, v82
 v_mfma_f32_32x32x16_bf16 a[64:79], a[192:195], v[152:155], a[64:79]
 v_exp_f32 v35, v83
 s_waitcnt lgkmcnt(8)
 v_mfma_f32_32x32x16_bf16 a[16:31], a[196:199], v[144:147], a[16:31]
 ds_read_b64_tr_b16 a[216:217], v10 offset:12800
 ds_read_b64_tr_b16 a[218:219], v10 offset:14848
 v_add_f32 v26, v26, v34
 v_add_f32 v26, v26, v35
 v_cvt_pk_bf16_f32 v137, v34, v35
 v_exp_f32 v36, v84
 v_mfma_f32_32x32x16_bf16 a[80:95], a[196:199], v[152:155], a[80:95]
 v_exp_f32 v37, v85
 s_waitcnt lgkmcnt(8)
 v_mfma_f32_32x32x16_bf16 a[32:47], a[200:203], v[144:147], a[32:47]
 ds_read_b64_tr_b16 a[220:221], v10 offset:13056
 ds_read_b64_tr_b16 a[222:223], v10 offset:15104
 v_add_f32 v26, v26, v36
 v_add_f32 v26, v26, v37
 v_cvt_pk_bf16_f32 v138, v36, v37
 v_exp_f32 v38, v86
 v_mfma_f32_32x32x16_bf16 a[96:111], a[200:203], v[152:155], a[96:111]
 s_waitcnt vmcnt(0)
 s_barrier
 v_exp_f32 v39, v87
 s_waitcnt lgkmcnt(8)
 v_mfma_f32_32x32x16_bf16 a[48:63], a[204:207], v[144:147], a[48:63]
 ds_read_b64_tr_b16 a[192:193], v10 offset:16384
 ds_read_b64_tr_b16 a[194:195], v10 offset:18432
 v_add_f32 v26, v26, v38
 v_add_f32 v26, v26, v39
 v_cvt_pk_bf16_f32 v139, v38, v39
 v_exp_f32 v32, v88
 v_mfma_f32_32x32x16_bf16 a[112:127], a[204:207], v[152:155], a[112:127]
 v_exp_f32 v33, v89
 s_waitcnt lgkmcnt(8)
 v_mfma_f32_32x32x16_bf16 a[0:15], a[208:211], v[148:151], a[0:15]
 ds_read_b64_tr_b16 a[196:197], v10 offset:16640
 ds_read_b64_tr_b16 a[198:199], v10 offset:18688
 v_add_f32 v26, v26, v32
 v_add_f32 v26, v26, v33
 v_cvt_pk_bf16_f32 v140, v32, v33
 v_exp_f32 v34, v90
 v_mfma_f32_32x32x16_bf16 a[64:79], a[208:211], v[156:159], a[64:79]
 v_exp_f32 v35, v91
 s_waitcnt lgkmcnt(8)
 v_mfma_f32_32x32x16_bf16 a[16:31], a[212:215], v[148:151], a[16:31]
 ds_read_b64_tr_b16 a[200:201], v10 offset:16896
 ds_read_b64_tr_b16 a[202:203], v10 offset:18944
 v_add_f32 v26, v26, v34
 v_add_f32 v26, v26, v35
 v_cvt_pk_bf16_f32 v141, v34, v35
 v_exp_f32 v36, v92
 v_mfma_f32_32x32x16_bf16 a[80:95], a[212:215], v[156:159], a[80:95]
 v_exp_f32 v37, v93
 s_waitcnt lgkmcnt(8)
 v_mfma_f32_32x32x16_bf16 a[32:47], a[216:219], v[148:151], a[32:47]
 ds_read_b64_tr_b16 a[204:205], v10 offset:17152
 ds_read_b64_tr_b16 a[206:207], v10 offset:19200
 v_add_f32 v26, v26, v36
 v_add_f32 v26, v26, v37
 v_cvt_pk_bf16_f32 v142, v36, v37
 v_exp_f32 v38, v94
 v_mfma_f32_32x32x16_bf16 a[96:111], a[216:219], v[156:159], a[96:111]
 v_exp_f32 v39, v95
 s_waitcnt lgkmcnt(8)
 v_mfma_f32_32x32x16_bf16 a[48:63], a[220:223], v[148:151], a[48:63]
 ds_read_b64_tr_b16 a[208:209], v10 offset:20480
 ds_read_b64_tr_b16 a[210:211], v10 offset:22528
 v_add_f32 v26, v26, v38
 v_add_f32 v26, v26, v39
 v_cvt_pk_bf16_f32 v143, v38, v39
 v_mfma_f32_32x32x16_bf16 a[112:127], a[220:223], v[156:159], a[112:127]
 v_max_f32 v29, v25, v26
 v_cmp_lt_f32 vcc, s36, v29
 s_cbranch_vccnz attn_kernel_rs42
attn_kernel_rb43:
 s_waitcnt lgkmcnt(8)
 v_mfma_f32_32x32x16_bf16 a[0:15], a[192:195], v[128:131], a[0:15]
 ds_read_b64_tr_b16 a[212:213], v10 offset:20736
 ds_read_b64_tr_b16 a[214:215], v10 offset:22784
 v_add_f32 v23, v23, v25
 v_add_f32 v24, v24, v26
 v_exp_f32 v32, v96
 v_exp_f32 v33, v97
 v_exp_f32 v34, v98
 v_mfma_f32_32x32x16_bf16 a[64:79], a[192:195], v[136:139], a[64:79]
 v_add_f32 v27, v32, v33
 v_cvt_pk_bf16_f32 v144, v32, v33
 v_exp_f32 v35, v99
 v_exp_f32 v36, v100
 s_waitcnt lgkmcnt(8)
 v_mfma_f32_32x32x16_bf16 a[16:31], a[196:199], v[128:131], a[16:31]
 ds_read_b64_tr_b16 a[216:217], v10 offset:20992
 ds_read_b64_tr_b16 a[218:219], v10 offset:23040
 v_add_f32 v27, v27, v34
 v_add_f32 v27, v27, v35
 v_cvt_pk_bf16_f32 v145, v34, v35
 v_exp_f32 v37, v101
 v_exp_f32 v38, v102
 v_mfma_f32_32x32x16_bf16 a[80:95], a[196:199], v[136:139], a[80:95]
 v_add_f32 v27, v27, v36
 v_add_f32 v27, v27, v37
 v_cvt_pk_bf16_f32 v146, v36, v37
 v_exp_f32 v39, v103
 v_exp_f32 v32, v104
 v_exp_f32 v33, v105
 s_waitcnt lgkmcnt(8)
 v_mfma_f32_32x32x16_bf16 a[32:47], a[200:203], v[128:131], a[32:47]
 ds_read_b64_tr_b16 a[220:221], v10 offset:21248
 ds_read_b64_tr_b16 a[222:223], v10 offset:23296
 v_add_f32 v27, v27, v38
 v_add_f32 v27, v27, v39
 v_cvt_pk_bf16_f32 v147, v38, v39
 v_add_f32 v27, v27, v32
 v_add_f32 v27, v27, v33
 v_cvt_pk_bf16_f32 v148, v32, v33
 v_exp_f32 v34, v106
 v_exp_f32 v35, v107
 v_mfma_f32_32x32x16_bf16 a[96:111], a[200:203], v[136:139], a[96:111]
 v_add_f32 v27, v27, v34
 v_add_f32 v27, v27, v35
 v_cvt_pk_bf16_f32 v149, v34, v35
 v_exp_f32 v36, v108
 v_exp_f32 v37, v109
 s_waitcnt lgkmcnt(8)
 v_mfma_f32_32x32x16_bf16 a[48:63], a[204:207], v[128:131], a[48:63]
 ds_read_b64_tr_b16 a[192:193], v10 offset:24576
 ds_read_b64_tr_b16 a[194:195], v10 offset:26624
 v_add_f32 v27, v27, v36
 v_add_f32 v27, v27, v37
 v_cvt_pk_bf16_f32 v150, v36, v37
 v_exp_f32 v38, v110
 v_exp_f32 v39, v111
 v_mfma_f32_32x32x16_bf16 a[112:127], a[204:207], v[136:139], a[112:127]
 v_add_f32 v27, v27, v38
 v_add_f32 v27, v27, v39
 v_cvt_pk_bf16_f32 v151, v38, v39
 v_exp_f32 v32, v112
 v_exp_f32 v33, v113
 v_exp_f32 v34, v114
 s_waitcnt lgkmcnt(8)
 v_mfma_f32_32x32x16_bf16 a[0:15], a[208:211], v[132:135], a[0:15]
 ds_read_b64_tr_b16 a[196:197], v10 offset:24832
 ds_read_b64_tr_b16 a[198:199], v10 offset:26880
 v_add_f32 v28, v32, v33
 v_cvt_pk_bf16_f32 v152, v32, v33
 v_exp_f32 v35, v115
 v_exp_f32 v36, v116
 v_mfma_f32_32x32x16_bf16 a[64:79], a[208:211], v[140:143], a[64:79]
 v_add_f32 v28, v28, v34
 v_add_f32 v28, v28, v35
 v_cvt_pk_bf16_f32 v153, v34, v35
 v_exp_f32 v37, v117
 v_exp_f32 v38, v118
 s_waitcnt lgkmcnt(8)
 v_mfma_f32_32x32x16_bf16 a[16:31], a[212:215], v[132:135], a[16:31]
 ds_read_b64_tr_b16 a[200:201], v10 offset:25088
 ds_read_b64_tr_b16 a[202:203], v10 offset:27136
 v_add_f32 v28, v28, v36
 v_add_f32 v28, v28, v37
 v_cvt_pk_bf16_f32 v154, v36, v37
 v_exp_f32 v39, v119
 v_exp_f32 v32, v120
 v_exp_f32 v33, v121
 v_mfma_f32_32x32x16_bf16 a[80:95], a[212:215], v[140:143], a[80:95]
 v_add_f32 v28, v28, v38
 v_add_f32 v28, v28, v39
 v_cvt_pk_bf16_f32 v155, v38, v39
 v_add_f32 v28, v28, v32
 v_add_f32 v28, v28, v33
 v_cvt_pk_bf16_f32 v156, v32, v33
 v_exp_f32 v34, v122
 v_exp_f32 v35, v123
 s_waitcnt lgkmcnt(8)
 v_mfma_f32_32x32x16_bf16 a[32:47], a[216:219], v[132:135], a[32:47]
 ds_read_b64_tr_b16 a[204:205], v10 offset:25344
 ds_read_b64_tr_b16 a[206:207], v10 offset:27392
 v_add_f32 v28, v28, v34
 v_add_f32 v28, v28, v35
 v_cvt_pk_bf16_f32 v157, v34, v35
 v_exp_f32 v36, v124
 v_exp_f32 v37, v125
 v_mfma_f32_32x32x16_bf16 a[96:111], a[216:219], v[140:143], a[96:111]
 v_add_f32 v28, v28, v36
 v_add_f32 v28, v28, v37
 v_cvt_pk_bf16_f32 v158, v36, v37
 v_exp_f32 v38, v126
 v_exp_f32 v39, v127
 s_waitcnt lgkmcnt(8)
 v_mfma_f32_32x32x16_bf16 a[48:63], a[220:223], v[132:135], a[48:63]
 ds_read_b64_tr_b16 a[208:209], v10 offset:28672
 ds_read_b64_tr_b16 a[210:211], v10 offset:30720
 v_add_f32 v28, v28, v38
 v_add_f32 v28, v28, v39
 v_cvt_pk_bf16_f32 v159, v38, v39
 v_mfma_f32_32x32x16_bf16 a[112:127], a[220:223], v[140:143], a[112:127]
 v_max_f32 v29, v27, v28
 v_cmp_lt_f32 vcc, s36, v29
 s_cbranch_vccnz attn_kernel_rs44
attn_kernel_rb45:
 s_waitcnt lgkmcnt(8)
 v_mfma_f32_32x32x16_bf16 a[0:15], a[192:195], v[144:147], a[0:15]
 ds_read_b64_tr_b16 a[212:213], v10 offset:28928
 ds_read_b64_tr_b16 a[214:215], v10 offset:30976
 v_add_f32 v23, v23, v27
 v_add_f32 v24, v24, v28
 v_mfma_f32_32x32x16_bf16 a[64:79], a[192:195], v[152:155], a[64:79]
 s_waitcnt lgkmcnt(8)
 v_mfma_f32_32x32x16_bf16 a[16:31], a[196:199], v[144:147], a[16:31]
 ds_read_b64_tr_b16 a[216:217], v10 offset:29184
 ds_read_b64_tr_b16 a[218:219], v10 offset:31232
 v_mfma_f32_32x32x16_bf16 a[80:95], a[196:199], v[152:155], a[80:95]
 s_waitcnt lgkmcnt(8)
 v_mfma_f32_32x32x16_bf16 a[32:47], a[200:203], v[144:147], a[32:47]
 ds_read_b64_tr_b16 a[220:221], v10 offset:29440
 ds_read_b64_tr_b16 a[222:223], v10 offset:31488
 v_mfma_f32_32x32x16_bf16 a[96:111], a[200:203], v[152:155], a[96:111]
 s_barrier
 s_waitcnt lgkmcnt(8)
 v_mfma_f32_32x32x16_bf16 a[48:63], a[204:207], v[144:147], a[48:63]
 v_mfma_f32_32x32x16_bf16 a[112:127], a[204:207], v[152:155], a[112:127]
 s_waitcnt lgkmcnt(6)
 v_mfma_f32_32x32x16_bf16 a[0:15], a[208:211], v[148:151], a[0:15]
 v_mfma_f32_32x32x16_bf16 a[64:79], a[208:211], v[156:159], a[64:79]
 s_waitcnt lgkmcnt(4)
 v_mfma_f32_32x32x16_bf16 a[16:31], a[212:215], v[148:151], a[16:31]
 v_mfma_f32_32x32x16_bf16 a[80:95], a[212:215], v[156:159], a[80:95]
 s_waitcnt lgkmcnt(2)
 v_mfma_f32_32x32x16_bf16 a[32:47], a[216:219], v[148:151], a[32:47]
 v_mfma_f32_32x32x16_bf16 a[96:111], a[216:219], v[156:159], a[96:111]
 s_waitcnt lgkmcnt(0)
 v_mfma_f32_32x32x16_bf16 a[48:63], a[220:223], v[148:151], a[48:63]
 v_mfma_f32_32x32x16_bf16 a[112:127], a[220:223], v[156:159], a[112:127]
 s_nop 15
 v_mov_b32 v29, v23
 s_nop 1
 v_permlane32_swap_b32 v23, v29
 s_nop 1
 v_add_f32 v23, v23, v29
 v_rcp_f32 v23, v23
 v_mov_b32 v29, v24
 s_nop 1
 v_permlane32_swap_b32 v24, v29
 s_nop 1
 v_add_f32 v24, v24, v29
 v_rcp_f32 v24, v24
 v_accvgpr_read_b32 v64, a0
 v_accvgpr_read_b32 v65, a1
 v_accvgpr_read_b32 v66, a2
 v_accvgpr_read_b32 v67, a3
 v_accvgpr_read_b32 v68, a4
 v_accvgpr_read_b32 v69, a5
 v_accvgpr_read_b32 v70, a6
 v_accvgpr_read_b32 v71, a7
 v_mul_f32 v64, v64, v23
 v_mul_f32 v65, v65, v23
 v_mul_f32 v66, v66, v23
 v_mul_f32 v67, v67, v23
 v_mul_f32 v68, v68, v23
 v_mul_f32 v69, v69, v23
 v_mul_f32 v70, v70, v23
 v_mul_f32 v71, v71, v23
 v_cvt_pk_bf16_f32 v72, v64, v65
 v_cvt_pk_bf16_f32 v73, v66, v67
 v_cvt_pk_bf16_f32 v74, v68, v69
 v_cvt_pk_bf16_f32 v75, v70, v71
 s_mov_b32 s34, 0
 buffer_store_dwordx4 v[72:75], v205, s[24:27], s34 offen offset:0 sc0 sc1
 v_accvgpr_read_b32 v76, a8
 v_accvgpr_read_b32 v77, a9
 v_accvgpr_read_b32 v78, a10
 v_accvgpr_read_b32 v79, a11
 v_accvgpr_read_b32 v80, a12
 v_accvgpr_read_b32 v81, a13
 v_accvgpr_read_b32 v82, a14
 v_accvgpr_read_b32 v83, a15
 v_mul_f32 v76, v76, v23
 v_mul_f32 v77, v77, v23
 v_mul_f32 v78, v78, v23
 v_mul_f32 v79, v79, v23
 v_mul_f32 v80, v80, v23
 v_mul_f32 v81, v81, v23
 v_mul_f32 v82, v82, v23
 v_mul_f32 v83, v83, v23
 v_cvt_pk_bf16_f32 v84, v76, v77
 v_cvt_pk_bf16_f32 v85, v78, v79
 v_cvt_pk_bf16_f32 v86, v80, v81
 v_cvt_pk_bf16_f32 v87, v82, v83
 s_mov_b32 s34, 0
 buffer_store_dwordx4 v[84:87], v205, s[24:27], s34 offen offset:1024 sc0 sc1
 v_accvgpr_read_b32 v88, a16
 v_accvgpr_read_b32 v89, a17
 v_accvgpr_read_b32 v90, a18
 v_accvgpr_read_b32 v91, a19
 v_accvgpr_read_b32 v92, a20
 v_accvgpr_read_b32 v93, a21
 v_accvgpr_read_b32 v94, a22
 v_accvgpr_read_b32 v95, a23
 v_mul_f32 v88, v88, v23
 v_mul_f32 v89, v89, v23
 v_mul_f32 v90, v90, v23
 v_mul_f32 v91, v91, v23
 v_mul_f32 v92, v92, v23
 v_mul_f32 v93, v93, v23
 v_mul_f32 v94, v94, v23
 v_mul_f32 v95, v95, v23
 v_cvt_pk_bf16_f32 v96, v88, v89
 v_cvt_pk_bf16_f32 v97, v90, v91
 v_cvt_pk_bf16_f32 v98, v92, v93
 v_cvt_pk_bf16_f32 v99, v94, v95
 s_mov_b32 s34, 2048
 buffer_store_dwordx4 v[96:99], v205, s[24:27], s34 offen offset:0 sc0 sc1
 v_accvgpr_read_b32 v100, a24
 v_accvgpr_read_b32 v101, a25
 v_accvgpr_read_b32 v102, a26
 v_accvgpr_read_b32 v103, a27
 v_accvgpr_read_b32 v104, a28
 v_accvgpr_read_b32 v105, a29
 v_accvgpr_read_b32 v106, a30
 v_accvgpr_read_b32 v107, a31
 v_mul_f32 v100, v100, v23
 v_mul_f32 v101, v101, v23
 v_mul_f32 v102, v102, v23
 v_mul_f32 v103, v103, v23
 v_mul_f32 v104, v104, v23
 v_mul_f32 v105, v105, v23
 v_mul_f32 v106, v106, v23
 v_mul_f32 v107, v107, v23
 v_cvt_pk_bf16_f32 v108, v100, v101
 v_cvt_pk_bf16_f32 v109, v102, v103
 v_cvt_pk_bf16_f32 v110, v104, v105
 v_cvt_pk_bf16_f32 v111, v106, v107
 s_mov_b32 s34, 2048
 buffer_store_dwordx4 v[108:111], v205, s[24:27], s34 offen offset:1024 sc0 sc1
 v_accvgpr_read_b32 v112, a32
 v_accvgpr_read_b32 v113, a33
 v_accvgpr_read_b32 v114, a34
 v_accvgpr_read_b32 v115, a35
 v_accvgpr_read_b32 v116, a36
 v_accvgpr_read_b32 v117, a37
 v_accvgpr_read_b32 v118, a38
 v_accvgpr_read_b32 v119, a39
 v_mul_f32 v112, v112, v23
 v_mul_f32 v113, v113, v23
 v_mul_f32 v114, v114, v23
 v_mul_f32 v115, v115, v23
 v_mul_f32 v116, v116, v23
 v_mul_f32 v117, v117, v23
 v_mul_f32 v118, v118, v23
 v_mul_f32 v119, v119, v23
 v_cvt_pk_bf16_f32 v120, v112, v113
 v_cvt_pk_bf16_f32 v121, v114, v115
 v_cvt_pk_bf16_f32 v122, v116, v117
 v_cvt_pk_bf16_f32 v123, v118, v119
 s_mov_b32 s34, 4096
 buffer_store_dwordx4 v[120:123], v205, s[24:27], s34 offen offset:0 sc0 sc1
 v_accvgpr_read_b32 v124, a40
 v_accvgpr_read_b32 v125, a41
 v_accvgpr_read_b32 v126, a42
 v_accvgpr_read_b32 v127, a43
 v_accvgpr_read_b32 v128, a44
 v_accvgpr_read_b32 v129, a45
 v_accvgpr_read_b32 v130, a46
 v_accvgpr_read_b32 v131, a47
 v_mul_f32 v124, v124, v23
 v_mul_f32 v125, v125, v23
 v_mul_f32 v126, v126, v23
 v_mul_f32 v127, v127, v23
 v_mul_f32 v128, v128, v23
 v_mul_f32 v129, v129, v23
 v_mul_f32 v130, v130, v23
 v_mul_f32 v131, v131, v23
 v_cvt_pk_bf16_f32 v132, v124, v125
 v_cvt_pk_bf16_f32 v133, v126, v127
 v_cvt_pk_bf16_f32 v134, v128, v129
 v_cvt_pk_bf16_f32 v135, v130, v131
 s_mov_b32 s34, 4096
 buffer_store_dwordx4 v[132:135], v205, s[24:27], s34 offen offset:1024 sc0 sc1
 v_accvgpr_read_b32 v136, a48
 v_accvgpr_read_b32 v137, a49
 v_accvgpr_read_b32 v138, a50
 v_accvgpr_read_b32 v139, a51
 v_accvgpr_read_b32 v140, a52
 v_accvgpr_read_b32 v141, a53
 v_accvgpr_read_b32 v142, a54
 v_accvgpr_read_b32 v143, a55
 v_mul_f32 v136, v136, v23
 v_mul_f32 v137, v137, v23
 v_mul_f32 v138, v138, v23
 v_mul_f32 v139, v139, v23
 v_mul_f32 v140, v140, v23
 v_mul_f32 v141, v141, v23
 v_mul_f32 v142, v142, v23
 v_mul_f32 v143, v143, v23
 v_cvt_pk_bf16_f32 v144, v136, v137
 v_cvt_pk_bf16_f32 v145, v138, v139
 v_cvt_pk_bf16_f32 v146, v140, v141
 v_cvt_pk_bf16_f32 v147, v142, v143
 s_mov_b32 s34, 6144
 buffer_store_dwordx4 v[144:147], v205, s[24:27], s34 offen offset:0 sc0 sc1
 v_accvgpr_read_b32 v148, a56
 v_accvgpr_read_b32 v149, a57
 v_accvgpr_read_b32 v150, a58
 v_accvgpr_read_b32 v151, a59
 v_accvgpr_read_b32 v152, a60
 v_accvgpr_read_b32 v153, a61
 v_accvgpr_read_b32 v154, a62
 v_accvgpr_read_b32 v155, a63
 v_mul_f32 v148, v148, v23
 v_mul_f32 v149, v149, v23
 v_mul_f32 v150, v150, v23
 v_mul_f32 v151, v151, v23
 v_mul_f32 v152, v152, v23
 v_mul_f32 v153, v153, v23
 v_mul_f32 v154, v154, v23
 v_mul_f32 v155, v155, v23
 v_cvt_pk_bf16_f32 v156, v148, v149
 v_cvt_pk_bf16_f32 v157, v150, v151
 v_cvt_pk_bf16_f32 v158, v152, v153
 v_cvt_pk_bf16_f32 v159, v154, v155
 s_mov_b32 s34, 6144
 buffer_store_dwordx4 v[156:159], v205, s[24:27], s34 offen offset:1024 sc0 sc1
 v_accvgpr_read_b32 v64, a64
 v_accvgpr_read_b32 v65, a65
 v_accvgpr_read_b32 v66, a66
 v_accvgpr_read_b32 v67, a67
 v_accvgpr_read_b32 v68, a68
 v_accvgpr_read_b32 v69, a69
 v_accvgpr_read_b32 v70, a70
 v_accvgpr_read_b32 v71, a71
 v_mul_f32 v64, v64, v24
 v_mul_f32 v65, v65, v24
 v_mul_f32 v66, v66, v24
 v_mul_f32 v67, v67, v24
 v_mul_f32 v68, v68, v24
 v_mul_f32 v69, v69, v24
 v_mul_f32 v70, v70, v24
 v_mul_f32 v71, v71, v24
 v_cvt_pk_bf16_f32 v72, v64, v65
 v_cvt_pk_bf16_f32 v73, v66, v67
 v_cvt_pk_bf16_f32 v74, v68, v69
 v_cvt_pk_bf16_f32 v75, v70, v71
 s_mov_b32 s34, 262144
 buffer_store_dwordx4 v[72:75], v205, s[24:27], s34 offen offset:0 sc0 sc1
 v_accvgpr_read_b32 v76, a72
 v_accvgpr_read_b32 v77, a73
 v_accvgpr_read_b32 v78, a74
 v_accvgpr_read_b32 v79, a75
 v_accvgpr_read_b32 v80, a76
 v_accvgpr_read_b32 v81, a77
 v_accvgpr_read_b32 v82, a78
 v_accvgpr_read_b32 v83, a79
 v_mul_f32 v76, v76, v24
 v_mul_f32 v77, v77, v24
 v_mul_f32 v78, v78, v24
 v_mul_f32 v79, v79, v24
 v_mul_f32 v80, v80, v24
 v_mul_f32 v81, v81, v24
 v_mul_f32 v82, v82, v24
 v_mul_f32 v83, v83, v24
 v_cvt_pk_bf16_f32 v84, v76, v77
 v_cvt_pk_bf16_f32 v85, v78, v79
 v_cvt_pk_bf16_f32 v86, v80, v81
 v_cvt_pk_bf16_f32 v87, v82, v83
 s_mov_b32 s34, 262144
 buffer_store_dwordx4 v[84:87], v205, s[24:27], s34 offen offset:1024 sc0 sc1
 v_accvgpr_read_b32 v88, a80
 v_accvgpr_read_b32 v89, a81
 v_accvgpr_read_b32 v90, a82
 v_accvgpr_read_b32 v91, a83
 v_accvgpr_read_b32 v92, a84
 v_accvgpr_read_b32 v93, a85
 v_accvgpr_read_b32 v94, a86
 v_accvgpr_read_b32 v95, a87
 v_mul_f32 v88, v88, v24
 v_mul_f32 v89, v89, v24
 v_mul_f32 v90, v90, v24
 v_mul_f32 v91, v91, v24
 v_mul_f32 v92, v92, v24
 v_mul_f32 v93, v93, v24
 v_mul_f32 v94, v94, v24
 v_mul_f32 v95, v95, v24
 v_cvt_pk_bf16_f32 v96, v88, v89
 v_cvt_pk_bf16_f32 v97, v90, v91
 v_cvt_pk_bf16_f32 v98, v92, v93
 v_cvt_pk_bf16_f32 v99, v94, v95
 s_mov_b32 s34, 264192
 buffer_store_dwordx4 v[96:99], v205, s[24:27], s34 offen offset:0 sc0 sc1
 v_accvgpr_read_b32 v100, a88
 v_accvgpr_read_b32 v101, a89
 v_accvgpr_read_b32 v102, a90
 v_accvgpr_read_b32 v103, a91
 v_accvgpr_read_b32 v104, a92
 v_accvgpr_read_b32 v105, a93
 v_accvgpr_read_b32 v106, a94
 v_accvgpr_read_b32 v107, a95
 v_mul_f32 v100, v100, v24
 v_mul_f32 v101, v101, v24
 v_mul_f32 v102, v102, v24
 v_mul_f32 v103, v103, v24
 v_mul_f32 v104, v104, v24
 v_mul_f32 v105, v105, v24
 v_mul_f32 v106, v106, v24
 v_mul_f32 v107, v107, v24
 v_cvt_pk_bf16_f32 v108, v100, v101
 v_cvt_pk_bf16_f32 v109, v102, v103
 v_cvt_pk_bf16_f32 v110, v104, v105
 v_cvt_pk_bf16_f32 v111, v106, v107
 s_mov_b32 s34, 264192
 buffer_store_dwordx4 v[108:111], v205, s[24:27], s34 offen offset:1024 sc0 sc1
 v_accvgpr_read_b32 v112, a96
 v_accvgpr_read_b32 v113, a97
 v_accvgpr_read_b32 v114, a98
 v_accvgpr_read_b32 v115, a99
 v_accvgpr_read_b32 v116, a100
 v_accvgpr_read_b32 v117, a101
 v_accvgpr_read_b32 v118, a102
 v_accvgpr_read_b32 v119, a103
 v_mul_f32 v112, v112, v24
 v_mul_f32 v113, v113, v24
 v_mul_f32 v114, v114, v24
 v_mul_f32 v115, v115, v24
 v_mul_f32 v116, v116, v24
 v_mul_f32 v117, v117, v24
 v_mul_f32 v118, v118, v24
 v_mul_f32 v119, v119, v24
 v_cvt_pk_bf16_f32 v120, v112, v113
 v_cvt_pk_bf16_f32 v121, v114, v115
 v_cvt_pk_bf16_f32 v122, v116, v117
 v_cvt_pk_bf16_f32 v123, v118, v119
 s_mov_b32 s34, 266240
 buffer_store_dwordx4 v[120:123], v205, s[24:27], s34 offen offset:0 sc0 sc1
 v_accvgpr_read_b32 v124, a104
 v_accvgpr_read_b32 v125, a105
 v_accvgpr_read_b32 v126, a106
 v_accvgpr_read_b32 v127, a107
 v_accvgpr_read_b32 v128, a108
 v_accvgpr_read_b32 v129, a109
 v_accvgpr_read_b32 v130, a110
 v_accvgpr_read_b32 v131, a111
 v_mul_f32 v124, v124, v24
 v_mul_f32 v125, v125, v24
 v_mul_f32 v126, v126, v24
 v_mul_f32 v127, v127, v24
 v_mul_f32 v128, v128, v24
 v_mul_f32 v129, v129, v24
 v_mul_f32 v130, v130, v24
 v_mul_f32 v131, v131, v24
 v_cvt_pk_bf16_f32 v132, v124, v125
 v_cvt_pk_bf16_f32 v133, v126, v127
 v_cvt_pk_bf16_f32 v134, v128, v129
 v_cvt_pk_bf16_f32 v135, v130, v131
 s_mov_b32 s34, 266240
 buffer_store_dwordx4 v[132:135], v205, s[24:27], s34 offen offset:1024 sc0 sc1
 v_accvgpr_read_b32 v136, a112
 v_accvgpr_read_b32 v137, a113
 v_accvgpr_read_b32 v138, a114
 v_accvgpr_read_b32 v139, a115
 v_accvgpr_read_b32 v140, a116
 v_accvgpr_read_b32 v141, a117
 v_accvgpr_read_b32 v142, a118
 v_accvgpr_read_b32 v143, a119
 v_mul_f32 v136, v136, v24
 v_mul_f32 v137, v137, v24
 v_mul_f32 v138, v138, v24
 v_mul_f32 v139, v139, v24
 v_mul_f32 v140, v140, v24
 v_mul_f32 v141, v141, v24
 v_mul_f32 v142, v142, v24
 v_mul_f32 v143, v143, v24
 v_cvt_pk_bf16_f32 v144, v136, v137
 v_cvt_pk_bf16_f32 v145, v138, v139
 v_cvt_pk_bf16_f32 v146, v140, v141
 v_cvt_pk_bf16_f32 v147, v142, v143
 s_mov_b32 s34, 268288
 buffer_store_dwordx4 v[144:147], v205, s[24:27], s34 offen offset:0 sc0 sc1
 v_accvgpr_read_b32 v148, a120
 v_accvgpr_read_b32 v149, a121
 v_accvgpr_read_b32 v150, a122
 v_accvgpr_read_b32 v151, a123
 v_accvgpr_read_b32 v152, a124
 v_accvgpr_read_b32 v153, a125
 v_accvgpr_read_b32 v154, a126
 v_accvgpr_read_b32 v155, a127
 v_mul_f32 v148, v148, v24
 v_mul_f32 v149, v149, v24
 v_mul_f32 v150, v150, v24
 v_mul_f32 v151, v151, v24
 v_mul_f32 v152, v152, v24
 v_mul_f32 v153, v153, v24
 v_mul_f32 v154, v154, v24
 v_mul_f32 v155, v155, v24
 v_cvt_pk_bf16_f32 v156, v148, v149
 v_cvt_pk_bf16_f32 v157, v150, v151
 v_cvt_pk_bf16_f32 v158, v152, v153
 v_cvt_pk_bf16_f32 v159, v154, v155
 s_mov_b32 s34, 268288
 buffer_store_dwordx4 v[156:159], v205, s[24:27], s34 offen offset:1024 sc0 sc1
 s_cmp_eq_u32 s79, 0
 s_cbranch_scc1 attn_kernel_noz246
 s_waitcnt vmcnt(16)
 v_add_f32 v214, v214, v216
 v_add_f32 v215, v215, v217
 v_add_f32 v214, v214, v218
 v_add_f32 v215, v215, v219
 v_add_f32 v214, v214, v220
 v_add_f32 v215, v215, v221
 v_add_f32 v214, v214, v222
 v_add_f32 v215, v215, v223
 v_add_f32 v214, v214, v224
 v_add_f32 v215, v215, v225
 v_add_f32 v214, v214, v226
 v_add_f32 v215, v215, v227
 v_add_f32 v214, v214, v228
 v_add_f32 v215, v215, v229
 v_add_f32 v214, v214, v230
 v_add_f32 v215, v215, v231
 v_add_f32 v214, v214, v232
 v_add_f32 v215, v215, v233
 v_add_f32 v214, v214, v234
 v_add_f32 v215, v215, v235
 v_add_f32 v214, v214, v236
 v_add_f32 v215, v215, v237
 v_add_f32 v214, v214, v238
 v_add_f32 v215, v215, v239
 v_add_f32 v214, v214, v240
 v_add_f32 v215, v215, v241
 v_mov_b32 v32, v214
 v_mov_b32 v34, v214
 v_mov_b32 v33, v215
 v_mov_b32 v35, v215
 s_nop 1
 v_permlane32_swap_b32 v32, v34
 v_permlane32_swap_b32 v33, v35
 s_nop 1
 v_mul_f32 v32, 0x3a97b426, v32
 v_mul_f32 v33, 0x3a97b426, v33
 v_fma_f32 v33, -v32, v32, v33
 v_max_f32 v33, 0, v33
 v_cvt_pk_bf16_f32 v32, v32, v32
 v_and_b32 v32, 0xffff0000, v32
 v_cvt_pk_bf16_f32 v33, v33, v33
 v_and_b32 v33, 0xffff0000, v33
 v_add_f32 v33, 0x3727c5ac, v33
 v_cvt_pk_bf16_f32 v33, v33, v33
 v_and_b32 v33, 0xffff0000, v33
 v_sqrt_f32 v33, v33
 s_nop 0
 v_cvt_pk_bf16_f32 v33, v33, v33
 v_and_b32 v33, 0xffff0000, v33
 v_rcp_f32 v33, v33
 s_nop 0
 v_mul_f32 v34, 0x3a97b426, v34
 v_mul_f32 v35, 0x3a97b426, v35
 v_fma_f32 v35, -v34, v34, v35
 v_max_f32 v35, 0, v35
 v_cvt_pk_bf16_f32 v34, v34, v34
 v_and_b32 v34, 0xffff0000, v34
 v_cvt_pk_bf16_f32 v35, v35, v35
 v_and_b32 v35, 0xffff0000, v35
 v_add_f32 v35, 0x3727c5ac, v35
 v_cvt_pk_bf16_f32 v35, v35, v35
 v_and_b32 v35, 0xffff0000, v35
 v_sqrt_f32 v35, v35
 s_nop 0
 v_cvt_pk_bf16_f32 v35, v35, v35
 v_and_b32 v35, 0xffff0000, v35
 v_rcp_f32 v35, v35
 s_nop 0
 s_cmp_eq_u32 s78, 0
 s_cbranch_scc1 attn_kernel_nz47
 s_lshl_b32 s34, s29, 2
 s_add_u32 s34, s34, 10
 s_sub_u32 s34, s34, 64
 s_mul_i32 s44, s34, 7282
 s_lshr_b32 s44, s44, 16
 s_mul_i32 s45, s44, 9
 s_sub_u32 s45, s34, s45
 s_mul_i32 s44, s44, 655360
 s_lshr_b32 s46, s45, 1
 s_lshl_b32 s46, s46, 8
 s_add_u32 s44, s44, s46
 s_and_b32 s46, s45, 1
 s_lshl_b32 s46, s46, 5
 s_add_u32 s44, s44, s46
 s_add_u32 s45, s44, 10240
 v_accvgpr_read_b32 v72, a224
 v_accvgpr_read_b32 v73, a225
 v_accvgpr_read_b32 v74, a226
 v_accvgpr_read_b32 v75, a227
 v_lshlrev_b32 v64, 16, v72
 v_and_b32 v65, 0xffff0000, v72
 v_sub_f32 v64, v64, v32
 v_sub_f32 v65, v65, v32
 v_cvt_pk_bf16_f32 v72, v64, v65
 v_lshlrev_b32 v64, 16, v72
 v_and_b32 v65, 0xffff0000, v72
 v_mul_f32 v64, v64, v33
 v_mul_f32 v65, v65, v33
 v_cvt_pk_bf16_f32 v72, v64, v65
 v_lshlrev_b32 v66, 16, v73
 v_and_b32 v67, 0xffff0000, v73
 v_sub_f32 v66, v66, v32
 v_sub_f32 v67, v67, v32
 v_cvt_pk_bf16_f32 v73, v66, v67
 v_lshlrev_b32 v66, 16, v73
 v_and_b32 v67, 0xffff0000, v73
 v_mul_f32 v66, v66, v33
 v_mul_f32 v67, v67, v33
 v_cvt_pk_bf16_f32 v73, v66, v67
 v_lshlrev_b32 v68, 16, v74
 v_and_b32 v69, 0xffff0000, v74
 v_sub_f32 v68, v68, v32
 v_sub_f32 v69, v69, v32
 v_cvt_pk_bf16_f32 v74, v68, v69
 v_lshlrev_b32 v68, 16, v74
 v_and_b32 v69, 0xffff0000, v74
 v_mul_f32 v68, v68, v33
 v_mul_f32 v69, v69, v33
 v_cvt_pk_bf16_f32 v74, v68, v69
 v_lshlrev_b32 v70, 16, v75
 v_and_b32 v71, 0xffff0000, v75
 v_sub_f32 v70, v70, v32
 v_sub_f32 v71, v71, v32
 v_cvt_pk_bf16_f32 v75, v70, v71
 v_lshlrev_b32 v70, 16, v75
 v_and_b32 v71, 0xffff0000, v75
 v_mul_f32 v70, v70, v33
 v_mul_f32 v71, v71, v33
 v_cvt_pk_bf16_f32 v75, v70, v71
 buffer_store_dwordx4 v[72:75], v211, s[68:71], s44 offen sc0 sc1
 v_accvgpr_read_b32 v84, a240
 v_accvgpr_read_b32 v85, a241
 v_accvgpr_read_b32 v86, a242
 v_accvgpr_read_b32 v87, a243
 v_lshlrev_b32 v76, 16, v84
 v_and_b32 v77, 0xffff0000, v84
 v_sub_f32 v76, v76, v34
 v_sub_f32 v77, v77, v34
 v_cvt_pk_bf16_f32 v84, v76, v77
 v_lshlrev_b32 v76, 16, v84
 v_and_b32 v77, 0xffff0000, v84
 v_mul_f32 v76, v76, v35
 v_mul_f32 v77, v77, v35
 v_cvt_pk_bf16_f32 v84, v76, v77
 v_lshlrev_b32 v78, 16, v85
 v_and_b32 v79, 0xffff0000, v85
 v_sub_f32 v78, v78, v34
 v_sub_f32 v79, v79, v34
 v_cvt_pk_bf16_f32 v85, v78, v79
 v_lshlrev_b32 v78, 16, v85
 v_and_b32 v79, 0xffff0000, v85
 v_mul_f32 v78, v78, v35
 v_mul_f32 v79, v79, v35
 v_cvt_pk_bf16_f32 v85, v78, v79
 v_lshlrev_b32 v80, 16, v86
 v_and_b32 v81, 0xffff0000, v86
 v_sub_f32 v80, v80, v34
 v_sub_f32 v81, v81, v34
 v_cvt_pk_bf16_f32 v86, v80, v81
 v_lshlrev_b32 v80, 16, v86
 v_and_b32 v81, 0xffff0000, v86
 v_mul_f32 v80, v80, v35
 v_mul_f32 v81, v81, v35
 v_cvt_pk_bf16_f32 v86, v80, v81
 v_lshlrev_b32 v82, 16, v87
 v_and_b32 v83, 0xffff0000, v87
 v_sub_f32 v82, v82, v34
 v_sub_f32 v83, v83, v34
 v_cvt_pk_bf16_f32 v87, v82, v83
 v_lshlrev_b32 v82, 16, v87
 v_and_b32 v83, 0xffff0000, v87
 v_mul_f32 v82, v82, v35
 v_mul_f32 v83, v83, v35
 v_cvt_pk_bf16_f32 v87, v82, v83
 buffer_store_dwordx4 v[84:87], v211, s[68:71], s45 offen sc0 sc1
 s_lshl_b32 s34, s29, 2
 s_add_u32 s34, s34, 11
 s_sub_u32 s34, s34, 64
 s_mul_i32 s44, s34, 7282
 s_lshr_b32 s44, s44, 16
 s_mul_i32 s45, s44, 9
 s_sub_u32 s45, s34, s45
 s_mul_i32 s44, s44, 655360
 s_lshr_b32 s46, s45, 1
 s_lshl_b32 s46, s46, 8
 s_add_u32 s44, s44, s46
 s_and_b32 s46, s45, 1
 s_lshl_b32 s46, s46, 5
 s_add_u32 s44, s44, s46
 s_add_u32 s45, s44, 10240
 v_accvgpr_read_b32 v96, a228
 v_accvgpr_read_b32 v97, a229
 v_accvgpr_read_b32 v98, a230
 v_accvgpr_read_b32 v99, a231
 v_lshlrev_b32 v88, 16, v96
 v_and_b32 v89, 0xffff0000, v96
 v_sub_f32 v88, v88, v32
 v_sub_f32 v89, v89, v32
 v_cvt_pk_bf16_f32 v96, v88, v89
 v_lshlrev_b32 v88, 16, v96
 v_and_b32 v89, 0xffff0000, v96
 v_mul_f32 v88, v88, v33
 v_mul_f32 v89, v89, v33
 v_cvt_pk_bf16_f32 v96, v88, v89
 v_lshlrev_b32 v90, 16, v97
 v_and_b32 v91, 0xffff0000, v97
 v_sub_f32 v90, v90, v32
 v_sub_f32 v91, v91, v32
 v_cvt_pk_bf16_f32 v97, v90, v91
 v_lshlrev_b32 v90, 16, v97
 v_and_b32 v91, 0xffff0000, v97
 v_mul_f32 v90, v90, v33
 v_mul_f32 v91, v91, v33
 v_cvt_pk_bf16_f32 v97, v90, v91
 v_lshlrev_b32 v92, 16, v98
 v_and_b32 v93, 0xffff0000, v98
 v_sub_f32 v92, v92, v32
 v_sub_f32 v93, v93, v32
 v_cvt_pk_bf16_f32 v98, v92, v93
 v_lshlrev_b32 v92, 16, v98
 v_and_b32 v93, 0xffff0000, v98
 v_mul_f32 v92, v92, v33
 v_mul_f32 v93, v93, v33
 v_cvt_pk_bf16_f32 v98, v92, v93
 v_lshlrev_b32 v94, 16, v99
 v_and_b32 v95, 0xffff0000, v99
 v_sub_f32 v94, v94, v32
 v_sub_f32 v95, v95, v32
 v_cvt_pk_bf16_f32 v99, v94, v95
 v_lshlrev_b32 v94, 16, v99
 v_and_b32 v95, 0xffff0000, v99
 v_mul_f32 v94, v94, v33
 v_mul_f32 v95, v95, v33
 v_cvt_pk_bf16_f32 v99, v94, v95
 buffer_store_dwordx4 v[96:99], v211, s[68:71], s44 offen sc0 sc1
 v_accvgpr_read_b32 v108, a244
 v_accvgpr_read_b32 v109, a245
 v_accvgpr_read_b32 v110, a246
 v_accvgpr_read_b32 v111, a247
 v_lshlrev_b32 v100, 16, v108
 v_and_b32 v101, 0xffff0000, v108
 v_sub_f32 v100, v100, v34
 v_sub_f32 v101, v101, v34
 v_cvt_pk_bf16_f32 v108, v100, v101
 v_lshlrev_b32 v100, 16, v108
 v_and_b32 v101, 0xffff0000, v108
 v_mul_f32 v100, v100, v35
 v_mul_f32 v101, v101, v35
 v_cvt_pk_bf16_f32 v108, v100, v101
 v_lshlrev_b32 v102, 16, v109
 v_and_b32 v103, 0xffff0000, v109
 v_sub_f32 v102, v102, v34
 v_sub_f32 v103, v103, v34
 v_cvt_pk_bf16_f32 v109, v102, v103
 v_lshlrev_b32 v102, 16, v109
 v_and_b32 v103, 0xffff0000, v109
 v_mul_f32 v102, v102, v35
 v_mul_f32 v103, v103, v35
 v_cvt_pk_bf16_f32 v109, v102, v103
 v_lshlrev_b32 v104, 16, v110
 v_and_b32 v105, 0xffff0000, v110
 v_sub_f32 v104, v104, v34
 v_sub_f32 v105, v105, v34
 v_cvt_pk_bf16_f32 v110, v104, v105
 v_lshlrev_b32 v104, 16, v110
 v_and_b32 v105, 0xffff0000, v110
 v_mul_f32 v104, v104, v35
 v_mul_f32 v105, v105, v35
 v_cvt_pk_bf16_f32 v110, v104, v105
 v_lshlrev_b32 v106, 16, v111
 v_and_b32 v107, 0xffff0000, v111
 v_sub_f32 v106, v106, v34
 v_sub_f32 v107, v107, v34
 v_cvt_pk_bf16_f32 v111, v106, v107
 v_lshlrev_b32 v106, 16, v111
 v_and_b32 v107, 0xffff0000, v111
 v_mul_f32 v106, v106, v35
 v_mul_f32 v107, v107, v35
 v_cvt_pk_bf16_f32 v111, v106, v107
 buffer_store_dwordx4 v[108:111], v211, s[68:71], s45 offen sc0 sc1
attn_kernel_nz47:
 s_cmp_eq_u32 s79, 0
 s_cbranch_scc1 attn_kernel_nz48
 s_lshl_b32 s34, s29, 2
 s_add_u32 s34, s34, 12
 s_sub_u32 s34, s34, 64
 s_mul_i32 s44, s34, 7282
 s_lshr_b32 s44, s44, 16
 s_mul_i32 s45, s44, 9
 s_sub_u32 s45, s34, s45
 s_mul_i32 s44, s44, 655360
 s_lshr_b32 s46, s45, 1
 s_lshl_b32 s46, s46, 8
 s_add_u32 s44, s44, s46
 s_and_b32 s46, s45, 1
 s_lshl_b32 s46, s46, 5
 s_add_u32 s44, s44, s46
 s_add_u32 s45, s44, 10240
 v_accvgpr_read_b32 v120, a232
 v_accvgpr_read_b32 v121, a233
 v_accvgpr_read_b32 v122, a234
 v_accvgpr_read_b32 v123, a235
 v_lshlrev_b32 v112, 16, v120
 v_and_b32 v113, 0xffff0000, v120
 v_sub_f32 v112, v112, v32
 v_sub_f32 v113, v113, v32
 v_cvt_pk_bf16_f32 v120, v112, v113
 v_lshlrev_b32 v112, 16, v120
 v_and_b32 v113, 0xffff0000, v120
 v_mul_f32 v112, v112, v33
 v_mul_f32 v113, v113, v33
 v_cvt_pk_bf16_f32 v120, v112, v113
 v_lshlrev_b32 v114, 16, v121
 v_and_b32 v115, 0xffff0000, v121
 v_sub_f32 v114, v114, v32
 v_sub_f32 v115, v115, v32
 v_cvt_pk_bf16_f32 v121, v114, v115
 v_lshlrev_b32 v114, 16, v121
 v_and_b32 v115, 0xffff0000, v121
 v_mul_f32 v114, v114, v33
 v_mul_f32 v115, v115, v33
 v_cvt_pk_bf16_f32 v121, v114, v115
 v_lshlrev_b32 v116, 16, v122
 v_and_b32 v117, 0xffff0000, v122
 v_sub_f32 v116, v116, v32
 v_sub_f32 v117, v117, v32
 v_cvt_pk_bf16_f32 v122, v116, v117
 v_lshlrev_b32 v116, 16, v122
 v_and_b32 v117, 0xffff0000, v122
 v_mul_f32 v116, v116, v33
 v_mul_f32 v117, v117, v33
 v_cvt_pk_bf16_f32 v122, v116, v117
 v_lshlrev_b32 v118, 16, v123
 v_and_b32 v119, 0xffff0000, v123
 v_sub_f32 v118, v118, v32
 v_sub_f32 v119, v119, v32
 v_cvt_pk_bf16_f32 v123, v118, v119
 v_lshlrev_b32 v118, 16, v123
 v_and_b32 v119, 0xffff0000, v123
 v_mul_f32 v118, v118, v33
 v_mul_f32 v119, v119, v33
 v_cvt_pk_bf16_f32 v123, v118, v119
 buffer_store_dwordx4 v[120:123], v211, s[68:71], s44 offen sc0 sc1
 v_accvgpr_read_b32 v132, a248
 v_accvgpr_read_b32 v133, a249
 v_accvgpr_read_b32 v134, a250
 v_accvgpr_read_b32 v135, a251
 v_lshlrev_b32 v124, 16, v132
 v_and_b32 v125, 0xffff0000, v132
 v_sub_f32 v124, v124, v34
 v_sub_f32 v125, v125, v34
 v_cvt_pk_bf16_f32 v132, v124, v125
 v_lshlrev_b32 v124, 16, v132
 v_and_b32 v125, 0xffff0000, v132
 v_mul_f32 v124, v124, v35
 v_mul_f32 v125, v125, v35
 v_cvt_pk_bf16_f32 v132, v124, v125
 v_lshlrev_b32 v126, 16, v133
 v_and_b32 v127, 0xffff0000, v133
 v_sub_f32 v126, v126, v34
 v_sub_f32 v127, v127, v34
 v_cvt_pk_bf16_f32 v133, v126, v127
 v_lshlrev_b32 v126, 16, v133
 v_and_b32 v127, 0xffff0000, v133
 v_mul_f32 v126, v126, v35
 v_mul_f32 v127, v127, v35
 v_cvt_pk_bf16_f32 v133, v126, v127
 v_lshlrev_b32 v128, 16, v134
 v_and_b32 v129, 0xffff0000, v134
 v_sub_f32 v128, v128, v34
 v_sub_f32 v129, v129, v34
 v_cvt_pk_bf16_f32 v134, v128, v129
 v_lshlrev_b32 v128, 16, v134
 v_and_b32 v129, 0xffff0000, v134
 v_mul_f32 v128, v128, v35
 v_mul_f32 v129, v129, v35
 v_cvt_pk_bf16_f32 v134, v128, v129
 v_lshlrev_b32 v130, 16, v135
 v_and_b32 v131, 0xffff0000, v135
 v_sub_f32 v130, v130, v34
 v_sub_f32 v131, v131, v34
 v_cvt_pk_bf16_f32 v135, v130, v131
 v_lshlrev_b32 v130, 16, v135
 v_and_b32 v131, 0xffff0000, v135
 v_mul_f32 v130, v130, v35
 v_mul_f32 v131, v131, v35
 v_cvt_pk_bf16_f32 v135, v130, v131
 buffer_store_dwordx4 v[132:135], v211, s[68:71], s45 offen sc0 sc1
 s_lshl_b32 s34, s29, 2
 s_add_u32 s34, s34, 13
 s_sub_u32 s34, s34, 64
 s_mul_i32 s44, s34, 7282
 s_lshr_b32 s44, s44, 16
 s_mul_i32 s45, s44, 9
 s_sub_u32 s45, s34, s45
 s_mul_i32 s44, s44, 655360
 s_lshr_b32 s46, s45, 1
 s_lshl_b32 s46, s46, 8
 s_add_u32 s44, s44, s46
 s_and_b32 s46, s45, 1
 s_lshl_b32 s46, s46, 5
 s_add_u32 s44, s44, s46
 s_add_u32 s45, s44, 10240
 v_accvgpr_read_b32 v144, a236
 v_accvgpr_read_b32 v145, a237
 v_accvgpr_read_b32 v146, a238
 v_accvgpr_read_b32 v147, a239
 v_lshlrev_b32 v136, 16, v144
 v_and_b32 v137, 0xffff0000, v144
 v_sub_f32 v136, v136, v32
 v_sub_f32 v137, v137, v32
 v_cvt_pk_bf16_f32 v144, v136, v137
 v_lshlrev_b32 v136, 16, v144
 v_and_b32 v137, 0xffff0000, v144
 v_mul_f32 v136, v136, v33
 v_mul_f32 v137, v137, v33
 v_cvt_pk_bf16_f32 v144, v136, v137
 v_lshlrev_b32 v138, 16, v145
 v_and_b32 v139, 0xffff0000, v145
 v_sub_f32 v138, v138, v32
 v_sub_f32 v139, v139, v32
 v_cvt_pk_bf16_f32 v145, v138, v139
 v_lshlrev_b32 v138, 16, v145
 v_and_b32 v139, 0xffff0000, v145
 v_mul_f32 v138, v138, v33
 v_mul_f32 v139, v139, v33
 v_cvt_pk_bf16_f32 v145, v138, v139
 v_lshlrev_b32 v140, 16, v146
 v_and_b32 v141, 0xffff0000, v146
 v_sub_f32 v140, v140, v32
 v_sub_f32 v141, v141, v32
 v_cvt_pk_bf16_f32 v146, v140, v141
 v_lshlrev_b32 v140, 16, v146
 v_and_b32 v141, 0xffff0000, v146
 v_mul_f32 v140, v140, v33
 v_mul_f32 v141, v141, v33
 v_cvt_pk_bf16_f32 v146, v140, v141
 v_lshlrev_b32 v142, 16, v147
 v_and_b32 v143, 0xffff0000, v147
 v_sub_f32 v142, v142, v32
 v_sub_f32 v143, v143, v32
 v_cvt_pk_bf16_f32 v147, v142, v143
 v_lshlrev_b32 v142, 16, v147
 v_and_b32 v143, 0xffff0000, v147
 v_mul_f32 v142, v142, v33
 v_mul_f32 v143, v143, v33
 v_cvt_pk_bf16_f32 v147, v142, v143
 buffer_store_dwordx4 v[144:147], v211, s[68:71], s44 offen sc0 sc1
 v_accvgpr_read_b32 v156, a252
 v_accvgpr_read_b32 v157, a253
 v_accvgpr_read_b32 v158, a254
 v_accvgpr_read_b32 v159, a255
 v_lshlrev_b32 v148, 16, v156
 v_and_b32 v149, 0xffff0000, v156
 v_sub_f32 v148, v148, v34
 v_sub_f32 v149, v149, v34
 v_cvt_pk_bf16_f32 v156, v148, v149
 v_lshlrev_b32 v148, 16, v156
 v_and_b32 v149, 0xffff0000, v156
 v_mul_f32 v148, v148, v35
 v_mul_f32 v149, v149, v35
 v_cvt_pk_bf16_f32 v156, v148, v149
 v_lshlrev_b32 v150, 16, v157
 v_and_b32 v151, 0xffff0000, v157
 v_sub_f32 v150, v150, v34
 v_sub_f32 v151, v151, v34
 v_cvt_pk_bf16_f32 v157, v150, v151
 v_lshlrev_b32 v150, 16, v157
 v_and_b32 v151, 0xffff0000, v157
 v_mul_f32 v150, v150, v35
 v_mul_f32 v151, v151, v35
 v_cvt_pk_bf16_f32 v157, v150, v151
 v_lshlrev_b32 v152, 16, v158
 v_and_b32 v153, 0xffff0000, v158
 v_sub_f32 v152, v152, v34
 v_sub_f32 v153, v153, v34
 v_cvt_pk_bf16_f32 v158, v152, v153
 v_lshlrev_b32 v152, 16, v158
 v_and_b32 v153, 0xffff0000, v158
 v_mul_f32 v152, v152, v35
 v_mul_f32 v153, v153, v35
 v_cvt_pk_bf16_f32 v158, v152, v153
 v_lshlrev_b32 v154, 16, v159
 v_and_b32 v155, 0xffff0000, v159
 v_sub_f32 v154, v154, v34
 v_sub_f32 v155, v155, v34
 v_cvt_pk_bf16_f32 v159, v154, v155
 v_lshlrev_b32 v154, 16, v159
 v_and_b32 v155, 0xffff0000, v159
 v_mul_f32 v154, v154, v35
 v_mul_f32 v155, v155, v35
 v_cvt_pk_bf16_f32 v159, v154, v155
 buffer_store_dwordx4 v[156:159], v211, s[68:71], s45 offen sc0 sc1
attn_kernel_nz48:
attn_kernel_noz246:
attn_kernel_done1:
 s_endpgm
attn_kernel_rs9:
 s_call_b64 s[40:41], attn_rare0
 s_branch attn_kernel_rb10
attn_kernel_rs11:
 s_call_b64 s[40:41], attn_rare1
 s_branch attn_kernel_rb12
attn_kernel_rs14:
 s_call_b64 s[40:41], attn_rare0
 s_branch attn_kernel_rb15
attn_kernel_rs16:
 s_call_b64 s[40:41], attn_rare1
 s_branch attn_kernel_rb17
attn_kernel_rs18:
 s_call_b64 s[40:41], attn_rare0
 s_branch attn_kernel_rb19
attn_kernel_rs20:
 s_call_b64 s[40:41], attn_rare1
 s_branch attn_kernel_rb21
attn_kernel_rs22:
 s_call_b64 s[40:41], attn_rare0
 s_branch attn_kernel_rb23
attn_kernel_rs24:
 s_call_b64 s[40:41], attn_rare1
 s_branch attn_kernel_rb25
attn_kernel_rs26:
 s_call_b64 s[40:41], attn_rare0
 s_branch attn_kernel_rb27
attn_kernel_rs28:
 s_call_b64 s[40:41], attn_rare1
 s_branch attn_kernel_rb29
attn_kernel_rs31:
 s_call_b64 s[40:41], attn_rare0
 s_branch attn_kernel_rb32
attn_kernel_rs33:
 s_call_b64 s[40:41], attn_rare1
 s_branch attn_kernel_rb34
attn_kernel_rs35:
 s_call_b64 s[40:41], attn_rare0
 s_branch attn_kernel_rb36
attn_kernel_rs37:
 s_call_b64 s[40:41], attn_rare1
 s_branch attn_kernel_rb38
attn_kernel_rs42:
 s_call_b64 s[40:41], attn_rare0
 s_branch attn_kernel_rb43
attn_kernel_rs44:
 s_call_b64 s[40:41], attn_rare1
 s_branch attn_kernel_rb45
attn_rare0:
 s_nop 15
 s_nop 15
 v_max3_f32 v40, v64, v65, v66
 v_max3_f32 v40, v40, v67, v68
 v_max3_f32 v40, v40, v69, v70
 v_max3_f32 v40, v40, v71, v72
 v_max3_f32 v40, v40, v73, v74
 v_max3_f32 v40, v40, v75, v76
 v_max3_f32 v40, v40, v77, v78
 v_max_f32 v40, v40, v79
 v_mov_b32 v41, v40
 s_nop 1
 v_permlane32_swap_b32 v40, v41
 s_nop 1
 v_max_f32 v40, v40, v41
 v_max_f32 v40, 0, v40
 v_sub_f32 v64, v64, v40
 v_sub_f32 v96, v96, v40
 v_sub_f32 v160, v160, v40
 v_sub_f32 v65, v65, v40
 v_sub_f32 v97, v97, v40
 v_sub_f32 v161, v161, v40
 v_sub_f32 v66, v66, v40
 v_sub_f32 v98, v98, v40
 v_sub_f32 v162, v162, v40
 v_sub_f32 v67, v67, v40
 v_sub_f32 v99, v99, v40
 v_sub_f32 v163, v163, v40
 v_sub_f32 v68, v68, v40
 v_sub_f32 v100, v100, v40
 v_sub_f32 v164, v164, v40
 v_sub_f32 v69, v69, v40
 v_sub_f32 v101, v101, v40
 v_sub_f32 v165, v165, v40
 v_sub_f32 v70, v70, v40
 v_sub_f32 v102, v102, v40
 v_sub_f32 v166, v166, v40
 v_sub_f32 v71, v71, v40
 v_sub_f32 v103, v103, v40
 v_sub_f32 v167, v167, v40
 v_sub_f32 v72, v72, v40
 v_sub_f32 v104, v104, v40
 v_sub_f32 v168, v168, v40
 v_sub_f32 v73, v73, v40
 v_sub_f32 v105, v105, v40
 v_sub_f32 v169, v169, v40
 v_sub_f32 v74, v74, v40
 v_sub_f32 v106, v106, v40
 v_sub_f32 v170, v170, v40
 v_sub_f32 v75, v75, v40
 v_sub_f32 v107, v107, v40
 v_sub_f32 v171, v171, v40
 v_sub_f32 v76, v76, v40
 v_sub_f32 v108, v108, v40
 v_sub_f32 v172, v172, v40
 v_sub_f32 v77, v77, v40
 v_sub_f32 v109, v109, v40
 v_sub_f32 v173, v173, v40
 v_sub_f32 v78, v78, v40
 v_sub_f32 v110, v110, v40
 v_sub_f32 v174, v174, v40
 v_sub_f32 v79, v79, v40
 v_sub_f32 v111, v111, v40
 v_sub_f32 v175, v175, v40
 v_sub_f32 v42, 0, v40
 v_exp_f32 v42, v42
 s_nop 0
 v_mul_f32 v23, v23, v42
 v_accvgpr_read_b32 v44, a0
 v_accvgpr_read_b32 v45, a1
 v_accvgpr_read_b32 v46, a2
 v_accvgpr_read_b32 v47, a3
 v_mul_f32 v44, v44, v42
 v_mul_f32 v45, v45, v42
 v_mul_f32 v46, v46, v42
 v_mul_f32 v47, v47, v42
 v_accvgpr_write_b32 a0, v44
 v_accvgpr_write_b32 a1, v45
 v_accvgpr_write_b32 a2, v46
 v_accvgpr_write_b32 a3, v47
 v_accvgpr_read_b32 v44, a4
 v_accvgpr_read_b32 v45, a5
 v_accvgpr_read_b32 v46, a6
 v_accvgpr_read_b32 v47, a7
 v_mul_f32 v44, v44, v42
 v_mul_f32 v45, v45, v42
 v_mul_f32 v46, v46, v42
 v_mul_f32 v47, v47, v42
 v_accvgpr_write_b32 a4, v44
 v_accvgpr_write_b32 a5, v45
 v_accvgpr_write_b32 a6, v46
 v_accvgpr_write_b32 a7, v47
 v_accvgpr_read_b32 v44, a8
 v_accvgpr_read_b32 v45, a9
 v_accvgpr_read_b32 v46, a10
 v_accvgpr_read_b32 v47, a11
 v_mul_f32 v44, v44, v42
 v_mul_f32 v45, v45, v42
 v_mul_f32 v46, v46, v42
 v_mul_f32 v47, v47, v42
 v_accvgpr_write_b32 a8, v44
 v_accvgpr_write_b32 a9, v45
 v_accvgpr_write_b32 a10, v46
 v_accvgpr_write_b32 a11, v47
 v_accvgpr_read_b32 v44, a12
 v_accvgpr_read_b32 v45, a13
 v_accvgpr_read_b32 v46, a14
 v_accvgpr_read_b32 v47, a15
 v_mul_f32 v44, v44, v42
 v_mul_f32 v45, v45, v42
 v_mul_f32 v46, v46, v42
 v_mul_f32 v47, v47, v42
 v_accvgpr_write_b32 a12, v44
 v_accvgpr_write_b32 a13, v45
 v_accvgpr_write_b32 a14, v46
 v_accvgpr_write_b32 a15, v47
 v_accvgpr_read_b32 v44, a16
 v_accvgpr_read_b32 v45, a17
 v_accvgpr_read_b32 v46, a18
 v_accvgpr_read_b32 v47, a19
 v_mul_f32 v44, v44, v42
 v_mul_f32 v45, v45, v42
 v_mul_f32 v46, v46, v42
 v_mul_f32 v47, v47, v42
 v_accvgpr_write_b32 a16, v44
 v_accvgpr_write_b32 a17, v45
 v_accvgpr_write_b32 a18, v46
 v_accvgpr_write_b32 a19, v47
 v_accvgpr_read_b32 v44, a20
 v_accvgpr_read_b32 v45, a21
 v_accvgpr_read_b32 v46, a22
 v_accvgpr_read_b32 v47, a23
 v_mul_f32 v44, v44, v42
 v_mul_f32 v45, v45, v42
 v_mul_f32 v46, v46, v42
 v_mul_f32 v47, v47, v42
 v_accvgpr_write_b32 a20, v44
 v_accvgpr_write_b32 a21, v45
 v_accvgpr_write_b32 a22, v46
 v_accvgpr_write_b32 a23, v47
 v_accvgpr_read_b32 v44, a24
 v_accvgpr_read_b32 v45, a25
 v_accvgpr_read_b32 v46, a26
 v_accvgpr_read_b32 v47, a27
 v_mul_f32 v44, v44, v42
 v_mul_f32 v45, v45, v42
 v_mul_f32 v46, v46, v42
 v_mul_f32 v47, v47, v42
 v_accvgpr_write_b32 a24, v44
 v_accvgpr_write_b32 a25, v45
 v_accvgpr_write_b32 a26, v46
 v_accvgpr_write_b32 a27, v47
 v_accvgpr_read_b32 v44, a28
 v_accvgpr_read_b32 v45, a29
 v_accvgpr_read_b32 v46, a30
 v_accvgpr_read_b32 v47, a31
 v_mul_f32 v44, v44, v42
 v_mul_f32 v45, v45, v42
 v_mul_f32 v46, v46, v42
 v_mul_f32 v47, v47, v42
 v_accvgpr_write_b32 a28, v44
 v_accvgpr_write_b32 a29, v45
 v_accvgpr_write_b32 a30, v46
 v_accvgpr_write_b32 a31, v47
 v_accvgpr_read_b32 v44, a32
 v_accvgpr_read_b32 v45, a33
 v_accvgpr_read_b32 v46, a34
 v_accvgpr_read_b32 v47, a35
 v_mul_f32 v44, v44, v42
 v_mul_f32 v45, v45, v42
 v_mul_f32 v46, v46, v42
 v_mul_f32 v47, v47, v42
 v_accvgpr_write_b32 a32, v44
 v_accvgpr_write_b32 a33, v45
 v_accvgpr_write_b32 a34, v46
 v_accvgpr_write_b32 a35, v47
 v_accvgpr_read_b32 v44, a36
 v_accvgpr_read_b32 v45, a37
 v_accvgpr_read_b32 v46, a38
 v_accvgpr_read_b32 v47, a39
 v_mul_f32 v44, v44, v42
 v_mul_f32 v45, v45, v42
 v_mul_f32 v46, v46, v42
 v_mul_f32 v47, v47, v42
 v_accvgpr_write_b32 a36, v44
 v_accvgpr_write_b32 a37, v45
 v_accvgpr_write_b32 a38, v46
 v_accvgpr_write_b32 a39, v47
 v_accvgpr_read_b32 v44, a40
 v_accvgpr_read_b32 v45, a41
 v_accvgpr_read_b32 v46, a42
 v_accvgpr_read_b32 v47, a43
 v_mul_f32 v44, v44, v42
 v_mul_f32 v45, v45, v42
 v_mul_f32 v46, v46, v42
 v_mul_f32 v47, v47, v42
 v_accvgpr_write_b32 a40, v44
 v_accvgpr_write_b32 a41, v45
 v_accvgpr_write_b32 a42, v46
 v_accvgpr_write_b32 a43, v47
 v_accvgpr_read_b32 v44, a44
 v_accvgpr_read_b32 v45, a45
 v_accvgpr_read_b32 v46, a46
 v_accvgpr_read_b32 v47, a47
 v_mul_f32 v44, v44, v42
 v_mul_f32 v45, v45, v42
 v_mul_f32 v46, v46, v42
 v_mul_f32 v47, v47, v42
 v_accvgpr_write_b32 a44, v44
 v_accvgpr_write_b32 a45, v45
 v_accvgpr_write_b32 a46, v46
 v_accvgpr_write_b32 a47, v47
 v_accvgpr_read_b32 v44, a48
 v_accvgpr_read_b32 v45, a49
 v_accvgpr_read_b32 v46, a50
 v_accvgpr_read_b32 v47, a51
 v_mul_f32 v44, v44, v42
 v_mul_f32 v45, v45, v42
 v_mul_f32 v46, v46, v42
 v_mul_f32 v47, v47, v42
 v_accvgpr_write_b32 a48, v44
 v_accvgpr_write_b32 a49, v45
 v_accvgpr_write_b32 a50, v46
 v_accvgpr_write_b32 a51, v47
 v_accvgpr_read_b32 v44, a52
 v_accvgpr_read_b32 v45, a53
 v_accvgpr_read_b32 v46, a54
 v_accvgpr_read_b32 v47, a55
 v_mul_f32 v44, v44, v42
 v_mul_f32 v45, v45, v42
 v_mul_f32 v46, v46, v42
 v_mul_f32 v47, v47, v42
 v_accvgpr_write_b32 a52, v44
 v_accvgpr_write_b32 a53, v45
 v_accvgpr_write_b32 a54, v46
 v_accvgpr_write_b32 a55, v47
 v_accvgpr_read_b32 v44, a56
 v_accvgpr_read_b32 v45, a57
 v_accvgpr_read_b32 v46, a58
 v_accvgpr_read_b32 v47, a59
 v_mul_f32 v44, v44, v42
 v_mul_f32 v45, v45, v42
 v_mul_f32 v46, v46, v42
 v_mul_f32 v47, v47, v42
 v_accvgpr_write_b32 a56, v44
 v_accvgpr_write_b32 a57, v45
 v_accvgpr_write_b32 a58, v46
 v_accvgpr_write_b32 a59, v47
 v_accvgpr_read_b32 v44, a60
 v_accvgpr_read_b32 v45, a61
 v_accvgpr_read_b32 v46, a62
 v_accvgpr_read_b32 v47, a63
 v_mul_f32 v44, v44, v42
 v_mul_f32 v45, v45, v42
 v_mul_f32 v46, v46, v42
 v_mul_f32 v47, v47, v42
 v_accvgpr_write_b32 a60, v44
 v_accvgpr_write_b32 a61, v45
 v_accvgpr_write_b32 a62, v46
 v_accvgpr_write_b32 a63, v47
 v_exp_f32 v44, v64
 v_exp_f32 v45, v65
 s_nop 0
 v_add_f32 v25, v44, v45
 v_cvt_pk_bf16_f32 v128, v44, v45
 v_exp_f32 v44, v66
 v_exp_f32 v45, v67
 s_nop 0
 v_add_f32 v25, v25, v44
 v_add_f32 v25, v25, v45
 v_cvt_pk_bf16_f32 v129, v44, v45
 v_exp_f32 v44, v68
 v_exp_f32 v45, v69
 s_nop 0
 v_add_f32 v25, v25, v44
 v_add_f32 v25, v25, v45
 v_cvt_pk_bf16_f32 v130, v44, v45
 v_exp_f32 v44, v70
 v_exp_f32 v45, v71
 s_nop 0
 v_add_f32 v25, v25, v44
 v_add_f32 v25, v25, v45
 v_cvt_pk_bf16_f32 v131, v44, v45
 v_exp_f32 v44, v72
 v_exp_f32 v45, v73
 s_nop 0
 v_add_f32 v25, v25, v44
 v_add_f32 v25, v25, v45
 v_cvt_pk_bf16_f32 v132, v44, v45
 v_exp_f32 v44, v74
 v_exp_f32 v45, v75
 s_nop 0
 v_add_f32 v25, v25, v44
 v_add_f32 v25, v25, v45
 v_cvt_pk_bf16_f32 v133, v44, v45
 v_exp_f32 v44, v76
 v_exp_f32 v45, v77
 s_nop 0
 v_add_f32 v25, v25, v44
 v_add_f32 v25, v25, v45
 v_cvt_pk_bf16_f32 v134, v44, v45
 v_exp_f32 v44, v78
 v_exp_f32 v45, v79
 s_nop 0
 v_add_f32 v25, v25, v44
 v_add_f32 v25, v25, v45
 v_cvt_pk_bf16_f32 v135, v44, v45
 v_max3_f32 v40, v80, v81, v82
 v_max3_f32 v40, v40, v83, v84
 v_max3_f32 v40, v40, v85, v86
 v_max3_f32 v40, v40, v87, v88
 v_max3_f32 v40, v40, v89, v90
 v_max3_f32 v40, v40, v91, v92
 v_max3_f32 v40, v40, v93, v94
 v_max_f32 v40, v40, v95
 v_mov_b32 v41, v40
 s_nop 1
 v_permlane32_swap_b32 v40, v41
 s_nop 1
 v_max_f32 v40, v40, v41
 v_max_f32 v40, 0, v40
 v_sub_f32 v80, v80, v40
 v_sub_f32 v112, v112, v40
 v_sub_f32 v176, v176, v40
 v_sub_f32 v81, v81, v40
 v_sub_f32 v113, v113, v40
 v_sub_f32 v177, v177, v40
 v_sub_f32 v82, v82, v40
 v_sub_f32 v114, v114, v40
 v_sub_f32 v178, v178, v40
 v_sub_f32 v83, v83, v40
 v_sub_f32 v115, v115, v40
 v_sub_f32 v179, v179, v40
 v_sub_f32 v84, v84, v40
 v_sub_f32 v116, v116, v40
 v_sub_f32 v180, v180, v40
 v_sub_f32 v85, v85, v40
 v_sub_f32 v117, v117, v40
 v_sub_f32 v181, v181, v40
 v_sub_f32 v86, v86, v40
 v_sub_f32 v118, v118, v40
 v_sub_f32 v182, v182, v40
 v_sub_f32 v87, v87, v40
 v_sub_f32 v119, v119, v40
 v_sub_f32 v183, v183, v40
 v_sub_f32 v88, v88, v40
 v_sub_f32 v120, v120, v40
 v_sub_f32 v184, v184, v40
 v_sub_f32 v89, v89, v40
 v_sub_f32 v121, v121, v40
 v_sub_f32 v185, v185, v40
 v_sub_f32 v90, v90, v40
 v_sub_f32 v122, v122, v40
 v_sub_f32 v186, v186, v40
 v_sub_f32 v91, v91, v40
 v_sub_f32 v123, v123, v40
 v_sub_f32 v187, v187, v40
 v_sub_f32 v92, v92, v40
 v_sub_f32 v124, v124, v40
 v_sub_f32 v188, v188, v40
 v_sub_f32 v93, v93, v40
 v_sub_f32 v125, v125, v40
 v_sub_f32 v189, v189, v40
 v_sub_f32 v94, v94, v40
 v_sub_f32 v126, v126, v40
 v_sub_f32 v190, v190, v40
 v_sub_f32 v95, v95, v40
 v_sub_f32 v127, v127, v40
 v_sub_f32 v191, v191, v40
 v_sub_f32 v42, 0, v40
 v_exp_f32 v42, v42
 s_nop 0
 v_mul_f32 v24, v24, v42
 v_accvgpr_read_b32 v44, a64
 v_accvgpr_read_b32 v45, a65
 v_accvgpr_read_b32 v46, a66
 v_accvgpr_read_b32 v47, a67
 v_mul_f32 v44, v44, v42
 v_mul_f32 v45, v45, v42
 v_mul_f32 v46, v46, v42
 v_mul_f32 v47, v47, v42
 v_accvgpr_write_b32 a64, v44
 v_accvgpr_write_b32 a65, v45
 v_accvgpr_write_b32 a66, v46
 v_accvgpr_write_b32 a67, v47
 v_accvgpr_read_b32 v44, a68
 v_accvgpr_read_b32 v45, a69
 v_accvgpr_read_b32 v46, a70
 v_accvgpr_read_b32 v47, a71
 v_mul_f32 v44, v44, v42
 v_mul_f32 v45, v45, v42
 v_mul_f32 v46, v46, v42
 v_mul_f32 v47, v47, v42
 v_accvgpr_write_b32 a68, v44
 v_accvgpr_write_b32 a69, v45
 v_accvgpr_write_b32 a70, v46
 v_accvgpr_write_b32 a71, v47
 v_accvgpr_read_b32 v44, a72
 v_accvgpr_read_b32 v45, a73
 v_accvgpr_read_b32 v46, a74
 v_accvgpr_read_b32 v47, a75
 v_mul_f32 v44, v44, v42
 v_mul_f32 v45, v45, v42
 v_mul_f32 v46, v46, v42
 v_mul_f32 v47, v47, v42
 v_accvgpr_write_b32 a72, v44
 v_accvgpr_write_b32 a73, v45
 v_accvgpr_write_b32 a74, v46
 v_accvgpr_write_b32 a75, v47
 v_accvgpr_read_b32 v44, a76
 v_accvgpr_read_b32 v45, a77
 v_accvgpr_read_b32 v46, a78
 v_accvgpr_read_b32 v47, a79
 v_mul_f32 v44, v44, v42
 v_mul_f32 v45, v45, v42
 v_mul_f32 v46, v46, v42
 v_mul_f32 v47, v47, v42
 v_accvgpr_write_b32 a76, v44
 v_accvgpr_write_b32 a77, v45
 v_accvgpr_write_b32 a78, v46
 v_accvgpr_write_b32 a79, v47
 v_accvgpr_read_b32 v44, a80
 v_accvgpr_read_b32 v45, a81
 v_accvgpr_read_b32 v46, a82
 v_accvgpr_read_b32 v47, a83
 v_mul_f32 v44, v44, v42
 v_mul_f32 v45, v45, v42
 v_mul_f32 v46, v46, v42
 v_mul_f32 v47, v47, v42
 v_accvgpr_write_b32 a80, v44
 v_accvgpr_write_b32 a81, v45
 v_accvgpr_write_b32 a82, v46
 v_accvgpr_write_b32 a83, v47
 v_accvgpr_read_b32 v44, a84
 v_accvgpr_read_b32 v45, a85
 v_accvgpr_read_b32 v46, a86
 v_accvgpr_read_b32 v47, a87
 v_mul_f32 v44, v44, v42
 v_mul_f32 v45, v45, v42
 v_mul_f32 v46, v46, v42
 v_mul_f32 v47, v47, v42
 v_accvgpr_write_b32 a84, v44
 v_accvgpr_write_b32 a85, v45
 v_accvgpr_write_b32 a86, v46
 v_accvgpr_write_b32 a87, v47
 v_accvgpr_read_b32 v44, a88
 v_accvgpr_read_b32 v45, a89
 v_accvgpr_read_b32 v46, a90
 v_accvgpr_read_b32 v47, a91
 v_mul_f32 v44, v44, v42
 v_mul_f32 v45, v45, v42
 v_mul_f32 v46, v46, v42
 v_mul_f32 v47, v47, v42
 v_accvgpr_write_b32 a88, v44
 v_accvgpr_write_b32 a89, v45
 v_accvgpr_write_b32 a90, v46
 v_accvgpr_write_b32 a91, v47
 v_accvgpr_read_b32 v44, a92
 v_accvgpr_read_b32 v45, a93
 v_accvgpr_read_b32 v46, a94
 v_accvgpr_read_b32 v47, a95
 v_mul_f32 v44, v44, v42
 v_mul_f32 v45, v45, v42
 v_mul_f32 v46, v46, v42
 v_mul_f32 v47, v47, v42
 v_accvgpr_write_b32 a92, v44
 v_accvgpr_write_b32 a93, v45
 v_accvgpr_write_b32 a94, v46
 v_accvgpr_write_b32 a95, v47
 v_accvgpr_read_b32 v44, a96
 v_accvgpr_read_b32 v45, a97
 v_accvgpr_read_b32 v46, a98
 v_accvgpr_read_b32 v47, a99
 v_mul_f32 v44, v44, v42
 v_mul_f32 v45, v45, v42
 v_mul_f32 v46, v46, v42
 v_mul_f32 v47, v47, v42
 v_accvgpr_write_b32 a96, v44
 v_accvgpr_write_b32 a97, v45
 v_accvgpr_write_b32 a98, v46
 v_accvgpr_write_b32 a99, v47
 v_accvgpr_read_b32 v44, a100
 v_accvgpr_read_b32 v45, a101
 v_accvgpr_read_b32 v46, a102
 v_accvgpr_read_b32 v47, a103
 v_mul_f32 v44, v44, v42
 v_mul_f32 v45, v45, v42
 v_mul_f32 v46, v46, v42
 v_mul_f32 v47, v47, v42
 v_accvgpr_write_b32 a100, v44
 v_accvgpr_write_b32 a101, v45
 v_accvgpr_write_b32 a102, v46
 v_accvgpr_write_b32 a103, v47
 v_accvgpr_read_b32 v44, a104
 v_accvgpr_read_b32 v45, a105
 v_accvgpr_read_b32 v46, a106
 v_accvgpr_read_b32 v47, a107
 v_mul_f32 v44, v44, v42
 v_mul_f32 v45, v45, v42
 v_mul_f32 v46, v46, v42
 v_mul_f32 v47, v47, v42
 v_accvgpr_write_b32 a104, v44
 v_accvgpr_write_b32 a105, v45
 v_accvgpr_write_b32 a106, v46
 v_accvgpr_write_b32 a107, v47
 v_accvgpr_read_b32 v44, a108
 v_accvgpr_read_b32 v45, a109
 v_accvgpr_read_b32 v46, a110
 v_accvgpr_read_b32 v47, a111
 v_mul_f32 v44, v44, v42
 v_mul_f32 v45, v45, v42
 v_mul_f32 v46, v46, v42
 v_mul_f32 v47, v47, v42
 v_accvgpr_write_b32 a108, v44
 v_accvgpr_write_b32 a109, v45
 v_accvgpr_write_b32 a110, v46
 v_accvgpr_write_b32 a111, v47
 v_accvgpr_read_b32 v44, a112
 v_accvgpr_read_b32 v45, a113
 v_accvgpr_read_b32 v46, a114
 v_accvgpr_read_b32 v47, a115
 v_mul_f32 v44, v44, v42
 v_mul_f32 v45, v45, v42
 v_mul_f32 v46, v46, v42
 v_mul_f32 v47, v47, v42
 v_accvgpr_write_b32 a112, v44
 v_accvgpr_write_b32 a113, v45
 v_accvgpr_write_b32 a114, v46
 v_accvgpr_write_b32 a115, v47
 v_accvgpr_read_b32 v44, a116
 v_accvgpr_read_b32 v45, a117
 v_accvgpr_read_b32 v46, a118
 v_accvgpr_read_b32 v47, a119
 v_mul_f32 v44, v44, v42
 v_mul_f32 v45, v45, v42
 v_mul_f32 v46, v46, v42
 v_mul_f32 v47, v47, v42
 v_accvgpr_write_b32 a116, v44
 v_accvgpr_write_b32 a117, v45
 v_accvgpr_write_b32 a118, v46
 v_accvgpr_write_b32 a119, v47
 v_accvgpr_read_b32 v44, a120
 v_accvgpr_read_b32 v45, a121
 v_accvgpr_read_b32 v46, a122
 v_accvgpr_read_b32 v47, a123
 v_mul_f32 v44, v44, v42
 v_mul_f32 v45, v45, v42
 v_mul_f32 v46, v46, v42
 v_mul_f32 v47, v47, v42
 v_accvgpr_write_b32 a120, v44
 v_accvgpr_write_b32 a121, v45
 v_accvgpr_write_b32 a122, v46
 v_accvgpr_write_b32 a123, v47
 v_accvgpr_read_b32 v44, a124
 v_accvgpr_read_b32 v45, a125
 v_accvgpr_read_b32 v46, a126
 v_accvgpr_read_b32 v47, a127
 v_mul_f32 v44, v44, v42
 v_mul_f32 v45, v45, v42
 v_mul_f32 v46, v46, v42
 v_mul_f32 v47, v47, v42
 v_accvgpr_write_b32 a124, v44
 v_accvgpr_write_b32 a125, v45
 v_accvgpr_write_b32 a126, v46
 v_accvgpr_write_b32 a127, v47
 v_exp_f32 v44, v80
 v_exp_f32 v45, v81
 s_nop 0
 v_add_f32 v26, v44, v45
 v_cvt_pk_bf16_f32 v136, v44, v45
 v_exp_f32 v44, v82
 v_exp_f32 v45, v83
 s_nop 0
 v_add_f32 v26, v26, v44
 v_add_f32 v26, v26, v45
 v_cvt_pk_bf16_f32 v137, v44, v45
 v_exp_f32 v44, v84
 v_exp_f32 v45, v85
 s_nop 0
 v_add_f32 v26, v26, v44
 v_add_f32 v26, v26, v45
 v_cvt_pk_bf16_f32 v138, v44, v45
 v_exp_f32 v44, v86
 v_exp_f32 v45, v87
 s_nop 0
 v_add_f32 v26, v26, v44
 v_add_f32 v26, v26, v45
 v_cvt_pk_bf16_f32 v139, v44, v45
 v_exp_f32 v44, v88
 v_exp_f32 v45, v89
 s_nop 0
 v_add_f32 v26, v26, v44
 v_add_f32 v26, v26, v45
 v_cvt_pk_bf16_f32 v140, v44, v45
 v_exp_f32 v44, v90
 v_exp_f32 v45, v91
 s_nop 0
 v_add_f32 v26, v26, v44
 v_add_f32 v26, v26, v45
 v_cvt_pk_bf16_f32 v141, v44, v45
 v_exp_f32 v44, v92
 v_exp_f32 v45, v93
 s_nop 0
 v_add_f32 v26, v26, v44
 v_add_f32 v26, v26, v45
 v_cvt_pk_bf16_f32 v142, v44, v45
 v_exp_f32 v44, v94
 v_exp_f32 v45, v95
 s_nop 0
 v_add_f32 v26, v26, v44
 v_add_f32 v26, v26, v45
 v_cvt_pk_bf16_f32 v143, v44, v45
 s_nop 3
 s_setpc_b64 s[40:41]
attn_rare1:
 s_nop 15
 s_nop 15
 v_max3_f32 v40, v96, v97, v98
 v_max3_f32 v40, v40, v99, v100
 v_max3_f32 v40, v40, v101, v102
 v_max3_f32 v40, v40, v103, v104
 v_max3_f32 v40, v40, v105, v106
 v_max3_f32 v40, v40, v107, v108
 v_max3_f32 v40, v40, v109, v110
 v_max_f32 v40, v40, v111
 v_mov_b32 v41, v40
 s_nop 1
 v_permlane32_swap_b32 v40, v41
 s_nop 1
 v_max_f32 v40, v40, v41
 v_max_f32 v40, 0, v40
 v_sub_f32 v96, v96, v40
 v_sub_f32 v64, v64, v40
 v_sub_f32 v160, v160, v40
 v_sub_f32 v97, v97, v40
 v_sub_f32 v65, v65, v40
 v_sub_f32 v161, v161, v40
 v_sub_f32 v98, v98, v40
 v_sub_f32 v66, v66, v40
 v_sub_f32 v162, v162, v40
 v_sub_f32 v99, v99, v40
 v_sub_f32 v67, v67, v40
 v_sub_f32 v163, v163, v40
 v_sub_f32 v100, v100, v40
 v_sub_f32 v68, v68, v40
 v_sub_f32 v164, v164, v40
 v_sub_f32 v101, v101, v40
 v_sub_f32 v69, v69, v40
 v_sub_f32 v165, v165, v40
 v_sub_f32 v102, v102, v40
 v_sub_f32 v70, v70, v40
 v_sub_f32 v166, v166, v40
 v_sub_f32 v103, v103, v40
 v_sub_f32 v71, v71, v40
 v_sub_f32 v167, v167, v40
 v_sub_f32 v104, v104, v40
 v_sub_f32 v72, v72, v40
 v_sub_f32 v168, v168, v40
 v_sub_f32 v105, v105, v40
 v_sub_f32 v73, v73, v40
 v_sub_f32 v169, v169, v40
 v_sub_f32 v106, v106, v40
 v_sub_f32 v74, v74, v40
 v_sub_f32 v170, v170, v40
 v_sub_f32 v107, v107, v40
 v_sub_f32 v75, v75, v40
 v_sub_f32 v171, v171, v40
 v_sub_f32 v108, v108, v40
 v_sub_f32 v76, v76, v40
 v_sub_f32 v172, v172, v40
 v_sub_f32 v109, v109, v40
 v_sub_f32 v77, v77, v40
 v_sub_f32 v173, v173, v40
 v_sub_f32 v110, v110, v40
 v_sub_f32 v78, v78, v40
 v_sub_f32 v174, v174, v40
 v_sub_f32 v111, v111, v40
 v_sub_f32 v79, v79, v40
 v_sub_f32 v175, v175, v40
 v_sub_f32 v42, 0, v40
 v_exp_f32 v42, v42
 s_nop 0
 v_mul_f32 v23, v23, v42
 v_accvgpr_read_b32 v44, a0
 v_accvgpr_read_b32 v45, a1
 v_accvgpr_read_b32 v46, a2
 v_accvgpr_read_b32 v47, a3
 v_mul_f32 v44, v44, v42
 v_mul_f32 v45, v45, v42
 v_mul_f32 v46, v46, v42
 v_mul_f32 v47, v47, v42
 v_accvgpr_write_b32 a0, v44
 v_accvgpr_write_b32 a1, v45
 v_accvgpr_write_b32 a2, v46
 v_accvgpr_write_b32 a3, v47
 v_accvgpr_read_b32 v44, a4
 v_accvgpr_read_b32 v45, a5
 v_accvgpr_read_b32 v46, a6
 v_accvgpr_read_b32 v47, a7
 v_mul_f32 v44, v44, v42
 v_mul_f32 v45, v45, v42
 v_mul_f32 v46, v46, v42
 v_mul_f32 v47, v47, v42
 v_accvgpr_write_b32 a4, v44
 v_accvgpr_write_b32 a5, v45
 v_accvgpr_write_b32 a6, v46
 v_accvgpr_write_b32 a7, v47
 v_accvgpr_read_b32 v44, a8
 v_accvgpr_read_b32 v45, a9
 v_accvgpr_read_b32 v46, a10
 v_accvgpr_read_b32 v47, a11
 v_mul_f32 v44, v44, v42
 v_mul_f32 v45, v45, v42
 v_mul_f32 v46, v46, v42
 v_mul_f32 v47, v47, v42
 v_accvgpr_write_b32 a8, v44
 v_accvgpr_write_b32 a9, v45
 v_accvgpr_write_b32 a10, v46
 v_accvgpr_write_b32 a11, v47
 v_accvgpr_read_b32 v44, a12
 v_accvgpr_read_b32 v45, a13
 v_accvgpr_read_b32 v46, a14
 v_accvgpr_read_b32 v47, a15
 v_mul_f32 v44, v44, v42
 v_mul_f32 v45, v45, v42
 v_mul_f32 v46, v46, v42
 v_mul_f32 v47, v47, v42
 v_accvgpr_write_b32 a12, v44
 v_accvgpr_write_b32 a13, v45
 v_accvgpr_write_b32 a14, v46
 v_accvgpr_write_b32 a15, v47
 v_accvgpr_read_b32 v44, a16
 v_accvgpr_read_b32 v45, a17
 v_accvgpr_read_b32 v46, a18
 v_accvgpr_read_b32 v47, a19
 v_mul_f32 v44, v44, v42
 v_mul_f32 v45, v45, v42
 v_mul_f32 v46, v46, v42
 v_mul_f32 v47, v47, v42
 v_accvgpr_write_b32 a16, v44
 v_accvgpr_write_b32 a17, v45
 v_accvgpr_write_b32 a18, v46
 v_accvgpr_write_b32 a19, v47
 v_accvgpr_read_b32 v44, a20
 v_accvgpr_read_b32 v45, a21
 v_accvgpr_read_b32 v46, a22
 v_accvgpr_read_b32 v47, a23
 v_mul_f32 v44, v44, v42
 v_mul_f32 v45, v45, v42
 v_mul_f32 v46, v46, v42
 v_mul_f32 v47, v47, v42
 v_accvgpr_write_b32 a20, v44
 v_accvgpr_write_b32 a21, v45
 v_accvgpr_write_b32 a22, v46
 v_accvgpr_write_b32 a23, v47
 v_accvgpr_read_b32 v44, a24
 v_accvgpr_read_b32 v45, a25
 v_accvgpr_read_b32 v46, a26
 v_accvgpr_read_b32 v47, a27
 v_mul_f32 v44, v44, v42
 v_mul_f32 v45, v45, v42
 v_mul_f32 v46, v46, v42
 v_mul_f32 v47, v47, v42
 v_accvgpr_write_b32 a24, v44
 v_accvgpr_write_b32 a25, v45
 v_accvgpr_write_b32 a26, v46
 v_accvgpr_write_b32 a27, v47
 v_accvgpr_read_b32 v44, a28
 v_accvgpr_read_b32 v45, a29
 v_accvgpr_read_b32 v46, a30
 v_accvgpr_read_b32 v47, a31
 v_mul_f32 v44, v44, v42
 v_mul_f32 v45, v45, v42
 v_mul_f32 v46, v46, v42
 v_mul_f32 v47, v47, v42
 v_accvgpr_write_b32 a28, v44
 v_accvgpr_write_b32 a29, v45
 v_accvgpr_write_b32 a30, v46
 v_accvgpr_write_b32 a31, v47
 v_accvgpr_read_b32 v44, a32
 v_accvgpr_read_b32 v45, a33
 v_accvgpr_read_b32 v46, a34
 v_accvgpr_read_b32 v47, a35
 v_mul_f32 v44, v44, v42
 v_mul_f32 v45, v45, v42
 v_mul_f32 v46, v46, v42
 v_mul_f32 v47, v47, v42
 v_accvgpr_write_b32 a32, v44
 v_accvgpr_write_b32 a33, v45
 v_accvgpr_write_b32 a34, v46
 v_accvgpr_write_b32 a35, v47
 v_accvgpr_read_b32 v44, a36
 v_accvgpr_read_b32 v45, a37
 v_accvgpr_read_b32 v46, a38
 v_accvgpr_read_b32 v47, a39
 v_mul_f32 v44, v44, v42
 v_mul_f32 v45, v45, v42
 v_mul_f32 v46, v46, v42
 v_mul_f32 v47, v47, v42
 v_accvgpr_write_b32 a36, v44
 v_accvgpr_write_b32 a37, v45
 v_accvgpr_write_b32 a38, v46
 v_accvgpr_write_b32 a39, v47
 v_accvgpr_read_b32 v44, a40
 v_accvgpr_read_b32 v45, a41
 v_accvgpr_read_b32 v46, a42
 v_accvgpr_read_b32 v47, a43
 v_mul_f32 v44, v44, v42
 v_mul_f32 v45, v45, v42
 v_mul_f32 v46, v46, v42
 v_mul_f32 v47, v47, v42
 v_accvgpr_write_b32 a40, v44
 v_accvgpr_write_b32 a41, v45
 v_accvgpr_write_b32 a42, v46
 v_accvgpr_write_b32 a43, v47
 v_accvgpr_read_b32 v44, a44
 v_accvgpr_read_b32 v45, a45
 v_accvgpr_read_b32 v46, a46
 v_accvgpr_read_b32 v47, a47
 v_mul_f32 v44, v44, v42
 v_mul_f32 v45, v45, v42
 v_mul_f32 v46, v46, v42
 v_mul_f32 v47, v47, v42
 v_accvgpr_write_b32 a44, v44
 v_accvgpr_write_b32 a45, v45
 v_accvgpr_write_b32 a46, v46
 v_accvgpr_write_b32 a47, v47
 v_accvgpr_read_b32 v44, a48
 v_accvgpr_read_b32 v45, a49
 v_accvgpr_read_b32 v46, a50
 v_accvgpr_read_b32 v47, a51
 v_mul_f32 v44, v44, v42
 v_mul_f32 v45, v45, v42
 v_mul_f32 v46, v46, v42
 v_mul_f32 v47, v47, v42
 v_accvgpr_write_b32 a48, v44
 v_accvgpr_write_b32 a49, v45
 v_accvgpr_write_b32 a50, v46
 v_accvgpr_write_b32 a51, v47
 v_accvgpr_read_b32 v44, a52
 v_accvgpr_read_b32 v45, a53
 v_accvgpr_read_b32 v46, a54
 v_accvgpr_read_b32 v47, a55
 v_mul_f32 v44, v44, v42
 v_mul_f32 v45, v45, v42
 v_mul_f32 v46, v46, v42
 v_mul_f32 v47, v47, v42
 v_accvgpr_write_b32 a52, v44
 v_accvgpr_write_b32 a53, v45
 v_accvgpr_write_b32 a54, v46
 v_accvgpr_write_b32 a55, v47
 v_accvgpr_read_b32 v44, a56
 v_accvgpr_read_b32 v45, a57
 v_accvgpr_read_b32 v46, a58
 v_accvgpr_read_b32 v47, a59
 v_mul_f32 v44, v44, v42
 v_mul_f32 v45, v45, v42
 v_mul_f32 v46, v46, v42
 v_mul_f32 v47, v47, v42
 v_accvgpr_write_b32 a56, v44
 v_accvgpr_write_b32 a57, v45
 v_accvgpr_write_b32 a58, v46
 v_accvgpr_write_b32 a59, v47
 v_accvgpr_read_b32 v44, a60
 v_accvgpr_read_b32 v45, a61
 v_accvgpr_read_b32 v46, a62
 v_accvgpr_read_b32 v47, a63
 v_mul_f32 v44, v44, v42
 v_mul_f32 v45, v45, v42
 v_mul_f32 v46, v46, v42
 v_mul_f32 v47, v47, v42
 v_accvgpr_write_b32 a60, v44
 v_accvgpr_write_b32 a61, v45
 v_accvgpr_write_b32 a62, v46
 v_accvgpr_write_b32 a63, v47
 v_exp_f32 v44, v96
 v_exp_f32 v45, v97
 s_nop 0
 v_add_f32 v27, v44, v45
 v_cvt_pk_bf16_f32 v144, v44, v45
 v_exp_f32 v44, v98
 v_exp_f32 v45, v99
 s_nop 0
 v_add_f32 v27, v27, v44
 v_add_f32 v27, v27, v45
 v_cvt_pk_bf16_f32 v145, v44, v45
 v_exp_f32 v44, v100
 v_exp_f32 v45, v101
 s_nop 0
 v_add_f32 v27, v27, v44
 v_add_f32 v27, v27, v45
 v_cvt_pk_bf16_f32 v146, v44, v45
 v_exp_f32 v44, v102
 v_exp_f32 v45, v103
 s_nop 0
 v_add_f32 v27, v27, v44
 v_add_f32 v27, v27, v45
 v_cvt_pk_bf16_f32 v147, v44, v45
 v_exp_f32 v44, v104
 v_exp_f32 v45, v105
 s_nop 0
 v_add_f32 v27, v27, v44
 v_add_f32 v27, v27, v45
 v_cvt_pk_bf16_f32 v148, v44, v45
 v_exp_f32 v44, v106
 v_exp_f32 v45, v107
 s_nop 0
 v_add_f32 v27, v27, v44
 v_add_f32 v27, v27, v45
 v_cvt_pk_bf16_f32 v149, v44, v45
 v_exp_f32 v44, v108
 v_exp_f32 v45, v109
 s_nop 0
 v_add_f32 v27, v27, v44
 v_add_f32 v27, v27, v45
 v_cvt_pk_bf16_f32 v150, v44, v45
 v_exp_f32 v44, v110
 v_exp_f32 v45, v111
 s_nop 0
 v_add_f32 v27, v27, v44
 v_add_f32 v27, v27, v45
 v_cvt_pk_bf16_f32 v151, v44, v45
 v_max3_f32 v40, v112, v113, v114
 v_max3_f32 v40, v40, v115, v116
 v_max3_f32 v40, v40, v117, v118
 v_max3_f32 v40, v40, v119, v120
 v_max3_f32 v40, v40, v121, v122
 v_max3_f32 v40, v40, v123, v124
 v_max3_f32 v40, v40, v125, v126
 v_max_f32 v40, v40, v127
 v_mov_b32 v41, v40
 s_nop 1
 v_permlane32_swap_b32 v40, v41
 s_nop 1
 v_max_f32 v40, v40, v41
 v_max_f32 v40, 0, v40
 v_sub_f32 v112, v112, v40
 v_sub_f32 v80, v80, v40
 v_sub_f32 v176, v176, v40
 v_sub_f32 v113, v113, v40
 v_sub_f32 v81, v81, v40
 v_sub_f32 v177, v177, v40
 v_sub_f32 v114, v114, v40
 v_sub_f32 v82, v82, v40
 v_sub_f32 v178, v178, v40
 v_sub_f32 v115, v115, v40
 v_sub_f32 v83, v83, v40
 v_sub_f32 v179, v179, v40
 v_sub_f32 v116, v116, v40
 v_sub_f32 v84, v84, v40
 v_sub_f32 v180, v180, v40
 v_sub_f32 v117, v117, v40
 v_sub_f32 v85, v85, v40
 v_sub_f32 v181, v181, v40
 v_sub_f32 v118, v118, v40
 v_sub_f32 v86, v86, v40
 v_sub_f32 v182, v182, v40
 v_sub_f32 v119, v119, v40
 v_sub_f32 v87, v87, v40
 v_sub_f32 v183, v183, v40
 v_sub_f32 v120, v120, v40
 v_sub_f32 v88, v88, v40
 v_sub_f32 v184, v184, v40
 v_sub_f32 v121, v121, v40
 v_sub_f32 v89, v89, v40
 v_sub_f32 v185, v185, v40
 v_sub_f32 v122, v122, v40
 v_sub_f32 v90, v90, v40
 v_sub_f32 v186, v186, v40
 v_sub_f32 v123, v123, v40
 v_sub_f32 v91, v91, v40
 v_sub_f32 v187, v187, v40
 v_sub_f32 v124, v124, v40
 v_sub_f32 v92, v92, v40
 v_sub_f32 v188, v188, v40
 v_sub_f32 v125, v125, v40
 v_sub_f32 v93, v93, v40
 v_sub_f32 v189, v189, v40
 v_sub_f32 v126, v126, v40
 v_sub_f32 v94, v94, v40
 v_sub_f32 v190, v190, v40
 v_sub_f32 v127, v127, v40
 v_sub_f32 v95, v95, v40
 v_sub_f32 v191, v191, v40
 v_sub_f32 v42, 0, v40
 v_exp_f32 v42, v42
 s_nop 0
 v_mul_f32 v24, v24, v42
 v_accvgpr_read_b32 v44, a64
 v_accvgpr_read_b32 v45, a65
 v_accvgpr_read_b32 v46, a66
 v_accvgpr_read_b32 v47, a67
 v_mul_f32 v44, v44, v42
 v_mul_f32 v45, v45, v42
 v_mul_f32 v46, v46, v42
 v_mul_f32 v47, v47, v42
 v_accvgpr_write_b32 a64, v44
 v_accvgpr_write_b32 a65, v45
 v_accvgpr_write_b32 a66, v46
 v_accvgpr_write_b32 a67, v47
 v_accvgpr_read_b32 v44, a68
 v_accvgpr_read_b32 v45, a69
 v_accvgpr_read_b32 v46, a70
 v_accvgpr_read_b32 v47, a71
 v_mul_f32 v44, v44, v42
 v_mul_f32 v45, v45, v42
 v_mul_f32 v46, v46, v42
 v_mul_f32 v47, v47, v42
 v_accvgpr_write_b32 a68, v44
 v_accvgpr_write_b32 a69, v45
 v_accvgpr_write_b32 a70, v46
 v_accvgpr_write_b32 a71, v47
 v_accvgpr_read_b32 v44, a72
 v_accvgpr_read_b32 v45, a73
 v_accvgpr_read_b32 v46, a74
 v_accvgpr_read_b32 v47, a75
 v_mul_f32 v44, v44, v42
 v_mul_f32 v45, v45, v42
 v_mul_f32 v46, v46, v42
 v_mul_f32 v47, v47, v42
 v_accvgpr_write_b32 a72, v44
 v_accvgpr_write_b32 a73, v45
 v_accvgpr_write_b32 a74, v46
 v_accvgpr_write_b32 a75, v47
 v_accvgpr_read_b32 v44, a76
 v_accvgpr_read_b32 v45, a77
 v_accvgpr_read_b32 v46, a78
 v_accvgpr_read_b32 v47, a79
 v_mul_f32 v44, v44, v42
 v_mul_f32 v45, v45, v42
 v_mul_f32 v46, v46, v42
 v_mul_f32 v47, v47, v42
 v_accvgpr_write_b32 a76, v44
 v_accvgpr_write_b32 a77, v45
 v_accvgpr_write_b32 a78, v46
 v_accvgpr_write_b32 a79, v47
 v_accvgpr_read_b32 v44, a80
 v_accvgpr_read_b32 v45, a81
 v_accvgpr_read_b32 v46, a82
 v_accvgpr_read_b32 v47, a83
 v_mul_f32 v44, v44, v42
 v_mul_f32 v45, v45, v42
 v_mul_f32 v46, v46, v42
 v_mul_f32 v47, v47, v42
 v_accvgpr_write_b32 a80, v44
 v_accvgpr_write_b32 a81, v45
 v_accvgpr_write_b32 a82, v46
 v_accvgpr_write_b32 a83, v47
 v_accvgpr_read_b32 v44, a84
 v_accvgpr_read_b32 v45, a85
 v_accvgpr_read_b32 v46, a86
 v_accvgpr_read_b32 v47, a87
 v_mul_f32 v44, v44, v42
 v_mul_f32 v45, v45, v42
 v_mul_f32 v46, v46, v42
 v_mul_f32 v47, v47, v42
 v_accvgpr_write_b32 a84, v44
 v_accvgpr_write_b32 a85, v45
 v_accvgpr_write_b32 a86, v46
 v_accvgpr_write_b32 a87, v47
 v_accvgpr_read_b32 v44, a88
 v_accvgpr_read_b32 v45, a89
 v_accvgpr_read_b32 v46, a90
 v_accvgpr_read_b32 v47, a91
 v_mul_f32 v44, v44, v42
 v_mul_f32 v45, v45, v42
 v_mul_f32 v46, v46, v42
 v_mul_f32 v47, v47, v42
 v_accvgpr_write_b32 a88, v44
 v_accvgpr_write_b32 a89, v45
 v_accvgpr_write_b32 a90, v46
 v_accvgpr_write_b32 a91, v47
 v_accvgpr_read_b32 v44, a92
 v_accvgpr_read_b32 v45, a93
 v_accvgpr_read_b32 v46, a94
 v_accvgpr_read_b32 v47, a95
 v_mul_f32 v44, v44, v42
 v_mul_f32 v45, v45, v42
 v_mul_f32 v46, v46, v42
 v_mul_f32 v47, v47, v42
 v_accvgpr_write_b32 a92, v44
 v_accvgpr_write_b32 a93, v45
 v_accvgpr_write_b32 a94, v46
 v_accvgpr_write_b32 a95, v47
 v_accvgpr_read_b32 v44, a96
 v_accvgpr_read_b32 v45, a97
 v_accvgpr_read_b32 v46, a98
 v_accvgpr_read_b32 v47, a99
 v_mul_f32 v44, v44, v42
 v_mul_f32 v45, v45, v42
 v_mul_f32 v46, v46, v42
 v_mul_f32 v47, v47, v42
 v_accvgpr_write_b32 a96, v44
 v_accvgpr_write_b32 a97, v45
 v_accvgpr_write_b32 a98, v46
 v_accvgpr_write_b32 a99, v47
 v_accvgpr_read_b32 v44, a100
 v_accvgpr_read_b32 v45, a101
 v_accvgpr_read_b32 v46, a102
 v_accvgpr_read_b32 v47, a103
 v_mul_f32 v44, v44, v42
 v_mul_f32 v45, v45, v42
 v_mul_f32 v46, v46, v42
 v_mul_f32 v47, v47, v42
 v_accvgpr_write_b32 a100, v44
 v_accvgpr_write_b32 a101, v45
 v_accvgpr_write_b32 a102, v46
 v_accvgpr_write_b32 a103, v47
 v_accvgpr_read_b32 v44, a104
 v_accvgpr_read_b32 v45, a105
 v_accvgpr_read_b32 v46, a106
 v_accvgpr_read_b32 v47, a107
 v_mul_f32 v44, v44, v42
 v_mul_f32 v45, v45, v42
 v_mul_f32 v46, v46, v42
 v_mul_f32 v47, v47, v42
 v_accvgpr_write_b32 a104, v44
 v_accvgpr_write_b32 a105, v45
 v_accvgpr_write_b32 a106, v46
 v_accvgpr_write_b32 a107, v47
 v_accvgpr_read_b32 v44, a108
 v_accvgpr_read_b32 v45, a109
 v_accvgpr_read_b32 v46, a110
 v_accvgpr_read_b32 v47, a111
 v_mul_f32 v44, v44, v42
 v_mul_f32 v45, v45, v42
 v_mul_f32 v46, v46, v42
 v_mul_f32 v47, v47, v42
 v_accvgpr_write_b32 a108, v44
 v_accvgpr_write_b32 a109, v45
 v_accvgpr_write_b32 a110, v46
 v_accvgpr_write_b32 a111, v47
 v_accvgpr_read_b32 v44, a112
 v_accvgpr_read_b32 v45, a113
 v_accvgpr_read_b32 v46, a114
 v_accvgpr_read_b32 v47, a115
 v_mul_f32 v44, v44, v42
 v_mul_f32 v45, v45, v42
 v_mul_f32 v46, v46, v42
 v_mul_f32 v47, v47, v42
 v_accvgpr_write_b32 a112, v44
 v_accvgpr_write_b32 a113, v45
 v_accvgpr_write_b32 a114, v46
 v_accvgpr_write_b32 a115, v47
 v_accvgpr_read_b32 v44, a116
 v_accvgpr_read_b32 v45, a117
 v_accvgpr_read_b32 v46, a118
 v_accvgpr_read_b32 v47, a119
 v_mul_f32 v44, v44, v42
 v_mul_f32 v45, v45, v42
 v_mul_f32 v46, v46, v42
 v_mul_f32 v47, v47, v42
 v_accvgpr_write_b32 a116, v44
 v_accvgpr_write_b32 a117, v45
 v_accvgpr_write_b32 a118, v46
 v_accvgpr_write_b32 a119, v47
 v_accvgpr_read_b32 v44, a120
 v_accvgpr_read_b32 v45, a121
 v_accvgpr_read_b32 v46, a122
 v_accvgpr_read_b32 v47, a123
 v_mul_f32 v44, v44, v42
 v_mul_f32 v45, v45, v42
 v_mul_f32 v46, v46, v42
 v_mul_f32 v47, v47, v42
 v_accvgpr_write_b32 a120, v44
 v_accvgpr_write_b32 a121, v45
 v_accvgpr_write_b32 a122, v46
 v_accvgpr_write_b32 a123, v47
 v_accvgpr_read_b32 v44, a124
 v_accvgpr_read_b32 v45, a125
 v_accvgpr_read_b32 v46, a126
 v_accvgpr_read_b32 v47, a127
 v_mul_f32 v44, v44, v42
 v_mul_f32 v45, v45, v42
 v_mul_f32 v46, v46, v42
 v_mul_f32 v47, v47, v42
 v_accvgpr_write_b32 a124, v44
 v_accvgpr_write_b32 a125, v45
 v_accvgpr_write_b32 a126, v46
 v_accvgpr_write_b32 a127, v47
 v_exp_f32 v44, v112
 v_exp_f32 v45, v113
 s_nop 0
 v_add_f32 v28, v44, v45
 v_cvt_pk_bf16_f32 v152, v44, v45
 v_exp_f32 v44, v114
 v_exp_f32 v45, v115
 s_nop 0
 v_add_f32 v28, v28, v44
 v_add_f32 v28, v28, v45
 v_cvt_pk_bf16_f32 v153, v44, v45
 v_exp_f32 v44, v116
 v_exp_f32 v45, v117
 s_nop 0
 v_add_f32 v28, v28, v44
 v_add_f32 v28, v28, v45
 v_cvt_pk_bf16_f32 v154, v44, v45
 v_exp_f32 v44, v118
 v_exp_f32 v45, v119
 s_nop 0
 v_add_f32 v28, v28, v44
 v_add_f32 v28, v28, v45
 v_cvt_pk_bf16_f32 v155, v44, v45
 v_exp_f32 v44, v120
 v_exp_f32 v45, v121
 s_nop 0
 v_add_f32 v28, v28, v44
 v_add_f32 v28, v28, v45
 v_cvt_pk_bf16_f32 v156, v44, v45
 v_exp_f32 v44, v122
 v_exp_f32 v45, v123
 s_nop 0
 v_add_f32 v28, v28, v44
 v_add_f32 v28, v28, v45
 v_cvt_pk_bf16_f32 v157, v44, v45
 v_exp_f32 v44, v124
 v_exp_f32 v45, v125
 s_nop 0
 v_add_f32 v28, v28, v44
 v_add_f32 v28, v28, v45
 v_cvt_pk_bf16_f32 v158, v44, v45
 v_exp_f32 v44, v126
 v_exp_f32 v45, v127
 s_nop 0
 v_add_f32 v28, v28, v44
 v_add_f32 v28, v28, v45
 v_cvt_pk_bf16_f32 v159, v44, v45
 s_nop 3
 s_setpc_b64 s[40:41]

.section .rodata,"a"
.p2align 6
.amdhsa_kernel attn_kernel
  .amdhsa_next_free_vgpr 500
  .amdhsa_next_free_sgpr 102
  .amdhsa_accum_offset 244
  .amdhsa_group_segment_fixed_size 0
  .amdhsa_kernarg_size 104
  .amdhsa_user_sgpr_count 2
  .amdhsa_user_sgpr_kernarg_segment_ptr 1
  .amdhsa_system_sgpr_workgroup_id_x 1
.end_amdhsa_kernel

.text
.globl mid_kernel
.p2align 8
.type mid_kernel,@function
mid_kernel:
 s_cmp_ge_u32 s2, 256
 s_cbranch_scc1 mid_kernel_done1
 s_getpc_b64 s[96:97]
mid_kernel_pc2:
 s_sub_u32 s96, s96, mid_kernel_pc2-TEXT_START
 s_subb_u32 s97, s97, 0
 s_and_b32 s97, s97, 0xffff
 s_mov_b32 s98, TEXT_END-TEXT_START
 s_mov_b32 s99, 0x00020000
 s_bfe_u32 s100, s2, 0x30003
 s_lshl_b32 s100, s100, 14
 v_lshlrev_b32 v126, 6, v0
 buffer_load_dword v127, v126, s[96:99], s100 offen
 v_lshrrev_b32 v1, 6, v0
 s_nop 0
 v_readfirstlane_b32 s28, v1
 v_and_b32 v0, 63, v0
 s_load_dwordx2 s[44:45], s[0:1], 32
 s_load_dwordx4 s[56:59], s[0:1], 56
 s_load_dwordx2 s[50:51], s[0:1], 96
 s_load_dwordx2 s[60:61], s[0:1], 88
 s_load_dwordx2 s[62:63], s[0:1], 0
 s_load_dwordx4 s[92:95], s[0:1], 72
 s_cmp_ge_u32 s2, 96
 s_cbranch_scc1 mid_kernel_oproj3
 s_and_b32 s29, s2, 15
 s_lshr_b32 s30, s2, 4
 s_mul_i32 s43, s30, 655360
 s_mov_b32 s46, s30
 s_lshr_b32 s47, s29, 3
 s_mul_i32 s49, s46, 5
 s_mul_i32 s48, s47, 16
 s_add_u32 s49, s49, s48
 s_and_b32 s49, s49, 31
 s_mul_i32 s29, s29, 128
 s_mul_i32 s30, s30, 144
 s_mov_b32 s31, 0
 s_waitcnt lgkmcnt(0)
 s_mov_b32 s8, s56
 s_and_b32 s9, s57, 0xffff
 s_mov_b32 s10, 8388608
 s_mov_b32 s11, 0x00020000
 s_add_u32 s52, s50, 12582912
 s_addc_u32 s53, s51, 0
 s_mov_b32 s12, s52
 s_and_b32 s13, s53, 0xffff
 s_mov_b32 s14, 3932160
 s_mov_b32 s15, 0x00020000
 s_add_u32 s52, s50, 37748736
 s_addc_u32 s53, s51, 0
 s_mov_b32 s16, s52
 s_and_b32 s17, s53, 0xffff
 s_mov_b32 s18, 3538944
 s_mov_b32 s19, 0x00020000
 s_add_u32 s52, s50, 4194304
 s_addc_u32 s53, s51, 0
 s_mov_b32 s20, s52
 s_and_b32 s21, s53, 0xffff
 s_mov_b32 s22, 7077888
 s_mov_b32 s23, 0x00020000
 s_mov_b32 s24, s58
 s_and_b32 s25, s59, 0xffff
 s_mov_b32 s26, 4096
 s_mov_b32 s27, 0x00020000
 s_mov_b32 s66, s28
 s_and_b32 s67, s28, 0
 s_mul_i32 s66, s66, 32
 s_mul_i32 s67, s67, 160
 s_mul_i32 s69, s28, 256
 v_add_u32 v16, s69, v0
 v_lshrrev_b32 v17, 3, v16
 v_and_b32 v18, 7, v16
 v_bfe_u32 v19, v17, 1, 3
 v_xor_b32 v18, v18, v19
 v_add_u32 v17, s29, v17
 s_mov_b32 s68, 4096
 v_mul_lo_u32 v17, v17, s68
 v_lshl_add_u32 v2, v18, 4, v17
 v_add_u32 v16, s69, v0
 v_add_u32 v16, 64, v16
 v_lshrrev_b32 v17, 3, v16
 v_and_b32 v18, 7, v16
 v_bfe_u32 v19, v17, 1, 3
 v_xor_b32 v18, v18, v19
 v_add_u32 v17, s29, v17
 s_mov_b32 s68, 4096
 v_mul_lo_u32 v17, v17, s68
 v_lshl_add_u32 v3, v18, 4, v17
 v_add_u32 v16, s69, v0
 v_add_u32 v16, 128, v16
 v_lshrrev_b32 v17, 3, v16
 v_and_b32 v18, 7, v16
 v_bfe_u32 v19, v17, 1, 3
 v_xor_b32 v18, v18, v19
 v_add_u32 v17, s29, v17
 s_mov_b32 s68, 4096
 v_mul_lo_u32 v17, v17, s68
 v_lshl_add_u32 v4, v18, 4, v17
 v_add_u32 v16, s69, v0
 v_add_u32 v16, 192, v16
 v_lshrrev_b32 v17, 3, v16
 v_and_b32 v18, 7, v16
 v_bfe_u32 v19, v17, 1, 3
 v_xor_b32 v18, v18, v19
 v_add_u32 v17, s29, v17
 s_mov_b32 s68, 4096
 v_mul_lo_u32 v17, v17, s68
 v_lshl_add_u32 v5, v18, 4, v17
 v_bfe_u32 v20, v0, 2, 2
 v_and_b32 v21, 3, v0
 s_mul_i32 s69, s28, 5
 s_add_u32 s69, s69, 0
 s_min_u32 s69, s69, 19
 s_lshl_b32 s70, s69, 10
 s_add_u32 s70, s70, 16384
 s_lshl_b32 s69, s69, 10
 s_add_u32 s69, s69, s43
 v_lshlrev_b32 v16, 4, v0
 v_add_u32 v6, s69, v16
 s_mul_i32 s69, s28, 5
 s_add_u32 s69, s69, 1
 s_min_u32 s69, s69, 19
 s_lshl_b32 s71, s69, 10
 s_add_u32 s71, s71, 16384
 s_lshl_b32 s69, s69, 10
 s_add_u32 s69, s69, s43
 v_lshlrev_b32 v16, 4, v0
 v_add_u32 v7, s69, v16
 s_mul_i32 s69, s28, 5
 s_add_u32 s69, s69, 2
 s_min_u32 s69, s69, 19
 s_lshl_b32 s72, s69, 10
 s_add_u32 s72, s72, 16384
 s_lshl_b32 s69, s69, 10
 s_add_u32 s69, s69, s43
 v_lshlrev_b32 v16, 4, v0
 v_add_u32 v8, s69, v16
 s_mul_i32 s69, s28, 5
 s_add_u32 s69, s69, 3
 s_min_u32 s69, s69, 19
 s_lshl_b32 s73, s69, 10
 s_add_u32 s73, s73, 16384
 s_lshl_b32 s69, s69, 10
 s_add_u32 s69, s69, s43
 v_lshlrev_b32 v16, 4, v0
 v_add_u32 v9, s69, v16
 s_mul_i32 s69, s28, 5
 s_add_u32 s69, s69, 4
 s_min_u32 s69, s69, 19
 s_lshl_b32 s74, s69, 10
 s_add_u32 s74, s74, 16384
 s_lshl_b32 s69, s69, 10
 s_add_u32 s69, s69, s43
 v_lshlrev_b32 v16, 4, v0
 v_add_u32 v10, s69, v16
 v_and_b32 v16, 31, v0
 v_add_u32 v16, s66, v16
 v_lshrrev_b32 v17, 5, v0
 v_bfe_u32 v19, v16, 1, 3
 v_add_u32 v18, 0, v17
 v_xor_b32 v18, v18, v19
 v_lshlrev_b32 v18, 4, v18
 v_lshl_add_u32 v11, v16, 7, v18
 v_add_u32 v18, 2, v17
 v_xor_b32 v18, v18, v19
 v_lshlrev_b32 v18, 4, v18
 v_lshl_add_u32 v12, v16, 7, v18
 v_add_u32 v18, 4, v17
 v_xor_b32 v18, v18, v19
 v_lshlrev_b32 v18, 4, v18
 v_lshl_add_u32 v13, v16, 7, v18
 v_add_u32 v18, 6, v17
 v_xor_b32 v18, v18, v19
 v_lshlrev_b32 v18, 4, v18
 v_lshl_add_u32 v14, v16, 7, v18
 v_lshlrev_b32 v18, 6, v20
 v_bfe_u32 v19, v0, 4, 1
 v_lshl_add_u32 v18, v19, 5, v18
 v_and_b32 v19, 1, v21
 v_lshl_add_u32 v18, v19, 4, v18
 v_lshrrev_b32 v19, 1, v21
 v_lshl_add_u32 v18, v19, 3, v18
 v_mul_u32_u24 v19, 2560, v17
 v_add_u32 v18, v18, v19
 s_lshl_b32 s69, s67, 3
 v_add_u32 v18, s69, v18
 v_add_u32 v15, 16384, v18
 s_lshl_b32 s64, s31, 1
 s_mov_b32 s65, 0
 s_mul_i32 s68, s28, 4096
 v_add_u32 v22, 65536, v11
 v_add_u32 v23, 65536, v12
 v_add_u32 v24, 65536, v13
 v_add_u32 v25, 65536, v14
 v_add_u32 v26, 65536, v15
 v_add_u32 v27, 131072, v11
 v_add_u32 v28, 131072, v12
 v_add_u32 v29, 131072, v13
 v_add_u32 v30, 131072, v14
 v_add_u32 v31, 131072, v15
 s_add_u32 m0, s68, 0
 s_nop 0
 buffer_load_dwordx4 v2, s[8:11], s64 offen lds
 s_add_u32 m0, s68, 1024
 s_nop 0
 buffer_load_dwordx4 v3, s[8:11], s64 offen lds
 s_add_u32 m0, s68, 2048
 s_nop 0
 buffer_load_dwordx4 v4, s[8:11], s64 offen lds
 s_add_u32 m0, s68, 3072
 s_nop 0
 buffer_load_dwordx4 v5, s[8:11], s64 offen lds
 s_add_u32 s64, s64, 128
 s_add_u32 m0, s70, 0
 s_nop 0
 buffer_load_dwordx4 v6, s[12:15], s65 offen lds
 s_add_u32 m0, s71, 0
 s_nop 0
 buffer_load_dwordx4 v7, s[12:15], s65 offen lds
 s_add_u32 m0, s72, 0
 s_nop 0
 buffer_load_dwordx4 v8, s[12:15], s65 offen lds
 s_add_u32 m0, s73, 0
 s_nop 0
 buffer_load_dwordx4 v9, s[12:15], s65 offen lds
 s_add_u32 m0, s74, 0
 s_nop 0
 buffer_load_dwordx4 v10, s[12:15], s65 offen lds
 s_add_u32 s65, s65, 20480
 s_add_u32 m0, s68, 36864
 s_nop 0
 buffer_load_dwordx4 v2, s[8:11], s64 offen lds
 s_add_u32 m0, s68, 37888
 s_nop 0
 buffer_load_dwordx4 v3, s[8:11], s64 offen lds
 s_add_u32 m0, s68, 38912
 s_nop 0
 buffer_load_dwordx4 v4, s[8:11], s64 offen lds
 s_add_u32 m0, s68, 39936
 s_nop 0
 buffer_load_dwordx4 v5, s[8:11], s64 offen lds
 s_add_u32 s64, s64, 128
 s_add_u32 m0, s70, 36864
 s_nop 0
 buffer_load_dwordx4 v6, s[12:15], s65 offen lds
 s_add_u32 m0, s71, 36864
 s_nop 0
 buffer_load_dwordx4 v7, s[12:15], s65 offen lds
 s_add_u32 m0, s72, 36864
 s_nop 0
 buffer_load_dwordx4 v8, s[12:15], s65 offen lds
 s_add_u32 m0, s73, 36864
 s_nop 0
 buffer_load_dwordx4 v9, s[12:15], s65 offen lds
 s_add_u32 m0, s74, 36864
 s_nop 0
 buffer_load_dwordx4 v10, s[12:15], s65 offen lds
 s_add_u32 s65, s65, 20480
 s_waitcnt vmcnt(9)
 s_barrier
 ds_read_b64_tr_b16 a[84:85], v15 offset:0
 ds_read_b64_tr_b16 a[86:87], v15 offset:1280
 ds_read_b128 a[80:83], v11 offset:0
 ds_read_b64_tr_b16 a[88:89], v15 offset:256
 ds_read_b64_tr_b16 a[90:91], v15 offset:1536
 ds_read_b64_tr_b16 a[92:93], v15 offset:512
 ds_read_b64_tr_b16 a[94:95], v15 offset:1792
 ds_read_b64_tr_b16 a[96:97], v15 offset:768
 ds_read_b64_tr_b16 a[98:99], v15 offset:2048
 ds_read_b64_tr_b16 a[100:101], v15 offset:1024
 ds_read_b64_tr_b16 a[102:103], v15 offset:2304
 s_waitcnt lgkmcnt(9)
 s_waitcnt lgkmcnt(8)
 v_mfma_f32_32x32x16_bf16 a[0:15], a[84:87], a[80:83], 0
 ds_read_b64_tr_b16 a[108:109], v15 offset:5120
 ds_read_b64_tr_b16 a[110:111], v15 offset:6400
 ds_read_b128 a[104:107], v12 offset:0
 s_add_u32 m0, s68, 73728
 s_nop 0
 buffer_load_dwordx4 v2, s[8:11], s64 offen lds
 s_waitcnt lgkmcnt(9)
 v_mfma_f32_32x32x16_bf16 a[16:31], a[88:91], a[80:83], 0
 ds_read_b64_tr_b16 a[112:113], v15 offset:5376
 ds_read_b64_tr_b16 a[114:115], v15 offset:6656
 ds_read_b64_tr_b16 a[116:117], v15 offset:5632
 s_add_u32 m0, s68, 74752
 s_nop 0
 buffer_load_dwordx4 v3, s[8:11], s64 offen lds
 s_waitcnt lgkmcnt(10)
 v_mfma_f32_32x32x16_bf16 a[32:47], a[92:95], a[80:83], 0
 ds_read_b64_tr_b16 a[118:119], v15 offset:6912
 ds_read_b64_tr_b16 a[120:121], v15 offset:5888
 ds_read_b64_tr_b16 a[122:123], v15 offset:7168
 s_add_u32 m0, s68, 75776
 s_nop 0
 buffer_load_dwordx4 v4, s[8:11], s64 offen lds
 s_waitcnt lgkmcnt(11)
 v_mfma_f32_32x32x16_bf16 a[48:63], a[96:99], a[80:83], 0
 ds_read_b64_tr_b16 a[124:125], v15 offset:6144
 ds_read_b64_tr_b16 a[126:127], v15 offset:7424
 s_add_u32 m0, s68, 76800
 s_nop 0
 buffer_load_dwordx4 v5, s[8:11], s64 offen lds
 s_add_u32 s64, s64, 128
 s_waitcnt lgkmcnt(11)
 v_mfma_f32_32x32x16_bf16 a[64:79], a[100:103], a[80:83], 0
 s_add_u32 m0, s70, 73728
 s_nop 0
 buffer_load_dwordx4 v6, s[12:15], s65 offen lds
 s_waitcnt lgkmcnt(9)
 s_waitcnt lgkmcnt(8)
 v_mfma_f32_32x32x16_bf16 a[0:15], a[108:111], a[104:107], a[0:15]
 ds_read_b64_tr_b16 a[84:85], v15 offset:10240
 ds_read_b64_tr_b16 a[86:87], v15 offset:11520
 ds_read_b128 a[80:83], v13 offset:0
 s_add_u32 m0, s71, 73728
 s_nop 0
 buffer_load_dwordx4 v7, s[12:15], s65 offen lds
 s_waitcnt lgkmcnt(9)
 v_mfma_f32_32x32x16_bf16 a[16:31], a[112:115], a[104:107], a[16:31]
 ds_read_b64_tr_b16 a[88:89], v15 offset:10496
 ds_read_b64_tr_b16 a[90:91], v15 offset:11776
 ds_read_b64_tr_b16 a[92:93], v15 offset:10752
 s_add_u32 m0, s72, 73728
 s_nop 0
 buffer_load_dwordx4 v8, s[12:15], s65 offen lds
 s_waitcnt lgkmcnt(10)
 v_mfma_f32_32x32x16_bf16 a[32:47], a[116:119], a[104:107], a[32:47]
 ds_read_b64_tr_b16 a[94:95], v15 offset:12032
 ds_read_b64_tr_b16 a[96:97], v15 offset:11008
 ds_read_b64_tr_b16 a[98:99], v15 offset:12288
 s_add_u32 m0, s73, 73728
 s_nop 0
 buffer_load_dwordx4 v9, s[12:15], s65 offen lds
 s_waitcnt lgkmcnt(11)
 v_mfma_f32_32x32x16_bf16 a[48:63], a[120:123], a[104:107], a[48:63]
 ds_read_b64_tr_b16 a[100:101], v15 offset:11264
 ds_read_b64_tr_b16 a[102:103], v15 offset:12544
 s_add_u32 m0, s74, 73728
 s_nop 0
 buffer_load_dwordx4 v10, s[12:15], s65 offen lds
 s_add_u32 s65, s65, 20480
 s_waitcnt lgkmcnt(11)
 v_mfma_f32_32x32x16_bf16 a[64:79], a[124:127], a[104:107], a[64:79]
 s_add_u32 m0, s68, 110592
 s_nop 0
 buffer_load_dwordx4 v2, s[8:11], s64 offen lds
 s_waitcnt lgkmcnt(9)
 s_waitcnt lgkmcnt(8)
 v_mfma_f32_32x32x16_bf16 a[0:15], a[84:87], a[80:83], a[0:15]
 ds_read_b64_tr_b16 a[108:109], v15 offset:15360
 ds_read_b64_tr_b16 a[110:111], v15 offset:16640
 ds_read_b128 a[104:107], v14 offset:0
 s_add_u32 m0, s68, 111616
 s_nop 0
 buffer_load_dwordx4 v3, s[8:11], s64 offen lds
 s_waitcnt lgkmcnt(9)
 v_mfma_f32_32x32x16_bf16 a[16:31], a[88:91], a[80:83], a[16:31]
 ds_read_b64_tr_b16 a[112:113], v15 offset:15616
 ds_read_b64_tr_b16 a[114:115], v15 offset:16896
 ds_read_b64_tr_b16 a[116:117], v15 offset:15872
 s_add_u32 m0, s68, 112640
 s_nop 0
 buffer_load_dwordx4 v4, s[8:11], s64 offen lds
 s_waitcnt lgkmcnt(10)
 v_mfma_f32_32x32x16_bf16 a[32:47], a[92:95], a[80:83], a[32:47]
 ds_read_b64_tr_b16 a[118:119], v15 offset:17152
 ds_read_b64_tr_b16 a[120:121], v15 offset:16128
 ds_read_b64_tr_b16 a[122:123], v15 offset:17408
 s_add_u32 m0, s68, 113664
 s_nop 0
 buffer_load_dwordx4 v5, s[8:11], s64 offen lds
 s_add_u32 s64, s64, 128
 s_waitcnt lgkmcnt(11)
 v_mfma_f32_32x32x16_bf16 a[48:63], a[96:99], a[80:83], a[48:63]
 ds_read_b64_tr_b16 a[124:125], v15 offset:16384
 ds_read_b64_tr_b16 a[126:127], v15 offset:17664
 s_add_u32 m0, s70, 110592
 s_nop 0
 buffer_load_dwordx4 v6, s[12:15], s65 offen lds
 s_waitcnt lgkmcnt(11)
 v_mfma_f32_32x32x16_bf16 a[64:79], a[100:103], a[80:83], a[64:79]
 s_add_u32 m0, s71, 110592
 s_nop 0
 buffer_load_dwordx4 v7, s[12:15], s65 offen lds
 s_add_u32 s40, s29, s66
 v_and_b32 v33, 31, v0
 v_add_u32 v33, s40, v33
 v_lshlrev_b32 v32, 1, v33
 buffer_load_ushort v35, v32, s[24:27], 0 offen offset:0
 s_lshr_b32 s40, s40, 5
 s_add_u32 s41, s30, s67
 s_lshr_b32 s41, s41, 4
 s_mul_i32 s48, s40, 108
 s_add_u32 s48, s48, s41
 s_lshl_b32 s48, s48, 10
 v_lshlrev_b32 v33, 4, v0
 v_add_u32 v34, s48, v33
 s_mul_i32 s48, s40, 54
 s_add_u32 s48, s48, s41
 s_lshl_b32 s48, s48, 10
 v_add_u32 v38, s48, v33
 s_mov_b32 s40, 0
 buffer_load_dwordx4 v[40:43], v34, s[20:23], s40 offen offset:0
 buffer_load_dwordx4 v[44:47], v34, s[20:23], s40 offen offset:1024
 s_mov_b32 s40, 2048
 buffer_load_dwordx4 v[48:51], v34, s[20:23], s40 offen offset:0
 buffer_load_dwordx4 v[52:55], v34, s[20:23], s40 offen offset:1024
 s_mov_b32 s40, 4096
 buffer_load_dwordx4 v[56:59], v34, s[20:23], s40 offen offset:0
 buffer_load_dwordx4 v[60:63], v34, s[20:23], s40 offen offset:1024
 s_mov_b32 s40, 6144
 buffer_load_dwordx4 v[64:67], v34, s[20:23], s40 offen offset:0
 buffer_load_dwordx4 v[68:71], v34, s[20:23], s40 offen offset:1024
 s_mov_b32 s40, 8192
 buffer_load_dwordx4 v[72:75], v34, s[20:23], s40 offen offset:0
 s_waitcnt lgkmcnt(9)
 s_waitcnt lgkmcnt(8)
 v_mfma_f32_32x32x16_bf16 a[0:15], a[108:111], a[104:107], a[0:15]
 s_waitcnt vmcnt(25)
 s_waitcnt lgkmcnt(0)
 s_barrier
 ds_read_b64_tr_b16 a[84:85], v15 offset:36864
 ds_read_b64_tr_b16 a[86:87], v15 offset:38144
 s_add_u32 m0, s72, 110592
 s_nop 0
 buffer_load_dwordx4 v8, s[12:15], s65 offen lds
 v_mfma_f32_32x32x16_bf16 a[16:31], a[112:115], a[104:107], a[16:31]
 ds_read_b128 a[80:83], v11 offset:36864
 ds_read_b64_tr_b16 a[88:89], v15 offset:37120
 ds_read_b64_tr_b16 a[90:91], v15 offset:38400
 s_add_u32 m0, s73, 110592
 s_nop 0
 buffer_load_dwordx4 v9, s[12:15], s65 offen lds
 v_mfma_f32_32x32x16_bf16 a[32:47], a[116:119], a[104:107], a[32:47]
 ds_read_b64_tr_b16 a[92:93], v15 offset:37376
 ds_read_b64_tr_b16 a[94:95], v15 offset:38656
 ds_read_b64_tr_b16 a[96:97], v15 offset:37632
 s_add_u32 m0, s74, 110592
 s_nop 0
 buffer_load_dwordx4 v10, s[12:15], s65 offen lds
 s_add_u32 s65, s65, 20480
 v_mfma_f32_32x32x16_bf16 a[48:63], a[120:123], a[104:107], a[48:63]
 ds_read_b64_tr_b16 a[98:99], v15 offset:38912
 ds_read_b64_tr_b16 a[100:101], v15 offset:37888
 ds_read_b64_tr_b16 a[102:103], v15 offset:39168
 s_add_u32 m0, s68, 0
 s_nop 0
 buffer_load_dwordx4 v2, s[8:11], s64 offen lds
 v_mfma_f32_32x32x16_bf16 a[64:79], a[124:127], a[104:107], a[64:79]
 s_add_u32 m0, s68, 1024
 s_nop 0
 buffer_load_dwordx4 v3, s[8:11], s64 offen lds
 s_waitcnt lgkmcnt(9)
 s_waitcnt lgkmcnt(8)
 v_mfma_f32_32x32x16_bf16 a[0:15], a[84:87], a[80:83], a[0:15]
 ds_read_b64_tr_b16 a[108:109], v15 offset:41984
 ds_read_b64_tr_b16 a[110:111], v15 offset:43264
 ds_read_b128 a[104:107], v12 offset:36864
 s_add_u32 m0, s68, 2048
 s_nop 0
 buffer_load_dwordx4 v4, s[8:11], s64 offen lds
 s_waitcnt lgkmcnt(9)
 v_mfma_f32_32x32x16_bf16 a[16:31], a[88:91], a[80:83], a[16:31]
 ds_read_b64_tr_b16 a[112:113], v15 offset:42240
 ds_read_b64_tr_b16 a[114:115], v15 offset:43520
 ds_read_b64_tr_b16 a[116:117], v15 offset:42496
 s_add_u32 m0, s68, 3072
 s_nop 0
 buffer_load_dwordx4 v5, s[8:11], s64 offen lds
 s_add_u32 s64, s64, 128
 s_waitcnt lgkmcnt(10)
 v_mfma_f32_32x32x16_bf16 a[32:47], a[92:95], a[80:83], a[32:47]
 ds_read_b64_tr_b16 a[118:119], v15 offset:43776
 ds_read_b64_tr_b16 a[120:121], v15 offset:42752
 ds_read_b64_tr_b16 a[122:123], v15 offset:44032
 s_add_u32 m0, s70, 0
 s_nop 0
 buffer_load_dwordx4 v6, s[12:15], s65 offen lds
 s_waitcnt lgkmcnt(11)
 v_mfma_f32_32x32x16_bf16 a[48:63], a[96:99], a[80:83], a[48:63]
 ds_read_b64_tr_b16 a[124:125], v15 offset:43008
 ds_read_b64_tr_b16 a[126:127], v15 offset:44288
 s_add_u32 m0, s71, 0
 s_nop 0
 buffer_load_dwordx4 v7, s[12:15], s65 offen lds
 s_waitcnt lgkmcnt(11)
 v_mfma_f32_32x32x16_bf16 a[64:79], a[100:103], a[80:83], a[64:79]
 s_add_u32 m0, s72, 0
 s_nop 0
 buffer_load_dwordx4 v8, s[12:15], s65 offen lds
 s_waitcnt lgkmcnt(9)
 s_waitcnt lgkmcnt(8)
 v_mfma_f32_32x32x16_bf16 a[0:15], a[108:111], a[104:107], a[0:15]
 ds_read_b64_tr_b16 a[84:85], v15 offset:47104
 ds_read_b64_tr_b16 a[86:87], v15 offset:48384
 ds_read_b128 a[80:83], v13 offset:36864
 s_add_u32 m0, s73, 0
 s_nop 0
 buffer_load_dwordx4 v9, s[12:15], s65 offen lds
 s_waitcnt lgkmcnt(9)
 v_mfma_f32_32x32x16_bf16 a[16:31], a[112:115], a[104:107], a[16:31]
 ds_read_b64_tr_b16 a[88:89], v15 offset:47360
 ds_read_b64_tr_b16 a[90:91], v15 offset:48640
 ds_read_b64_tr_b16 a[92:93], v15 offset:47616
 s_add_u32 m0, s74, 0
 s_nop 0
 buffer_load_dwordx4 v10, s[12:15], s65 offen lds
 s_add_u32 s65, s65, 20480
 s_waitcnt lgkmcnt(10)
 v_mfma_f32_32x32x16_bf16 a[32:47], a[116:119], a[104:107], a[32:47]
 ds_read_b64_tr_b16 a[94:95], v15 offset:48896
 ds_read_b64_tr_b16 a[96:97], v15 offset:47872
 ds_read_b64_tr_b16 a[98:99], v15 offset:49152
 s_waitcnt lgkmcnt(11)
 v_mfma_f32_32x32x16_bf16 a[48:63], a[120:123], a[104:107], a[48:63]
 ds_read_b64_tr_b16 a[100:101], v15 offset:48128
 ds_read_b64_tr_b16 a[102:103], v15 offset:49408
 s_waitcnt lgkmcnt(11)
 v_mfma_f32_32x32x16_bf16 a[64:79], a[124:127], a[104:107], a[64:79]
 s_waitcnt lgkmcnt(9)
 s_waitcnt lgkmcnt(8)
 v_mfma_f32_32x32x16_bf16 a[0:15], a[84:87], a[80:83], a[0:15]
 ds_read_b64_tr_b16 a[108:109], v15 offset:52224
 ds_read_b64_tr_b16 a[110:111], v15 offset:53504
 ds_read_b128 a[104:107], v14 offset:36864
 s_waitcnt lgkmcnt(9)
 v_mfma_f32_32x32x16_bf16 a[16:31], a[88:91], a[80:83], a[16:31]
 ds_read_b64_tr_b16 a[112:113], v15 offset:52480
 ds_read_b64_tr_b16 a[114:115], v15 offset:53760
 ds_read_b64_tr_b16 a[116:117], v15 offset:52736
 s_waitcnt lgkmcnt(10)
 v_mfma_f32_32x32x16_bf16 a[32:47], a[92:95], a[80:83], a[32:47]
 ds_read_b64_tr_b16 a[118:119], v15 offset:54016
 ds_read_b64_tr_b16 a[120:121], v15 offset:52992
 ds_read_b64_tr_b16 a[122:123], v15 offset:54272
 s_waitcnt lgkmcnt(11)
 v_mfma_f32_32x32x16_bf16 a[48:63], a[96:99], a[80:83], a[48:63]
 ds_read_b64_tr_b16 a[124:125], v15 offset:53248
 ds_read_b64_tr_b16 a[126:127], v15 offset:54528
 s_waitcnt lgkmcnt(11)
 v_mfma_f32_32x32x16_bf16 a[64:79], a[100:103], a[80:83], a[64:79]
 s_waitcnt lgkmcnt(9)
 s_waitcnt lgkmcnt(8)
 v_mfma_f32_32x32x16_bf16 a[0:15], a[108:111], a[104:107], a[0:15]
 s_waitcnt vmcnt(28)
 s_waitcnt lgkmcnt(0)
 s_barrier
 ds_read_b64_tr_b16 a[84:85], v26 offset:8192
 ds_read_b64_tr_b16 a[86:87], v26 offset:9472
 v_mfma_f32_32x32x16_bf16 a[16:31], a[112:115], a[104:107], a[16:31]
 ds_read_b128 a[80:83], v22 offset:8192
 ds_read_b64_tr_b16 a[88:89], v26 offset:8448
 ds_read_b64_tr_b16 a[90:91], v26 offset:9728
 s_add_u32 m0, s68, 36864
 s_nop 0
 buffer_load_dwordx4 v2, s[8:11], s64 offen lds
 v_mfma_f32_32x32x16_bf16 a[32:47], a[116:119], a[104:107], a[32:47]
 ds_read_b64_tr_b16 a[92:93], v26 offset:8704
 ds_read_b64_tr_b16 a[94:95], v26 offset:9984
 ds_read_b64_tr_b16 a[96:97], v26 offset:8960
 v_mfma_f32_32x32x16_bf16 a[48:63], a[120:123], a[104:107], a[48:63]
 ds_read_b64_tr_b16 a[98:99], v26 offset:10240
 ds_read_b64_tr_b16 a[100:101], v26 offset:9216
 ds_read_b64_tr_b16 a[102:103], v26 offset:10496
 s_add_u32 m0, s68, 37888
 s_nop 0
 buffer_load_dwordx4 v3, s[8:11], s64 offen lds
 v_mfma_f32_32x32x16_bf16 a[64:79], a[124:127], a[104:107], a[64:79]
 s_waitcnt lgkmcnt(9)
 s_waitcnt lgkmcnt(8)
 v_mfma_f32_32x32x16_bf16 a[0:15], a[84:87], a[80:83], a[0:15]
 ds_read_b64_tr_b16 a[108:109], v26 offset:13312
 ds_read_b64_tr_b16 a[110:111], v26 offset:14592
 ds_read_b128 a[104:107], v23 offset:8192
 s_add_u32 m0, s68, 38912
 s_nop 0
 buffer_load_dwordx4 v4, s[8:11], s64 offen lds
 s_waitcnt lgkmcnt(9)
 v_mfma_f32_32x32x16_bf16 a[16:31], a[88:91], a[80:83], a[16:31]
 ds_read_b64_tr_b16 a[112:113], v26 offset:13568
 ds_read_b64_tr_b16 a[114:115], v26 offset:14848
 ds_read_b64_tr_b16 a[116:117], v26 offset:13824
 s_waitcnt lgkmcnt(10)
 v_mfma_f32_32x32x16_bf16 a[32:47], a[92:95], a[80:83], a[32:47]
 ds_read_b64_tr_b16 a[118:119], v26 offset:15104
 ds_read_b64_tr_b16 a[120:121], v26 offset:14080
 ds_read_b64_tr_b16 a[122:123], v26 offset:15360
 s_add_u32 m0, s68, 39936
 s_nop 0
 buffer_load_dwordx4 v5, s[8:11], s64 offen lds
 s_add_u32 s64, s64, 128
 s_waitcnt lgkmcnt(11)
 v_mfma_f32_32x32x16_bf16 a[48:63], a[96:99], a[80:83], a[48:63]
 ds_read_b64_tr_b16 a[124:125], v26 offset:14336
 ds_read_b64_tr_b16 a[126:127], v26 offset:15616
 s_waitcnt lgkmcnt(11)
 v_mfma_f32_32x32x16_bf16 a[64:79], a[100:103], a[80:83], a[64:79]
 s_add_u32 m0, s70, 36864
 s_nop 0
 buffer_load_dwordx4 v6, s[12:15], s65 offen lds
 s_waitcnt lgkmcnt(9)
 s_waitcnt lgkmcnt(8)
 v_mfma_f32_32x32x16_bf16 a[0:15], a[108:111], a[104:107], a[0:15]
 ds_read_b64_tr_b16 a[84:85], v26 offset:18432
 ds_read_b64_tr_b16 a[86:87], v26 offset:19712
 ds_read_b128 a[80:83], v24 offset:8192
 s_waitcnt lgkmcnt(9)
 v_mfma_f32_32x32x16_bf16 a[16:31], a[112:115], a[104:107], a[16:31]
 ds_read_b64_tr_b16 a[88:89], v26 offset:18688
 ds_read_b64_tr_b16 a[90:91], v26 offset:19968
 ds_read_b64_tr_b16 a[92:93], v26 offset:18944
 s_add_u32 m0, s71, 36864
 s_nop 0
 buffer_load_dwordx4 v7, s[12:15], s65 offen lds
 s_waitcnt lgkmcnt(10)
 v_mfma_f32_32x32x16_bf16 a[32:47], a[116:119], a[104:107], a[32:47]
 ds_read_b64_tr_b16 a[94:95], v26 offset:20224
 ds_read_b64_tr_b16 a[96:97], v26 offset:19200
 ds_read_b64_tr_b16 a[98:99], v26 offset:20480
 s_waitcnt lgkmcnt(11)
 v_mfma_f32_32x32x16_bf16 a[48:63], a[120:123], a[104:107], a[48:63]
 ds_read_b64_tr_b16 a[100:101], v26 offset:19456
 ds_read_b64_tr_b16 a[102:103], v26 offset:20736
 s_add_u32 m0, s72, 36864
 s_nop 0
 buffer_load_dwordx4 v8, s[12:15], s65 offen lds
 s_waitcnt lgkmcnt(11)
 v_mfma_f32_32x32x16_bf16 a[64:79], a[124:127], a[104:107], a[64:79]
 s_waitcnt lgkmcnt(9)
 s_waitcnt lgkmcnt(8)
 v_mfma_f32_32x32x16_bf16 a[0:15], a[84:87], a[80:83], a[0:15]
 ds_read_b64_tr_b16 a[108:109], v26 offset:23552
 ds_read_b64_tr_b16 a[110:111], v26 offset:24832
 ds_read_b128 a[104:107], v25 offset:8192
 s_add_u32 m0, s73, 36864
 s_nop 0
 buffer_load_dwordx4 v9, s[12:15], s65 offen lds
 s_waitcnt lgkmcnt(9)
 v_mfma_f32_32x32x16_bf16 a[16:31], a[88:91], a[80:83], a[16:31]
 ds_read_b64_tr_b16 a[112:113], v26 offset:23808
 ds_read_b64_tr_b16 a[114:115], v26 offset:25088
 ds_read_b64_tr_b16 a[116:117], v26 offset:24064
 s_waitcnt lgkmcnt(10)
 v_mfma_f32_32x32x16_bf16 a[32:47], a[92:95], a[80:83], a[32:47]
 ds_read_b64_tr_b16 a[118:119], v26 offset:25344
 ds_read_b64_tr_b16 a[120:121], v26 offset:24320
 ds_read_b64_tr_b16 a[122:123], v26 offset:25600
 s_add_u32 m0, s74, 36864
 s_nop 0
 buffer_load_dwordx4 v10, s[12:15], s65 offen lds
 s_add_u32 s65, s65, 20480
 s_waitcnt lgkmcnt(11)
 v_mfma_f32_32x32x16_bf16 a[48:63], a[96:99], a[80:83], a[48:63]
 ds_read_b64_tr_b16 a[124:125], v26 offset:24576
 ds_read_b64_tr_b16 a[126:127], v26 offset:25856
 s_waitcnt lgkmcnt(11)
 v_mfma_f32_32x32x16_bf16 a[64:79], a[100:103], a[80:83], a[64:79]
 s_waitcnt lgkmcnt(9)
 s_waitcnt lgkmcnt(8)
 v_mfma_f32_32x32x16_bf16 a[0:15], a[108:111], a[104:107], a[0:15]
 s_waitcnt vmcnt(18)
 s_waitcnt lgkmcnt(0)
 s_barrier
 ds_read_b64_tr_b16 a[84:85], v26 offset:45056
 ds_read_b64_tr_b16 a[86:87], v26 offset:46336
 v_mfma_f32_32x32x16_bf16 a[16:31], a[112:115], a[104:107], a[16:31]
 ds_read_b128 a[80:83], v22 offset:45056
 ds_read_b64_tr_b16 a[88:89], v26 offset:45312
 ds_read_b64_tr_b16 a[90:91], v26 offset:46592
 s_add_u32 m0, s68, 73728
 s_nop 0
 buffer_load_dwordx4 v2, s[8:11], s64 offen lds
 v_mfma_f32_32x32x16_bf16 a[32:47], a[116:119], a[104:107], a[32:47]
 ds_read_b64_tr_b16 a[92:93], v26 offset:45568
 ds_read_b64_tr_b16 a[94:95], v26 offset:46848
 ds_read_b64_tr_b16 a[96:97], v26 offset:45824
 v_mfma_f32_32x32x16_bf16 a[48:63], a[120:123], a[104:107], a[48:63]
 ds_read_b64_tr_b16 a[98:99], v26 offset:47104
 ds_read_b64_tr_b16 a[100:101], v26 offset:46080
 ds_read_b64_tr_b16 a[102:103], v26 offset:47360
 s_add_u32 m0, s68, 74752
 s_nop 0
 buffer_load_dwordx4 v3, s[8:11], s64 offen lds
 v_mfma_f32_32x32x16_bf16 a[64:79], a[124:127], a[104:107], a[64:79]
 s_waitcnt lgkmcnt(9)
 s_waitcnt lgkmcnt(8)
 v_mfma_f32_32x32x16_bf16 a[0:15], a[84:87], a[80:83], a[0:15]
 ds_read_b64_tr_b16 a[108:109], v26 offset:50176
 ds_read_b64_tr_b16 a[110:111], v26 offset:51456
 ds_read_b128 a[104:107], v23 offset:45056
 s_add_u32 m0, s68, 75776
 s_nop 0
 buffer_load_dwordx4 v4, s[8:11], s64 offen lds
 s_waitcnt lgkmcnt(9)
 v_mfma_f32_32x32x16_bf16 a[16:31], a[88:91], a[80:83], a[16:31]
 ds_read_b64_tr_b16 a[112:113], v26 offset:50432
 ds_read_b64_tr_b16 a[114:115], v26 offset:51712
 ds_read_b64_tr_b16 a[116:117], v26 offset:50688
 s_waitcnt lgkmcnt(10)
 v_mfma_f32_32x32x16_bf16 a[32:47], a[92:95], a[80:83], a[32:47]
 ds_read_b64_tr_b16 a[118:119], v26 offset:51968
 ds_read_b64_tr_b16 a[120:121], v26 offset:50944
 ds_read_b64_tr_b16 a[122:123], v26 offset:52224
 s_add_u32 m0, s68, 76800
 s_nop 0
 buffer_load_dwordx4 v5, s[8:11], s64 offen lds
 s_add_u32 s64, s64, 128
 s_waitcnt lgkmcnt(11)
 v_mfma_f32_32x32x16_bf16 a[48:63], a[96:99], a[80:83], a[48:63]
 ds_read_b64_tr_b16 a[124:125], v26 offset:51200
 ds_read_b64_tr_b16 a[126:127], v26 offset:52480
 s_waitcnt lgkmcnt(11)
 v_mfma_f32_32x32x16_bf16 a[64:79], a[100:103], a[80:83], a[64:79]
 s_add_u32 m0, s70, 73728
 s_nop 0
 buffer_load_dwordx4 v6, s[12:15], s65 offen lds
 s_waitcnt lgkmcnt(9)
 s_waitcnt lgkmcnt(8)
 v_mfma_f32_32x32x16_bf16 a[0:15], a[108:111], a[104:107], a[0:15]
 ds_read_b64_tr_b16 a[84:85], v26 offset:55296
 ds_read_b64_tr_b16 a[86:87], v26 offset:56576
 ds_read_b128 a[80:83], v24 offset:45056
 s_waitcnt lgkmcnt(9)
 v_mfma_f32_32x32x16_bf16 a[16:31], a[112:115], a[104:107], a[16:31]
 ds_read_b64_tr_b16 a[88:89], v26 offset:55552
 ds_read_b64_tr_b16 a[90:91], v26 offset:56832
 ds_read_b64_tr_b16 a[92:93], v26 offset:55808
 s_add_u32 m0, s71, 73728
 s_nop 0
 buffer_load_dwordx4 v7, s[12:15], s65 offen lds
 s_waitcnt lgkmcnt(10)
 v_mfma_f32_32x32x16_bf16 a[32:47], a[116:119], a[104:107], a[32:47]
 ds_read_b64_tr_b16 a[94:95], v26 offset:57088
 ds_read_b64_tr_b16 a[96:97], v26 offset:56064
 ds_read_b64_tr_b16 a[98:99], v26 offset:57344
 s_waitcnt lgkmcnt(11)
 v_mfma_f32_32x32x16_bf16 a[48:63], a[120:123], a[104:107], a[48:63]
 ds_read_b64_tr_b16 a[100:101], v26 offset:56320
 ds_read_b64_tr_b16 a[102:103], v26 offset:57600
 s_add_u32 m0, s72, 73728
 s_nop 0
 buffer_load_dwordx4 v8, s[12:15], s65 offen lds
 s_waitcnt lgkmcnt(11)
 v_mfma_f32_32x32x16_bf16 a[64:79], a[124:127], a[104:107], a[64:79]
 s_waitcnt lgkmcnt(9)
 s_waitcnt lgkmcnt(8)
 v_mfma_f32_32x32x16_bf16 a[0:15], a[84:87], a[80:83], a[0:15]
 ds_read_b64_tr_b16 a[108:109], v26 offset:60416
 ds_read_b64_tr_b16 a[110:111], v26 offset:61696
 ds_read_b128 a[104:107], v25 offset:45056
 s_add_u32 m0, s73, 73728
 s_nop 0
 buffer_load_dwordx4 v9, s[12:15], s65 offen lds
 s_waitcnt lgkmcnt(9)
 v_mfma_f32_32x32x16_bf16 a[16:31], a[88:91], a[80:83], a[16:31]
 ds_read_b64_tr_b16 a[112:113], v26 offset:60672
 ds_read_b64_tr_b16 a[114:115], v26 offset:61952
 ds_read_b64_tr_b16 a[116:117], v26 offset:60928
 s_waitcnt lgkmcnt(10)
 v_mfma_f32_32x32x16_bf16 a[32:47], a[92:95], a[80:83], a[32:47]
 ds_read_b64_tr_b16 a[118:119], v26 offset:62208
 ds_read_b64_tr_b16 a[120:121], v26 offset:61184
 ds_read_b64_tr_b16 a[122:123], v26 offset:62464
 s_add_u32 m0, s74, 73728
 s_nop 0
 buffer_load_dwordx4 v10, s[12:15], s65 offen lds
 s_add_u32 s65, s65, 20480
 s_waitcnt lgkmcnt(11)
 v_mfma_f32_32x32x16_bf16 a[48:63], a[96:99], a[80:83], a[48:63]
 ds_read_b64_tr_b16 a[124:125], v26 offset:61440
 ds_read_b64_tr_b16 a[126:127], v26 offset:62720
 s_waitcnt lgkmcnt(11)
 v_mfma_f32_32x32x16_bf16 a[64:79], a[100:103], a[80:83], a[64:79]
 s_waitcnt lgkmcnt(9)
 s_waitcnt lgkmcnt(8)
 v_mfma_f32_32x32x16_bf16 a[0:15], a[108:111], a[104:107], a[0:15]
 s_waitcnt vmcnt(18)
 s_waitcnt lgkmcnt(0)
 s_barrier
 ds_read_b64_tr_b16 a[84:85], v15 offset:0
 ds_read_b64_tr_b16 a[86:87], v15 offset:1280
 v_mfma_f32_32x32x16_bf16 a[16:31], a[112:115], a[104:107], a[16:31]
 ds_read_b128 a[80:83], v11 offset:0
 ds_read_b64_tr_b16 a[88:89], v15 offset:256
 ds_read_b64_tr_b16 a[90:91], v15 offset:1536
 s_add_u32 m0, s68, 110592
 s_nop 0
 buffer_load_dwordx4 v2, s[8:11], s64 offen lds
 v_mfma_f32_32x32x16_bf16 a[32:47], a[116:119], a[104:107], a[32:47]
 ds_read_b64_tr_b16 a[92:93], v15 offset:512
 ds_read_b64_tr_b16 a[94:95], v15 offset:1792
 ds_read_b64_tr_b16 a[96:97], v15 offset:768
 v_mfma_f32_32x32x16_bf16 a[48:63], a[120:123], a[104:107], a[48:63]
 ds_read_b64_tr_b16 a[98:99], v15 offset:2048
 ds_read_b64_tr_b16 a[100:101], v15 offset:1024
 ds_read_b64_tr_b16 a[102:103], v15 offset:2304
 s_add_u32 m0, s68, 111616
 s_nop 0
 buffer_load_dwordx4 v3, s[8:11], s64 offen lds
 v_mfma_f32_32x32x16_bf16 a[64:79], a[124:127], a[104:107], a[64:79]
 s_mov_b32 s80, 6
mid_kernel_kloop4:
 s_waitcnt lgkmcnt(9)
 s_waitcnt lgkmcnt(8)
 v_mfma_f32_32x32x16_bf16 a[0:15], a[84:87], a[80:83], a[0:15]
 ds_read_b64_tr_b16 a[108:109], v15 offset:5120
 ds_read_b64_tr_b16 a[110:111], v15 offset:6400
 ds_read_b128 a[104:107], v12 offset:0
 s_add_u32 m0, s68, 112640
 s_nop 0
 buffer_load_dwordx4 v4, s[8:11], s64 offen lds
 s_waitcnt lgkmcnt(9)
 v_mfma_f32_32x32x16_bf16 a[16:31], a[88:91], a[80:83], a[16:31]
 ds_read_b64_tr_b16 a[112:113], v15 offset:5376
 ds_read_b64_tr_b16 a[114:115], v15 offset:6656
 ds_read_b64_tr_b16 a[116:117], v15 offset:5632
 s_waitcnt lgkmcnt(10)
 v_mfma_f32_32x32x16_bf16 a[32:47], a[92:95], a[80:83], a[32:47]
 ds_read_b64_tr_b16 a[118:119], v15 offset:6912
 ds_read_b64_tr_b16 a[120:121], v15 offset:5888
 ds_read_b64_tr_b16 a[122:123], v15 offset:7168
 s_add_u32 m0, s68, 113664
 s_nop 0
 buffer_load_dwordx4 v5, s[8:11], s64 offen lds
 s_add_u32 s64, s64, 128
 s_waitcnt lgkmcnt(11)
 v_mfma_f32_32x32x16_bf16 a[48:63], a[96:99], a[80:83], a[48:63]
 ds_read_b64_tr_b16 a[124:125], v15 offset:6144
 ds_read_b64_tr_b16 a[126:127], v15 offset:7424
 s_waitcnt lgkmcnt(11)
 v_mfma_f32_32x32x16_bf16 a[64:79], a[100:103], a[80:83], a[64:79]
 s_add_u32 m0, s70, 110592
 s_nop 0
 buffer_load_dwordx4 v6, s[12:15], s65 offen lds
 s_waitcnt lgkmcnt(9)
 s_waitcnt lgkmcnt(8)
 v_mfma_f32_32x32x16_bf16 a[0:15], a[108:111], a[104:107], a[0:15]
 ds_read_b64_tr_b16 a[84:85], v15 offset:10240
 ds_read_b64_tr_b16 a[86:87], v15 offset:11520
 ds_read_b128 a[80:83], v13 offset:0
 s_waitcnt lgkmcnt(9)
 v_mfma_f32_32x32x16_bf16 a[16:31], a[112:115], a[104:107], a[16:31]
 ds_read_b64_tr_b16 a[88:89], v15 offset:10496
 ds_read_b64_tr_b16 a[90:91], v15 offset:11776
 ds_read_b64_tr_b16 a[92:93], v15 offset:10752
 s_add_u32 m0, s71, 110592
 s_nop 0
 buffer_load_dwordx4 v7, s[12:15], s65 offen lds
 s_waitcnt lgkmcnt(10)
 v_mfma_f32_32x32x16_bf16 a[32:47], a[116:119], a[104:107], a[32:47]
 ds_read_b64_tr_b16 a[94:95], v15 offset:12032
 ds_read_b64_tr_b16 a[96:97], v15 offset:11008
 ds_read_b64_tr_b16 a[98:99], v15 offset:12288
 s_waitcnt lgkmcnt(11)
 v_mfma_f32_32x32x16_bf16 a[48:63], a[120:123], a[104:107], a[48:63]
 ds_read_b64_tr_b16 a[100:101], v15 offset:11264
 ds_read_b64_tr_b16 a[102:103], v15 offset:12544
 s_add_u32 m0, s72, 110592
 s_nop 0
 buffer_load_dwordx4 v8, s[12:15], s65 offen lds
 s_waitcnt lgkmcnt(11)
 v_mfma_f32_32x32x16_bf16 a[64:79], a[124:127], a[104:107], a[64:79]
 s_waitcnt lgkmcnt(9)
 s_waitcnt lgkmcnt(8)
 v_mfma_f32_32x32x16_bf16 a[0:15], a[84:87], a[80:83], a[0:15]
 ds_read_b64_tr_b16 a[108:109], v15 offset:15360
 ds_read_b64_tr_b16 a[110:111], v15 offset:16640
 ds_read_b128 a[104:107], v14 offset:0
 s_add_u32 m0, s73, 110592
 s_nop 0
 buffer_load_dwordx4 v9, s[12:15], s65 offen lds
 s_waitcnt lgkmcnt(9)
 v_mfma_f32_32x32x16_bf16 a[16:31], a[88:91], a[80:83], a[16:31]
 ds_read_b64_tr_b16 a[112:113], v15 offset:15616
 ds_read_b64_tr_b16 a[114:115], v15 offset:16896
 ds_read_b64_tr_b16 a[116:117], v15 offset:15872
 s_waitcnt lgkmcnt(10)
 v_mfma_f32_32x32x16_bf16 a[32:47], a[92:95], a[80:83], a[32:47]
 ds_read_b64_tr_b16 a[118:119], v15 offset:17152
 ds_read_b64_tr_b16 a[120:121], v15 offset:16128
 ds_read_b64_tr_b16 a[122:123], v15 offset:17408
 s_add_u32 m0, s74, 110592
 s_nop 0
 buffer_load_dwordx4 v10, s[12:15], s65 offen lds
 s_add_u32 s65, s65, 20480
 s_waitcnt lgkmcnt(11)
 v_mfma_f32_32x32x16_bf16 a[48:63], a[96:99], a[80:83], a[48:63]
 ds_read_b64_tr_b16 a[124:125], v15 offset:16384
 ds_read_b64_tr_b16 a[126:127], v15 offset:17664
 s_waitcnt lgkmcnt(11)
 v_mfma_f32_32x32x16_bf16 a[64:79], a[100:103], a[80:83], a[64:79]
 s_waitcnt lgkmcnt(9)
 s_waitcnt lgkmcnt(8)
 v_mfma_f32_32x32x16_bf16 a[0:15], a[108:111], a[104:107], a[0:15]
 s_waitcnt vmcnt(18)
 s_waitcnt lgkmcnt(0)
 s_barrier
 ds_read_b64_tr_b16 a[84:85], v15 offset:36864
 ds_read_b64_tr_b16 a[86:87], v15 offset:38144
 v_mfma_f32_32x32x16_bf16 a[16:31], a[112:115], a[104:107], a[16:31]
 ds_read_b128 a[80:83], v11 offset:36864
 ds_read_b64_tr_b16 a[88:89], v15 offset:37120
 ds_read_b64_tr_b16 a[90:91], v15 offset:38400
 s_add_u32 m0, s68, 0
 s_nop 0
 buffer_load_dwordx4 v2, s[8:11], s64 offen lds
 v_mfma_f32_32x32x16_bf16 a[32:47], a[116:119], a[104:107], a[32:47]
 ds_read_b64_tr_b16 a[92:93], v15 offset:37376
 ds_read_b64_tr_b16 a[94:95], v15 offset:38656
 ds_read_b64_tr_b16 a[96:97], v15 offset:37632
 v_mfma_f32_32x32x16_bf16 a[48:63], a[120:123], a[104:107], a[48:63]
 ds_read_b64_tr_b16 a[98:99], v15 offset:38912
 ds_read_b64_tr_b16 a[100:101], v15 offset:37888
 ds_read_b64_tr_b16 a[102:103], v15 offset:39168
 s_add_u32 m0, s68, 1024
 s_nop 0
 buffer_load_dwordx4 v3, s[8:11], s64 offen lds
 v_mfma_f32_32x32x16_bf16 a[64:79], a[124:127], a[104:107], a[64:79]
 s_waitcnt lgkmcnt(9)
 s_waitcnt lgkmcnt(8)
 v_mfma_f32_32x32x16_bf16 a[0:15], a[84:87], a[80:83], a[0:15]
 ds_read_b64_tr_b16 a[108:109], v15 offset:41984
 ds_read_b64_tr_b16 a[110:111], v15 offset:43264
 ds_read_b128 a[104:107], v12 offset:36864
 s_add_u32 m0, s68, 2048
 s_nop 0
 buffer_load_dwordx4 v4, s[8:11], s64 offen lds
 s_waitcnt lgkmcnt(9)
 v_mfma_f32_32x32x16_bf16 a[16:31], a[88:91], a[80:83], a[16:31]
 ds_read_b64_tr_b16 a[112:113], v15 offset:42240
 ds_read_b64_tr_b16 a[114:115], v15 offset:43520
 ds_read_b64_tr_b16 a[116:117], v15 offset:42496
 s_waitcnt lgkmcnt(10)
 v_mfma_f32_32x32x16_bf16 a[32:47], a[92:95], a[80:83], a[32:47]
 ds_read_b64_tr_b16 a[118:119], v15 offset:43776
 ds_read_b64_tr_b16 a[120:121], v15 offset:42752
 ds_read_b64_tr_b16 a[122:123], v15 offset:44032
 s_add_u32 m0, s68, 3072
 s_nop 0
 buffer_load_dwordx4 v5, s[8:11], s64 offen lds
 s_add_u32 s64, s64, 128
 s_waitcnt lgkmcnt(11)
 v_mfma_f32_32x32x16_bf16 a[48:63], a[96:99], a[80:83], a[48:63]
 ds_read_b64_tr_b16 a[124:125], v15 offset:43008
 ds_read_b64_tr_b16 a[126:127], v15 offset:44288
 s_waitcnt lgkmcnt(11)
 v_mfma_f32_32x32x16_bf16 a[64:79], a[100:103], a[80:83], a[64:79]
 s_add_u32 m0, s70, 0
 s_nop 0
 buffer_load_dwordx4 v6, s[12:15], s65 offen lds
 s_waitcnt lgkmcnt(9)
 s_waitcnt lgkmcnt(8)
 v_mfma_f32_32x32x16_bf16 a[0:15], a[108:111], a[104:107], a[0:15]
 ds_read_b64_tr_b16 a[84:85], v15 offset:47104
 ds_read_b64_tr_b16 a[86:87], v15 offset:48384
 ds_read_b128 a[80:83], v13 offset:36864
 s_waitcnt lgkmcnt(9)
 v_mfma_f32_32x32x16_bf16 a[16:31], a[112:115], a[104:107], a[16:31]
 ds_read_b64_tr_b16 a[88:89], v15 offset:47360
 ds_read_b64_tr_b16 a[90:91], v15 offset:48640
 ds_read_b64_tr_b16 a[92:93], v15 offset:47616
 s_add_u32 m0, s71, 0
 s_nop 0
 buffer_load_dwordx4 v7, s[12:15], s65 offen lds
 s_waitcnt lgkmcnt(10)
 v_mfma_f32_32x32x16_bf16 a[32:47], a[116:119], a[104:107], a[32:47]
 ds_read_b64_tr_b16 a[94:95], v15 offset:48896
 ds_read_b64_tr_b16 a[96:97], v15 offset:47872
 ds_read_b64_tr_b16 a[98:99], v15 offset:49152
 s_waitcnt lgkmcnt(11)
 v_mfma_f32_32x32x16_bf16 a[48:63], a[120:123], a[104:107], a[48:63]
 ds_read_b64_tr_b16 a[100:101], v15 offset:48128
 ds_read_b64_tr_b16 a[102:103], v15 offset:49408
 s_add_u32 m0, s72, 0
 s_nop 0
 buffer_load_dwordx4 v8, s[12:15], s65 offen lds
 s_waitcnt lgkmcnt(11)
 v_mfma_f32_32x32x16_bf16 a[64:79], a[124:127], a[104:107], a[64:79]
 s_waitcnt lgkmcnt(9)
 s_waitcnt lgkmcnt(8)
 v_mfma_f32_32x32x16_bf16 a[0:15], a[84:87], a[80:83], a[0:15]
 ds_read_b64_tr_b16 a[108:109], v15 offset:52224
 ds_read_b64_tr_b16 a[110:111], v15 offset:53504
 ds_read_b128 a[104:107], v14 offset:36864
 s_add_u32 m0, s73, 0
 s_nop 0
 buffer_load_dwordx4 v9, s[12:15], s65 offen lds
 s_waitcnt lgkmcnt(9)
 v_mfma_f32_32x32x16_bf16 a[16:31], a[88:91], a[80:83], a[16:31]
 ds_read_b64_tr_b16 a[112:113], v15 offset:52480
 ds_read_b64_tr_b16 a[114:115], v15 offset:53760
 ds_read_b64_tr_b16 a[116:117], v15 offset:52736
 s_waitcnt lgkmcnt(10)
 v_mfma_f32_32x32x16_bf16 a[32:47], a[92:95], a[80:83], a[32:47]
 ds_read_b64_tr_b16 a[118:119], v15 offset:54016
 ds_read_b64_tr_b16 a[120:121], v15 offset:52992
 ds_read_b64_tr_b16 a[122:123], v15 offset:54272
 s_add_u32 m0, s74, 0
 s_nop 0
 buffer_load_dwordx4 v10, s[12:15], s65 offen lds
 s_add_u32 s65, s65, 20480
 s_waitcnt lgkmcnt(11)
 v_mfma_f32_32x32x16_bf16 a[48:63], a[96:99], a[80:83], a[48:63]
 ds_read_b64_tr_b16 a[124:125], v15 offset:53248
 ds_read_b64_tr_b16 a[126:127], v15 offset:54528
 s_waitcnt lgkmcnt(11)
 v_mfma_f32_32x32x16_bf16 a[64:79], a[100:103], a[80:83], a[64:79]
 s_waitcnt lgkmcnt(9)
 s_waitcnt lgkmcnt(8)
 v_mfma_f32_32x32x16_bf16 a[0:15], a[108:111], a[104:107], a[0:15]
 s_waitcnt vmcnt(18)
 s_waitcnt lgkmcnt(0)
 s_barrier
 ds_read_b64_tr_b16 a[84:85], v26 offset:8192
 ds_read_b64_tr_b16 a[86:87], v26 offset:9472
 v_mfma_f32_32x32x16_bf16 a[16:31], a[112:115], a[104:107], a[16:31]
 ds_read_b128 a[80:83], v22 offset:8192
 ds_read_b64_tr_b16 a[88:89], v26 offset:8448
 ds_read_b64_tr_b16 a[90:91], v26 offset:9728
 s_add_u32 m0, s68, 36864
 s_nop 0
 buffer_load_dwordx4 v2, s[8:11], s64 offen lds
 v_mfma_f32_32x32x16_bf16 a[32:47], a[116:119], a[104:107], a[32:47]
 ds_read_b64_tr_b16 a[92:93], v26 offset:8704
 ds_read_b64_tr_b16 a[94:95], v26 offset:9984
 ds_read_b64_tr_b16 a[96:97], v26 offset:8960
 v_mfma_f32_32x32x16_bf16 a[48:63], a[120:123], a[104:107], a[48:63]
 ds_read_b64_tr_b16 a[98:99], v26 offset:10240
 ds_read_b64_tr_b16 a[100:101], v26 offset:9216
 ds_read_b64_tr_b16 a[102:103], v26 offset:10496
 s_add_u32 m0, s68, 37888
 s_nop 0
 buffer_load_dwordx4 v3, s[8:11], s64 offen lds
 v_mfma_f32_32x32x16_bf16 a[64:79], a[124:127], a[104:107], a[64:79]
 s_waitcnt lgkmcnt(9)
 s_waitcnt lgkmcnt(8)
 v_mfma_f32_32x32x16_bf16 a[0:15], a[84:87], a[80:83], a[0:15]
 ds_read_b64_tr_b16 a[108:109], v26 offset:13312
 ds_read_b64_tr_b16 a[110:111], v26 offset:14592
 ds_read_b128 a[104:107], v23 offset:8192
 s_add_u32 m0, s68, 38912
 s_nop 0
 buffer_load_dwordx4 v4, s[8:11], s64 offen lds
 s_waitcnt lgkmcnt(9)
 v_mfma_f32_32x32x16_bf16 a[16:31], a[88:91], a[80:83], a[16:31]
 ds_read_b64_tr_b16 a[112:113], v26 offset:13568
 ds_read_b64_tr_b16 a[114:115], v26 offset:14848
 ds_read_b64_tr_b16 a[116:117], v26 offset:13824
 s_waitcnt lgkmcnt(10)
 v_mfma_f32_32x32x16_bf16 a[32:47], a[92:95], a[80:83], a[32:47]
 ds_read_b64_tr_b16 a[118:119], v26 offset:15104
 ds_read_b64_tr_b16 a[120:121], v26 offset:14080
 ds_read_b64_tr_b16 a[122:123], v26 offset:15360
 s_add_u32 m0, s68, 39936
 s_nop 0
 buffer_load_dwordx4 v5, s[8:11], s64 offen lds
 s_add_u32 s64, s64, 128
 s_waitcnt lgkmcnt(11)
 v_mfma_f32_32x32x16_bf16 a[48:63], a[96:99], a[80:83], a[48:63]
 ds_read_b64_tr_b16 a[124:125], v26 offset:14336
 ds_read_b64_tr_b16 a[126:127], v26 offset:15616
 s_waitcnt lgkmcnt(11)
 v_mfma_f32_32x32x16_bf16 a[64:79], a[100:103], a[80:83], a[64:79]
 s_add_u32 m0, s70, 36864
 s_nop 0
 buffer_load_dwordx4 v6, s[12:15], s65 offen lds
 s_waitcnt lgkmcnt(9)
 s_waitcnt lgkmcnt(8)
 v_mfma_f32_32x32x16_bf16 a[0:15], a[108:111], a[104:107], a[0:15]
 ds_read_b64_tr_b16 a[84:85], v26 offset:18432
 ds_read_b64_tr_b16 a[86:87], v26 offset:19712
 ds_read_b128 a[80:83], v24 offset:8192
 s_waitcnt lgkmcnt(9)
 v_mfma_f32_32x32x16_bf16 a[16:31], a[112:115], a[104:107], a[16:31]
 ds_read_b64_tr_b16 a[88:89], v26 offset:18688
 ds_read_b64_tr_b16 a[90:91], v26 offset:19968
 ds_read_b64_tr_b16 a[92:93], v26 offset:18944
 s_add_u32 m0, s71, 36864
 s_nop 0
 buffer_load_dwordx4 v7, s[12:15], s65 offen lds
 s_waitcnt lgkmcnt(10)
 v_mfma_f32_32x32x16_bf16 a[32:47], a[116:119], a[104:107], a[32:47]
 ds_read_b64_tr_b16 a[94:95], v26 offset:20224
 ds_read_b64_tr_b16 a[96:97], v26 offset:19200
 ds_read_b64_tr_b16 a[98:99], v26 offset:20480
 s_waitcnt lgkmcnt(11)
 v_mfma_f32_32x32x16_bf16 a[48:63], a[120:123], a[104:107], a[48:63]
 ds_read_b64_tr_b16 a[100:101], v26 offset:19456
 ds_read_b64_tr_b16 a[102:103], v26 offset:20736
 s_add_u32 m0, s72, 36864
 s_nop 0
 buffer_load_dwordx4 v8, s[12:15], s65 offen lds
 s_waitcnt lgkmcnt(11)
 v_mfma_f32_32x32x16_bf16 a[64:79], a[124:127], a[104:107], a[64:79]
 s_waitcnt lgkmcnt(9)
 s_waitcnt lgkmcnt(8)
 v_mfma_f32_32x32x16_bf16 a[0:15], a[84:87], a[80:83], a[0:15]
 ds_read_b64_tr_b16 a[108:109], v26 offset:23552
 ds_read_b64_tr_b16 a[110:111], v26 offset:24832
 ds_read_b128 a[104:107], v25 offset:8192
 s_add_u32 m0, s73, 36864
 s_nop 0
 buffer_load_dwordx4 v9, s[12:15], s65 offen lds
 s_waitcnt lgkmcnt(9)
 v_mfma_f32_32x32x16_bf16 a[16:31], a[88:91], a[80:83], a[16:31]
 ds_read_b64_tr_b16 a[112:113], v26 offset:23808
 ds_read_b64_tr_b16 a[114:115], v26 offset:25088
 ds_read_b64_tr_b16 a[116:117], v26 offset:24064
 s_waitcnt lgkmcnt(10)
 v_mfma_f32_32x32x16_bf16 a[32:47], a[92:95], a[80:83], a[32:47]
 ds_read_b64_tr_b16 a[118:119], v26 offset:25344
 ds_read_b64_tr_b16 a[120:121], v26 offset:24320
 ds_read_b64_tr_b16 a[122:123], v26 offset:25600
 s_add_u32 m0, s74, 36864
 s_nop 0
 buffer_load_dwordx4 v10, s[12:15], s65 offen lds
 s_add_u32 s65, s65, 20480
 s_waitcnt lgkmcnt(11)
 v_mfma_f32_32x32x16_bf16 a[48:63], a[96:99], a[80:83], a[48:63]
 ds_read_b64_tr_b16 a[124:125], v26 offset:24576
 ds_read_b64_tr_b16 a[126:127], v26 offset:25856
 s_waitcnt lgkmcnt(11)
 v_mfma_f32_32x32x16_bf16 a[64:79], a[100:103], a[80:83], a[64:79]
 s_waitcnt lgkmcnt(9)
 s_waitcnt lgkmcnt(8)
 v_mfma_f32_32x32x16_bf16 a[0:15], a[108:111], a[104:107], a[0:15]
 s_waitcnt vmcnt(18)
 s_waitcnt lgkmcnt(0)
 s_barrier
 ds_read_b64_tr_b16 a[84:85], v26 offset:45056
 ds_read_b64_tr_b16 a[86:87], v26 offset:46336
 v_mfma_f32_32x32x16_bf16 a[16:31], a[112:115], a[104:107], a[16:31]
 ds_read_b128 a[80:83], v22 offset:45056
 ds_read_b64_tr_b16 a[88:89], v26 offset:45312
 ds_read_b64_tr_b16 a[90:91], v26 offset:46592
 s_add_u32 m0, s68, 73728
 s_nop 0
 buffer_load_dwordx4 v2, s[8:11], s64 offen lds
 v_mfma_f32_32x32x16_bf16 a[32:47], a[116:119], a[104:107], a[32:47]
 ds_read_b64_tr_b16 a[92:93], v26 offset:45568
 ds_read_b64_tr_b16 a[94:95], v26 offset:46848
 ds_read_b64_tr_b16 a[96:97], v26 offset:45824
 v_mfma_f32_32x32x16_bf16 a[48:63], a[120:123], a[104:107], a[48:63]
 ds_read_b64_tr_b16 a[98:99], v26 offset:47104
 ds_read_b64_tr_b16 a[100:101], v26 offset:46080
 ds_read_b64_tr_b16 a[102:103], v26 offset:47360
 s_add_u32 m0, s68, 74752
 s_nop 0
 buffer_load_dwordx4 v3, s[8:11], s64 offen lds
 v_mfma_f32_32x32x16_bf16 a[64:79], a[124:127], a[104:107], a[64:79]
 s_waitcnt lgkmcnt(9)
 s_waitcnt lgkmcnt(8)
 v_mfma_f32_32x32x16_bf16 a[0:15], a[84:87], a[80:83], a[0:15]
 ds_read_b64_tr_b16 a[108:109], v26 offset:50176
 ds_read_b64_tr_b16 a[110:111], v26 offset:51456
 ds_read_b128 a[104:107], v23 offset:45056
 s_add_u32 m0, s68, 75776
 s_nop 0
 buffer_load_dwordx4 v4, s[8:11], s64 offen lds
 s_waitcnt lgkmcnt(9)
 v_mfma_f32_32x32x16_bf16 a[16:31], a[88:91], a[80:83], a[16:31]
 ds_read_b64_tr_b16 a[112:113], v26 offset:50432
 ds_read_b64_tr_b16 a[114:115], v26 offset:51712
 ds_read_b64_tr_b16 a[116:117], v26 offset:50688
 s_waitcnt lgkmcnt(10)
 v_mfma_f32_32x32x16_bf16 a[32:47], a[92:95], a[80:83], a[32:47]
 ds_read_b64_tr_b16 a[118:119], v26 offset:51968
 ds_read_b64_tr_b16 a[120:121], v26 offset:50944
 ds_read_b64_tr_b16 a[122:123], v26 offset:52224
 s_add_u32 m0, s68, 76800
 s_nop 0
 buffer_load_dwordx4 v5, s[8:11], s64 offen lds
 s_add_u32 s64, s64, 128
 s_waitcnt lgkmcnt(11)
 v_mfma_f32_32x32x16_bf16 a[48:63], a[96:99], a[80:83], a[48:63]
 ds_read_b64_tr_b16 a[124:125], v26 offset:51200
 ds_read_b64_tr_b16 a[126:127], v26 offset:52480
 s_waitcnt lgkmcnt(11)
 v_mfma_f32_32x32x16_bf16 a[64:79], a[100:103], a[80:83], a[64:79]
 s_add_u32 m0, s70, 73728
 s_nop 0
 buffer_load_dwordx4 v6, s[12:15], s65 offen lds
 s_waitcnt lgkmcnt(9)
 s_waitcnt lgkmcnt(8)
 v_mfma_f32_32x32x16_bf16 a[0:15], a[108:111], a[104:107], a[0:15]
 ds_read_b64_tr_b16 a[84:85], v26 offset:55296
 ds_read_b64_tr_b16 a[86:87], v26 offset:56576
 ds_read_b128 a[80:83], v24 offset:45056
 s_waitcnt lgkmcnt(9)
 v_mfma_f32_32x32x16_bf16 a[16:31], a[112:115], a[104:107], a[16:31]
 ds_read_b64_tr_b16 a[88:89], v26 offset:55552
 ds_read_b64_tr_b16 a[90:91], v26 offset:56832
 ds_read_b64_tr_b16 a[92:93], v26 offset:55808
 s_add_u32 m0, s71, 73728
 s_nop 0
 buffer_load_dwordx4 v7, s[12:15], s65 offen lds
 s_waitcnt lgkmcnt(10)
 v_mfma_f32_32x32x16_bf16 a[32:47], a[116:119], a[104:107], a[32:47]
 ds_read_b64_tr_b16 a[94:95], v26 offset:57088
 ds_read_b64_tr_b16 a[96:97], v26 offset:56064
 ds_read_b64_tr_b16 a[98:99], v26 offset:57344
 s_waitcnt lgkmcnt(11)
 v_mfma_f32_32x32x16_bf16 a[48:63], a[120:123], a[104:107], a[48:63]
 ds_read_b64_tr_b16 a[100:101], v26 offset:56320
 ds_read_b64_tr_b16 a[102:103], v26 offset:57600
 s_add_u32 m0, s72, 73728
 s_nop 0
 buffer_load_dwordx4 v8, s[12:15], s65 offen lds
 s_waitcnt lgkmcnt(11)
 v_mfma_f32_32x32x16_bf16 a[64:79], a[124:127], a[104:107], a[64:79]
 s_waitcnt lgkmcnt(9)
 s_waitcnt lgkmcnt(8)
 v_mfma_f32_32x32x16_bf16 a[0:15], a[84:87], a[80:83], a[0:15]
 ds_read_b64_tr_b16 a[108:109], v26 offset:60416
 ds_read_b64_tr_b16 a[110:111], v26 offset:61696
 ds_read_b128 a[104:107], v25 offset:45056
 s_add_u32 m0, s73, 73728
 s_nop 0
 buffer_load_dwordx4 v9, s[12:15], s65 offen lds
 s_waitcnt lgkmcnt(9)
 v_mfma_f32_32x32x16_bf16 a[16:31], a[88:91], a[80:83], a[16:31]
 ds_read_b64_tr_b16 a[112:113], v26 offset:60672
 ds_read_b64_tr_b16 a[114:115], v26 offset:61952
 ds_read_b64_tr_b16 a[116:117], v26 offset:60928
 s_waitcnt lgkmcnt(10)
 v_mfma_f32_32x32x16_bf16 a[32:47], a[92:95], a[80:83], a[32:47]
 ds_read_b64_tr_b16 a[118:119], v26 offset:62208
 ds_read_b64_tr_b16 a[120:121], v26 offset:61184
 ds_read_b64_tr_b16 a[122:123], v26 offset:62464
 s_add_u32 m0, s74, 73728
 s_nop 0
 buffer_load_dwordx4 v10, s[12:15], s65 offen lds
 s_add_u32 s65, s65, 20480
 s_waitcnt lgkmcnt(11)
 v_mfma_f32_32x32x16_bf16 a[48:63], a[96:99], a[80:83], a[48:63]
 ds_read_b64_tr_b16 a[124:125], v26 offset:61440
 ds_read_b64_tr_b16 a[126:127], v26 offset:62720
 s_waitcnt lgkmcnt(11)
 v_mfma_f32_32x32x16_bf16 a[64:79], a[100:103], a[80:83], a[64:79]
 s_waitcnt lgkmcnt(9)
 s_waitcnt lgkmcnt(8)
 v_mfma_f32_32x32x16_bf16 a[0:15], a[108:111], a[104:107], a[0:15]
 s_waitcnt vmcnt(18)
 s_waitcnt lgkmcnt(0)
 s_barrier
 ds_read_b64_tr_b16 a[84:85], v15 offset:0
 ds_read_b64_tr_b16 a[86:87], v15 offset:1280
 v_mfma_f32_32x32x16_bf16 a[16:31], a[112:115], a[104:107], a[16:31]
 ds_read_b128 a[80:83], v11 offset:0
 ds_read_b64_tr_b16 a[88:89], v15 offset:256
 ds_read_b64_tr_b16 a[90:91], v15 offset:1536
 s_add_u32 m0, s68, 110592
 s_nop 0
 buffer_load_dwordx4 v2, s[8:11], s64 offen lds
 v_mfma_f32_32x32x16_bf16 a[32:47], a[116:119], a[104:107], a[32:47]
 ds_read_b64_tr_b16 a[92:93], v15 offset:512
 ds_read_b64_tr_b16 a[94:95], v15 offset:1792
 ds_read_b64_tr_b16 a[96:97], v15 offset:768
 v_mfma_f32_32x32x16_bf16 a[48:63], a[120:123], a[104:107], a[48:63]
 ds_read_b64_tr_b16 a[98:99], v15 offset:2048
 ds_read_b64_tr_b16 a[100:101], v15 offset:1024
 ds_read_b64_tr_b16 a[102:103], v15 offset:2304
 s_add_u32 m0, s68, 111616
 s_nop 0
 buffer_load_dwordx4 v3, s[8:11], s64 offen lds
 v_mfma_f32_32x32x16_bf16 a[64:79], a[124:127], a[104:107], a[64:79]
 s_sub_u32 s80, s80, 1
 s_cmp_lg_u32 s80, 0
 s_cbranch_scc1 mid_kernel_kloop4
 s_waitcnt lgkmcnt(9)
 s_waitcnt lgkmcnt(8)
 v_mfma_f32_32x32x16_bf16 a[0:15], a[84:87], a[80:83], a[0:15]
 ds_read_b64_tr_b16 a[108:109], v15 offset:5120
 ds_read_b64_tr_b16 a[110:111], v15 offset:6400
 ds_read_b128 a[104:107], v12 offset:0
 s_add_u32 m0, s68, 112640
 s_nop 0
 buffer_load_dwordx4 v4, s[8:11], s64 offen lds
 s_waitcnt lgkmcnt(9)
 v_mfma_f32_32x32x16_bf16 a[16:31], a[88:91], a[80:83], a[16:31]
 ds_read_b64_tr_b16 a[112:113], v15 offset:5376
 ds_read_b64_tr_b16 a[114:115], v15 offset:6656
 ds_read_b64_tr_b16 a[116:117], v15 offset:5632
 s_waitcnt lgkmcnt(10)
 v_mfma_f32_32x32x16_bf16 a[32:47], a[92:95], a[80:83], a[32:47]
 ds_read_b64_tr_b16 a[118:119], v15 offset:6912
 ds_read_b64_tr_b16 a[120:121], v15 offset:5888
 ds_read_b64_tr_b16 a[122:123], v15 offset:7168
 s_add_u32 m0, s68, 113664
 s_nop 0
 buffer_load_dwordx4 v5, s[8:11], s64 offen lds
 s_add_u32 s64, s64, 128
 s_waitcnt lgkmcnt(11)
 v_mfma_f32_32x32x16_bf16 a[48:63], a[96:99], a[80:83], a[48:63]
 ds_read_b64_tr_b16 a[124:125], v15 offset:6144
 ds_read_b64_tr_b16 a[126:127], v15 offset:7424
 s_waitcnt lgkmcnt(11)
 v_mfma_f32_32x32x16_bf16 a[64:79], a[100:103], a[80:83], a[64:79]
 s_add_u32 m0, s70, 110592
 s_nop 0
 buffer_load_dwordx4 v6, s[12:15], s65 offen lds
 s_waitcnt lgkmcnt(9)
 s_waitcnt lgkmcnt(8)
 v_mfma_f32_32x32x16_bf16 a[0:15], a[108:111], a[104:107], a[0:15]
 ds_read_b64_tr_b16 a[84:85], v15 offset:10240
 ds_read_b64_tr_b16 a[86:87], v15 offset:11520
 ds_read_b128 a[80:83], v13 offset:0
 s_waitcnt lgkmcnt(9)
 v_mfma_f32_32x32x16_bf16 a[16:31], a[112:115], a[104:107], a[16:31]
 ds_read_b64_tr_b16 a[88:89], v15 offset:10496
 ds_read_b64_tr_b16 a[90:91], v15 offset:11776
 ds_read_b64_tr_b16 a[92:93], v15 offset:10752
 s_add_u32 m0, s71, 110592
 s_nop 0
 buffer_load_dwordx4 v7, s[12:15], s65 offen lds
 s_waitcnt lgkmcnt(10)
 v_mfma_f32_32x32x16_bf16 a[32:47], a[116:119], a[104:107], a[32:47]
 ds_read_b64_tr_b16 a[94:95], v15 offset:12032
 ds_read_b64_tr_b16 a[96:97], v15 offset:11008
 ds_read_b64_tr_b16 a[98:99], v15 offset:12288
 s_waitcnt lgkmcnt(11)
 v_mfma_f32_32x32x16_bf16 a[48:63], a[120:123], a[104:107], a[48:63]
 ds_read_b64_tr_b16 a[100:101], v15 offset:11264
 ds_read_b64_tr_b16 a[102:103], v15 offset:12544
 s_add_u32 m0, s72, 110592
 s_nop 0
 buffer_load_dwordx4 v8, s[12:15], s65 offen lds
 s_waitcnt lgkmcnt(11)
 v_mfma_f32_32x32x16_bf16 a[64:79], a[124:127], a[104:107], a[64:79]
 s_waitcnt lgkmcnt(9)
 s_waitcnt lgkmcnt(8)
 v_mfma_f32_32x32x16_bf16 a[0:15], a[84:87], a[80:83], a[0:15]
 ds_read_b64_tr_b16 a[108:109], v15 offset:15360
 ds_read_b64_tr_b16 a[110:111], v15 offset:16640
 ds_read_b128 a[104:107], v14 offset:0
 s_add_u32 m0, s73, 110592
 s_nop 0
 buffer_load_dwordx4 v9, s[12:15], s65 offen lds
 s_waitcnt lgkmcnt(9)
 v_mfma_f32_32x32x16_bf16 a[16:31], a[88:91], a[80:83], a[16:31]
 ds_read_b64_tr_b16 a[112:113], v15 offset:15616
 ds_read_b64_tr_b16 a[114:115], v15 offset:16896
 ds_read_b64_tr_b16 a[116:117], v15 offset:15872
 s_waitcnt lgkmcnt(10)
 v_mfma_f32_32x32x16_bf16 a[32:47], a[92:95], a[80:83], a[32:47]
 ds_read_b64_tr_b16 a[118:119], v15 offset:17152
 ds_read_b64_tr_b16 a[120:121], v15 offset:16128
 ds_read_b64_tr_b16 a[122:123], v15 offset:17408
 s_add_u32 m0, s74, 110592
 s_nop 0
 buffer_load_dwordx4 v10, s[12:15], s65 offen lds
 s_add_u32 s65, s65, 20480
 s_waitcnt lgkmcnt(11)
 v_mfma_f32_32x32x16_bf16 a[48:63], a[96:99], a[80:83], a[48:63]
 ds_read_b64_tr_b16 a[124:125], v15 offset:16384
 ds_read_b64_tr_b16 a[126:127], v15 offset:17664
 s_waitcnt lgkmcnt(11)
 v_mfma_f32_32x32x16_bf16 a[64:79], a[100:103], a[80:83], a[64:79]
 s_waitcnt lgkmcnt(9)
 s_waitcnt lgkmcnt(8)
 v_mfma_f32_32x32x16_bf16 a[0:15], a[108:111], a[104:107], a[0:15]
 s_waitcnt vmcnt(18)
 s_waitcnt lgkmcnt(0)
 s_barrier
 ds_read_b64_tr_b16 a[84:85], v15 offset:36864
 ds_read_b64_tr_b16 a[86:87], v15 offset:38144
 v_mfma_f32_32x32x16_bf16 a[16:31], a[112:115], a[104:107], a[16:31]
 ds_read_b128 a[80:83], v11 offset:36864
 ds_read_b64_tr_b16 a[88:89], v15 offset:37120
 ds_read_b64_tr_b16 a[90:91], v15 offset:38400
 v_mfma_f32_32x32x16_bf16 a[32:47], a[116:119], a[104:107], a[32:47]
 ds_read_b64_tr_b16 a[92:93], v15 offset:37376
 ds_read_b64_tr_b16 a[94:95], v15 offset:38656
 ds_read_b64_tr_b16 a[96:97], v15 offset:37632
 v_mfma_f32_32x32x16_bf16 a[48:63], a[120:123], a[104:107], a[48:63]
 ds_read_b64_tr_b16 a[98:99], v15 offset:38912
 ds_read_b64_tr_b16 a[100:101], v15 offset:37888
 ds_read_b64_tr_b16 a[102:103], v15 offset:39168
 v_mfma_f32_32x32x16_bf16 a[64:79], a[124:127], a[104:107], a[64:79]
 s_waitcnt lgkmcnt(9)
 s_waitcnt lgkmcnt(8)
 v_mfma_f32_32x32x16_bf16 a[0:15], a[84:87], a[80:83], a[0:15]
 ds_read_b64_tr_b16 a[108:109], v15 offset:41984
 ds_read_b64_tr_b16 a[110:111], v15 offset:43264
 ds_read_b128 a[104:107], v12 offset:36864
 s_waitcnt lgkmcnt(9)
 v_mfma_f32_32x32x16_bf16 a[16:31], a[88:91], a[80:83], a[16:31]
 ds_read_b64_tr_b16 a[112:113], v15 offset:42240
 ds_read_b64_tr_b16 a[114:115], v15 offset:43520
 ds_read_b64_tr_b16 a[116:117], v15 offset:42496
 s_waitcnt lgkmcnt(10)
 v_mfma_f32_32x32x16_bf16 a[32:47], a[92:95], a[80:83], a[32:47]
 ds_read_b64_tr_b16 a[118:119], v15 offset:43776
 ds_read_b64_tr_b16 a[120:121], v15 offset:42752
 ds_read_b64_tr_b16 a[122:123], v15 offset:44032
 s_waitcnt lgkmcnt(11)
 v_mfma_f32_32x32x16_bf16 a[48:63], a[96:99], a[80:83], a[48:63]
 ds_read_b64_tr_b16 a[124:125], v15 offset:43008
 ds_read_b64_tr_b16 a[126:127], v15 offset:44288
 s_waitcnt lgkmcnt(11)
 v_mfma_f32_32x32x16_bf16 a[64:79], a[100:103], a[80:83], a[64:79]
 s_waitcnt lgkmcnt(9)
 s_waitcnt lgkmcnt(8)
 v_mfma_f32_32x32x16_bf16 a[0:15], a[108:111], a[104:107], a[0:15]
 ds_read_b64_tr_b16 a[84:85], v15 offset:47104
 ds_read_b64_tr_b16 a[86:87], v15 offset:48384
 ds_read_b128 a[80:83], v13 offset:36864
 s_waitcnt lgkmcnt(9)
 v_mfma_f32_32x32x16_bf16 a[16:31], a[112:115], a[104:107], a[16:31]
 ds_read_b64_tr_b16 a[88:89], v15 offset:47360
 ds_read_b64_tr_b16 a[90:91], v15 offset:48640
 ds_read_b64_tr_b16 a[92:93], v15 offset:47616
 s_waitcnt lgkmcnt(10)
 v_mfma_f32_32x32x16_bf16 a[32:47], a[116:119], a[104:107], a[32:47]
 ds_read_b64_tr_b16 a[94:95], v15 offset:48896
 ds_read_b64_tr_b16 a[96:97], v15 offset:47872
 ds_read_b64_tr_b16 a[98:99], v15 offset:49152
 s_waitcnt lgkmcnt(11)
 v_mfma_f32_32x32x16_bf16 a[48:63], a[120:123], a[104:107], a[48:63]
 ds_read_b64_tr_b16 a[100:101], v15 offset:48128
 ds_read_b64_tr_b16 a[102:103], v15 offset:49408
 s_waitcnt lgkmcnt(11)
 v_mfma_f32_32x32x16_bf16 a[64:79], a[124:127], a[104:107], a[64:79]
 s_waitcnt lgkmcnt(9)
 s_waitcnt lgkmcnt(8)
 v_mfma_f32_32x32x16_bf16 a[0:15], a[84:87], a[80:83], a[0:15]
 ds_read_b64_tr_b16 a[108:109], v15 offset:52224
 ds_read_b64_tr_b16 a[110:111], v15 offset:53504
 ds_read_b128 a[104:107], v14 offset:36864
 s_waitcnt lgkmcnt(9)
 v_mfma_f32_32x32x16_bf16 a[16:31], a[88:91], a[80:83], a[16:31]
 ds_read_b64_tr_b16 a[112:113], v15 offset:52480
 ds_read_b64_tr_b16 a[114:115], v15 offset:53760
 ds_read_b64_tr_b16 a[116:117], v15 offset:52736
 s_waitcnt lgkmcnt(10)
 v_mfma_f32_32x32x16_bf16 a[32:47], a[92:95], a[80:83], a[32:47]
 ds_read_b64_tr_b16 a[118:119], v15 offset:54016
 ds_read_b64_tr_b16 a[120:121], v15 offset:52992
 ds_read_b64_tr_b16 a[122:123], v15 offset:54272
 s_waitcnt lgkmcnt(11)
 v_mfma_f32_32x32x16_bf16 a[48:63], a[96:99], a[80:83], a[48:63]
 ds_read_b64_tr_b16 a[124:125], v15 offset:53248
 ds_read_b64_tr_b16 a[126:127], v15 offset:54528
 s_waitcnt lgkmcnt(11)
 v_mfma_f32_32x32x16_bf16 a[64:79], a[100:103], a[80:83], a[64:79]
 s_waitcnt lgkmcnt(9)
 s_waitcnt lgkmcnt(8)
 v_mfma_f32_32x32x16_bf16 a[0:15], a[108:111], a[104:107], a[0:15]
 s_waitcnt vmcnt(9)
 s_waitcnt lgkmcnt(0)
 s_barrier
 ds_read_b64_tr_b16 a[84:85], v26 offset:8192
 ds_read_b64_tr_b16 a[86:87], v26 offset:9472
 v_mfma_f32_32x32x16_bf16 a[16:31], a[112:115], a[104:107], a[16:31]
 ds_read_b128 a[80:83], v22 offset:8192
 ds_read_b64_tr_b16 a[88:89], v26 offset:8448
 ds_read_b64_tr_b16 a[90:91], v26 offset:9728
 v_mfma_f32_32x32x16_bf16 a[32:47], a[116:119], a[104:107], a[32:47]
 ds_read_b64_tr_b16 a[92:93], v26 offset:8704
 ds_read_b64_tr_b16 a[94:95], v26 offset:9984
 ds_read_b64_tr_b16 a[96:97], v26 offset:8960
 v_mfma_f32_32x32x16_bf16 a[48:63], a[120:123], a[104:107], a[48:63]
 ds_read_b64_tr_b16 a[98:99], v26 offset:10240
 ds_read_b64_tr_b16 a[100:101], v26 offset:9216
 ds_read_b64_tr_b16 a[102:103], v26 offset:10496
 v_mfma_f32_32x32x16_bf16 a[64:79], a[124:127], a[104:107], a[64:79]
 s_waitcnt lgkmcnt(9)
 s_waitcnt lgkmcnt(8)
 v_mfma_f32_32x32x16_bf16 a[0:15], a[84:87], a[80:83], a[0:15]
 ds_read_b64_tr_b16 a[108:109], v26 offset:13312
 ds_read_b64_tr_b16 a[110:111], v26 offset:14592
 ds_read_b128 a[104:107], v23 offset:8192
 s_waitcnt lgkmcnt(9)
 v_mfma_f32_32x32x16_bf16 a[16:31], a[88:91], a[80:83], a[16:31]
 ds_read_b64_tr_b16 a[112:113], v26 offset:13568
 ds_read_b64_tr_b16 a[114:115], v26 offset:14848
 ds_read_b64_tr_b16 a[116:117], v26 offset:13824
 s_waitcnt lgkmcnt(10)
 v_mfma_f32_32x32x16_bf16 a[32:47], a[92:95], a[80:83], a[32:47]
 ds_read_b64_tr_b16 a[118:119], v26 offset:15104
 ds_read_b64_tr_b16 a[120:121], v26 offset:14080
 ds_read_b64_tr_b16 a[122:123], v26 offset:15360
 s_waitcnt lgkmcnt(11)
 v_mfma_f32_32x32x16_bf16 a[48:63], a[96:99], a[80:83], a[48:63]
 ds_read_b64_tr_b16 a[124:125], v26 offset:14336
 ds_read_b64_tr_b16 a[126:127], v26 offset:15616
 s_waitcnt lgkmcnt(11)
 v_mfma_f32_32x32x16_bf16 a[64:79], a[100:103], a[80:83], a[64:79]
 s_waitcnt lgkmcnt(9)
 s_waitcnt lgkmcnt(8)
 v_mfma_f32_32x32x16_bf16 a[0:15], a[108:111], a[104:107], a[0:15]
 ds_read_b64_tr_b16 a[84:85], v26 offset:18432
 ds_read_b64_tr_b16 a[86:87], v26 offset:19712
 ds_read_b128 a[80:83], v24 offset:8192
 s_waitcnt lgkmcnt(9)
 v_mfma_f32_32x32x16_bf16 a[16:31], a[112:115], a[104:107], a[16:31]
 ds_read_b64_tr_b16 a[88:89], v26 offset:18688
 ds_read_b64_tr_b16 a[90:91], v26 offset:19968
 ds_read_b64_tr_b16 a[92:93], v26 offset:18944
 s_waitcnt lgkmcnt(10)
 v_mfma_f32_32x32x16_bf16 a[32:47], a[116:119], a[104:107], a[32:47]
 ds_read_b64_tr_b16 a[94:95], v26 offset:20224
 ds_read_b64_tr_b16 a[96:97], v26 offset:19200
 ds_read_b64_tr_b16 a[98:99], v26 offset:20480
 s_waitcnt lgkmcnt(11)
 v_mfma_f32_32x32x16_bf16 a[48:63], a[120:123], a[104:107], a[48:63]
 ds_read_b64_tr_b16 a[100:101], v26 offset:19456
 ds_read_b64_tr_b16 a[102:103], v26 offset:20736
 s_waitcnt lgkmcnt(11)
 v_mfma_f32_32x32x16_bf16 a[64:79], a[124:127], a[104:107], a[64:79]
 s_waitcnt lgkmcnt(9)
 s_waitcnt lgkmcnt(8)
 v_mfma_f32_32x32x16_bf16 a[0:15], a[84:87], a[80:83], a[0:15]
 ds_read_b64_tr_b16 a[108:109], v26 offset:23552
 ds_read_b64_tr_b16 a[110:111], v26 offset:24832
 ds_read_b128 a[104:107], v25 offset:8192
 s_waitcnt lgkmcnt(9)
 v_mfma_f32_32x32x16_bf16 a[16:31], a[88:91], a[80:83], a[16:31]
 ds_read_b64_tr_b16 a[112:113], v26 offset:23808
 ds_read_b64_tr_b16 a[114:115], v26 offset:25088
 ds_read_b64_tr_b16 a[116:117], v26 offset:24064
 s_waitcnt lgkmcnt(10)
 v_mfma_f32_32x32x16_bf16 a[32:47], a[92:95], a[80:83], a[32:47]
 ds_read_b64_tr_b16 a[118:119], v26 offset:25344
 ds_read_b64_tr_b16 a[120:121], v26 offset:24320
 ds_read_b64_tr_b16 a[122:123], v26 offset:25600
 s_waitcnt lgkmcnt(11)
 v_mfma_f32_32x32x16_bf16 a[48:63], a[96:99], a[80:83], a[48:63]
 ds_read_b64_tr_b16 a[124:125], v26 offset:24576
 ds_read_b64_tr_b16 a[126:127], v26 offset:25856
 s_waitcnt lgkmcnt(11)
 v_mfma_f32_32x32x16_bf16 a[64:79], a[100:103], a[80:83], a[64:79]
 s_waitcnt lgkmcnt(9)
 s_waitcnt lgkmcnt(8)
 v_mfma_f32_32x32x16_bf16 a[0:15], a[108:111], a[104:107], a[0:15]
 s_waitcnt vmcnt(0)
 s_waitcnt lgkmcnt(0)
 s_barrier
 ds_read_b64_tr_b16 a[84:85], v26 offset:45056
 ds_read_b64_tr_b16 a[86:87], v26 offset:46336
 v_mfma_f32_32x32x16_bf16 a[16:31], a[112:115], a[104:107], a[16:31]
 ds_read_b128 a[80:83], v22 offset:45056
 ds_read_b64_tr_b16 a[88:89], v26 offset:45312
 ds_read_b64_tr_b16 a[90:91], v26 offset:46592
 v_mfma_f32_32x32x16_bf16 a[32:47], a[116:119], a[104:107], a[32:47]
 ds_read_b64_tr_b16 a[92:93], v26 offset:45568
 ds_read_b64_tr_b16 a[94:95], v26 offset:46848
 ds_read_b64_tr_b16 a[96:97], v26 offset:45824
 v_mfma_f32_32x32x16_bf16 a[48:63], a[120:123], a[104:107], a[48:63]
 ds_read_b64_tr_b16 a[98:99], v26 offset:47104
 ds_read_b64_tr_b16 a[100:101], v26 offset:46080
 ds_read_b64_tr_b16 a[102:103], v26 offset:47360
 v_mfma_f32_32x32x16_bf16 a[64:79], a[124:127], a[104:107], a[64:79]
 s_waitcnt lgkmcnt(9)
 s_waitcnt lgkmcnt(8)
 v_mfma_f32_32x32x16_bf16 a[0:15], a[84:87], a[80:83], a[0:15]
 ds_read_b64_tr_b16 a[108:109], v26 offset:50176
 ds_read_b64_tr_b16 a[110:111], v26 offset:51456
 ds_read_b128 a[104:107], v23 offset:45056
 s_waitcnt lgkmcnt(9)
 v_mfma_f32_32x32x16_bf16 a[16:31], a[88:91], a[80:83], a[16:31]
 ds_read_b64_tr_b16 a[112:113], v26 offset:50432
 ds_read_b64_tr_b16 a[114:115], v26 offset:51712
 ds_read_b64_tr_b16 a[116:117], v26 offset:50688
 s_waitcnt lgkmcnt(10)
 v_mfma_f32_32x32x16_bf16 a[32:47], a[92:95], a[80:83], a[32:47]
 ds_read_b64_tr_b16 a[118:119], v26 offset:51968
 ds_read_b64_tr_b16 a[120:121], v26 offset:50944
 ds_read_b64_tr_b16 a[122:123], v26 offset:52224
 s_waitcnt lgkmcnt(11)
 v_mfma_f32_32x32x16_bf16 a[48:63], a[96:99], a[80:83], a[48:63]
 ds_read_b64_tr_b16 a[124:125], v26 offset:51200
 ds_read_b64_tr_b16 a[126:127], v26 offset:52480
 s_waitcnt lgkmcnt(11)
 v_mfma_f32_32x32x16_bf16 a[64:79], a[100:103], a[80:83], a[64:79]
 s_waitcnt lgkmcnt(9)
 s_waitcnt lgkmcnt(8)
 v_mfma_f32_32x32x16_bf16 a[0:15], a[108:111], a[104:107], a[0:15]
 ds_read_b64_tr_b16 a[84:85], v26 offset:55296
 ds_read_b64_tr_b16 a[86:87], v26 offset:56576
 ds_read_b128 a[80:83], v24 offset:45056
 s_waitcnt lgkmcnt(9)
 v_mfma_f32_32x32x16_bf16 a[16:31], a[112:115], a[104:107], a[16:31]
 ds_read_b64_tr_b16 a[88:89], v26 offset:55552
 ds_read_b64_tr_b16 a[90:91], v26 offset:56832
 ds_read_b64_tr_b16 a[92:93], v26 offset:55808
 s_waitcnt lgkmcnt(10)
 v_mfma_f32_32x32x16_bf16 a[32:47], a[116:119], a[104:107], a[32:47]
 ds_read_b64_tr_b16 a[94:95], v26 offset:57088
 ds_read_b64_tr_b16 a[96:97], v26 offset:56064
 ds_read_b64_tr_b16 a[98:99], v26 offset:57344
 s_waitcnt lgkmcnt(11)
 v_mfma_f32_32x32x16_bf16 a[48:63], a[120:123], a[104:107], a[48:63]
 ds_read_b64_tr_b16 a[100:101], v26 offset:56320
 ds_read_b64_tr_b16 a[102:103], v26 offset:57600
 s_waitcnt lgkmcnt(11)
 v_mfma_f32_32x32x16_bf16 a[64:79], a[124:127], a[104:107], a[64:79]
 s_waitcnt lgkmcnt(9)
 s_waitcnt lgkmcnt(8)
 v_mfma_f32_32x32x16_bf16 a[0:15], a[84:87], a[80:83], a[0:15]
 ds_read_b64_tr_b16 a[108:109], v26 offset:60416
 ds_read_b64_tr_b16 a[110:111], v26 offset:61696
 ds_read_b128 a[104:107], v25 offset:45056
 s_waitcnt lgkmcnt(9)
 v_mfma_f32_32x32x16_bf16 a[16:31], a[88:91], a[80:83], a[16:31]
 ds_read_b64_tr_b16 a[112:113], v26 offset:60672
 ds_read_b64_tr_b16 a[114:115], v26 offset:61952
 ds_read_b64_tr_b16 a[116:117], v26 offset:60928
 s_waitcnt lgkmcnt(10)
 v_mfma_f32_32x32x16_bf16 a[32:47], a[92:95], a[80:83], a[32:47]
 ds_read_b64_tr_b16 a[118:119], v26 offset:62208
 ds_read_b64_tr_b16 a[120:121], v26 offset:61184
 ds_read_b64_tr_b16 a[122:123], v26 offset:62464
 s_waitcnt lgkmcnt(11)
 v_mfma_f32_32x32x16_bf16 a[48:63], a[96:99], a[80:83], a[48:63]
 ds_read_b64_tr_b16 a[124:125], v26 offset:61440
 ds_read_b64_tr_b16 a[126:127], v26 offset:62720
 s_waitcnt lgkmcnt(11)
 v_mfma_f32_32x32x16_bf16 a[64:79], a[100:103], a[80:83], a[64:79]
 s_waitcnt lgkmcnt(9)
 s_waitcnt lgkmcnt(8)
 v_mfma_f32_32x32x16_bf16 a[0:15], a[108:111], a[104:107], a[0:15]
 s_waitcnt lgkmcnt(6)
 v_mfma_f32_32x32x16_bf16 a[16:31], a[112:115], a[104:107], a[16:31]
 s_waitcnt lgkmcnt(4)
 v_mfma_f32_32x32x16_bf16 a[32:47], a[116:119], a[104:107], a[32:47]
 s_waitcnt lgkmcnt(2)
 v_mfma_f32_32x32x16_bf16 a[48:63], a[120:123], a[104:107], a[48:63]
 s_waitcnt lgkmcnt(0)
 v_mfma_f32_32x32x16_bf16 a[64:79], a[124:127], a[104:107], a[64:79]
 s_nop 15
 s_waitcnt vmcnt(0)
 v_lshlrev_b32 v35, 16, v35
 s_mov_b32 s40, 0
 v_accvgpr_read_b32 v76, a0
 v_accvgpr_read_b32 v77, a1
 v_accvgpr_read_b32 v78, a2
 v_accvgpr_read_b32 v79, a3
 v_accvgpr_read_b32 v80, a4
 v_accvgpr_read_b32 v81, a5
 v_accvgpr_read_b32 v82, a6
 v_accvgpr_read_b32 v83, a7
 v_add_f32 v76, v76, v35
 v_add_f32 v77, v77, v35
 v_add_f32 v78, v78, v35
 v_add_f32 v79, v79, v35
 v_add_f32 v80, v80, v35
 v_add_f32 v81, v81, v35
 v_add_f32 v82, v82, v35
 v_add_f32 v83, v83, v35
 v_lshlrev_b32 v84, 16, v40
 v_and_b32 v85, 0xffff0000, v40
 v_lshlrev_b32 v86, 16, v41
 v_and_b32 v87, 0xffff0000, v41
 v_lshlrev_b32 v88, 16, v42
 v_and_b32 v89, 0xffff0000, v42
 v_lshlrev_b32 v90, 16, v43
 v_and_b32 v91, 0xffff0000, v43
 v_mul_f32 v76, v76, v84
 v_mul_f32 v77, v77, v85
 v_mul_f32 v78, v78, v86
 v_mul_f32 v79, v79, v87
 v_mul_f32 v80, v80, v88
 v_mul_f32 v81, v81, v89
 v_mul_f32 v82, v82, v90
 v_mul_f32 v83, v83, v91
 v_cvt_pk_bf16_f32 v40, v76, v77
 v_cvt_pk_bf16_f32 v41, v78, v79
 v_cvt_pk_bf16_f32 v42, v80, v81
 v_cvt_pk_bf16_f32 v43, v82, v83
 buffer_store_dwordx4 v[40:43], v38, s[16:19], s40 offen offset:0 sc0 sc1
 v_accvgpr_read_b32 v92, a8
 v_accvgpr_read_b32 v93, a9
 v_accvgpr_read_b32 v94, a10
 v_accvgpr_read_b32 v95, a11
 v_accvgpr_read_b32 v96, a12
 v_accvgpr_read_b32 v97, a13
 v_accvgpr_read_b32 v98, a14
 v_accvgpr_read_b32 v99, a15
 v_add_f32 v92, v92, v35
 v_add_f32 v93, v93, v35
 v_add_f32 v94, v94, v35
 v_add_f32 v95, v95, v35
 v_add_f32 v96, v96, v35
 v_add_f32 v97, v97, v35
 v_add_f32 v98, v98, v35
 v_add_f32 v99, v99, v35
 v_lshlrev_b32 v100, 16, v44
 v_and_b32 v101, 0xffff0000, v44
 v_lshlrev_b32 v102, 16, v45
 v_and_b32 v103, 0xffff0000, v45
 v_lshlrev_b32 v104, 16, v46
 v_and_b32 v105, 0xffff0000, v46
 v_lshlrev_b32 v106, 16, v47
 v_and_b32 v107, 0xffff0000, v47
 v_mul_f32 v92, v92, v100
 v_mul_f32 v93, v93, v101
 v_mul_f32 v94, v94, v102
 v_mul_f32 v95, v95, v103
 v_mul_f32 v96, v96, v104
 v_mul_f32 v97, v97, v105
 v_mul_f32 v98, v98, v106
 v_mul_f32 v99, v99, v107
 v_cvt_pk_bf16_f32 v44, v92, v93
 v_cvt_pk_bf16_f32 v45, v94, v95
 v_cvt_pk_bf16_f32 v46, v96, v97
 v_cvt_pk_bf16_f32 v47, v98, v99
 buffer_store_dwordx4 v[44:47], v38, s[16:19], s40 offen offset:1024 sc0 sc1
 s_mov_b32 s40, 2048
 v_accvgpr_read_b32 v108, a16
 v_accvgpr_read_b32 v109, a17
 v_accvgpr_read_b32 v110, a18
 v_accvgpr_read_b32 v111, a19
 v_accvgpr_read_b32 v112, a20
 v_accvgpr_read_b32 v113, a21
 v_accvgpr_read_b32 v114, a22
 v_accvgpr_read_b32 v115, a23
 v_add_f32 v108, v108, v35
 v_add_f32 v109, v109, v35
 v_add_f32 v110, v110, v35
 v_add_f32 v111, v111, v35
 v_add_f32 v112, v112, v35
 v_add_f32 v113, v113, v35
 v_add_f32 v114, v114, v35
 v_add_f32 v115, v115, v35
 v_lshlrev_b32 v116, 16, v48
 v_and_b32 v117, 0xffff0000, v48
 v_lshlrev_b32 v118, 16, v49
 v_and_b32 v119, 0xffff0000, v49
 v_lshlrev_b32 v120, 16, v50
 v_and_b32 v121, 0xffff0000, v50
 v_lshlrev_b32 v122, 16, v51
 v_and_b32 v123, 0xffff0000, v51
 v_mul_f32 v108, v108, v116
 v_mul_f32 v109, v109, v117
 v_mul_f32 v110, v110, v118
 v_mul_f32 v111, v111, v119
 v_mul_f32 v112, v112, v120
 v_mul_f32 v113, v113, v121
 v_mul_f32 v114, v114, v122
 v_mul_f32 v115, v115, v123
 v_cvt_pk_bf16_f32 v48, v108, v109
 v_cvt_pk_bf16_f32 v49, v110, v111
 v_cvt_pk_bf16_f32 v50, v112, v113
 v_cvt_pk_bf16_f32 v51, v114, v115
 buffer_store_dwordx4 v[48:51], v38, s[16:19], s40 offen offset:0 sc0 sc1
 v_accvgpr_read_b32 v124, a24
 v_accvgpr_read_b32 v125, a25
 v_accvgpr_read_b32 v126, a26
 v_accvgpr_read_b32 v127, a27
 v_accvgpr_read_b32 v128, a28
 v_accvgpr_read_b32 v129, a29
 v_accvgpr_read_b32 v130, a30
 v_accvgpr_read_b32 v131, a31
 v_add_f32 v124, v124, v35
 v_add_f32 v125, v125, v35
 v_add_f32 v126, v126, v35
 v_add_f32 v127, v127, v35
 v_add_f32 v128, v128, v35
 v_add_f32 v129, v129, v35
 v_add_f32 v130, v130, v35
 v_add_f32 v131, v131, v35
 v_lshlrev_b32 v132, 16, v52
 v_and_b32 v133, 0xffff0000, v52
 v_lshlrev_b32 v134, 16, v53
 v_and_b32 v135, 0xffff0000, v53
 v_lshlrev_b32 v136, 16, v54
 v_and_b32 v137, 0xffff0000, v54
 v_lshlrev_b32 v138, 16, v55
 v_and_b32 v139, 0xffff0000, v55
 v_mul_f32 v124, v124, v132
 v_mul_f32 v125, v125, v133
 v_mul_f32 v126, v126, v134
 v_mul_f32 v127, v127, v135
 v_mul_f32 v128, v128, v136
 v_mul_f32 v129, v129, v137
 v_mul_f32 v130, v130, v138
 v_mul_f32 v131, v131, v139
 v_cvt_pk_bf16_f32 v52, v124, v125
 v_cvt_pk_bf16_f32 v53, v126, v127
 v_cvt_pk_bf16_f32 v54, v128, v129
 v_cvt_pk_bf16_f32 v55, v130, v131
 buffer_store_dwordx4 v[52:55], v38, s[16:19], s40 offen offset:1024 sc0 sc1
 s_mov_b32 s40, 4096
 v_accvgpr_read_b32 v76, a32
 v_accvgpr_read_b32 v77, a33
 v_accvgpr_read_b32 v78, a34
 v_accvgpr_read_b32 v79, a35
 v_accvgpr_read_b32 v80, a36
 v_accvgpr_read_b32 v81, a37
 v_accvgpr_read_b32 v82, a38
 v_accvgpr_read_b32 v83, a39
 v_add_f32 v76, v76, v35
 v_add_f32 v77, v77, v35
 v_add_f32 v78, v78, v35
 v_add_f32 v79, v79, v35
 v_add_f32 v80, v80, v35
 v_add_f32 v81, v81, v35
 v_add_f32 v82, v82, v35
 v_add_f32 v83, v83, v35
 v_lshlrev_b32 v84, 16, v56
 v_and_b32 v85, 0xffff0000, v56
 v_lshlrev_b32 v86, 16, v57
 v_and_b32 v87, 0xffff0000, v57
 v_lshlrev_b32 v88, 16, v58
 v_and_b32 v89, 0xffff0000, v58
 v_lshlrev_b32 v90, 16, v59
 v_and_b32 v91, 0xffff0000, v59
 v_mul_f32 v76, v76, v84
 v_mul_f32 v77, v77, v85
 v_mul_f32 v78, v78, v86
 v_mul_f32 v79, v79, v87
 v_mul_f32 v80, v80, v88
 v_mul_f32 v81, v81, v89
 v_mul_f32 v82, v82, v90
 v_mul_f32 v83, v83, v91
 v_cvt_pk_bf16_f32 v56, v76, v77
 v_cvt_pk_bf16_f32 v57, v78, v79
 v_cvt_pk_bf16_f32 v58, v80, v81
 v_cvt_pk_bf16_f32 v59, v82, v83
 buffer_store_dwordx4 v[56:59], v38, s[16:19], s40 offen offset:0 sc0 sc1
 v_accvgpr_read_b32 v92, a40
 v_accvgpr_read_b32 v93, a41
 v_accvgpr_read_b32 v94, a42
 v_accvgpr_read_b32 v95, a43
 v_accvgpr_read_b32 v96, a44
 v_accvgpr_read_b32 v97, a45
 v_accvgpr_read_b32 v98, a46
 v_accvgpr_read_b32 v99, a47
 v_add_f32 v92, v92, v35
 v_add_f32 v93, v93, v35
 v_add_f32 v94, v94, v35
 v_add_f32 v95, v95, v35
 v_add_f32 v96, v96, v35
 v_add_f32 v97, v97, v35
 v_add_f32 v98, v98, v35
 v_add_f32 v99, v99, v35
 v_lshlrev_b32 v100, 16, v60
 v_and_b32 v101, 0xffff0000, v60
 v_lshlrev_b32 v102, 16, v61
 v_and_b32 v103, 0xffff0000, v61
 v_lshlrev_b32 v104, 16, v62
 v_and_b32 v105, 0xffff0000, v62
 v_lshlrev_b32 v106, 16, v63
 v_and_b32 v107, 0xffff0000, v63
 v_mul_f32 v92, v92, v100
 v_mul_f32 v93, v93, v101
 v_mul_f32 v94, v94, v102
 v_mul_f32 v95, v95, v103
 v_mul_f32 v96, v96, v104
 v_mul_f32 v97, v97, v105
 v_mul_f32 v98, v98, v106
 v_mul_f32 v99, v99, v107
 v_cvt_pk_bf16_f32 v60, v92, v93
 v_cvt_pk_bf16_f32 v61, v94, v95
 v_cvt_pk_bf16_f32 v62, v96, v97
 v_cvt_pk_bf16_f32 v63, v98, v99
 buffer_store_dwordx4 v[60:63], v38, s[16:19], s40 offen offset:1024 sc0 sc1
 s_mov_b32 s40, 6144
 v_accvgpr_read_b32 v108, a48
 v_accvgpr_read_b32 v109, a49
 v_accvgpr_read_b32 v110, a50
 v_accvgpr_read_b32 v111, a51
 v_accvgpr_read_b32 v112, a52
 v_accvgpr_read_b32 v113, a53
 v_accvgpr_read_b32 v114, a54
 v_accvgpr_read_b32 v115, a55
 v_add_f32 v108, v108, v35
 v_add_f32 v109, v109, v35
 v_add_f32 v110, v110, v35
 v_add_f32 v111, v111, v35
 v_add_f32 v112, v112, v35
 v_add_f32 v113, v113, v35
 v_add_f32 v114, v114, v35
 v_add_f32 v115, v115, v35
 v_lshlrev_b32 v116, 16, v64
 v_and_b32 v117, 0xffff0000, v64
 v_lshlrev_b32 v118, 16, v65
 v_and_b32 v119, 0xffff0000, v65
 v_lshlrev_b32 v120, 16, v66
 v_and_b32 v121, 0xffff0000, v66
 v_lshlrev_b32 v122, 16, v67
 v_and_b32 v123, 0xffff0000, v67
 v_mul_f32 v108, v108, v116
 v_mul_f32 v109, v109, v117
 v_mul_f32 v110, v110, v118
 v_mul_f32 v111, v111, v119
 v_mul_f32 v112, v112, v120
 v_mul_f32 v113, v113, v121
 v_mul_f32 v114, v114, v122
 v_mul_f32 v115, v115, v123
 v_cvt_pk_bf16_f32 v64, v108, v109
 v_cvt_pk_bf16_f32 v65, v110, v111
 v_cvt_pk_bf16_f32 v66, v112, v113
 v_cvt_pk_bf16_f32 v67, v114, v115
 buffer_store_dwordx4 v[64:67], v38, s[16:19], s40 offen offset:0 sc0 sc1
 v_accvgpr_read_b32 v124, a56
 v_accvgpr_read_b32 v125, a57
 v_accvgpr_read_b32 v126, a58
 v_accvgpr_read_b32 v127, a59
 v_accvgpr_read_b32 v128, a60
 v_accvgpr_read_b32 v129, a61
 v_accvgpr_read_b32 v130, a62
 v_accvgpr_read_b32 v131, a63
 v_add_f32 v124, v124, v35
 v_add_f32 v125, v125, v35
 v_add_f32 v126, v126, v35
 v_add_f32 v127, v127, v35
 v_add_f32 v128, v128, v35
 v_add_f32 v129, v129, v35
 v_add_f32 v130, v130, v35
 v_add_f32 v131, v131, v35
 v_lshlrev_b32 v132, 16, v68
 v_and_b32 v133, 0xffff0000, v68
 v_lshlrev_b32 v134, 16, v69
 v_and_b32 v135, 0xffff0000, v69
 v_lshlrev_b32 v136, 16, v70
 v_and_b32 v137, 0xffff0000, v70
 v_lshlrev_b32 v138, 16, v71
 v_and_b32 v139, 0xffff0000, v71
 v_mul_f32 v124, v124, v132
 v_mul_f32 v125, v125, v133
 v_mul_f32 v126, v126, v134
 v_mul_f32 v127, v127, v135
 v_mul_f32 v128, v128, v136
 v_mul_f32 v129, v129, v137
 v_mul_f32 v130, v130, v138
 v_mul_f32 v131, v131, v139
 v_cvt_pk_bf16_f32 v68, v124, v125
 v_cvt_pk_bf16_f32 v69, v126, v127
 v_cvt_pk_bf16_f32 v70, v128, v129
 v_cvt_pk_bf16_f32 v71, v130, v131
 buffer_store_dwordx4 v[68:71], v38, s[16:19], s40 offen offset:1024 sc0 sc1
 s_mov_b32 s40, 8192
 v_accvgpr_read_b32 v76, a64
 v_accvgpr_read_b32 v77, a65
 v_accvgpr_read_b32 v78, a66
 v_accvgpr_read_b32 v79, a67
 v_accvgpr_read_b32 v80, a68
 v_accvgpr_read_b32 v81, a69
 v_accvgpr_read_b32 v82, a70
 v_accvgpr_read_b32 v83, a71
 v_add_f32 v76, v76, v35
 v_add_f32 v77, v77, v35
 v_add_f32 v78, v78, v35
 v_add_f32 v79, v79, v35
 v_add_f32 v80, v80, v35
 v_add_f32 v81, v81, v35
 v_add_f32 v82, v82, v35
 v_add_f32 v83, v83, v35
 v_lshlrev_b32 v84, 16, v72
 v_and_b32 v85, 0xffff0000, v72
 v_lshlrev_b32 v86, 16, v73
 v_and_b32 v87, 0xffff0000, v73
 v_lshlrev_b32 v88, 16, v74
 v_and_b32 v89, 0xffff0000, v74
 v_lshlrev_b32 v90, 16, v75
 v_and_b32 v91, 0xffff0000, v75
 v_mul_f32 v76, v76, v84
 v_mul_f32 v77, v77, v85
 v_mul_f32 v78, v78, v86
 v_mul_f32 v79, v79, v87
 v_mul_f32 v80, v80, v88
 v_mul_f32 v81, v81, v89
 v_mul_f32 v82, v82, v90
 v_mul_f32 v83, v83, v91
 v_cvt_pk_bf16_f32 v72, v76, v77
 v_cvt_pk_bf16_f32 v73, v78, v79
 v_cvt_pk_bf16_f32 v74, v80, v81
 v_cvt_pk_bf16_f32 v75, v82, v83
 buffer_store_dwordx4 v[72:75], v38, s[16:19], s40 offen offset:0 sc0 sc1
 s_endpgm
mid_kernel_oproj3:
 s_sub_u32 s3, s2, 96
 s_bfe_u32 s42, s3, 0x10002
 s_and_b32 s29, s3, 3
 s_lshl_b32 s29, s29, 2
 s_bfe_u32 s47, s3, 0x20003
 s_add_u32 s29, s29, s47
 s_lshr_b32 s30, s3, 5
 s_mov_b32 s46, s30
 s_mul_i32 s49, s46, 6
 s_mul_i32 s48, s47, 8
 s_add_u32 s49, s49, s48
 s_add_u32 s49, s49, s47
 s_and_b32 s49, s49, 31
 s_lshl_b32 s43, s29, 20
 s_mul_i32 s41, s42, 131072
 s_add_u32 s43, s43, s41
 s_mul_i32 s29, s29, 128
 s_mul_i32 s30, s30, 128
 s_mul_i32 s31, s42, 2048
 s_waitcnt lgkmcnt(0)
 s_add_u32 s52, s50, 16777216
 s_addc_u32 s53, s51, 0
 s_mov_b32 s8, s52
 s_and_b32 s9, s53, 0xffff
 s_mov_b32 s10, 16777216
 s_mov_b32 s11, 0x00020000
 s_mov_b32 s12, s44
 s_and_b32 s13, s45, 0xffff
 s_mov_b32 s14, 5242880
 s_mov_b32 s15, 0x00020000
 s_add_u32 s52, s50, 41943040
 s_addc_u32 s53, s51, 0
 s_mov_b32 s16, s52
 s_and_b32 s17, s53, 0xffff
 s_mov_b32 s18, 10485760
 s_mov_b32 s19, 0x00020000
 s_lshr_b32 s66, s28, 1
 s_and_b32 s67, s28, 1
 s_mul_i32 s66, s66, 64
 s_mul_i32 s67, s67, 64
 s_mul_i32 s69, s28, 256
 s_mul_i32 s68, s28, 4
 s_add_u32 s68, s68, 0
 s_lshr_b32 s64, s68, 2
 s_mul_i32 s64, s64, 262144
 s_and_b32 s68, s68, 3
 s_lshl_b32 s68, s68, 10
 s_add_u32 s64, s64, s68
 s_add_u32 s64, s64, s43
 v_lshlrev_b32 v15, 4, v0
 v_add_u32 v2, s64, v15
 s_mul_i32 s68, s28, 4
 s_add_u32 s68, s68, 1
 s_lshr_b32 s64, s68, 2
 s_mul_i32 s64, s64, 262144
 s_and_b32 s68, s68, 3
 s_lshl_b32 s68, s68, 10
 s_add_u32 s64, s64, s68
 s_add_u32 s64, s64, s43
 v_lshlrev_b32 v15, 4, v0
 v_add_u32 v3, s64, v15
 s_mul_i32 s68, s28, 4
 s_add_u32 s68, s68, 2
 s_lshr_b32 s64, s68, 2
 s_mul_i32 s64, s64, 262144
 s_and_b32 s68, s68, 3
 s_lshl_b32 s68, s68, 10
 s_add_u32 s64, s64, s68
 s_add_u32 s64, s64, s43
 v_lshlrev_b32 v15, 4, v0
 v_add_u32 v4, s64, v15
 s_mul_i32 s68, s28, 4
 s_add_u32 s68, s68, 3
 s_lshr_b32 s64, s68, 2
 s_mul_i32 s64, s64, 262144
 s_and_b32 s68, s68, 3
 s_lshl_b32 s68, s68, 10
 s_add_u32 s64, s64, s68
 s_add_u32 s64, s64, s43
 v_lshlrev_b32 v15, 4, v0
 v_add_u32 v5, s64, v15
 v_bfe_u32 v19, v0, 2, 2
 v_and_b32 v20, 3, v0
 s_mul_i32 s69, s28, 4
 s_add_u32 s69, s69, 0
 s_min_u32 s69, s69, 15
 s_lshl_b32 s70, s69, 10
 s_add_u32 s70, s70, 16384
 s_lshl_b32 s69, s69, 2
 v_lshrrev_b32 v15, 4, v0
 v_add_u32 v15, s69, v15
 v_mul_u32_u24 v16, 16384, v15
 v_lshrrev_b32 v16, 16, v16
 v_mul_u32_u24 v17, 4, v16
 v_sub_u32 v17, v15, v17
 v_lshl_add_u32 v16, v16, 2, v19
 s_mov_b32 s68, 1280
 v_mul_lo_u32 v16, v16, s68
 v_lshlrev_b32 v17, 5, v17
 v_lshl_add_u32 v17, v20, 3, v17
 v_add_u32 v17, s30, v17
 v_lshl_add_u32 v6, v17, 1, v16
 s_mul_i32 s69, s28, 4
 s_add_u32 s69, s69, 1
 s_min_u32 s69, s69, 15
 s_lshl_b32 s71, s69, 10
 s_add_u32 s71, s71, 16384
 s_lshl_b32 s69, s69, 2
 v_lshrrev_b32 v15, 4, v0
 v_add_u32 v15, s69, v15
 v_mul_u32_u24 v16, 16384, v15
 v_lshrrev_b32 v16, 16, v16
 v_mul_u32_u24 v17, 4, v16
 v_sub_u32 v17, v15, v17
 v_lshl_add_u32 v16, v16, 2, v19
 s_mov_b32 s68, 1280
 v_mul_lo_u32 v16, v16, s68
 v_lshlrev_b32 v17, 5, v17
 v_lshl_add_u32 v17, v20, 3, v17
 v_add_u32 v17, s30, v17
 v_lshl_add_u32 v7, v17, 1, v16
 s_mul_i32 s69, s28, 4
 s_add_u32 s69, s69, 2
 s_min_u32 s69, s69, 15
 s_lshl_b32 s72, s69, 10
 s_add_u32 s72, s72, 16384
 s_lshl_b32 s69, s69, 2
 v_lshrrev_b32 v15, 4, v0
 v_add_u32 v15, s69, v15
 v_mul_u32_u24 v16, 16384, v15
 v_lshrrev_b32 v16, 16, v16
 v_mul_u32_u24 v17, 4, v16
 v_sub_u32 v17, v15, v17
 v_lshl_add_u32 v16, v16, 2, v19
 s_mov_b32 s68, 1280
 v_mul_lo_u32 v16, v16, s68
 v_lshlrev_b32 v17, 5, v17
 v_lshl_add_u32 v17, v20, 3, v17
 v_add_u32 v17, s30, v17
 v_lshl_add_u32 v8, v17, 1, v16
 s_mul_i32 s69, s28, 4
 s_add_u32 s69, s69, 3
 s_min_u32 s69, s69, 15
 s_lshl_b32 s73, s69, 10
 s_add_u32 s73, s73, 16384
 s_lshl_b32 s69, s69, 2
 v_lshrrev_b32 v15, 4, v0
 v_add_u32 v15, s69, v15
 v_mul_u32_u24 v16, 16384, v15
 v_lshrrev_b32 v16, 16, v16
 v_mul_u32_u24 v17, 4, v16
 v_sub_u32 v17, v15, v17
 v_lshl_add_u32 v16, v16, 2, v19
 s_mov_b32 s68, 1280
 v_mul_lo_u32 v16, v16, s68
 v_lshlrev_b32 v17, 5, v17
 v_lshl_add_u32 v17, v20, 3, v17
 v_add_u32 v17, s30, v17
 v_lshl_add_u32 v9, v17, 1, v16
 v_and_b32 v15, 31, v0
 v_add_u32 v15, s66, v15
 v_lshrrev_b32 v16, 5, v0
 v_bfe_u32 v18, v15, 1, 3
 s_mul_i32 s69, s66, 128
 v_lshlrev_b32 v17, 4, v0
 v_add_u32 v17, s69, v17
 v_add_u32 v10, 0, v17
 s_mul_i32 s69, s66, 128
 v_lshlrev_b32 v17, 4, v0
 v_add_u32 v17, s69, v17
 v_add_u32 v11, 1024, v17
 s_mul_i32 s69, s66, 128
 v_lshlrev_b32 v17, 4, v0
 v_add_u32 v17, s69, v17
 v_add_u32 v12, 2048, v17
 s_mul_i32 s69, s66, 128
 v_lshlrev_b32 v17, 4, v0
 v_add_u32 v17, s69, v17
 v_add_u32 v13, 3072, v17
 v_lshlrev_b32 v17, 6, v19
 v_bfe_u32 v18, v0, 4, 1
 v_lshl_add_u32 v17, v18, 5, v17
 v_and_b32 v18, 1, v20
 v_lshl_add_u32 v17, v18, 4, v17
 v_lshrrev_b32 v18, 1, v20
 v_lshl_add_u32 v17, v18, 3, v17
 v_mul_u32_u24 v18, 2048, v16
 v_add_u32 v17, v17, v18
 s_lshl_b32 s69, s67, 3
 v_add_u32 v17, s69, v17
 v_add_u32 v14, 16384, v17
 s_mov_b32 s64, 0
 s_mul_i32 s65, s31, 1280
 s_mul_i32 s68, s28, 4096
 v_add_u32 v21, 65536, v10
 v_add_u32 v22, 65536, v11
 v_add_u32 v23, 65536, v12
 v_add_u32 v24, 65536, v13
 v_add_u32 v25, 65536, v14
 s_add_u32 m0, s68, 0
 s_nop 0
 buffer_load_dwordx4 v2, s[8:11], s64 offen lds
 s_add_u32 m0, s68, 1024
 s_nop 0
 buffer_load_dwordx4 v3, s[8:11], s64 offen lds
 s_add_u32 m0, s68, 2048
 s_nop 0
 buffer_load_dwordx4 v4, s[8:11], s64 offen lds
 s_add_u32 m0, s68, 3072
 s_nop 0
 buffer_load_dwordx4 v5, s[8:11], s64 offen lds
 s_add_u32 s64, s64, 4096
 s_add_u32 m0, s70, 0
 s_nop 0
 buffer_load_dwordx4 v6, s[12:15], s65 offen lds
 s_add_u32 m0, s71, 0
 s_nop 0
 buffer_load_dwordx4 v7, s[12:15], s65 offen lds
 s_add_u32 m0, s72, 0
 s_nop 0
 buffer_load_dwordx4 v8, s[12:15], s65 offen lds
 s_add_u32 m0, s73, 0
 s_nop 0
 buffer_load_dwordx4 v9, s[12:15], s65 offen lds
 s_add_u32 s65, s65, 81920
 s_add_u32 m0, s68, 32768
 s_nop 0
 buffer_load_dwordx4 v2, s[8:11], s64 offen lds
 s_add_u32 m0, s68, 33792
 s_nop 0
 buffer_load_dwordx4 v3, s[8:11], s64 offen lds
 s_add_u32 m0, s68, 34816
 s_nop 0
 buffer_load_dwordx4 v4, s[8:11], s64 offen lds
 s_add_u32 m0, s68, 35840
 s_nop 0
 buffer_load_dwordx4 v5, s[8:11], s64 offen lds
 s_add_u32 s64, s64, 4096
 s_add_u32 m0, s70, 32768
 s_nop 0
 buffer_load_dwordx4 v6, s[12:15], s65 offen lds
 s_add_u32 m0, s71, 32768
 s_nop 0
 buffer_load_dwordx4 v7, s[12:15], s65 offen lds
 s_add_u32 m0, s72, 32768
 s_nop 0
 buffer_load_dwordx4 v8, s[12:15], s65 offen lds
 s_add_u32 m0, s73, 32768
 s_nop 0
 buffer_load_dwordx4 v9, s[12:15], s65 offen lds
 s_add_u32 s65, s65, 81920
 s_waitcnt vmcnt(8)
 s_barrier
 ds_read_b64_tr_b16 a[72:73], v14 offset:0
 ds_read_b64_tr_b16 a[74:75], v14 offset:1024
 ds_read_b128 a[64:67], v10 offset:0
 ds_read_b64_tr_b16 a[76:77], v14 offset:256
 ds_read_b64_tr_b16 a[78:79], v14 offset:1280
 ds_read_b128 a[68:71], v10 offset:4096
 s_waitcnt lgkmcnt(4)
 s_waitcnt lgkmcnt(3)
 v_mfma_f32_32x32x16_bf16 a[0:15], a[72:75], a[64:67], 0
 ds_read_b64_tr_b16 a[88:89], v14 offset:4096
 ds_read_b64_tr_b16 a[90:91], v14 offset:5120
 s_add_u32 m0, s68, 65536
 s_nop 0
 buffer_load_dwordx4 v2, s[8:11], s64 offen lds
 s_waitcnt lgkmcnt(2)
 v_mfma_f32_32x32x16_bf16 a[16:31], a[72:75], a[68:71], 0
 ds_read_b128 a[80:83], v11 offset:0
 ds_read_b64_tr_b16 a[92:93], v14 offset:4352
 s_add_u32 m0, s68, 66560
 s_nop 0
 buffer_load_dwordx4 v3, s[8:11], s64 offen lds
 v_mfma_f32_32x32x16_bf16 a[32:47], a[76:79], a[64:67], 0
 ds_read_b64_tr_b16 a[94:95], v14 offset:5376
 ds_read_b128 a[84:87], v11 offset:4096
 s_add_u32 m0, s68, 67584
 s_nop 0
 buffer_load_dwordx4 v4, s[8:11], s64 offen lds
 v_mfma_f32_32x32x16_bf16 a[48:63], a[76:79], a[68:71], 0
 s_add_u32 m0, s68, 68608
 s_nop 0
 buffer_load_dwordx4 v5, s[8:11], s64 offen lds
 s_add_u32 s64, s64, 4096
 s_waitcnt lgkmcnt(4)
 s_waitcnt lgkmcnt(3)
 v_mfma_f32_32x32x16_bf16 a[0:15], a[88:91], a[80:83], a[0:15]
 ds_read_b64_tr_b16 a[72:73], v14 offset:8192
 ds_read_b64_tr_b16 a[74:75], v14 offset:9216
 s_add_u32 m0, s70, 65536
 s_nop 0
 buffer_load_dwordx4 v6, s[12:15], s65 offen lds
 s_waitcnt lgkmcnt(2)
 v_mfma_f32_32x32x16_bf16 a[16:31], a[88:91], a[84:87], a[16:31]
 ds_read_b128 a[64:67], v12 offset:0
 ds_read_b64_tr_b16 a[76:77], v14 offset:8448
 s_add_u32 m0, s71, 65536
 s_nop 0
 buffer_load_dwordx4 v7, s[12:15], s65 offen lds
 v_mfma_f32_32x32x16_bf16 a[32:47], a[92:95], a[80:83], a[32:47]
 ds_read_b64_tr_b16 a[78:79], v14 offset:9472
 ds_read_b128 a[68:71], v12 offset:4096
 s_add_u32 m0, s72, 65536
 s_nop 0
 buffer_load_dwordx4 v8, s[12:15], s65 offen lds
 v_mfma_f32_32x32x16_bf16 a[48:63], a[92:95], a[84:87], a[48:63]
 s_add_u32 m0, s73, 65536
 s_nop 0
 buffer_load_dwordx4 v9, s[12:15], s65 offen lds
 s_add_u32 s65, s65, 81920
 s_waitcnt lgkmcnt(4)
 s_waitcnt lgkmcnt(3)
 v_mfma_f32_32x32x16_bf16 a[0:15], a[72:75], a[64:67], a[0:15]
 ds_read_b64_tr_b16 a[88:89], v14 offset:12288
 ds_read_b64_tr_b16 a[90:91], v14 offset:13312
 s_add_u32 m0, s68, 98304
 s_nop 0
 buffer_load_dwordx4 v2, s[8:11], s64 offen lds
 s_waitcnt lgkmcnt(2)
 v_mfma_f32_32x32x16_bf16 a[16:31], a[72:75], a[68:71], a[16:31]
 ds_read_b128 a[80:83], v13 offset:0
 ds_read_b64_tr_b16 a[92:93], v14 offset:12544
 s_add_u32 m0, s68, 99328
 s_nop 0
 buffer_load_dwordx4 v3, s[8:11], s64 offen lds
 v_mfma_f32_32x32x16_bf16 a[32:47], a[76:79], a[64:67], a[32:47]
 ds_read_b64_tr_b16 a[94:95], v14 offset:13568
 ds_read_b128 a[84:87], v13 offset:4096
 s_add_u32 m0, s68, 100352
 s_nop 0
 buffer_load_dwordx4 v4, s[8:11], s64 offen lds
 v_mfma_f32_32x32x16_bf16 a[48:63], a[76:79], a[68:71], a[48:63]
 s_add_u32 m0, s68, 101376
 s_nop 0
 buffer_load_dwordx4 v5, s[8:11], s64 offen lds
 s_add_u32 s64, s64, 4096
 s_waitcnt lgkmcnt(4)
 s_waitcnt lgkmcnt(3)
 v_mfma_f32_32x32x16_bf16 a[0:15], a[88:91], a[80:83], a[0:15]
 s_waitcnt vmcnt(12)
 s_waitcnt lgkmcnt(0)
 s_barrier
 ds_read_b64_tr_b16 a[72:73], v14 offset:32768
 s_add_u32 m0, s70, 98304
 s_nop 0
 buffer_load_dwordx4 v6, s[12:15], s65 offen lds
 v_mfma_f32_32x32x16_bf16 a[16:31], a[88:91], a[84:87], a[16:31]
 ds_read_b64_tr_b16 a[74:75], v14 offset:33792
 ds_read_b128 a[64:67], v10 offset:32768
 s_add_u32 m0, s71, 98304
 s_nop 0
 buffer_load_dwordx4 v7, s[12:15], s65 offen lds
 v_mfma_f32_32x32x16_bf16 a[32:47], a[92:95], a[80:83], a[32:47]
 ds_read_b64_tr_b16 a[76:77], v14 offset:33024
 ds_read_b64_tr_b16 a[78:79], v14 offset:34048
 s_add_u32 m0, s72, 98304
 s_nop 0
 buffer_load_dwordx4 v8, s[12:15], s65 offen lds
 v_mfma_f32_32x32x16_bf16 a[48:63], a[92:95], a[84:87], a[48:63]
 ds_read_b128 a[68:71], v10 offset:36864
 s_add_u32 m0, s73, 98304
 s_nop 0
 buffer_load_dwordx4 v9, s[12:15], s65 offen lds
 s_add_u32 s65, s65, 81920
 s_waitcnt lgkmcnt(4)
 s_waitcnt lgkmcnt(3)
 v_mfma_f32_32x32x16_bf16 a[0:15], a[72:75], a[64:67], a[0:15]
 ds_read_b64_tr_b16 a[88:89], v14 offset:36864
 ds_read_b64_tr_b16 a[90:91], v14 offset:37888
 s_add_u32 m0, s68, 0
 s_nop 0
 buffer_load_dwordx4 v2, s[8:11], s64 offen lds
 s_waitcnt lgkmcnt(2)
 v_mfma_f32_32x32x16_bf16 a[16:31], a[72:75], a[68:71], a[16:31]
 ds_read_b128 a[80:83], v11 offset:32768
 ds_read_b64_tr_b16 a[92:93], v14 offset:37120
 s_add_u32 m0, s68, 1024
 s_nop 0
 buffer_load_dwordx4 v3, s[8:11], s64 offen lds
 v_mfma_f32_32x32x16_bf16 a[32:47], a[76:79], a[64:67], a[32:47]
 ds_read_b64_tr_b16 a[94:95], v14 offset:38144
 ds_read_b128 a[84:87], v11 offset:36864
 s_add_u32 m0, s68, 2048
 s_nop 0
 buffer_load_dwordx4 v4, s[8:11], s64 offen lds
 v_mfma_f32_32x32x16_bf16 a[48:63], a[76:79], a[68:71], a[48:63]
 s_add_u32 m0, s68, 3072
 s_nop 0
 buffer_load_dwordx4 v5, s[8:11], s64 offen lds
 s_add_u32 s64, s64, 4096
 s_waitcnt lgkmcnt(4)
 s_waitcnt lgkmcnt(3)
 v_mfma_f32_32x32x16_bf16 a[0:15], a[88:91], a[80:83], a[0:15]
 ds_read_b64_tr_b16 a[72:73], v14 offset:40960
 ds_read_b64_tr_b16 a[74:75], v14 offset:41984
 s_add_u32 m0, s70, 0
 s_nop 0
 buffer_load_dwordx4 v6, s[12:15], s65 offen lds
 s_waitcnt lgkmcnt(2)
 v_mfma_f32_32x32x16_bf16 a[16:31], a[88:91], a[84:87], a[16:31]
 ds_read_b128 a[64:67], v12 offset:32768
 ds_read_b64_tr_b16 a[76:77], v14 offset:41216
 s_add_u32 m0, s71, 0
 s_nop 0
 buffer_load_dwordx4 v7, s[12:15], s65 offen lds
 v_mfma_f32_32x32x16_bf16 a[32:47], a[92:95], a[80:83], a[32:47]
 ds_read_b64_tr_b16 a[78:79], v14 offset:42240
 ds_read_b128 a[68:71], v12 offset:36864
 s_add_u32 m0, s72, 0
 s_nop 0
 buffer_load_dwordx4 v8, s[12:15], s65 offen lds
 v_mfma_f32_32x32x16_bf16 a[48:63], a[92:95], a[84:87], a[48:63]
 s_add_u32 m0, s73, 0
 s_nop 0
 buffer_load_dwordx4 v9, s[12:15], s65 offen lds
 s_add_u32 s65, s65, 81920
 s_waitcnt lgkmcnt(4)
 s_waitcnt lgkmcnt(3)
 v_mfma_f32_32x32x16_bf16 a[0:15], a[72:75], a[64:67], a[0:15]
 ds_read_b64_tr_b16 a[88:89], v14 offset:45056
 ds_read_b64_tr_b16 a[90:91], v14 offset:46080
 s_waitcnt lgkmcnt(2)
 v_mfma_f32_32x32x16_bf16 a[16:31], a[72:75], a[68:71], a[16:31]
 ds_read_b128 a[80:83], v13 offset:32768
 ds_read_b64_tr_b16 a[92:93], v14 offset:45312
 v_mfma_f32_32x32x16_bf16 a[32:47], a[76:79], a[64:67], a[32:47]
 ds_read_b64_tr_b16 a[94:95], v14 offset:46336
 ds_read_b128 a[84:87], v13 offset:36864
 v_mfma_f32_32x32x16_bf16 a[48:63], a[76:79], a[68:71], a[48:63]
 s_waitcnt lgkmcnt(4)
 s_waitcnt lgkmcnt(3)
 v_mfma_f32_32x32x16_bf16 a[0:15], a[88:91], a[80:83], a[0:15]
 s_waitcnt vmcnt(16)
 s_waitcnt lgkmcnt(0)
 s_barrier
 ds_read_b64_tr_b16 a[72:73], v25 offset:0
 v_mfma_f32_32x32x16_bf16 a[16:31], a[88:91], a[84:87], a[16:31]
 ds_read_b64_tr_b16 a[74:75], v25 offset:1024
 ds_read_b128 a[64:67], v21 offset:0
 s_add_u32 m0, s68, 32768
 s_nop 0
 buffer_load_dwordx4 v2, s[8:11], s64 offen lds
 v_mfma_f32_32x32x16_bf16 a[32:47], a[92:95], a[80:83], a[32:47]
 ds_read_b64_tr_b16 a[76:77], v25 offset:256
 ds_read_b64_tr_b16 a[78:79], v25 offset:1280
 s_add_u32 m0, s68, 33792
 s_nop 0
 buffer_load_dwordx4 v3, s[8:11], s64 offen lds
 v_mfma_f32_32x32x16_bf16 a[48:63], a[92:95], a[84:87], a[48:63]
 ds_read_b128 a[68:71], v21 offset:4096
 s_waitcnt lgkmcnt(4)
 s_waitcnt lgkmcnt(3)
 v_mfma_f32_32x32x16_bf16 a[0:15], a[72:75], a[64:67], a[0:15]
 ds_read_b64_tr_b16 a[88:89], v25 offset:4096
 ds_read_b64_tr_b16 a[90:91], v25 offset:5120
 s_add_u32 m0, s68, 34816
 s_nop 0
 buffer_load_dwordx4 v4, s[8:11], s64 offen lds
 s_waitcnt lgkmcnt(2)
 v_mfma_f32_32x32x16_bf16 a[16:31], a[72:75], a[68:71], a[16:31]
 ds_read_b128 a[80:83], v22 offset:0
 ds_read_b64_tr_b16 a[92:93], v25 offset:4352
 v_mfma_f32_32x32x16_bf16 a[32:47], a[76:79], a[64:67], a[32:47]
 ds_read_b64_tr_b16 a[94:95], v25 offset:5376
 ds_read_b128 a[84:87], v22 offset:4096
 s_add_u32 m0, s68, 35840
 s_nop 0
 buffer_load_dwordx4 v5, s[8:11], s64 offen lds
 s_add_u32 s64, s64, 4096
 v_mfma_f32_32x32x16_bf16 a[48:63], a[76:79], a[68:71], a[48:63]
 s_waitcnt lgkmcnt(4)
 s_waitcnt lgkmcnt(3)
 v_mfma_f32_32x32x16_bf16 a[0:15], a[88:91], a[80:83], a[0:15]
 ds_read_b64_tr_b16 a[72:73], v25 offset:8192
 ds_read_b64_tr_b16 a[74:75], v25 offset:9216
 s_add_u32 m0, s70, 32768
 s_nop 0
 buffer_load_dwordx4 v6, s[12:15], s65 offen lds
 s_waitcnt lgkmcnt(2)
 v_mfma_f32_32x32x16_bf16 a[16:31], a[88:91], a[84:87], a[16:31]
 ds_read_b128 a[64:67], v23 offset:0
 ds_read_b64_tr_b16 a[76:77], v25 offset:8448
 v_mfma_f32_32x32x16_bf16 a[32:47], a[92:95], a[80:83], a[32:47]
 ds_read_b64_tr_b16 a[78:79], v25 offset:9472
 ds_read_b128 a[68:71], v23 offset:4096
 s_add_u32 m0, s71, 32768
 s_nop 0
 buffer_load_dwordx4 v7, s[12:15], s65 offen lds
 v_mfma_f32_32x32x16_bf16 a[48:63], a[92:95], a[84:87], a[48:63]
 s_waitcnt lgkmcnt(4)
 s_waitcnt lgkmcnt(3)
 v_mfma_f32_32x32x16_bf16 a[0:15], a[72:75], a[64:67], a[0:15]
 ds_read_b64_tr_b16 a[88:89], v25 offset:12288
 ds_read_b64_tr_b16 a[90:91], v25 offset:13312
 s_add_u32 m0, s72, 32768
 s_nop 0
 buffer_load_dwordx4 v8, s[12:15], s65 offen lds
 s_waitcnt lgkmcnt(2)
 v_mfma_f32_32x32x16_bf16 a[16:31], a[72:75], a[68:71], a[16:31]
 ds_read_b128 a[80:83], v24 offset:0
 ds_read_b64_tr_b16 a[92:93], v25 offset:12544
 v_mfma_f32_32x32x16_bf16 a[32:47], a[76:79], a[64:67], a[32:47]
 ds_read_b64_tr_b16 a[94:95], v25 offset:13568
 ds_read_b128 a[84:87], v24 offset:4096
 s_add_u32 m0, s73, 32768
 s_nop 0
 buffer_load_dwordx4 v9, s[12:15], s65 offen lds
 s_add_u32 s65, s65, 81920
 v_mfma_f32_32x32x16_bf16 a[48:63], a[76:79], a[68:71], a[48:63]
 s_waitcnt lgkmcnt(4)
 s_waitcnt lgkmcnt(3)
 v_mfma_f32_32x32x16_bf16 a[0:15], a[88:91], a[80:83], a[0:15]
 s_waitcnt vmcnt(16)
 s_waitcnt lgkmcnt(0)
 s_barrier
 ds_read_b64_tr_b16 a[72:73], v25 offset:32768
 v_mfma_f32_32x32x16_bf16 a[16:31], a[88:91], a[84:87], a[16:31]
 ds_read_b64_tr_b16 a[74:75], v25 offset:33792
 ds_read_b128 a[64:67], v21 offset:32768
 s_add_u32 m0, s68, 65536
 s_nop 0
 buffer_load_dwordx4 v2, s[8:11], s64 offen lds
 v_mfma_f32_32x32x16_bf16 a[32:47], a[92:95], a[80:83], a[32:47]
 ds_read_b64_tr_b16 a[76:77], v25 offset:33024
 ds_read_b64_tr_b16 a[78:79], v25 offset:34048
 s_add_u32 m0, s68, 66560
 s_nop 0
 buffer_load_dwordx4 v3, s[8:11], s64 offen lds
 v_mfma_f32_32x32x16_bf16 a[48:63], a[92:95], a[84:87], a[48:63]
 ds_read_b128 a[68:71], v21 offset:36864
 s_waitcnt lgkmcnt(4)
 s_waitcnt lgkmcnt(3)
 v_mfma_f32_32x32x16_bf16 a[0:15], a[72:75], a[64:67], a[0:15]
 ds_read_b64_tr_b16 a[88:89], v25 offset:36864
 ds_read_b64_tr_b16 a[90:91], v25 offset:37888
 s_add_u32 m0, s68, 67584
 s_nop 0
 buffer_load_dwordx4 v4, s[8:11], s64 offen lds
 s_waitcnt lgkmcnt(2)
 v_mfma_f32_32x32x16_bf16 a[16:31], a[72:75], a[68:71], a[16:31]
 ds_read_b128 a[80:83], v22 offset:32768
 ds_read_b64_tr_b16 a[92:93], v25 offset:37120
 v_mfma_f32_32x32x16_bf16 a[32:47], a[76:79], a[64:67], a[32:47]
 ds_read_b64_tr_b16 a[94:95], v25 offset:38144
 ds_read_b128 a[84:87], v22 offset:36864
 s_add_u32 m0, s68, 68608
 s_nop 0
 buffer_load_dwordx4 v5, s[8:11], s64 offen lds
 s_add_u32 s64, s64, 4096
 v_mfma_f32_32x32x16_bf16 a[48:63], a[76:79], a[68:71], a[48:63]
 s_waitcnt lgkmcnt(4)
 s_waitcnt lgkmcnt(3)
 v_mfma_f32_32x32x16_bf16 a[0:15], a[88:91], a[80:83], a[0:15]
 ds_read_b64_tr_b16 a[72:73], v25 offset:40960
 ds_read_b64_tr_b16 a[74:75], v25 offset:41984
 s_add_u32 m0, s70, 65536
 s_nop 0
 buffer_load_dwordx4 v6, s[12:15], s65 offen lds
 s_waitcnt lgkmcnt(2)
 v_mfma_f32_32x32x16_bf16 a[16:31], a[88:91], a[84:87], a[16:31]
 ds_read_b128 a[64:67], v23 offset:32768
 ds_read_b64_tr_b16 a[76:77], v25 offset:41216
 v_mfma_f32_32x32x16_bf16 a[32:47], a[92:95], a[80:83], a[32:47]
 ds_read_b64_tr_b16 a[78:79], v25 offset:42240
 ds_read_b128 a[68:71], v23 offset:36864
 s_add_u32 m0, s71, 65536
 s_nop 0
 buffer_load_dwordx4 v7, s[12:15], s65 offen lds
 v_mfma_f32_32x32x16_bf16 a[48:63], a[92:95], a[84:87], a[48:63]
 s_waitcnt lgkmcnt(4)
 s_waitcnt lgkmcnt(3)
 v_mfma_f32_32x32x16_bf16 a[0:15], a[72:75], a[64:67], a[0:15]
 ds_read_b64_tr_b16 a[88:89], v25 offset:45056
 ds_read_b64_tr_b16 a[90:91], v25 offset:46080
 s_add_u32 m0, s72, 65536
 s_nop 0
 buffer_load_dwordx4 v8, s[12:15], s65 offen lds
 s_waitcnt lgkmcnt(2)
 v_mfma_f32_32x32x16_bf16 a[16:31], a[72:75], a[68:71], a[16:31]
 ds_read_b128 a[80:83], v24 offset:32768
 ds_read_b64_tr_b16 a[92:93], v25 offset:45312
 v_mfma_f32_32x32x16_bf16 a[32:47], a[76:79], a[64:67], a[32:47]
 ds_read_b64_tr_b16 a[94:95], v25 offset:46336
 ds_read_b128 a[84:87], v24 offset:36864
 s_add_u32 m0, s73, 65536
 s_nop 0
 buffer_load_dwordx4 v9, s[12:15], s65 offen lds
 s_add_u32 s65, s65, 81920
 v_mfma_f32_32x32x16_bf16 a[48:63], a[76:79], a[68:71], a[48:63]
 s_waitcnt lgkmcnt(4)
 s_waitcnt lgkmcnt(3)
 v_mfma_f32_32x32x16_bf16 a[0:15], a[88:91], a[80:83], a[0:15]
 s_waitcnt vmcnt(16)
 s_waitcnt lgkmcnt(0)
 s_barrier
 ds_read_b64_tr_b16 a[72:73], v14 offset:0
 v_mfma_f32_32x32x16_bf16 a[16:31], a[88:91], a[84:87], a[16:31]
 ds_read_b64_tr_b16 a[74:75], v14 offset:1024
 ds_read_b128 a[64:67], v10 offset:0
 s_add_u32 m0, s68, 98304
 s_nop 0
 buffer_load_dwordx4 v2, s[8:11], s64 offen lds
 v_mfma_f32_32x32x16_bf16 a[32:47], a[92:95], a[80:83], a[32:47]
 ds_read_b64_tr_b16 a[76:77], v14 offset:256
 ds_read_b64_tr_b16 a[78:79], v14 offset:1280
 s_add_u32 m0, s68, 99328
 s_nop 0
 buffer_load_dwordx4 v3, s[8:11], s64 offen lds
 v_mfma_f32_32x32x16_bf16 a[48:63], a[92:95], a[84:87], a[48:63]
 ds_read_b128 a[68:71], v10 offset:4096
 s_mov_b32 s80, 6
mid_kernel_kloop5:
 s_waitcnt lgkmcnt(4)
 s_waitcnt lgkmcnt(3)
 v_mfma_f32_32x32x16_bf16 a[0:15], a[72:75], a[64:67], a[0:15]
 ds_read_b64_tr_b16 a[88:89], v14 offset:4096
 ds_read_b64_tr_b16 a[90:91], v14 offset:5120
 s_add_u32 m0, s68, 100352
 s_nop 0
 buffer_load_dwordx4 v4, s[8:11], s64 offen lds
 s_waitcnt lgkmcnt(2)
 v_mfma_f32_32x32x16_bf16 a[16:31], a[72:75], a[68:71], a[16:31]
 ds_read_b128 a[80:83], v11 offset:0
 ds_read_b64_tr_b16 a[92:93], v14 offset:4352
 v_mfma_f32_32x32x16_bf16 a[32:47], a[76:79], a[64:67], a[32:47]
 ds_read_b64_tr_b16 a[94:95], v14 offset:5376
 ds_read_b128 a[84:87], v11 offset:4096
 s_add_u32 m0, s68, 101376
 s_nop 0
 buffer_load_dwordx4 v5, s[8:11], s64 offen lds
 s_add_u32 s64, s64, 4096
 v_mfma_f32_32x32x16_bf16 a[48:63], a[76:79], a[68:71], a[48:63]
 s_waitcnt lgkmcnt(4)
 s_waitcnt lgkmcnt(3)
 v_mfma_f32_32x32x16_bf16 a[0:15], a[88:91], a[80:83], a[0:15]
 ds_read_b64_tr_b16 a[72:73], v14 offset:8192
 ds_read_b64_tr_b16 a[74:75], v14 offset:9216
 s_add_u32 m0, s70, 98304
 s_nop 0
 buffer_load_dwordx4 v6, s[12:15], s65 offen lds
 s_waitcnt lgkmcnt(2)
 v_mfma_f32_32x32x16_bf16 a[16:31], a[88:91], a[84:87], a[16:31]
 ds_read_b128 a[64:67], v12 offset:0
 ds_read_b64_tr_b16 a[76:77], v14 offset:8448
 v_mfma_f32_32x32x16_bf16 a[32:47], a[92:95], a[80:83], a[32:47]
 ds_read_b64_tr_b16 a[78:79], v14 offset:9472
 ds_read_b128 a[68:71], v12 offset:4096
 s_add_u32 m0, s71, 98304
 s_nop 0
 buffer_load_dwordx4 v7, s[12:15], s65 offen lds
 v_mfma_f32_32x32x16_bf16 a[48:63], a[92:95], a[84:87], a[48:63]
 s_waitcnt lgkmcnt(4)
 s_waitcnt lgkmcnt(3)
 v_mfma_f32_32x32x16_bf16 a[0:15], a[72:75], a[64:67], a[0:15]
 ds_read_b64_tr_b16 a[88:89], v14 offset:12288
 ds_read_b64_tr_b16 a[90:91], v14 offset:13312
 s_add_u32 m0, s72, 98304
 s_nop 0
 buffer_load_dwordx4 v8, s[12:15], s65 offen lds
 s_waitcnt lgkmcnt(2)
 v_mfma_f32_32x32x16_bf16 a[16:31], a[72:75], a[68:71], a[16:31]
 ds_read_b128 a[80:83], v13 offset:0
 ds_read_b64_tr_b16 a[92:93], v14 offset:12544
 v_mfma_f32_32x32x16_bf16 a[32:47], a[76:79], a[64:67], a[32:47]
 ds_read_b64_tr_b16 a[94:95], v14 offset:13568
 ds_read_b128 a[84:87], v13 offset:4096
 s_add_u32 m0, s73, 98304
 s_nop 0
 buffer_load_dwordx4 v9, s[12:15], s65 offen lds
 s_add_u32 s65, s65, 81920
 v_mfma_f32_32x32x16_bf16 a[48:63], a[76:79], a[68:71], a[48:63]
 s_waitcnt lgkmcnt(4)
 s_waitcnt lgkmcnt(3)
 v_mfma_f32_32x32x16_bf16 a[0:15], a[88:91], a[80:83], a[0:15]
 s_waitcnt vmcnt(16)
 s_waitcnt lgkmcnt(0)
 s_barrier
 ds_read_b64_tr_b16 a[72:73], v14 offset:32768
 v_mfma_f32_32x32x16_bf16 a[16:31], a[88:91], a[84:87], a[16:31]
 ds_read_b64_tr_b16 a[74:75], v14 offset:33792
 ds_read_b128 a[64:67], v10 offset:32768
 s_add_u32 m0, s68, 0
 s_nop 0
 buffer_load_dwordx4 v2, s[8:11], s64 offen lds
 v_mfma_f32_32x32x16_bf16 a[32:47], a[92:95], a[80:83], a[32:47]
 ds_read_b64_tr_b16 a[76:77], v14 offset:33024
 ds_read_b64_tr_b16 a[78:79], v14 offset:34048
 s_add_u32 m0, s68, 1024
 s_nop 0
 buffer_load_dwordx4 v3, s[8:11], s64 offen lds
 v_mfma_f32_32x32x16_bf16 a[48:63], a[92:95], a[84:87], a[48:63]
 ds_read_b128 a[68:71], v10 offset:36864
 s_waitcnt lgkmcnt(4)
 s_waitcnt lgkmcnt(3)
 v_mfma_f32_32x32x16_bf16 a[0:15], a[72:75], a[64:67], a[0:15]
 ds_read_b64_tr_b16 a[88:89], v14 offset:36864
 ds_read_b64_tr_b16 a[90:91], v14 offset:37888
 s_add_u32 m0, s68, 2048
 s_nop 0
 buffer_load_dwordx4 v4, s[8:11], s64 offen lds
 s_waitcnt lgkmcnt(2)
 v_mfma_f32_32x32x16_bf16 a[16:31], a[72:75], a[68:71], a[16:31]
 ds_read_b128 a[80:83], v11 offset:32768
 ds_read_b64_tr_b16 a[92:93], v14 offset:37120
 v_mfma_f32_32x32x16_bf16 a[32:47], a[76:79], a[64:67], a[32:47]
 ds_read_b64_tr_b16 a[94:95], v14 offset:38144
 ds_read_b128 a[84:87], v11 offset:36864
 s_add_u32 m0, s68, 3072
 s_nop 0
 buffer_load_dwordx4 v5, s[8:11], s64 offen lds
 s_add_u32 s64, s64, 4096
 v_mfma_f32_32x32x16_bf16 a[48:63], a[76:79], a[68:71], a[48:63]
 s_waitcnt lgkmcnt(4)
 s_waitcnt lgkmcnt(3)
 v_mfma_f32_32x32x16_bf16 a[0:15], a[88:91], a[80:83], a[0:15]
 ds_read_b64_tr_b16 a[72:73], v14 offset:40960
 ds_read_b64_tr_b16 a[74:75], v14 offset:41984
 s_add_u32 m0, s70, 0
 s_nop 0
 buffer_load_dwordx4 v6, s[12:15], s65 offen lds
 s_waitcnt lgkmcnt(2)
 v_mfma_f32_32x32x16_bf16 a[16:31], a[88:91], a[84:87], a[16:31]
 ds_read_b128 a[64:67], v12 offset:32768
 ds_read_b64_tr_b16 a[76:77], v14 offset:41216
 v_mfma_f32_32x32x16_bf16 a[32:47], a[92:95], a[80:83], a[32:47]
 ds_read_b64_tr_b16 a[78:79], v14 offset:42240
 ds_read_b128 a[68:71], v12 offset:36864
 s_add_u32 m0, s71, 0
 s_nop 0
 buffer_load_dwordx4 v7, s[12:15], s65 offen lds
 v_mfma_f32_32x32x16_bf16 a[48:63], a[92:95], a[84:87], a[48:63]
 s_waitcnt lgkmcnt(4)
 s_waitcnt lgkmcnt(3)
 v_mfma_f32_32x32x16_bf16 a[0:15], a[72:75], a[64:67], a[0:15]
 ds_read_b64_tr_b16 a[88:89], v14 offset:45056
 ds_read_b64_tr_b16 a[90:91], v14 offset:46080
 s_add_u32 m0, s72, 0
 s_nop 0
 buffer_load_dwordx4 v8, s[12:15], s65 offen lds
 s_waitcnt lgkmcnt(2)
 v_mfma_f32_32x32x16_bf16 a[16:31], a[72:75], a[68:71], a[16:31]
 ds_read_b128 a[80:83], v13 offset:32768
 ds_read_b64_tr_b16 a[92:93], v14 offset:45312
 v_mfma_f32_32x32x16_bf16 a[32:47], a[76:79], a[64:67], a[32:47]
 ds_read_b64_tr_b16 a[94:95], v14 offset:46336
 ds_read_b128 a[84:87], v13 offset:36864
 s_add_u32 m0, s73, 0
 s_nop 0
 buffer_load_dwordx4 v9, s[12:15], s65 offen lds
 s_add_u32 s65, s65, 81920
 v_mfma_f32_32x32x16_bf16 a[48:63], a[76:79], a[68:71], a[48:63]
 s_waitcnt lgkmcnt(4)
 s_waitcnt lgkmcnt(3)
 v_mfma_f32_32x32x16_bf16 a[0:15], a[88:91], a[80:83], a[0:15]
 s_waitcnt vmcnt(16)
 s_waitcnt lgkmcnt(0)
 s_barrier
 ds_read_b64_tr_b16 a[72:73], v25 offset:0
 v_mfma_f32_32x32x16_bf16 a[16:31], a[88:91], a[84:87], a[16:31]
 ds_read_b64_tr_b16 a[74:75], v25 offset:1024
 ds_read_b128 a[64:67], v21 offset:0
 s_add_u32 m0, s68, 32768
 s_nop 0
 buffer_load_dwordx4 v2, s[8:11], s64 offen lds
 v_mfma_f32_32x32x16_bf16 a[32:47], a[92:95], a[80:83], a[32:47]
 ds_read_b64_tr_b16 a[76:77], v25 offset:256
 ds_read_b64_tr_b16 a[78:79], v25 offset:1280
 s_add_u32 m0, s68, 33792
 s_nop 0
 buffer_load_dwordx4 v3, s[8:11], s64 offen lds
 v_mfma_f32_32x32x16_bf16 a[48:63], a[92:95], a[84:87], a[48:63]
 ds_read_b128 a[68:71], v21 offset:4096
 s_waitcnt lgkmcnt(4)
 s_waitcnt lgkmcnt(3)
 v_mfma_f32_32x32x16_bf16 a[0:15], a[72:75], a[64:67], a[0:15]
 ds_read_b64_tr_b16 a[88:89], v25 offset:4096
 ds_read_b64_tr_b16 a[90:91], v25 offset:5120
 s_add_u32 m0, s68, 34816
 s_nop 0
 buffer_load_dwordx4 v4, s[8:11], s64 offen lds
 s_waitcnt lgkmcnt(2)
 v_mfma_f32_32x32x16_bf16 a[16:31], a[72:75], a[68:71], a[16:31]
 ds_read_b128 a[80:83], v22 offset:0
 ds_read_b64_tr_b16 a[92:93], v25 offset:4352
 v_mfma_f32_32x32x16_bf16 a[32:47], a[76:79], a[64:67], a[32:47]
 ds_read_b64_tr_b16 a[94:95], v25 offset:5376
 ds_read_b128 a[84:87], v22 offset:4096
 s_add_u32 m0, s68, 35840
 s_nop 0
 buffer_load_dwordx4 v5, s[8:11], s64 offen lds
 s_add_u32 s64, s64, 4096
 v_mfma_f32_32x32x16_bf16 a[48:63], a[76:79], a[68:71], a[48:63]
 s_waitcnt lgkmcnt(4)
 s_waitcnt lgkmcnt(3)
 v_mfma_f32_32x32x16_bf16 a[0:15], a[88:91], a[80:83], a[0:15]
 ds_read_b64_tr_b16 a[72:73], v25 offset:8192
 ds_read_b64_tr_b16 a[74:75], v25 offset:9216
 s_add_u32 m0, s70, 32768
 s_nop 0
 buffer_load_dwordx4 v6, s[12:15], s65 offen lds
 s_waitcnt lgkmcnt(2)
 v_mfma_f32_32x32x16_bf16 a[16:31], a[88:91], a[84:87], a[16:31]
 ds_read_b128 a[64:67], v23 offset:0
 ds_read_b64_tr_b16 a[76:77], v25 offset:8448
 v_mfma_f32_32x32x16_bf16 a[32:47], a[92:95], a[80:83], a[32:47]
 ds_read_b64_tr_b16 a[78:79], v25 offset:9472
 ds_read_b128 a[68:71], v23 offset:4096
 s_add_u32 m0, s71, 32768
 s_nop 0
 buffer_load_dwordx4 v7, s[12:15], s65 offen lds
 v_mfma_f32_32x32x16_bf16 a[48:63], a[92:95], a[84:87], a[48:63]
 s_waitcnt lgkmcnt(4)
 s_waitcnt lgkmcnt(3)
 v_mfma_f32_32x32x16_bf16 a[0:15], a[72:75], a[64:67], a[0:15]
 ds_read_b64_tr_b16 a[88:89], v25 offset:12288
 ds_read_b64_tr_b16 a[90:91], v25 offset:13312
 s_add_u32 m0, s72, 32768
 s_nop 0
 buffer_load_dwordx4 v8, s[12:15], s65 offen lds
 s_waitcnt lgkmcnt(2)
 v_mfma_f32_32x32x16_bf16 a[16:31], a[72:75], a[68:71], a[16:31]
 ds_read_b128 a[80:83], v24 offset:0
 ds_read_b64_tr_b16 a[92:93], v25 offset:12544
 v_mfma_f32_32x32x16_bf16 a[32:47], a[76:79], a[64:67], a[32:47]
 ds_read_b64_tr_b16 a[94:95], v25 offset:13568
 ds_read_b128 a[84:87], v24 offset:4096
 s_add_u32 m0, s73, 32768
 s_nop 0
 buffer_load_dwordx4 v9, s[12:15], s65 offen lds
 s_add_u32 s65, s65, 81920
 v_mfma_f32_32x32x16_bf16 a[48:63], a[76:79], a[68:71], a[48:63]
 s_waitcnt lgkmcnt(4)
 s_waitcnt lgkmcnt(3)
 v_mfma_f32_32x32x16_bf16 a[0:15], a[88:91], a[80:83], a[0:15]
 s_waitcnt vmcnt(16)
 s_waitcnt lgkmcnt(0)
 s_barrier
 ds_read_b64_tr_b16 a[72:73], v25 offset:32768
 v_mfma_f32_32x32x16_bf16 a[16:31], a[88:91], a[84:87], a[16:31]
 ds_read_b64_tr_b16 a[74:75], v25 offset:33792
 ds_read_b128 a[64:67], v21 offset:32768
 s_add_u32 m0, s68, 65536
 s_nop 0
 buffer_load_dwordx4 v2, s[8:11], s64 offen lds
 v_mfma_f32_32x32x16_bf16 a[32:47], a[92:95], a[80:83], a[32:47]
 ds_read_b64_tr_b16 a[76:77], v25 offset:33024
 ds_read_b64_tr_b16 a[78:79], v25 offset:34048
 s_add_u32 m0, s68, 66560
 s_nop 0
 buffer_load_dwordx4 v3, s[8:11], s64 offen lds
 v_mfma_f32_32x32x16_bf16 a[48:63], a[92:95], a[84:87], a[48:63]
 ds_read_b128 a[68:71], v21 offset:36864
 s_waitcnt lgkmcnt(4)
 s_waitcnt lgkmcnt(3)
 v_mfma_f32_32x32x16_bf16 a[0:15], a[72:75], a[64:67], a[0:15]
 ds_read_b64_tr_b16 a[88:89], v25 offset:36864
 ds_read_b64_tr_b16 a[90:91], v25 offset:37888
 s_add_u32 m0, s68, 67584
 s_nop 0
 buffer_load_dwordx4 v4, s[8:11], s64 offen lds
 s_waitcnt lgkmcnt(2)
 v_mfma_f32_32x32x16_bf16 a[16:31], a[72:75], a[68:71], a[16:31]
 ds_read_b128 a[80:83], v22 offset:32768
 ds_read_b64_tr_b16 a[92:93], v25 offset:37120
 v_mfma_f32_32x32x16_bf16 a[32:47], a[76:79], a[64:67], a[32:47]
 ds_read_b64_tr_b16 a[94:95], v25 offset:38144
 ds_read_b128 a[84:87], v22 offset:36864
 s_add_u32 m0, s68, 68608
 s_nop 0
 buffer_load_dwordx4 v5, s[8:11], s64 offen lds
 s_add_u32 s64, s64, 4096
 v_mfma_f32_32x32x16_bf16 a[48:63], a[76:79], a[68:71], a[48:63]
 s_waitcnt lgkmcnt(4)
 s_waitcnt lgkmcnt(3)
 v_mfma_f32_32x32x16_bf16 a[0:15], a[88:91], a[80:83], a[0:15]
 ds_read_b64_tr_b16 a[72:73], v25 offset:40960
 ds_read_b64_tr_b16 a[74:75], v25 offset:41984
 s_add_u32 m0, s70, 65536
 s_nop 0
 buffer_load_dwordx4 v6, s[12:15], s65 offen lds
 s_waitcnt lgkmcnt(2)
 v_mfma_f32_32x32x16_bf16 a[16:31], a[88:91], a[84:87], a[16:31]
 ds_read_b128 a[64:67], v23 offset:32768
 ds_read_b64_tr_b16 a[76:77], v25 offset:41216
 v_mfma_f32_32x32x16_bf16 a[32:47], a[92:95], a[80:83], a[32:47]
 ds_read_b64_tr_b16 a[78:79], v25 offset:42240
 ds_read_b128 a[68:71], v23 offset:36864
 s_add_u32 m0, s71, 65536
 s_nop 0
 buffer_load_dwordx4 v7, s[12:15], s65 offen lds
 v_mfma_f32_32x32x16_bf16 a[48:63], a[92:95], a[84:87], a[48:63]
 s_waitcnt lgkmcnt(4)
 s_waitcnt lgkmcnt(3)
 v_mfma_f32_32x32x16_bf16 a[0:15], a[72:75], a[64:67], a[0:15]
 ds_read_b64_tr_b16 a[88:89], v25 offset:45056
 ds_read_b64_tr_b16 a[90:91], v25 offset:46080
 s_add_u32 m0, s72, 65536
 s_nop 0
 buffer_load_dwordx4 v8, s[12:15], s65 offen lds
 s_waitcnt lgkmcnt(2)
 v_mfma_f32_32x32x16_bf16 a[16:31], a[72:75], a[68:71], a[16:31]
 ds_read_b128 a[80:83], v24 offset:32768
 ds_read_b64_tr_b16 a[92:93], v25 offset:45312
 v_mfma_f32_32x32x16_bf16 a[32:47], a[76:79], a[64:67], a[32:47]
 ds_read_b64_tr_b16 a[94:95], v25 offset:46336
 ds_read_b128 a[84:87], v24 offset:36864
 s_add_u32 m0, s73, 65536
 s_nop 0
 buffer_load_dwordx4 v9, s[12:15], s65 offen lds
 s_add_u32 s65, s65, 81920
 v_mfma_f32_32x32x16_bf16 a[48:63], a[76:79], a[68:71], a[48:63]
 s_waitcnt lgkmcnt(4)
 s_waitcnt lgkmcnt(3)
 v_mfma_f32_32x32x16_bf16 a[0:15], a[88:91], a[80:83], a[0:15]
 s_waitcnt vmcnt(16)
 s_waitcnt lgkmcnt(0)
 s_barrier
 ds_read_b64_tr_b16 a[72:73], v14 offset:0
 v_mfma_f32_32x32x16_bf16 a[16:31], a[88:91], a[84:87], a[16:31]
 ds_read_b64_tr_b16 a[74:75], v14 offset:1024
 ds_read_b128 a[64:67], v10 offset:0
 s_add_u32 m0, s68, 98304
 s_nop 0
 buffer_load_dwordx4 v2, s[8:11], s64 offen lds
 v_mfma_f32_32x32x16_bf16 a[32:47], a[92:95], a[80:83], a[32:47]
 ds_read_b64_tr_b16 a[76:77], v14 offset:256
 ds_read_b64_tr_b16 a[78:79], v14 offset:1280
 s_add_u32 m0, s68, 99328
 s_nop 0
 buffer_load_dwordx4 v3, s[8:11], s64 offen lds
 v_mfma_f32_32x32x16_bf16 a[48:63], a[92:95], a[84:87], a[48:63]
 ds_read_b128 a[68:71], v10 offset:4096
 s_sub_u32 s80, s80, 1
 s_cmp_lg_u32 s80, 0
 s_cbranch_scc1 mid_kernel_kloop5
 s_waitcnt lgkmcnt(4)
 s_waitcnt lgkmcnt(3)
 v_mfma_f32_32x32x16_bf16 a[0:15], a[72:75], a[64:67], a[0:15]
 ds_read_b64_tr_b16 a[88:89], v14 offset:4096
 ds_read_b64_tr_b16 a[90:91], v14 offset:5120
 s_add_u32 m0, s68, 100352
 s_nop 0
 buffer_load_dwordx4 v4, s[8:11], s64 offen lds
 s_waitcnt lgkmcnt(2)
 v_mfma_f32_32x32x16_bf16 a[16:31], a[72:75], a[68:71], a[16:31]
 ds_read_b128 a[80:83], v11 offset:0
 ds_read_b64_tr_b16 a[92:93], v14 offset:4352
 v_mfma_f32_32x32x16_bf16 a[32:47], a[76:79], a[64:67], a[32:47]
 ds_read_b64_tr_b16 a[94:95], v14 offset:5376
 ds_read_b128 a[84:87], v11 offset:4096
 s_add_u32 m0, s68, 101376
 s_nop 0
 buffer_load_dwordx4 v5, s[8:11], s64 offen lds
 s_add_u32 s64, s64, 4096
 v_mfma_f32_32x32x16_bf16 a[48:63], a[76:79], a[68:71], a[48:63]
 s_waitcnt lgkmcnt(4)
 s_waitcnt lgkmcnt(3)
 v_mfma_f32_32x32x16_bf16 a[0:15], a[88:91], a[80:83], a[0:15]
 ds_read_b64_tr_b16 a[72:73], v14 offset:8192
 ds_read_b64_tr_b16 a[74:75], v14 offset:9216
 s_add_u32 m0, s70, 98304
 s_nop 0
 buffer_load_dwordx4 v6, s[12:15], s65 offen lds
 s_waitcnt lgkmcnt(2)
 v_mfma_f32_32x32x16_bf16 a[16:31], a[88:91], a[84:87], a[16:31]
 ds_read_b128 a[64:67], v12 offset:0
 ds_read_b64_tr_b16 a[76:77], v14 offset:8448
 v_mfma_f32_32x32x16_bf16 a[32:47], a[92:95], a[80:83], a[32:47]
 ds_read_b64_tr_b16 a[78:79], v14 offset:9472
 ds_read_b128 a[68:71], v12 offset:4096
 s_add_u32 m0, s71, 98304
 s_nop 0
 buffer_load_dwordx4 v7, s[12:15], s65 offen lds
 v_mfma_f32_32x32x16_bf16 a[48:63], a[92:95], a[84:87], a[48:63]
 s_waitcnt lgkmcnt(4)
 s_waitcnt lgkmcnt(3)
 v_mfma_f32_32x32x16_bf16 a[0:15], a[72:75], a[64:67], a[0:15]
 ds_read_b64_tr_b16 a[88:89], v14 offset:12288
 ds_read_b64_tr_b16 a[90:91], v14 offset:13312
 s_add_u32 m0, s72, 98304
 s_nop 0
 buffer_load_dwordx4 v8, s[12:15], s65 offen lds
 s_waitcnt lgkmcnt(2)
 v_mfma_f32_32x32x16_bf16 a[16:31], a[72:75], a[68:71], a[16:31]
 ds_read_b128 a[80:83], v13 offset:0
 ds_read_b64_tr_b16 a[92:93], v14 offset:12544
 v_mfma_f32_32x32x16_bf16 a[32:47], a[76:79], a[64:67], a[32:47]
 ds_read_b64_tr_b16 a[94:95], v14 offset:13568
 ds_read_b128 a[84:87], v13 offset:4096
 s_add_u32 m0, s73, 98304
 s_nop 0
 buffer_load_dwordx4 v9, s[12:15], s65 offen lds
 s_add_u32 s65, s65, 81920
 v_mfma_f32_32x32x16_bf16 a[48:63], a[76:79], a[68:71], a[48:63]
 s_waitcnt lgkmcnt(4)
 s_waitcnt lgkmcnt(3)
 v_mfma_f32_32x32x16_bf16 a[0:15], a[88:91], a[80:83], a[0:15]
 s_waitcnt vmcnt(16)
 s_waitcnt lgkmcnt(0)
 s_barrier
 ds_read_b64_tr_b16 a[72:73], v14 offset:32768
 v_mfma_f32_32x32x16_bf16 a[16:31], a[88:91], a[84:87], a[16:31]
 ds_read_b64_tr_b16 a[74:75], v14 offset:33792
 ds_read_b128 a[64:67], v10 offset:32768
 v_mfma_f32_32x32x16_bf16 a[32:47], a[92:95], a[80:83], a[32:47]
 ds_read_b64_tr_b16 a[76:77], v14 offset:33024
 ds_read_b64_tr_b16 a[78:79], v14 offset:34048
 v_mfma_f32_32x32x16_bf16 a[48:63], a[92:95], a[84:87], a[48:63]
 ds_read_b128 a[68:71], v10 offset:36864
 s_waitcnt lgkmcnt(4)
 s_waitcnt lgkmcnt(3)
 v_mfma_f32_32x32x16_bf16 a[0:15], a[72:75], a[64:67], a[0:15]
 ds_read_b64_tr_b16 a[88:89], v14 offset:36864
 ds_read_b64_tr_b16 a[90:91], v14 offset:37888
 s_waitcnt lgkmcnt(2)
 v_mfma_f32_32x32x16_bf16 a[16:31], a[72:75], a[68:71], a[16:31]
 ds_read_b128 a[80:83], v11 offset:32768
 ds_read_b64_tr_b16 a[92:93], v14 offset:37120
 v_mfma_f32_32x32x16_bf16 a[32:47], a[76:79], a[64:67], a[32:47]
 ds_read_b64_tr_b16 a[94:95], v14 offset:38144
 ds_read_b128 a[84:87], v11 offset:36864
 v_mfma_f32_32x32x16_bf16 a[48:63], a[76:79], a[68:71], a[48:63]
 s_waitcnt lgkmcnt(4)
 s_waitcnt lgkmcnt(3)
 v_mfma_f32_32x32x16_bf16 a[0:15], a[88:91], a[80:83], a[0:15]
 ds_read_b64_tr_b16 a[72:73], v14 offset:40960
 ds_read_b64_tr_b16 a[74:75], v14 offset:41984
 s_waitcnt lgkmcnt(2)
 v_mfma_f32_32x32x16_bf16 a[16:31], a[88:91], a[84:87], a[16:31]
 ds_read_b128 a[64:67], v12 offset:32768
 ds_read_b64_tr_b16 a[76:77], v14 offset:41216
 v_mfma_f32_32x32x16_bf16 a[32:47], a[92:95], a[80:83], a[32:47]
 ds_read_b64_tr_b16 a[78:79], v14 offset:42240
 ds_read_b128 a[68:71], v12 offset:36864
 v_mfma_f32_32x32x16_bf16 a[48:63], a[92:95], a[84:87], a[48:63]
 s_waitcnt lgkmcnt(4)
 s_waitcnt lgkmcnt(3)
 v_mfma_f32_32x32x16_bf16 a[0:15], a[72:75], a[64:67], a[0:15]
 ds_read_b64_tr_b16 a[88:89], v14 offset:45056
 ds_read_b64_tr_b16 a[90:91], v14 offset:46080
 s_waitcnt lgkmcnt(2)
 v_mfma_f32_32x32x16_bf16 a[16:31], a[72:75], a[68:71], a[16:31]
 ds_read_b128 a[80:83], v13 offset:32768
 ds_read_b64_tr_b16 a[92:93], v14 offset:45312
 v_mfma_f32_32x32x16_bf16 a[32:47], a[76:79], a[64:67], a[32:47]
 ds_read_b64_tr_b16 a[94:95], v14 offset:46336
 ds_read_b128 a[84:87], v13 offset:36864
 v_mfma_f32_32x32x16_bf16 a[48:63], a[76:79], a[68:71], a[48:63]
 s_waitcnt lgkmcnt(4)
 s_waitcnt lgkmcnt(3)
 v_mfma_f32_32x32x16_bf16 a[0:15], a[88:91], a[80:83], a[0:15]
 s_waitcnt vmcnt(8)
 s_waitcnt lgkmcnt(0)
 s_barrier
 ds_read_b64_tr_b16 a[72:73], v25 offset:0
 v_mfma_f32_32x32x16_bf16 a[16:31], a[88:91], a[84:87], a[16:31]
 ds_read_b64_tr_b16 a[74:75], v25 offset:1024
 ds_read_b128 a[64:67], v21 offset:0
 v_mfma_f32_32x32x16_bf16 a[32:47], a[92:95], a[80:83], a[32:47]
 ds_read_b64_tr_b16 a[76:77], v25 offset:256
 ds_read_b64_tr_b16 a[78:79], v25 offset:1280
 v_mfma_f32_32x32x16_bf16 a[48:63], a[92:95], a[84:87], a[48:63]
 ds_read_b128 a[68:71], v21 offset:4096
 s_waitcnt lgkmcnt(4)
 s_waitcnt lgkmcnt(3)
 v_mfma_f32_32x32x16_bf16 a[0:15], a[72:75], a[64:67], a[0:15]
 ds_read_b64_tr_b16 a[88:89], v25 offset:4096
 ds_read_b64_tr_b16 a[90:91], v25 offset:5120
 s_waitcnt lgkmcnt(2)
 v_mfma_f32_32x32x16_bf16 a[16:31], a[72:75], a[68:71], a[16:31]
 ds_read_b128 a[80:83], v22 offset:0
 ds_read_b64_tr_b16 a[92:93], v25 offset:4352
 v_mfma_f32_32x32x16_bf16 a[32:47], a[76:79], a[64:67], a[32:47]
 ds_read_b64_tr_b16 a[94:95], v25 offset:5376
 ds_read_b128 a[84:87], v22 offset:4096
 v_mfma_f32_32x32x16_bf16 a[48:63], a[76:79], a[68:71], a[48:63]
 s_waitcnt lgkmcnt(4)
 s_waitcnt lgkmcnt(3)
 v_mfma_f32_32x32x16_bf16 a[0:15], a[88:91], a[80:83], a[0:15]
 ds_read_b64_tr_b16 a[72:73], v25 offset:8192
 ds_read_b64_tr_b16 a[74:75], v25 offset:9216
 s_waitcnt lgkmcnt(2)
 v_mfma_f32_32x32x16_bf16 a[16:31], a[88:91], a[84:87], a[16:31]
 ds_read_b128 a[64:67], v23 offset:0
 ds_read_b64_tr_b16 a[76:77], v25 offset:8448
 v_mfma_f32_32x32x16_bf16 a[32:47], a[92:95], a[80:83], a[32:47]
 ds_read_b64_tr_b16 a[78:79], v25 offset:9472
 ds_read_b128 a[68:71], v23 offset:4096
 v_mfma_f32_32x32x16_bf16 a[48:63], a[92:95], a[84:87], a[48:63]
 s_waitcnt lgkmcnt(4)
 s_waitcnt lgkmcnt(3)
 v_mfma_f32_32x32x16_bf16 a[0:15], a[72:75], a[64:67], a[0:15]
 ds_read_b64_tr_b16 a[88:89], v25 offset:12288
 ds_read_b64_tr_b16 a[90:91], v25 offset:13312
 s_waitcnt lgkmcnt(2)
 v_mfma_f32_32x32x16_bf16 a[16:31], a[72:75], a[68:71], a[16:31]
 ds_read_b128 a[80:83], v24 offset:0
 ds_read_b64_tr_b16 a[92:93], v25 offset:12544
 v_mfma_f32_32x32x16_bf16 a[32:47], a[76:79], a[64:67], a[32:47]
 ds_read_b64_tr_b16 a[94:95], v25 offset:13568
 ds_read_b128 a[84:87], v24 offset:4096
 v_mfma_f32_32x32x16_bf16 a[48:63], a[76:79], a[68:71], a[48:63]
 s_waitcnt lgkmcnt(4)
 s_waitcnt lgkmcnt(3)
 v_mfma_f32_32x32x16_bf16 a[0:15], a[88:91], a[80:83], a[0:15]
 s_waitcnt vmcnt(0)
 s_waitcnt lgkmcnt(0)
 s_barrier
 ds_read_b64_tr_b16 a[72:73], v25 offset:32768
 v_mfma_f32_32x32x16_bf16 a[16:31], a[88:91], a[84:87], a[16:31]
 ds_read_b64_tr_b16 a[74:75], v25 offset:33792
 ds_read_b128 a[64:67], v21 offset:32768
 v_mfma_f32_32x32x16_bf16 a[32:47], a[92:95], a[80:83], a[32:47]
 ds_read_b64_tr_b16 a[76:77], v25 offset:33024
 ds_read_b64_tr_b16 a[78:79], v25 offset:34048
 v_mfma_f32_32x32x16_bf16 a[48:63], a[92:95], a[84:87], a[48:63]
 ds_read_b128 a[68:71], v21 offset:36864
 s_waitcnt lgkmcnt(4)
 s_waitcnt lgkmcnt(3)
 v_mfma_f32_32x32x16_bf16 a[0:15], a[72:75], a[64:67], a[0:15]
 ds_read_b64_tr_b16 a[88:89], v25 offset:36864
 ds_read_b64_tr_b16 a[90:91], v25 offset:37888
 s_waitcnt lgkmcnt(2)
 v_mfma_f32_32x32x16_bf16 a[16:31], a[72:75], a[68:71], a[16:31]
 ds_read_b128 a[80:83], v22 offset:32768
 ds_read_b64_tr_b16 a[92:93], v25 offset:37120
 v_mfma_f32_32x32x16_bf16 a[32:47], a[76:79], a[64:67], a[32:47]
 ds_read_b64_tr_b16 a[94:95], v25 offset:38144
 ds_read_b128 a[84:87], v22 offset:36864
 v_mfma_f32_32x32x16_bf16 a[48:63], a[76:79], a[68:71], a[48:63]
 s_waitcnt lgkmcnt(4)
 s_waitcnt lgkmcnt(3)
 v_mfma_f32_32x32x16_bf16 a[0:15], a[88:91], a[80:83], a[0:15]
 ds_read_b64_tr_b16 a[72:73], v25 offset:40960
 ds_read_b64_tr_b16 a[74:75], v25 offset:41984
 s_waitcnt lgkmcnt(2)
 v_mfma_f32_32x32x16_bf16 a[16:31], a[88:91], a[84:87], a[16:31]
 ds_read_b128 a[64:67], v23 offset:32768
 ds_read_b64_tr_b16 a[76:77], v25 offset:41216
 v_mfma_f32_32x32x16_bf16 a[32:47], a[92:95], a[80:83], a[32:47]
 ds_read_b64_tr_b16 a[78:79], v25 offset:42240
 ds_read_b128 a[68:71], v23 offset:36864
 v_mfma_f32_32x32x16_bf16 a[48:63], a[92:95], a[84:87], a[48:63]
 s_waitcnt lgkmcnt(4)
 s_waitcnt lgkmcnt(3)
 v_mfma_f32_32x32x16_bf16 a[0:15], a[72:75], a[64:67], a[0:15]
 ds_read_b64_tr_b16 a[88:89], v25 offset:45056
 ds_read_b64_tr_b16 a[90:91], v25 offset:46080
 s_waitcnt lgkmcnt(2)
 v_mfma_f32_32x32x16_bf16 a[16:31], a[72:75], a[68:71], a[16:31]
 ds_read_b128 a[80:83], v24 offset:32768
 ds_read_b64_tr_b16 a[92:93], v25 offset:45312
 v_mfma_f32_32x32x16_bf16 a[32:47], a[76:79], a[64:67], a[32:47]
 ds_read_b64_tr_b16 a[94:95], v25 offset:46336
 ds_read_b128 a[84:87], v24 offset:36864
 v_mfma_f32_32x32x16_bf16 a[48:63], a[76:79], a[68:71], a[48:63]
 s_waitcnt lgkmcnt(4)
 s_waitcnt lgkmcnt(3)
 v_mfma_f32_32x32x16_bf16 a[0:15], a[88:91], a[80:83], a[0:15]
 s_waitcnt lgkmcnt(0)
 v_mfma_f32_32x32x16_bf16 a[16:31], a[88:91], a[84:87], a[16:31]
 v_mfma_f32_32x32x16_bf16 a[32:47], a[92:95], a[80:83], a[32:47]
 v_mfma_f32_32x32x16_bf16 a[48:63], a[92:95], a[84:87], a[48:63]
 s_nop 15
 s_add_u32 s40, s29, s66
 s_lshr_b32 s40, s40, 5
 s_mul_i32 s40, s40, 20
 s_add_u32 s41, s30, s67
 s_lshr_b32 s41, s41, 5
 s_add_u32 s40, s40, s41
 s_lshl_b32 s40, s40, 12
 s_mul_i32 s41, s42, 5242880
 s_add_u32 s40, s40, s41
 v_lshlrev_b32 v26, 4, v0
 v_add_u32 v26, s40, v26
 s_mov_b32 s40, 0
 buffer_store_dwordx4 a[0:3], v26, s[16:19], s40 offen offset:0 sc0 sc1
 buffer_store_dwordx4 a[4:7], v26, s[16:19], s40 offen offset:1024 sc0 sc1
 buffer_store_dwordx4 a[8:11], v26, s[16:19], s40 offen offset:2048 sc0 sc1
 buffer_store_dwordx4 a[12:15], v26, s[16:19], s40 offen offset:3072 sc0 sc1
 s_mov_b32 s40, 4096
 buffer_store_dwordx4 a[32:35], v26, s[16:19], s40 offen offset:0 sc0 sc1
 buffer_store_dwordx4 a[36:39], v26, s[16:19], s40 offen offset:1024 sc0 sc1
 buffer_store_dwordx4 a[40:43], v26, s[16:19], s40 offen offset:2048 sc0 sc1
 buffer_store_dwordx4 a[44:47], v26, s[16:19], s40 offen offset:3072 sc0 sc1
 s_mov_b32 s40, 81920
 buffer_store_dwordx4 a[16:19], v26, s[16:19], s40 offen offset:0 sc0 sc1
 buffer_store_dwordx4 a[20:23], v26, s[16:19], s40 offen offset:1024 sc0 sc1
 buffer_store_dwordx4 a[24:27], v26, s[16:19], s40 offen offset:2048 sc0 sc1
 buffer_store_dwordx4 a[28:31], v26, s[16:19], s40 offen offset:3072 sc0 sc1
 s_mov_b32 s40, 86016
 buffer_store_dwordx4 a[48:51], v26, s[16:19], s40 offen offset:0 sc0 sc1
 buffer_store_dwordx4 a[52:55], v26, s[16:19], s40 offen offset:1024 sc0 sc1
 buffer_store_dwordx4 a[56:59], v26, s[16:19], s40 offen offset:2048 sc0 sc1
 buffer_store_dwordx4 a[60:63], v26, s[16:19], s40 offen offset:3072 sc0 sc1
mid_kernel_done1:
 s_endpgm

.section .rodata,"a"
.p2align 6
.amdhsa_kernel mid_kernel
  .amdhsa_next_free_vgpr 288
  .amdhsa_next_free_sgpr 102
  .amdhsa_accum_offset 160
  .amdhsa_group_segment_fixed_size 0
  .amdhsa_kernarg_size 104
  .amdhsa_user_sgpr_count 2
  .amdhsa_user_sgpr_kernarg_segment_ptr 1
  .amdhsa_system_sgpr_workgroup_id_x 1
.end_amdhsa_kernel

.text
.globl fin_kernel
.p2align 8
.type fin_kernel,@function
fin_kernel:
 s_cmp_ge_u32 s2, 160
 s_cbranch_scc1 fin_kernel_done1
 s_getpc_b64 s[96:97]
fin_kernel_pc2:
 s_sub_u32 s96, s96, fin_kernel_pc2-TEXT_START
 s_subb_u32 s97, s97, 0
 s_and_b32 s97, s97, 0xffff
 s_mov_b32 s98, TEXT_END-TEXT_START
 s_mov_b32 s99, 0x00020000
 s_bfe_u32 s100, s2, 0x30003
 s_lshl_b32 s100, s100, 14
 v_lshlrev_b32 v126, 6, v0
 buffer_load_dword v127, v126, s[96:99], s100 offen
 v_lshrrev_b32 v1, 6, v0
 s_nop 0
 v_readfirstlane_b32 s28, v1
 v_and_b32 v0, 63, v0
 s_load_dwordx2 s[44:45], s[0:1], 0
 s_load_dwordx4 s[56:59], s[0:1], 72
 s_load_dwordx2 s[50:51], s[0:1], 96
 s_and_b32 s29, s2, 15
 s_lshr_b32 s30, s2, 4
 s_mul_i32 s43, s29, 221184
 s_mov_b32 s46, s30
 s_lshr_b32 s47, s29, 3
 s_mul_i32 s29, s29, 128
 s_mul_i32 s30, s30, 64
 s_mov_b32 s31, 0
 s_waitcnt lgkmcnt(0)
 s_add_u32 s52, s50, 37748736
 s_addc_u32 s53, s51, 0
 s_mov_b32 s8, s52
 s_and_b32 s9, s53, 0xffff
 s_mov_b32 s10, 3538944
 s_mov_b32 s11, 0x00020000
 s_mov_b32 s12, s56
 s_and_b32 s13, s57, 0xffff
 s_mov_b32 s14, 1105920
 s_mov_b32 s15, 0x00020000
 s_mov_b32 s16, s58
 s_and_b32 s17, s59, 0xffff
 s_mov_b32 s18, 2621440
 s_mov_b32 s19, 0x00020000
 s_add_u32 s52, s50, 41943040
 s_addc_u32 s53, s51, 0
 s_mov_b32 s20, s52
 s_and_b32 s21, s53, 0xffff
 s_mov_b32 s22, 10485760
 s_mov_b32 s23, 0x00020000
 s_mov_b32 s24, s44
 s_and_b32 s25, s45, 0xffff
 s_mov_b32 s26, 2621440
 s_mov_b32 s27, 0x00020000
 s_mov_b32 s66, s28
 s_and_b32 s67, s28, 0
 s_mul_i32 s66, s66, 32
 s_mul_i32 s67, s67, 64
 s_mul_i32 s69, s28, 128
 s_mul_i32 s68, s28, 2
 s_add_u32 s68, s68, 0
 s_lshr_b32 s64, s68, 1
 s_mul_i32 s64, s64, 55296
 s_and_b32 s68, s68, 1
 s_lshl_b32 s68, s68, 10
 s_add_u32 s64, s64, s68
 s_add_u32 s64, s64, s43
 v_lshlrev_b32 v8, 4, v0
 v_add_u32 v2, s64, v8
 s_mul_i32 s68, s28, 2
 s_add_u32 s68, s68, 1
 s_lshr_b32 s64, s68, 1
 s_mul_i32 s64, s64, 55296
 s_and_b32 s68, s68, 1
 s_lshl_b32 s68, s68, 10
 s_add_u32 s64, s64, s68
 s_add_u32 s64, s64, s43
 v_lshlrev_b32 v8, 4, v0
 v_add_u32 v3, s64, v8
 v_bfe_u32 v12, v0, 2, 2
 v_and_b32 v13, 3, v0
 s_mul_i32 s69, s28, 1
 s_add_u32 s69, s69, 0
 s_min_u32 s69, s69, 3
 s_lshl_b32 s70, s69, 10
 s_add_u32 s70, s70, 8192
 s_lshl_b32 s69, s69, 2
 v_lshrrev_b32 v8, 4, v0
 v_add_u32 v8, s69, v8
 v_mul_u32_u24 v9, 32768, v8
 v_lshrrev_b32 v9, 16, v9
 v_mul_u32_u24 v10, 2, v9
 v_sub_u32 v10, v8, v10
 v_lshl_add_u32 v9, v9, 2, v12
 s_mov_b32 s68, 1280
 v_mul_lo_u32 v9, v9, s68
 v_lshlrev_b32 v10, 5, v10
 v_lshl_add_u32 v10, v13, 3, v10
 v_add_u32 v10, s30, v10
 v_lshl_add_u32 v4, v10, 1, v9
 v_and_b32 v8, 31, v0
 v_add_u32 v8, s66, v8
 v_lshrrev_b32 v9, 5, v0
 v_bfe_u32 v11, v8, 2, 2
 s_mul_i32 s69, s66, 64
 v_lshlrev_b32 v10, 4, v0
 v_add_u32 v10, s69, v10
 v_add_u32 v5, 0, v10
 s_mul_i32 s69, s66, 64
 v_lshlrev_b32 v10, 4, v0
 v_add_u32 v10, s69, v10
 v_add_u32 v6, 1024, v10
 v_lshlrev_b32 v10, 6, v12
 v_bfe_u32 v11, v0, 4, 1
 v_lshl_add_u32 v10, v11, 5, v10
 v_and_b32 v11, 1, v13
 v_lshl_add_u32 v10, v11, 4, v10
 v_lshrrev_b32 v11, 1, v13
 v_lshl_add_u32 v10, v11, 3, v10
 v_mul_u32_u24 v11, 1024, v9
 v_add_u32 v10, v10, v11
 s_lshl_b32 s69, s67, 3
 v_add_u32 v10, s69, v10
 v_add_u32 v7, 8192, v10
 s_mov_b32 s64, 0
 s_mul_i32 s65, s31, 1280
 s_mul_i32 s68, s28, 2048
 v_add_u32 v14, 65536, v5
 v_add_u32 v15, 65536, v6
 v_add_u32 v16, 65536, v7
 v_add_u32 v17, 131072, v5
 v_add_u32 v18, 131072, v6
 v_add_u32 v19, 131072, v7
 s_add_u32 m0, s68, 0
 s_nop 0
 buffer_load_dwordx4 v2, s[8:11], s64 offen lds
 s_add_u32 m0, s68, 1024
 s_nop 0
 buffer_load_dwordx4 v3, s[8:11], s64 offen lds
 s_add_u32 s64, s64, 2048
 s_add_u32 m0, s70, 0
 s_nop 0
 buffer_load_dwordx4 v4, s[12:15], s65 offen lds
 s_add_u32 s65, s65, 40960
 s_add_u32 m0, s68, 12288
 s_nop 0
 buffer_load_dwordx4 v2, s[8:11], s64 offen lds
 s_add_u32 m0, s68, 13312
 s_nop 0
 buffer_load_dwordx4 v3, s[8:11], s64 offen lds
 s_add_u32 s64, s64, 2048
 s_add_u32 m0, s70, 12288
 s_nop 0
 buffer_load_dwordx4 v4, s[12:15], s65 offen lds
 s_add_u32 s65, s65, 40960
 s_waitcnt vmcnt(3)
 s_barrier
 ds_read_b64_tr_b16 a[36:37], v7 offset:0
 ds_read_b64_tr_b16 a[38:39], v7 offset:512
 ds_read_b128 a[32:35], v5 offset:0
 ds_read_b64_tr_b16 a[40:41], v7 offset:256
 ds_read_b64_tr_b16 a[42:43], v7 offset:768
 ds_read_b64_tr_b16 a[48:49], v7 offset:2048
 ds_read_b64_tr_b16 a[50:51], v7 offset:2560
 ds_read_b128 a[44:47], v6 offset:0
 ds_read_b64_tr_b16 a[52:53], v7 offset:2304
 ds_read_b64_tr_b16 a[54:55], v7 offset:2816
 s_waitcnt lgkmcnt(8)
 s_waitcnt lgkmcnt(7)
 v_mfma_f32_32x32x16_bf16 a[0:15], a[36:39], a[32:35], 0
 s_waitcnt vmcnt(0)
 s_barrier
 ds_read_b64_tr_b16 a[60:61], v7 offset:12288
 ds_read_b64_tr_b16 a[62:63], v7 offset:12800
 s_add_u32 m0, s68, 24576
 s_nop 0
 buffer_load_dwordx4 v2, s[8:11], s64 offen lds
 s_add_u32 m0, s68, 25600
 s_nop 0
 buffer_load_dwordx4 v3, s[8:11], s64 offen lds
 s_add_u32 s64, s64, 2048
 s_waitcnt lgkmcnt(7)
 v_mfma_f32_32x32x16_bf16 a[16:31], a[40:43], a[32:35], 0
 ds_read_b128 a[56:59], v5 offset:12288
 ds_read_b64_tr_b16 a[64:65], v7 offset:12544
 ds_read_b64_tr_b16 a[66:67], v7 offset:13056
 s_add_u32 m0, s70, 24576
 s_nop 0
 buffer_load_dwordx4 v4, s[12:15], s65 offen lds
 s_add_u32 s65, s65, 40960
 s_add_u32 m0, s68, 36864
 s_nop 0
 buffer_load_dwordx4 v2, s[8:11], s64 offen lds
 s_waitcnt lgkmcnt(8)
 s_waitcnt lgkmcnt(7)
 v_mfma_f32_32x32x16_bf16 a[0:15], a[48:51], a[44:47], a[0:15]
 ds_read_b64_tr_b16 a[36:37], v7 offset:14336
 ds_read_b64_tr_b16 a[38:39], v7 offset:14848
 ds_read_b128 a[32:35], v6 offset:12288
 s_add_u32 m0, s68, 37888
 s_nop 0
 buffer_load_dwordx4 v3, s[8:11], s64 offen lds
 s_add_u32 s64, s64, 2048
 s_add_u32 m0, s70, 36864
 s_nop 0
 buffer_load_dwordx4 v4, s[12:15], s65 offen lds
 s_add_u32 s65, s65, 40960
 s_waitcnt lgkmcnt(8)
 v_mfma_f32_32x32x16_bf16 a[16:31], a[52:55], a[44:47], a[16:31]
 ds_read_b64_tr_b16 a[40:41], v7 offset:14592
 ds_read_b64_tr_b16 a[42:43], v7 offset:15104
 s_add_u32 m0, s68, 49152
 s_nop 0
 buffer_load_dwordx4 v2, s[8:11], s64 offen lds
 s_add_u32 m0, s68, 50176
 s_nop 0
 buffer_load_dwordx4 v3, s[8:11], s64 offen lds
 s_add_u32 s64, s64, 2048
 s_waitcnt lgkmcnt(8)
 s_waitcnt lgkmcnt(7)
 v_mfma_f32_32x32x16_bf16 a[0:15], a[60:63], a[56:59], a[0:15]
 s_waitcnt vmcnt(5)
 s_barrier
 ds_read_b64_tr_b16 a[48:49], v7 offset:24576
 ds_read_b64_tr_b16 a[50:51], v7 offset:25088
 s_add_u32 m0, s70, 49152
 s_nop 0
 buffer_load_dwordx4 v4, s[12:15], s65 offen lds
 s_add_u32 s65, s65, 40960
 s_add_u32 m0, s68, 61440
 s_nop 0
 buffer_load_dwordx4 v2, s[8:11], s64 offen lds
 s_waitcnt lgkmcnt(7)
 v_mfma_f32_32x32x16_bf16 a[16:31], a[64:67], a[56:59], a[16:31]
 ds_read_b128 a[44:47], v5 offset:24576
 ds_read_b64_tr_b16 a[52:53], v7 offset:24832
 ds_read_b64_tr_b16 a[54:55], v7 offset:25344
 s_add_u32 m0, s68, 62464
 s_nop 0
 buffer_load_dwordx4 v3, s[8:11], s64 offen lds
 s_add_u32 s64, s64, 2048
 s_add_u32 m0, s70, 61440
 s_nop 0
 buffer_load_dwordx4 v4, s[12:15], s65 offen lds
 s_add_u32 s65, s65, 40960
 s_add_u32 s40, s29, s66
 v_and_b32 v20, 31, v0
 v_add_u32 v20, s40, v20
 s_mov_b32 s40, 1280
 v_mul_lo_u32 v20, v20, s40
 s_add_u32 s40, s30, s67
 v_lshrrev_b32 v21, 5, v0
 v_lshlrev_b32 v21, 3, v21
 v_add_u32 v21, s40, v21
 v_lshl_add_u32 v20, v21, 1, v20
 s_add_u32 s40, s29, s66
 s_lshr_b32 s40, s40, 5
 s_mul_i32 s40, s40, 20
 s_add_u32 s41, s30, s67
 s_lshr_b32 s41, s41, 5
 s_add_u32 s40, s40, s41
 s_lshl_b32 s40, s40, 12
 v_lshlrev_b32 v22, 4, v0
 v_add_u32 v22, s40, v22
 s_mov_b32 s40, 0
 buffer_load_dwordx4 v[24:27], v20, s[24:27], s40 offen offset:0
 s_mov_b32 s40, 0
 buffer_load_dwordx4 v[28:31], v22, s[20:23], s40 offen offset:0
 buffer_load_dwordx4 v[32:35], v22, s[20:23], s40 offen offset:1024
 s_mov_b32 s40, 5242880
 buffer_load_dwordx4 v[36:39], v22, s[20:23], s40 offen offset:0
 buffer_load_dwordx4 v[40:43], v22, s[20:23], s40 offen offset:1024
 s_mov_b32 s40, 0
 buffer_load_dwordx4 v[44:47], v20, s[24:27], s40 offen offset:32
 s_mov_b32 s40, 0
 buffer_load_dwordx4 v[48:51], v22, s[20:23], s40 offen offset:2048
 buffer_load_dwordx4 v[52:55], v22, s[20:23], s40 offen offset:3072
 s_mov_b32 s40, 5242880
 buffer_load_dwordx4 v[56:59], v22, s[20:23], s40 offen offset:2048
 buffer_load_dwordx4 v[60:63], v22, s[20:23], s40 offen offset:3072
 s_mov_b32 s40, 0
 buffer_load_dwordx4 v[64:67], v20, s[24:27], s40 offen offset:64
 s_mov_b32 s40, 4096
 buffer_load_dwordx4 v[68:71], v22, s[20:23], s40 offen offset:0
 buffer_load_dwordx4 v[72:75], v22, s[20:23], s40 offen offset:1024
 s_mov_b32 s40, 5246976
 buffer_load_dwordx4 v[76:79], v22, s[20:23], s40 offen offset:0
 buffer_load_dwordx4 v[80:83], v22, s[20:23], s40 offen offset:1024
 s_mov_b32 s40, 0
 buffer_load_dwordx4 v[84:87], v20, s[24:27], s40 offen offset:96
 s_mov_b32 s40, 4096
 buffer_load_dwordx4 v[88:91], v22, s[20:23], s40 offen offset:2048
 buffer_load_dwordx4 v[92:95], v22, s[20:23], s40 offen offset:3072
 s_mov_b32 s40, 5246976
 buffer_load_dwordx4 v[96:99], v22, s[20:23], s40 offen offset:2048
 buffer_load_dwordx4 v[100:103], v22, s[20:23], s40 offen offset:3072
 s_waitcnt lgkmcnt(8)
 s_waitcnt lgkmcnt(7)
 v_mfma_f32_32x32x16_bf16 a[0:15], a[36:39], a[32:35], a[0:15]
 ds_read_b64_tr_b16 a[60:61], v7 offset:26624
 ds_read_b64_tr_b16 a[62:63], v7 offset:27136
 ds_read_b128 a[56:59], v6 offset:24576
 s_add_u32 m0, s68, 73728
 s_nop 0
 buffer_load_dwordx4 v2, s[8:11], s64 offen lds
 s_add_u32 m0, s68, 74752
 s_nop 0
 buffer_load_dwordx4 v3, s[8:11], s64 offen lds
 s_add_u32 s64, s64, 2048
 s_waitcnt lgkmcnt(8)
 v_mfma_f32_32x32x16_bf16 a[16:31], a[40:43], a[32:35], a[16:31]
 ds_read_b64_tr_b16 a[64:65], v7 offset:26880
 ds_read_b64_tr_b16 a[66:67], v7 offset:27392
 s_add_u32 m0, s70, 73728
 s_nop 0
 buffer_load_dwordx4 v4, s[12:15], s65 offen lds
 s_add_u32 s65, s65, 40960
 s_add_u32 m0, s68, 86016
 s_nop 0
 buffer_load_dwordx4 v2, s[8:11], s64 offen lds
 s_waitcnt lgkmcnt(8)
 s_waitcnt lgkmcnt(7)
 v_mfma_f32_32x32x16_bf16 a[0:15], a[48:51], a[44:47], a[0:15]
 s_waitcnt vmcnt(30)
 s_barrier
 ds_read_b64_tr_b16 a[36:37], v7 offset:36864
 ds_read_b64_tr_b16 a[38:39], v7 offset:37376
 s_add_u32 m0, s68, 87040
 s_nop 0
 buffer_load_dwordx4 v3, s[8:11], s64 offen lds
 s_add_u32 s64, s64, 2048
 s_add_u32 m0, s70, 86016
 s_nop 0
 buffer_load_dwordx4 v4, s[12:15], s65 offen lds
 s_add_u32 s65, s65, 40960
 s_waitcnt lgkmcnt(7)
 v_mfma_f32_32x32x16_bf16 a[16:31], a[52:55], a[44:47], a[16:31]
 ds_read_b128 a[32:35], v5 offset:36864
 ds_read_b64_tr_b16 a[40:41], v7 offset:37120
 ds_read_b64_tr_b16 a[42:43], v7 offset:37632
 s_add_u32 m0, s68, 98304
 s_nop 0
 buffer_load_dwordx4 v2, s[8:11], s64 offen lds
 s_add_u32 m0, s68, 99328
 s_nop 0
 buffer_load_dwordx4 v3, s[8:11], s64 offen lds
 s_add_u32 s64, s64, 2048
 s_waitcnt lgkmcnt(8)
 s_waitcnt lgkmcnt(7)
 v_mfma_f32_32x32x16_bf16 a[0:15], a[60:63], a[56:59], a[0:15]
 ds_read_b64_tr_b16 a[48:49], v7 offset:38912
 ds_read_b64_tr_b16 a[50:51], v7 offset:39424
 ds_read_b128 a[44:47], v6 offset:36864
 s_add_u32 m0, s70, 98304
 s_nop 0
 buffer_load_dwordx4 v4, s[12:15], s65 offen lds
 s_add_u32 s65, s65, 40960
 s_add_u32 m0, s68, 110592
 s_nop 0
 buffer_load_dwordx4 v2, s[8:11], s64 offen lds
 s_waitcnt lgkmcnt(8)
 v_mfma_f32_32x32x16_bf16 a[16:31], a[64:67], a[56:59], a[16:31]
 ds_read_b64_tr_b16 a[52:53], v7 offset:39168
 ds_read_b64_tr_b16 a[54:55], v7 offset:39680
 s_add_u32 m0, s68, 111616
 s_nop 0
 buffer_load_dwordx4 v3, s[8:11], s64 offen lds
 s_add_u32 s64, s64, 2048
 s_add_u32 m0, s70, 110592
 s_nop 0
 buffer_load_dwordx4 v4, s[12:15], s65 offen lds
 s_add_u32 s65, s65, 40960
 s_waitcnt lgkmcnt(8)
 s_waitcnt lgkmcnt(7)
 v_mfma_f32_32x32x16_bf16 a[0:15], a[36:39], a[32:35], a[0:15]
 s_waitcnt vmcnt(35)
 s_barrier
 ds_read_b64_tr_b16 a[60:61], v7 offset:49152
 ds_read_b64_tr_b16 a[62:63], v7 offset:49664
 s_add_u32 m0, s68, 122880
 s_nop 0
 buffer_load_dwordx4 v2, s[8:11], s64 offen lds
 s_add_u32 m0, s68, 123904
 s_nop 0
 buffer_load_dwordx4 v3, s[8:11], s64 offen lds
 s_add_u32 s64, s64, 2048
 s_waitcnt lgkmcnt(7)
 v_mfma_f32_32x32x16_bf16 a[16:31], a[40:43], a[32:35], a[16:31]
 ds_read_b128 a[56:59], v5 offset:49152
 ds_read_b64_tr_b16 a[64:65], v7 offset:49408
 ds_read_b64_tr_b16 a[66:67], v7 offset:49920
 s_add_u32 m0, s70, 122880
 s_nop 0
 buffer_load_dwordx4 v4, s[12:15], s65 offen lds
 s_add_u32 s65, s65, 40960
 s_add_u32 m0, s68, 135168
 s_nop 0
 buffer_load_dwordx4 v2, s[8:11], s64 offen lds
 s_waitcnt lgkmcnt(8)
 s_waitcnt lgkmcnt(7)
 v_mfma_f32_32x32x16_bf16 a[0:15], a[48:51], a[44:47], a[0:15]
 ds_read_b64_tr_b16 a[36:37], v7 offset:51200
 ds_read_b64_tr_b16 a[38:39], v7 offset:51712
 ds_read_b128 a[32:35], v6 offset:49152
 s_add_u32 m0, s68, 136192
 s_nop 0
 buffer_load_dwordx4 v3, s[8:11], s64 offen lds
 s_add_u32 s64, s64, 2048
 s_add_u32 m0, s70, 135168
 s_nop 0
 buffer_load_dwordx4 v4, s[12:15], s65 offen lds
 s_add_u32 s65, s65, 40960
 s_waitcnt lgkmcnt(8)
 v_mfma_f32_32x32x16_bf16 a[16:31], a[52:55], a[44:47], a[16:31]
 ds_read_b64_tr_b16 a[40:41], v7 offset:51456
 ds_read_b64_tr_b16 a[42:43], v7 offset:51968
 s_add_u32 m0, s68, 0
 s_nop 0
 buffer_load_dwordx4 v2, s[8:11], s64 offen lds
 s_add_u32 m0, s68, 1024
 s_nop 0
 buffer_load_dwordx4 v3, s[8:11], s64 offen lds
 s_add_u32 s64, s64, 2048
 s_waitcnt lgkmcnt(8)
 s_waitcnt lgkmcnt(7)
 v_mfma_f32_32x32x16_bf16 a[0:15], a[60:63], a[56:59], a[0:15]
 s_waitcnt vmcnt(40)
 s_barrier
 ds_read_b64_tr_b16 a[48:49], v7 offset:61440
 ds_read_b64_tr_b16 a[50:51], v7 offset:61952
 s_add_u32 m0, s70, 0
 s_nop 0
 buffer_load_dwordx4 v4, s[12:15], s65 offen lds
 s_add_u32 s65, s65, 40960
 s_add_u32 m0, s68, 12288
 s_nop 0
 buffer_load_dwordx4 v2, s[8:11], s64 offen lds
 s_waitcnt lgkmcnt(7)
 v_mfma_f32_32x32x16_bf16 a[16:31], a[64:67], a[56:59], a[16:31]
 ds_read_b128 a[44:47], v5 offset:61440
 ds_read_b64_tr_b16 a[52:53], v7 offset:61696
 ds_read_b64_tr_b16 a[54:55], v7 offset:62208
 s_add_u32 m0, s68, 13312
 s_nop 0
 buffer_load_dwordx4 v3, s[8:11], s64 offen lds
 s_add_u32 s64, s64, 2048
 s_add_u32 m0, s70, 12288
 s_nop 0
 buffer_load_dwordx4 v4, s[12:15], s65 offen lds
 s_add_u32 s65, s65, 40960
 s_waitcnt lgkmcnt(8)
 s_waitcnt lgkmcnt(7)
 v_mfma_f32_32x32x16_bf16 a[0:15], a[36:39], a[32:35], a[0:15]
 ds_read_b64_tr_b16 a[60:61], v7 offset:63488
 ds_read_b64_tr_b16 a[62:63], v7 offset:64000
 ds_read_b128 a[56:59], v6 offset:61440
 s_add_u32 m0, s68, 24576
 s_nop 0
 buffer_load_dwordx4 v2, s[8:11], s64 offen lds
 s_add_u32 m0, s68, 25600
 s_nop 0
 buffer_load_dwordx4 v3, s[8:11], s64 offen lds
 s_add_u32 s64, s64, 2048
 s_waitcnt lgkmcnt(8)
 v_mfma_f32_32x32x16_bf16 a[16:31], a[40:43], a[32:35], a[16:31]
 ds_read_b64_tr_b16 a[64:65], v7 offset:63744
 ds_read_b64_tr_b16 a[66:67], v7 offset:64256
 s_add_u32 m0, s70, 24576
 s_nop 0
 buffer_load_dwordx4 v4, s[12:15], s65 offen lds
 s_add_u32 s65, s65, 40960
 s_add_u32 m0, s68, 36864
 s_nop 0
 buffer_load_dwordx4 v2, s[8:11], s64 offen lds
 s_waitcnt lgkmcnt(8)
 s_waitcnt lgkmcnt(7)
 v_mfma_f32_32x32x16_bf16 a[0:15], a[48:51], a[44:47], a[0:15]
 s_waitcnt vmcnt(25)
 s_barrier
 ds_read_b64_tr_b16 a[36:37], v16 offset:8192
 ds_read_b64_tr_b16 a[38:39], v16 offset:8704
 s_add_u32 m0, s68, 37888
 s_nop 0
 buffer_load_dwordx4 v3, s[8:11], s64 offen lds
 s_add_u32 s64, s64, 2048
 s_add_u32 m0, s70, 36864
 s_nop 0
 buffer_load_dwordx4 v4, s[12:15], s65 offen lds
 s_add_u32 s65, s65, 40960
 s_waitcnt lgkmcnt(7)
 v_mfma_f32_32x32x16_bf16 a[16:31], a[52:55], a[44:47], a[16:31]
 ds_read_b128 a[32:35], v14 offset:8192
 ds_read_b64_tr_b16 a[40:41], v16 offset:8448
 ds_read_b64_tr_b16 a[42:43], v16 offset:8960
 s_add_u32 m0, s68, 49152
 s_nop 0
 buffer_load_dwordx4 v2, s[8:11], s64 offen lds
 s_waitcnt lgkmcnt(8)
 s_waitcnt lgkmcnt(7)
 v_mfma_f32_32x32x16_bf16 a[0:15], a[60:63], a[56:59], a[0:15]
 ds_read_b64_tr_b16 a[48:49], v16 offset:10240
 ds_read_b64_tr_b16 a[50:51], v16 offset:10752
 ds_read_b128 a[44:47], v15 offset:8192
 s_add_u32 m0, s68, 50176
 s_nop 0
 buffer_load_dwordx4 v3, s[8:11], s64 offen lds
 s_add_u32 s64, s64, 2048
 s_waitcnt lgkmcnt(8)
 v_mfma_f32_32x32x16_bf16 a[16:31], a[64:67], a[56:59], a[16:31]
 ds_read_b64_tr_b16 a[52:53], v16 offset:10496
 ds_read_b64_tr_b16 a[54:55], v16 offset:11008
 s_add_u32 m0, s70, 49152
 s_nop 0
 buffer_load_dwordx4 v4, s[12:15], s65 offen lds
 s_add_u32 s65, s65, 40960
 s_waitcnt lgkmcnt(8)
 s_waitcnt lgkmcnt(7)
 v_mfma_f32_32x32x16_bf16 a[0:15], a[36:39], a[32:35], a[0:15]
 s_waitcnt vmcnt(27)
 s_barrier
 ds_read_b64_tr_b16 a[60:61], v16 offset:20480
 ds_read_b64_tr_b16 a[62:63], v16 offset:20992
 s_waitcnt lgkmcnt(7)
 v_mfma_f32_32x32x16_bf16 a[16:31], a[40:43], a[32:35], a[16:31]
 ds_read_b128 a[56:59], v14 offset:20480
 ds_read_b64_tr_b16 a[64:65], v16 offset:20736
 ds_read_b64_tr_b16 a[66:67], v16 offset:21248
 s_add_u32 m0, s68, 61440
 s_nop 0
 buffer_load_dwordx4 v2, s[8:11], s64 offen lds
 s_waitcnt lgkmcnt(8)
 s_waitcnt lgkmcnt(7)
 v_mfma_f32_32x32x16_bf16 a[0:15], a[48:51], a[44:47], a[0:15]
 ds_read_b64_tr_b16 a[36:37], v16 offset:22528
 ds_read_b64_tr_b16 a[38:39], v16 offset:23040
 ds_read_b128 a[32:35], v15 offset:20480
 s_add_u32 m0, s68, 62464
 s_nop 0
 buffer_load_dwordx4 v3, s[8:11], s64 offen lds
 s_add_u32 s64, s64, 2048
 s_waitcnt lgkmcnt(8)
 v_mfma_f32_32x32x16_bf16 a[16:31], a[52:55], a[44:47], a[16:31]
 ds_read_b64_tr_b16 a[40:41], v16 offset:22784
 ds_read_b64_tr_b16 a[42:43], v16 offset:23296
 s_add_u32 m0, s70, 61440
 s_nop 0
 buffer_load_dwordx4 v4, s[12:15], s65 offen lds
 s_add_u32 s65, s65, 40960
 s_waitcnt lgkmcnt(8)
 s_waitcnt lgkmcnt(7)
 v_mfma_f32_32x32x16_bf16 a[0:15], a[60:63], a[56:59], a[0:15]
 s_waitcnt vmcnt(27)
 s_barrier
 ds_read_b64_tr_b16 a[48:49], v16 offset:32768
 ds_read_b64_tr_b16 a[50:51], v16 offset:33280
 s_waitcnt lgkmcnt(7)
 v_mfma_f32_32x32x16_bf16 a[16:31], a[64:67], a[56:59], a[16:31]
 ds_read_b128 a[44:47], v14 offset:32768
 ds_read_b64_tr_b16 a[52:53], v16 offset:33024
 ds_read_b64_tr_b16 a[54:55], v16 offset:33536
 s_add_u32 m0, s68, 73728
 s_nop 0
 buffer_load_dwordx4 v2, s[8:11], s64 offen lds
 s_waitcnt lgkmcnt(8)
 s_waitcnt lgkmcnt(7)
 v_mfma_f32_32x32x16_bf16 a[0:15], a[36:39], a[32:35], a[0:15]
 ds_read_b64_tr_b16 a[60:61], v16 offset:34816
 ds_read_b64_tr_b16 a[62:63], v16 offset:35328
 ds_read_b128 a[56:59], v15 offset:32768
 s_add_u32 m0, s68, 74752
 s_nop 0
 buffer_load_dwordx4 v3, s[8:11], s64 offen lds
 s_add_u32 s64, s64, 2048
 s_waitcnt lgkmcnt(8)
 v_mfma_f32_32x32x16_bf16 a[16:31], a[40:43], a[32:35], a[16:31]
 ds_read_b64_tr_b16 a[64:65], v16 offset:35072
 ds_read_b64_tr_b16 a[66:67], v16 offset:35584
 s_add_u32 m0, s70, 73728
 s_nop 0
 buffer_load_dwordx4 v4, s[12:15], s65 offen lds
 s_add_u32 s65, s65, 40960
 s_waitcnt lgkmcnt(8)
 s_waitcnt lgkmcnt(7)
 v_mfma_f32_32x32x16_bf16 a[0:15], a[48:51], a[44:47], a[0:15]
 s_waitcnt vmcnt(27)
 s_barrier
 ds_read_b64_tr_b16 a[36:37], v16 offset:45056
 ds_read_b64_tr_b16 a[38:39], v16 offset:45568
 s_waitcnt lgkmcnt(7)
 v_mfma_f32_32x32x16_bf16 a[16:31], a[52:55], a[44:47], a[16:31]
 ds_read_b128 a[32:35], v14 offset:45056
 ds_read_b64_tr_b16 a[40:41], v16 offset:45312
 ds_read_b64_tr_b16 a[42:43], v16 offset:45824
 s_add_u32 m0, s68, 86016
 s_nop 0
 buffer_load_dwordx4 v2, s[8:11], s64 offen lds
 s_waitcnt lgkmcnt(8)
 s_waitcnt lgkmcnt(7)
 v_mfma_f32_32x32x16_bf16 a[0:15], a[60:63], a[56:59], a[0:15]
 ds_read_b64_tr_b16 a[48:49], v16 offset:47104
 ds_read_b64_tr_b16 a[50:51], v16 offset:47616
 ds_read_b128 a[44:47], v15 offset:45056
 s_add_u32 m0, s68, 87040
 s_nop 0
 buffer_load_dwordx4 v3, s[8:11], s64 offen lds
 s_add_u32 s64, s64, 2048
 s_waitcnt lgkmcnt(8)
 v_mfma_f32_32x32x16_bf16 a[16:31], a[64:67], a[56:59], a[16:31]
 ds_read_b64_tr_b16 a[52:53], v16 offset:47360
 ds_read_b64_tr_b16 a[54:55], v16 offset:47872
 s_add_u32 m0, s70, 86016
 s_nop 0
 buffer_load_dwordx4 v4, s[12:15], s65 offen lds
 s_add_u32 s65, s65, 40960
 s_waitcnt lgkmcnt(8)
 s_waitcnt lgkmcnt(7)
 v_mfma_f32_32x32x16_bf16 a[0:15], a[36:39], a[32:35], a[0:15]
 s_waitcnt vmcnt(27)
 s_barrier
 ds_read_b64_tr_b16 a[60:61], v16 offset:57344
 ds_read_b64_tr_b16 a[62:63], v16 offset:57856
 s_waitcnt lgkmcnt(7)
 v_mfma_f32_32x32x16_bf16 a[16:31], a[40:43], a[32:35], a[16:31]
 ds_read_b128 a[56:59], v14 offset:57344
 ds_read_b64_tr_b16 a[64:65], v16 offset:57600
 ds_read_b64_tr_b16 a[66:67], v16 offset:58112
 s_add_u32 m0, s68, 98304
 s_nop 0
 buffer_load_dwordx4 v2, s[8:11], s64 offen lds
 s_waitcnt lgkmcnt(8)
 s_waitcnt lgkmcnt(7)
 v_mfma_f32_32x32x16_bf16 a[0:15], a[48:51], a[44:47], a[0:15]
 ds_read_b64_tr_b16 a[36:37], v16 offset:59392
 ds_read_b64_tr_b16 a[38:39], v16 offset:59904
 ds_read_b128 a[32:35], v15 offset:57344
 s_add_u32 m0, s68, 99328
 s_nop 0
 buffer_load_dwordx4 v3, s[8:11], s64 offen lds
 s_add_u32 s64, s64, 2048
 s_waitcnt lgkmcnt(8)
 v_mfma_f32_32x32x16_bf16 a[16:31], a[52:55], a[44:47], a[16:31]
 ds_read_b64_tr_b16 a[40:41], v16 offset:59648
 ds_read_b64_tr_b16 a[42:43], v16 offset:60160
 s_add_u32 m0, s70, 98304
 s_nop 0
 buffer_load_dwordx4 v4, s[12:15], s65 offen lds
 s_add_u32 s65, s65, 40960
 s_waitcnt lgkmcnt(8)
 s_waitcnt lgkmcnt(7)
 v_mfma_f32_32x32x16_bf16 a[0:15], a[60:63], a[56:59], a[0:15]
 s_waitcnt vmcnt(27)
 s_barrier
 ds_read_b64_tr_b16 a[48:49], v19 offset:4096
 ds_read_b64_tr_b16 a[50:51], v19 offset:4608
 s_waitcnt lgkmcnt(7)
 v_mfma_f32_32x32x16_bf16 a[16:31], a[64:67], a[56:59], a[16:31]
 ds_read_b128 a[44:47], v17 offset:4096
 ds_read_b64_tr_b16 a[52:53], v19 offset:4352
 ds_read_b64_tr_b16 a[54:55], v19 offset:4864
 s_add_u32 m0, s68, 110592
 s_nop 0
 buffer_load_dwordx4 v2, s[8:11], s64 offen lds
 s_waitcnt lgkmcnt(8)
 s_waitcnt lgkmcnt(7)
 v_mfma_f32_32x32x16_bf16 a[0:15], a[36:39], a[32:35], a[0:15]
 ds_read_b64_tr_b16 a[60:61], v19 offset:6144
 ds_read_b64_tr_b16 a[62:63], v19 offset:6656
 ds_read_b128 a[56:59], v18 offset:4096
 s_add_u32 m0, s68, 111616
 s_nop 0
 buffer_load_dwordx4 v3, s[8:11], s64 offen lds
 s_add_u32 s64, s64, 2048
 s_waitcnt lgkmcnt(8)
 v_mfma_f32_32x32x16_bf16 a[16:31], a[40:43], a[32:35], a[16:31]
 ds_read_b64_tr_b16 a[64:65], v19 offset:6400
 ds_read_b64_tr_b16 a[66:67], v19 offset:6912
 s_add_u32 m0, s70, 110592
 s_nop 0
 buffer_load_dwordx4 v4, s[12:15], s65 offen lds
 s_add_u32 s65, s65, 40960
 s_waitcnt lgkmcnt(8)
 s_waitcnt lgkmcnt(7)
 v_mfma_f32_32x32x16_bf16 a[0:15], a[48:51], a[44:47], a[0:15]
 s_waitcnt vmcnt(27)
 s_barrier
 ds_read_b64_tr_b16 a[36:37], v7 offset:0
 ds_read_b64_tr_b16 a[38:39], v7 offset:512
 s_waitcnt lgkmcnt(7)
 v_mfma_f32_32x32x16_bf16 a[16:31], a[52:55], a[44:47], a[16:31]
 ds_read_b128 a[32:35], v5 offset:0
 ds_read_b64_tr_b16 a[40:41], v7 offset:256
 ds_read_b64_tr_b16 a[42:43], v7 offset:768
 s_add_u32 m0, s68, 122880
 s_nop 0
 buffer_load_dwordx4 v2, s[8:11], s64 offen lds
 s_waitcnt lgkmcnt(8)
 s_waitcnt lgkmcnt(7)
 v_mfma_f32_32x32x16_bf16 a[0:15], a[60:63], a[56:59], a[0:15]
 ds_read_b64_tr_b16 a[48:49], v7 offset:2048
 ds_read_b64_tr_b16 a[50:51], v7 offset:2560
 ds_read_b128 a[44:47], v6 offset:0
 s_add_u32 m0, s68, 123904
 s_nop 0
 buffer_load_dwordx4 v3, s[8:11], s64 offen lds
 s_add_u32 s64, s64, 2048
 s_waitcnt lgkmcnt(8)
 v_mfma_f32_32x32x16_bf16 a[16:31], a[64:67], a[56:59], a[16:31]
 ds_read_b64_tr_b16 a[52:53], v7 offset:2304
 ds_read_b64_tr_b16 a[54:55], v7 offset:2816
 s_add_u32 m0, s70, 122880
 s_nop 0
 buffer_load_dwordx4 v4, s[12:15], s65 offen lds
 s_add_u32 s65, s65, 40960
 s_waitcnt lgkmcnt(8)
 s_waitcnt lgkmcnt(7)
 v_mfma_f32_32x32x16_bf16 a[0:15], a[36:39], a[32:35], a[0:15]
 s_waitcnt vmcnt(27)
 s_barrier
 ds_read_b64_tr_b16 a[60:61], v7 offset:12288
 ds_read_b64_tr_b16 a[62:63], v7 offset:12800
 s_waitcnt lgkmcnt(7)
 v_mfma_f32_32x32x16_bf16 a[16:31], a[40:43], a[32:35], a[16:31]
 ds_read_b128 a[56:59], v5 offset:12288
 ds_read_b64_tr_b16 a[64:65], v7 offset:12544
 ds_read_b64_tr_b16 a[66:67], v7 offset:13056
 s_add_u32 m0, s68, 135168
 s_nop 0
 buffer_load_dwordx4 v2, s[8:11], s64 offen lds
 s_waitcnt lgkmcnt(8)
 s_waitcnt lgkmcnt(7)
 v_mfma_f32_32x32x16_bf16 a[0:15], a[48:51], a[44:47], a[0:15]
 ds_read_b64_tr_b16 a[36:37], v7 offset:14336
 ds_read_b64_tr_b16 a[38:39], v7 offset:14848
 ds_read_b128 a[32:35], v6 offset:12288
 s_add_u32 m0, s68, 136192
 s_nop 0
 buffer_load_dwordx4 v3, s[8:11], s64 offen lds
 s_add_u32 s64, s64, 2048
 s_waitcnt lgkmcnt(8)
 v_mfma_f32_32x32x16_bf16 a[16:31], a[52:55], a[44:47], a[16:31]
 ds_read_b64_tr_b16 a[40:41], v7 offset:14592
 ds_read_b64_tr_b16 a[42:43], v7 offset:15104
 s_add_u32 m0, s70, 135168
 s_nop 0
 buffer_load_dwordx4 v4, s[12:15], s65 offen lds
 s_add_u32 s65, s65, 40960
 s_waitcnt lgkmcnt(8)
 s_waitcnt lgkmcnt(7)
 v_mfma_f32_32x32x16_bf16 a[0:15], a[60:63], a[56:59], a[0:15]
 s_waitcnt vmcnt(27)
 s_barrier
 ds_read_b64_tr_b16 a[48:49], v7 offset:24576
 ds_read_b64_tr_b16 a[50:51], v7 offset:25088
 s_waitcnt lgkmcnt(7)
 v_mfma_f32_32x32x16_bf16 a[16:31], a[64:67], a[56:59], a[16:31]
 ds_read_b128 a[44:47], v5 offset:24576
 ds_read_b64_tr_b16 a[52:53], v7 offset:24832
 ds_read_b64_tr_b16 a[54:55], v7 offset:25344
 s_add_u32 m0, s68, 0
 s_nop 0
 buffer_load_dwordx4 v2, s[8:11], s64 offen lds
 s_waitcnt lgkmcnt(8)
 s_waitcnt lgkmcnt(7)
 v_mfma_f32_32x32x16_bf16 a[0:15], a[36:39], a[32:35], a[0:15]
 ds_read_b64_tr_b16 a[60:61], v7 offset:26624
 ds_read_b64_tr_b16 a[62:63], v7 offset:27136
 ds_read_b128 a[56:59], v6 offset:24576
 s_add_u32 m0, s68, 1024
 s_nop 0
 buffer_load_dwordx4 v3, s[8:11], s64 offen lds
 s_add_u32 s64, s64, 2048
 s_waitcnt lgkmcnt(8)
 v_mfma_f32_32x32x16_bf16 a[16:31], a[40:43], a[32:35], a[16:31]
 ds_read_b64_tr_b16 a[64:65], v7 offset:26880
 ds_read_b64_tr_b16 a[66:67], v7 offset:27392
 s_add_u32 m0, s70, 0
 s_nop 0
 buffer_load_dwordx4 v4, s[12:15], s65 offen lds
 s_add_u32 s65, s65, 40960
 s_waitcnt lgkmcnt(8)
 s_waitcnt lgkmcnt(7)
 v_mfma_f32_32x32x16_bf16 a[0:15], a[48:51], a[44:47], a[0:15]
 s_waitcnt vmcnt(27)
 s_barrier
 ds_read_b64_tr_b16 a[36:37], v7 offset:36864
 ds_read_b64_tr_b16 a[38:39], v7 offset:37376
 s_waitcnt lgkmcnt(7)
 v_mfma_f32_32x32x16_bf16 a[16:31], a[52:55], a[44:47], a[16:31]
 ds_read_b128 a[32:35], v5 offset:36864
 ds_read_b64_tr_b16 a[40:41], v7 offset:37120
 ds_read_b64_tr_b16 a[42:43], v7 offset:37632
 s_add_u32 m0, s68, 12288
 s_nop 0
 buffer_load_dwordx4 v2, s[8:11], s64 offen lds
 s_waitcnt lgkmcnt(8)
 s_waitcnt lgkmcnt(7)
 v_mfma_f32_32x32x16_bf16 a[0:15], a[60:63], a[56:59], a[0:15]
 ds_read_b64_tr_b16 a[48:49], v7 offset:38912
 ds_read_b64_tr_b16 a[50:51], v7 offset:39424
 ds_read_b128 a[44:47], v6 offset:36864
 s_add_u32 m0, s68, 13312
 s_nop 0
 buffer_load_dwordx4 v3, s[8:11], s64 offen lds
 s_add_u32 s64, s64, 2048
 s_waitcnt lgkmcnt(8)
 v_mfma_f32_32x32x16_bf16 a[16:31], a[64:67], a[56:59], a[16:31]
 ds_read_b64_tr_b16 a[52:53], v7 offset:39168
 ds_read_b64_tr_b16 a[54:55], v7 offset:39680
 s_add_u32 m0, s70, 12288
 s_nop 0
 buffer_load_dwordx4 v4, s[12:15], s65 offen lds
 s_add_u32 s65, s65, 40960
 s_waitcnt lgkmcnt(8)
 s_waitcnt lgkmcnt(7)
 v_mfma_f32_32x32x16_bf16 a[0:15], a[36:39], a[32:35], a[0:15]
 s_waitcnt vmcnt(27)
 s_barrier
 ds_read_b64_tr_b16 a[60:61], v7 offset:49152
 ds_read_b64_tr_b16 a[62:63], v7 offset:49664
 s_waitcnt lgkmcnt(7)
 v_mfma_f32_32x32x16_bf16 a[16:31], a[40:43], a[32:35], a[16:31]
 ds_read_b128 a[56:59], v5 offset:49152
 ds_read_b64_tr_b16 a[64:65], v7 offset:49408
 ds_read_b64_tr_b16 a[66:67], v7 offset:49920
 s_add_u32 m0, s68, 24576
 s_nop 0
 buffer_load_dwordx4 v2, s[8:11], s64 offen lds
 s_waitcnt lgkmcnt(8)
 s_waitcnt lgkmcnt(7)
 v_mfma_f32_32x32x16_bf16 a[0:15], a[48:51], a[44:47], a[0:15]
 ds_read_b64_tr_b16 a[36:37], v7 offset:51200
 ds_read_b64_tr_b16 a[38:39], v7 offset:51712
 ds_read_b128 a[32:35], v6 offset:49152
 s_add_u32 m0, s68, 25600
 s_nop 0
 buffer_load_dwordx4 v3, s[8:11], s64 offen lds
 s_add_u32 s64, s64, 2048
 s_waitcnt lgkmcnt(8)
 v_mfma_f32_32x32x16_bf16 a[16:31], a[52:55], a[44:47], a[16:31]
 ds_read_b64_tr_b16 a[40:41], v7 offset:51456
 ds_read_b64_tr_b16 a[42:43], v7 offset:51968
 s_add_u32 m0, s70, 24576
 s_nop 0
 buffer_load_dwordx4 v4, s[12:15], s65 offen lds
 s_add_u32 s65, s65, 40960
 s_waitcnt lgkmcnt(8)
 s_waitcnt lgkmcnt(7)
 v_mfma_f32_32x32x16_bf16 a[0:15], a[60:63], a[56:59], a[0:15]
 s_waitcnt vmcnt(27)
 s_barrier
 ds_read_b64_tr_b16 a[48:49], v7 offset:61440
 ds_read_b64_tr_b16 a[50:51], v7 offset:61952
 s_waitcnt lgkmcnt(7)
 v_mfma_f32_32x32x16_bf16 a[16:31], a[64:67], a[56:59], a[16:31]
 ds_read_b128 a[44:47], v5 offset:61440
 ds_read_b64_tr_b16 a[52:53], v7 offset:61696
 ds_read_b64_tr_b16 a[54:55], v7 offset:62208
 s_waitcnt lgkmcnt(8)
 s_waitcnt lgkmcnt(7)
 v_mfma_f32_32x32x16_bf16 a[0:15], a[36:39], a[32:35], a[0:15]
 ds_read_b64_tr_b16 a[60:61], v7 offset:63488
 ds_read_b64_tr_b16 a[62:63], v7 offset:64000
 ds_read_b128 a[56:59], v6 offset:61440
 s_waitcnt lgkmcnt(8)
 v_mfma_f32_32x32x16_bf16 a[16:31], a[40:43], a[32:35], a[16:31]
 ds_read_b64_tr_b16 a[64:65], v7 offset:63744
 ds_read_b64_tr_b16 a[66:67], v7 offset:64256
 s_waitcnt lgkmcnt(8)
 s_waitcnt lgkmcnt(7)
 v_mfma_f32_32x32x16_bf16 a[0:15], a[48:51], a[44:47], a[0:15]
 s_waitcnt vmcnt(24)
 s_barrier
 ds_read_b64_tr_b16 a[36:37], v16 offset:8192
 ds_read_b64_tr_b16 a[38:39], v16 offset:8704
 s_waitcnt lgkmcnt(7)
 v_mfma_f32_32x32x16_bf16 a[16:31], a[52:55], a[44:47], a[16:31]
 ds_read_b128 a[32:35], v14 offset:8192
 ds_read_b64_tr_b16 a[40:41], v16 offset:8448
 ds_read_b64_tr_b16 a[42:43], v16 offset:8960
 s_waitcnt lgkmcnt(8)
 s_waitcnt lgkmcnt(7)
 v_mfma_f32_32x32x16_bf16 a[0:15], a[60:63], a[56:59], a[0:15]
 ds_read_b64_tr_b16 a[48:49], v16 offset:10240
 ds_read_b64_tr_b16 a[50:51], v16 offset:10752
 ds_read_b128 a[44:47], v15 offset:8192
 s_waitcnt lgkmcnt(8)
 v_mfma_f32_32x32x16_bf16 a[16:31], a[64:67], a[56:59], a[16:31]
 ds_read_b64_tr_b16 a[52:53], v16 offset:10496
 ds_read_b64_tr_b16 a[54:55], v16 offset:11008
 s_waitcnt lgkmcnt(8)
 s_waitcnt lgkmcnt(7)
 v_mfma_f32_32x32x16_bf16 a[0:15], a[36:39], a[32:35], a[0:15]
 s_waitcnt vmcnt(21)
 s_barrier
 ds_read_b64_tr_b16 a[60:61], v16 offset:20480
 ds_read_b64_tr_b16 a[62:63], v16 offset:20992
 s_waitcnt lgkmcnt(7)
 v_mfma_f32_32x32x16_bf16 a[16:31], a[40:43], a[32:35], a[16:31]
 ds_read_b128 a[56:59], v14 offset:20480
 ds_read_b64_tr_b16 a[64:65], v16 offset:20736
 ds_read_b64_tr_b16 a[66:67], v16 offset:21248
 s_waitcnt lgkmcnt(8)
 s_waitcnt lgkmcnt(7)
 v_mfma_f32_32x32x16_bf16 a[0:15], a[48:51], a[44:47], a[0:15]
 ds_read_b64_tr_b16 a[36:37], v16 offset:22528
 ds_read_b64_tr_b16 a[38:39], v16 offset:23040
 ds_read_b128 a[32:35], v15 offset:20480
 s_waitcnt lgkmcnt(8)
 v_mfma_f32_32x32x16_bf16 a[16:31], a[52:55], a[44:47], a[16:31]
 ds_read_b64_tr_b16 a[40:41], v16 offset:22784
 ds_read_b64_tr_b16 a[42:43], v16 offset:23296
 s_waitcnt lgkmcnt(8)
 s_waitcnt lgkmcnt(7)
 v_mfma_f32_32x32x16_bf16 a[0:15], a[60:63], a[56:59], a[0:15]
 s_waitcnt vmcnt(18)
 s_barrier
 ds_read_b64_tr_b16 a[48:49], v16 offset:32768
 ds_read_b64_tr_b16 a[50:51], v16 offset:33280
 s_waitcnt lgkmcnt(7)
 v_mfma_f32_32x32x16_bf16 a[16:31], a[64:67], a[56:59], a[16:31]
 ds_read_b128 a[44:47], v14 offset:32768
 ds_read_b64_tr_b16 a[52:53], v16 offset:33024
 ds_read_b64_tr_b16 a[54:55], v16 offset:33536
 s_waitcnt lgkmcnt(8)
 s_waitcnt lgkmcnt(7)
 v_mfma_f32_32x32x16_bf16 a[0:15], a[36:39], a[32:35], a[0:15]
 ds_read_b64_tr_b16 a[60:61], v16 offset:34816
 ds_read_b64_tr_b16 a[62:63], v16 offset:35328
 ds_read_b128 a[56:59], v15 offset:32768
 s_waitcnt lgkmcnt(8)
 v_mfma_f32_32x32x16_bf16 a[16:31], a[40:43], a[32:35], a[16:31]
 ds_read_b64_tr_b16 a[64:65], v16 offset:35072
 ds_read_b64_tr_b16 a[66:67], v16 offset:35584
 s_waitcnt lgkmcnt(8)
 s_waitcnt lgkmcnt(7)
 v_mfma_f32_32x32x16_bf16 a[0:15], a[48:51], a[44:47], a[0:15]
 s_waitcnt vmcnt(15)
 s_barrier
 ds_read_b64_tr_b16 a[36:37], v16 offset:45056
 ds_read_b64_tr_b16 a[38:39], v16 offset:45568
 s_waitcnt lgkmcnt(7)
 v_mfma_f32_32x32x16_bf16 a[16:31], a[52:55], a[44:47], a[16:31]
 ds_read_b128 a[32:35], v14 offset:45056
 ds_read_b64_tr_b16 a[40:41], v16 offset:45312
 ds_read_b64_tr_b16 a[42:43], v16 offset:45824
 s_waitcnt lgkmcnt(8)
 s_waitcnt lgkmcnt(7)
 v_mfma_f32_32x32x16_bf16 a[0:15], a[60:63], a[56:59], a[0:15]
 ds_read_b64_tr_b16 a[48:49], v16 offset:47104
 ds_read_b64_tr_b16 a[50:51], v16 offset:47616
 ds_read_b128 a[44:47], v15 offset:45056
 s_waitcnt lgkmcnt(8)
 v_mfma_f32_32x32x16_bf16 a[16:31], a[64:67], a[56:59], a[16:31]
 ds_read_b64_tr_b16 a[52:53], v16 offset:47360
 ds_read_b64_tr_b16 a[54:55], v16 offset:47872
 s_waitcnt lgkmcnt(8)
 s_waitcnt lgkmcnt(7)
 v_mfma_f32_32x32x16_bf16 a[0:15], a[36:39], a[32:35], a[0:15]
 s_waitcnt vmcnt(12)
 s_barrier
 ds_read_b64_tr_b16 a[60:61], v16 offset:57344
 ds_read_b64_tr_b16 a[62:63], v16 offset:57856
 s_waitcnt lgkmcnt(7)
 v_mfma_f32_32x32x16_bf16 a[16:31], a[40:43], a[32:35], a[16:31]
 ds_read_b128 a[56:59], v14 offset:57344
 ds_read_b64_tr_b16 a[64:65], v16 offset:57600
 ds_read_b64_tr_b16 a[66:67], v16 offset:58112
 s_waitcnt lgkmcnt(8)
 s_waitcnt lgkmcnt(7)
 v_mfma_f32_32x32x16_bf16 a[0:15], a[48:51], a[44:47], a[0:15]
 ds_read_b64_tr_b16 a[36:37], v16 offset:59392
 ds_read_b64_tr_b16 a[38:39], v16 offset:59904
 ds_read_b128 a[32:35], v15 offset:57344
 s_waitcnt lgkmcnt(8)
 v_mfma_f32_32x32x16_bf16 a[16:31], a[52:55], a[44:47], a[16:31]
 ds_read_b64_tr_b16 a[40:41], v16 offset:59648
 ds_read_b64_tr_b16 a[42:43], v16 offset:60160
 s_waitcnt lgkmcnt(8)
 s_waitcnt lgkmcnt(7)
 v_mfma_f32_32x32x16_bf16 a[0:15], a[60:63], a[56:59], a[0:15]
 s_waitcnt vmcnt(9)
 s_barrier
 ds_read_b64_tr_b16 a[48:49], v19 offset:4096
 ds_read_b64_tr_b16 a[50:51], v19 offset:4608
 s_waitcnt lgkmcnt(7)
 v_mfma_f32_32x32x16_bf16 a[16:31], a[64:67], a[56:59], a[16:31]
 ds_read_b128 a[44:47], v17 offset:4096
 ds_read_b64_tr_b16 a[52:53], v19 offset:4352
 ds_read_b64_tr_b16 a[54:55], v19 offset:4864
 s_waitcnt lgkmcnt(8)
 s_waitcnt lgkmcnt(7)
 v_mfma_f32_32x32x16_bf16 a[0:15], a[36:39], a[32:35], a[0:15]
 ds_read_b64_tr_b16 a[60:61], v19 offset:6144
 ds_read_b64_tr_b16 a[62:63], v19 offset:6656
 ds_read_b128 a[56:59], v18 offset:4096
 s_waitcnt lgkmcnt(8)
 v_mfma_f32_32x32x16_bf16 a[16:31], a[40:43], a[32:35], a[16:31]
 ds_read_b64_tr_b16 a[64:65], v19 offset:6400
 ds_read_b64_tr_b16 a[66:67], v19 offset:6912
 s_waitcnt lgkmcnt(8)
 s_waitcnt lgkmcnt(7)
 v_mfma_f32_32x32x16_bf16 a[0:15], a[48:51], a[44:47], a[0:15]
 s_waitcnt vmcnt(6)
 s_barrier
 ds_read_b64_tr_b16 a[36:37], v7 offset:0
 ds_read_b64_tr_b16 a[38:39], v7 offset:512
 s_waitcnt lgkmcnt(7)
 v_mfma_f32_32x32x16_bf16 a[16:31], a[52:55], a[44:47], a[16:31]
 ds_read_b128 a[32:35], v5 offset:0
 ds_read_b64_tr_b16 a[40:41], v7 offset:256
 ds_read_b64_tr_b16 a[42:43], v7 offset:768
 s_waitcnt lgkmcnt(8)
 s_waitcnt lgkmcnt(7)
 v_mfma_f32_32x32x16_bf16 a[0:15], a[60:63], a[56:59], a[0:15]
 ds_read_b64_tr_b16 a[48:49], v7 offset:2048
 ds_read_b64_tr_b16 a[50:51], v7 offset:2560
 ds_read_b128 a[44:47], v6 offset:0
 s_waitcnt lgkmcnt(8)
 v_mfma_f32_32x32x16_bf16 a[16:31], a[64:67], a[56:59], a[16:31]
 ds_read_b64_tr_b16 a[52:53], v7 offset:2304
 ds_read_b64_tr_b16 a[54:55], v7 offset:2816
 s_waitcnt lgkmcnt(8)
 s_waitcnt lgkmcnt(7)
 v_mfma_f32_32x32x16_bf16 a[0:15], a[36:39], a[32:35], a[0:15]
 s_waitcnt vmcnt(3)
 s_barrier
 ds_read_b64_tr_b16 a[60:61], v7 offset:12288
 ds_read_b64_tr_b16 a[62:63], v7 offset:12800
 s_waitcnt lgkmcnt(7)
 v_mfma_f32_32x32x16_bf16 a[16:31], a[40:43], a[32:35], a[16:31]
 ds_read_b128 a[56:59], v5 offset:12288
 ds_read_b64_tr_b16 a[64:65], v7 offset:12544
 ds_read_b64_tr_b16 a[66:67], v7 offset:13056
 s_waitcnt lgkmcnt(8)
 s_waitcnt lgkmcnt(7)
 v_mfma_f32_32x32x16_bf16 a[0:15], a[48:51], a[44:47], a[0:15]
 ds_read_b64_tr_b16 a[36:37], v7 offset:14336
 ds_read_b64_tr_b16 a[38:39], v7 offset:14848
 ds_read_b128 a[32:35], v6 offset:12288
 s_waitcnt lgkmcnt(8)
 v_mfma_f32_32x32x16_bf16 a[16:31], a[52:55], a[44:47], a[16:31]
 ds_read_b64_tr_b16 a[40:41], v7 offset:14592
 ds_read_b64_tr_b16 a[42:43], v7 offset:15104
 s_waitcnt lgkmcnt(8)
 s_waitcnt lgkmcnt(7)
 v_mfma_f32_32x32x16_bf16 a[0:15], a[60:63], a[56:59], a[0:15]
 s_waitcnt vmcnt(0)
 s_barrier
 ds_read_b64_tr_b16 a[48:49], v7 offset:24576
 ds_read_b64_tr_b16 a[50:51], v7 offset:25088
 s_waitcnt lgkmcnt(7)
 v_mfma_f32_32x32x16_bf16 a[16:31], a[64:67], a[56:59], a[16:31]
 ds_read_b128 a[44:47], v5 offset:24576
 ds_read_b64_tr_b16 a[52:53], v7 offset:24832
 ds_read_b64_tr_b16 a[54:55], v7 offset:25344
 s_waitcnt lgkmcnt(8)
 s_waitcnt lgkmcnt(7)
 v_mfma_f32_32x32x16_bf16 a[0:15], a[36:39], a[32:35], a[0:15]
 ds_read_b64_tr_b16 a[60:61], v7 offset:26624
 ds_read_b64_tr_b16 a[62:63], v7 offset:27136
 ds_read_b128 a[56:59], v6 offset:24576
 s_waitcnt lgkmcnt(8)
 v_mfma_f32_32x32x16_bf16 a[16:31], a[40:43], a[32:35], a[16:31]
 ds_read_b64_tr_b16 a[64:65], v7 offset:26880
 ds_read_b64_tr_b16 a[66:67], v7 offset:27392
 s_waitcnt lgkmcnt(8)
 s_waitcnt lgkmcnt(7)
 v_mfma_f32_32x32x16_bf16 a[0:15], a[48:51], a[44:47], a[0:15]
 s_waitcnt lgkmcnt(5)
 v_mfma_f32_32x32x16_bf16 a[16:31], a[52:55], a[44:47], a[16:31]
 s_waitcnt lgkmcnt(3)
 s_waitcnt lgkmcnt(2)
 v_mfma_f32_32x32x16_bf16 a[0:15], a[60:63], a[56:59], a[0:15]
 s_waitcnt lgkmcnt(0)
 v_mfma_f32_32x32x16_bf16 a[16:31], a[64:67], a[56:59], a[16:31]
 s_nop 15
 s_mov_b32 s41, 0xbfb8aa3b
 s_waitcnt vmcnt(0)
 s_mov_b32 s40, 0
 v_accvgpr_read_b32 v104, a0
 v_accvgpr_read_b32 v105, a1
 v_accvgpr_read_b32 v106, a2
 v_accvgpr_read_b32 v107, a3
 v_accvgpr_read_b32 v108, a4
 v_accvgpr_read_b32 v109, a5
 v_accvgpr_read_b32 v110, a6
 v_accvgpr_read_b32 v111, a7
 v_mul_f32 v112, s41, v104
 v_mul_f32 v113, s41, v105
 v_mul_f32 v114, s41, v106
 v_mul_f32 v115, s41, v107
 v_mul_f32 v116, s41, v108
 v_mul_f32 v117, s41, v109
 v_mul_f32 v118, s41, v110
 v_mul_f32 v119, s41, v111
 v_exp_f32 v112, v112
 v_exp_f32 v113, v113
 v_exp_f32 v114, v114
 v_exp_f32 v115, v115
 v_exp_f32 v116, v116
 v_exp_f32 v117, v117
 v_exp_f32 v118, v118
 v_exp_f32 v119, v119
 v_add_f32 v112, 1.0, v112
 v_add_f32 v113, 1.0, v113
 v_add_f32 v114, 1.0, v114
 v_add_f32 v115, 1.0, v115
 v_add_f32 v116, 1.0, v116
 v_add_f32 v117, 1.0, v117
 v_add_f32 v118, 1.0, v118
 v_add_f32 v119, 1.0, v119
 v_rcp_f32 v112, v112
 v_rcp_f32 v113, v113
 v_rcp_f32 v114, v114
 v_rcp_f32 v115, v115
 v_rcp_f32 v116, v116
 v_rcp_f32 v117, v117
 v_rcp_f32 v118, v118
 v_rcp_f32 v119, v119
 v_mul_f32 v104, v104, v112
 v_mul_f32 v105, v105, v113
 v_mul_f32 v106, v106, v114
 v_mul_f32 v107, v107, v115
 v_mul_f32 v108, v108, v116
 v_mul_f32 v109, v109, v117
 v_mul_f32 v110, v110, v118
 v_mul_f32 v111, v111, v119
 v_add_f32 v28, v28, v36
 v_add_f32 v29, v29, v37
 v_add_f32 v30, v30, v38
 v_add_f32 v31, v31, v39
 v_add_f32 v32, v32, v40
 v_add_f32 v33, v33, v41
 v_add_f32 v34, v34, v42
 v_add_f32 v35, v35, v43
 v_lshlrev_b32 v112, 16, v24
 v_and_b32 v113, 0xffff0000, v24
 v_lshlrev_b32 v114, 16, v25
 v_and_b32 v115, 0xffff0000, v25
 v_lshlrev_b32 v116, 16, v26
 v_and_b32 v117, 0xffff0000, v26
 v_lshlrev_b32 v118, 16, v27
 v_and_b32 v119, 0xffff0000, v27
 v_fma_f32 v104, v104, v28, v112
 v_fma_f32 v105, v105, v29, v113
 v_fma_f32 v106, v106, v30, v114
 v_fma_f32 v107, v107, v31, v115
 v_fma_f32 v108, v108, v32, v116
 v_fma_f32 v109, v109, v33, v117
 v_fma_f32 v110, v110, v34, v118
 v_fma_f32 v111, v111, v35, v119
 v_cvt_pk_bf16_f32 v24, v104, v105
 v_cvt_pk_bf16_f32 v25, v106, v107
 v_cvt_pk_bf16_f32 v26, v108, v109
 v_cvt_pk_bf16_f32 v27, v110, v111
 buffer_store_dwordx4 v[24:27], v20, s[16:19], s40 offen offset:0
 v_accvgpr_read_b32 v104, a8
 v_accvgpr_read_b32 v105, a9
 v_accvgpr_read_b32 v106, a10
 v_accvgpr_read_b32 v107, a11
 v_accvgpr_read_b32 v108, a12
 v_accvgpr_read_b32 v109, a13
 v_accvgpr_read_b32 v110, a14
 v_accvgpr_read_b32 v111, a15
 v_mul_f32 v112, s41, v104
 v_mul_f32 v113, s41, v105
 v_mul_f32 v114, s41, v106
 v_mul_f32 v115, s41, v107
 v_mul_f32 v116, s41, v108
 v_mul_f32 v117, s41, v109
 v_mul_f32 v118, s41, v110
 v_mul_f32 v119, s41, v111
 v_exp_f32 v112, v112
 v_exp_f32 v113, v113
 v_exp_f32 v114, v114
 v_exp_f32 v115, v115
 v_exp_f32 v116, v116
 v_exp_f32 v117, v117
 v_exp_f32 v118, v118
 v_exp_f32 v119, v119
 v_add_f32 v112, 1.0, v112
 v_add_f32 v113, 1.0, v113
 v_add_f32 v114, 1.0, v114
 v_add_f32 v115, 1.0, v115
 v_add_f32 v116, 1.0, v116
 v_add_f32 v117, 1.0, v117
 v_add_f32 v118, 1.0, v118
 v_add_f32 v119, 1.0, v119
 v_rcp_f32 v112, v112
 v_rcp_f32 v113, v113
 v_rcp_f32 v114, v114
 v_rcp_f32 v115, v115
 v_rcp_f32 v116, v116
 v_rcp_f32 v117, v117
 v_rcp_f32 v118, v118
 v_rcp_f32 v119, v119
 v_mul_f32 v104, v104, v112
 v_mul_f32 v105, v105, v113
 v_mul_f32 v106, v106, v114
 v_mul_f32 v107, v107, v115
 v_mul_f32 v108, v108, v116
 v_mul_f32 v109, v109, v117
 v_mul_f32 v110, v110, v118
 v_mul_f32 v111, v111, v119
 v_add_f32 v48, v48, v56
 v_add_f32 v49, v49, v57
 v_add_f32 v50, v50, v58
 v_add_f32 v51, v51, v59
 v_add_f32 v52, v52, v60
 v_add_f32 v53, v53, v61
 v_add_f32 v54, v54, v62
 v_add_f32 v55, v55, v63
 v_lshlrev_b32 v112, 16, v44
 v_and_b32 v113, 0xffff0000, v44
 v_lshlrev_b32 v114, 16, v45
 v_and_b32 v115, 0xffff0000, v45
 v_lshlrev_b32 v116, 16, v46
 v_and_b32 v117, 0xffff0000, v46
 v_lshlrev_b32 v118, 16, v47
 v_and_b32 v119, 0xffff0000, v47
 v_fma_f32 v104, v104, v48, v112
 v_fma_f32 v105, v105, v49, v113
 v_fma_f32 v106, v106, v50, v114
 v_fma_f32 v107, v107, v51, v115
 v_fma_f32 v108, v108, v52, v116
 v_fma_f32 v109, v109, v53, v117
 v_fma_f32 v110, v110, v54, v118
 v_fma_f32 v111, v111, v55, v119
 v_cvt_pk_bf16_f32 v44, v104, v105
 v_cvt_pk_bf16_f32 v45, v106, v107
 v_cvt_pk_bf16_f32 v46, v108, v109
 v_cvt_pk_bf16_f32 v47, v110, v111
 buffer_store_dwordx4 v[44:47], v20, s[16:19], s40 offen offset:32
 v_accvgpr_read_b32 v104, a16
 v_accvgpr_read_b32 v105, a17
 v_accvgpr_read_b32 v106, a18
 v_accvgpr_read_b32 v107, a19
 v_accvgpr_read_b32 v108, a20
 v_accvgpr_read_b32 v109, a21
 v_accvgpr_read_b32 v110, a22
 v_accvgpr_read_b32 v111, a23
 v_mul_f32 v112, s41, v104
 v_mul_f32 v113, s41, v105
 v_mul_f32 v114, s41, v106
 v_mul_f32 v115, s41, v107
 v_mul_f32 v116, s41, v108
 v_mul_f32 v117, s41, v109
 v_mul_f32 v118, s41, v110
 v_mul_f32 v119, s41, v111
 v_exp_f32 v112, v112
 v_exp_f32 v113, v113
 v_exp_f32 v114, v114
 v_exp_f32 v115, v115
 v_exp_f32 v116, v116
 v_exp_f32 v117, v117
 v_exp_f32 v118, v118
 v_exp_f32 v119, v119
 v_add_f32 v112, 1.0, v112
 v_add_f32 v113, 1.0, v113
 v_add_f32 v114, 1.0, v114
 v_add_f32 v115, 1.0, v115
 v_add_f32 v116, 1.0, v116
 v_add_f32 v117, 1.0, v117
 v_add_f32 v118, 1.0, v118
 v_add_f32 v119, 1.0, v119
 v_rcp_f32 v112, v112
 v_rcp_f32 v113, v113
 v_rcp_f32 v114, v114
 v_rcp_f32 v115, v115
 v_rcp_f32 v116, v116
 v_rcp_f32 v117, v117
 v_rcp_f32 v118, v118
 v_rcp_f32 v119, v119
 v_mul_f32 v104, v104, v112
 v_mul_f32 v105, v105, v113
 v_mul_f32 v106, v106, v114
 v_mul_f32 v107, v107, v115
 v_mul_f32 v108, v108, v116
 v_mul_f32 v109, v109, v117
 v_mul_f32 v110, v110, v118
 v_mul_f32 v111, v111, v119
 v_add_f32 v68, v68, v76
 v_add_f32 v69, v69, v77
 v_add_f32 v70, v70, v78
 v_add_f32 v71, v71, v79
 v_add_f32 v72, v72, v80
 v_add_f32 v73, v73, v81
 v_add_f32 v74, v74, v82
 v_add_f32 v75, v75, v83
 v_lshlrev_b32 v112, 16, v64
 v_and_b32 v113, 0xffff0000, v64
 v_lshlrev_b32 v114, 16, v65
 v_and_b32 v115, 0xffff0000, v65
 v_lshlrev_b32 v116, 16, v66
 v_and_b32 v117, 0xffff0000, v66
 v_lshlrev_b32 v118, 16, v67
 v_and_b32 v119, 0xffff0000, v67
 v_fma_f32 v104, v104, v68, v112
 v_fma_f32 v105, v105, v69, v113
 v_fma_f32 v106, v106, v70, v114
 v_fma_f32 v107, v107, v71, v115
 v_fma_f32 v108, v108, v72, v116
 v_fma_f32 v109, v109, v73, v117
 v_fma_f32 v110, v110, v74, v118
 v_fma_f32 v111, v111, v75, v119
 v_cvt_pk_bf16_f32 v64, v104, v105
 v_cvt_pk_bf16_f32 v65, v106, v107
 v_cvt_pk_bf16_f32 v66, v108, v109
 v_cvt_pk_bf16_f32 v67, v110, v111
 buffer_store_dwordx4 v[64:67], v20, s[16:19], s40 offen offset:64
 v_accvgpr_read_b32 v104, a24
 v_accvgpr_read_b32 v105, a25
 v_accvgpr_read_b32 v106, a26
 v_accvgpr_read_b32 v107, a27
 v_accvgpr_read_b32 v108, a28
 v_accvgpr_read_b32 v109, a29
 v_accvgpr_read_b32 v110, a30
 v_accvgpr_read_b32 v111, a31
 v_mul_f32 v112, s41, v104
 v_mul_f32 v113, s41, v105
 v_mul_f32 v114, s41, v106
 v_mul_f32 v115, s41, v107
 v_mul_f32 v116, s41, v108
 v_mul_f32 v117, s41, v109
 v_mul_f32 v118, s41, v110
 v_mul_f32 v119, s41, v111
 v_exp_f32 v112, v112
 v_exp_f32 v113, v113
 v_exp_f32 v114, v114
 v_exp_f32 v115, v115
 v_exp_f32 v116, v116
 v_exp_f32 v117, v117
 v_exp_f32 v118, v118
 v_exp_f32 v119, v119
 v_add_f32 v112, 1.0, v112
 v_add_f32 v113, 1.0, v113
 v_add_f32 v114, 1.0, v114
 v_add_f32 v115, 1.0, v115
 v_add_f32 v116, 1.0, v116
 v_add_f32 v117, 1.0, v117
 v_add_f32 v118, 1.0, v118
 v_add_f32 v119, 1.0, v119
 v_rcp_f32 v112, v112
 v_rcp_f32 v113, v113
 v_rcp_f32 v114, v114
 v_rcp_f32 v115, v115
 v_rcp_f32 v116, v116
 v_rcp_f32 v117, v117
 v_rcp_f32 v118, v118
 v_rcp_f32 v119, v119
 v_mul_f32 v104, v104, v112
 v_mul_f32 v105, v105, v113
 v_mul_f32 v106, v106, v114
 v_mul_f32 v107, v107, v115
 v_mul_f32 v108, v108, v116
 v_mul_f32 v109, v109, v117
 v_mul_f32 v110, v110, v118
 v_mul_f32 v111, v111, v119
 v_add_f32 v88, v88, v96
 v_add_f32 v89, v89, v97
 v_add_f32 v90, v90, v98
 v_add_f32 v91, v91, v99
 v_add_f32 v92, v92, v100
 v_add_f32 v93, v93, v101
 v_add_f32 v94, v94, v102
 v_add_f32 v95, v95, v103
 v_lshlrev_b32 v112, 16, v84
 v_and_b32 v113, 0xffff0000, v84
 v_lshlrev_b32 v114, 16, v85
 v_and_b32 v115, 0xffff0000, v85
 v_lshlrev_b32 v116, 16, v86
 v_and_b32 v117, 0xffff0000, v86
 v_lshlrev_b32 v118, 16, v87
 v_and_b32 v119, 0xffff0000, v87
 v_fma_f32 v104, v104, v88, v112
 v_fma_f32 v105, v105, v89, v113
 v_fma_f32 v106, v106, v90, v114
 v_fma_f32 v107, v107, v91, v115
 v_fma_f32 v108, v108, v92, v116
 v_fma_f32 v109, v109, v93, v117
 v_fma_f32 v110, v110, v94, v118
 v_fma_f32 v111, v111, v95, v119
 v_cvt_pk_bf16_f32 v84, v104, v105
 v_cvt_pk_bf16_f32 v85, v106, v107
 v_cvt_pk_bf16_f32 v86, v108, v109
 v_cvt_pk_bf16_f32 v87, v110, v111
 buffer_store_dwordx4 v[84:87], v20, s[16:19], s40 offen offset:96
fin_kernel_done1:
 s_endpgm

.section .rodata,"a"
.p2align 6
.amdhsa_kernel fin_kernel
  .amdhsa_next_free_vgpr 228
  .amdhsa_next_free_sgpr 102
  .amdhsa_accum_offset 160
  .amdhsa_group_segment_fixed_size 0
  .amdhsa_kernarg_size 104
  .amdhsa_user_sgpr_count 2
  .amdhsa_user_sgpr_kernarg_segment_ptr 1
  .amdhsa_system_sgpr_workgroup_id_x 1
.end_amdhsa_kernel

.text
TEXT_END:
 s_endpgm
```
